```python
import torch

def _softmax(x, axis=-1):
    return torch.softmax(x, dim=axis)

def _gelu(x):
    return torch.nn.functional.gelu(x, approximate='tanh')

def _silu(x):
    return torch.nn.functional.silu(x)

def _sigmoid(x):
    return torch.sigmoid(x)

def _layernorm(x, axis=-1, eps=1e-05):
    m = x.mean(dim=axis, keepdim=True)
    v = x.var(dim=axis, keepdim=True, unbiased=False)
    return (x - m) / torch.sqrt(v + eps)

def _scatter_add(tgt, idx, src, axis=0):
    return tgt.clone().index_add_(axis, idx, src)

def _segment_sum(src, seg, n):
    out = torch.zeros((n,) + src.shape[1:], dtype=src.dtype)
    return out.index_add_(0, seg, src)

def _pad(x, pw):
    flat = tuple((v for pair in reversed(pw) for v in pair))
    return torch.nn.functional.pad(x, flat)
kernel_name = 'adaLN_cond__mha_block_cached__dense_activation_silu__prompt'

def setup_inputs():

    _w = lambda a: (lambda t: t.to(torch.bfloat16) if t.is_floating_point() else t)(torch.as_tensor(a))

    def _A_setup():
        B, Sq, D = (1, 2048, 448)
        H, Sk, Dh = (16, 2048, 256)
        return {'x': _w((lambda *s: torch.randn(*s, dtype=torch.bfloat16) * 0.1)(B, Sq, D)), 'k_cache': _w((lambda *s: torch.randn(*s, dtype=torch.bfloat16) * 0.8)(B, H, Sk, Dh)), 'v_cache': _w((lambda *s: torch.randn(*s, dtype=torch.bfloat16) * 3.2)(B, H, Sk, Dh)), 'wq': _w((lambda *s: torch.randn(*s, dtype=torch.bfloat16) * 0.8)(D, H * Dh) * D ** (-0.5)), 'wo': _w((lambda *s: torch.randn(*s, dtype=torch.bfloat16) * 3.2)(H * Dh, D) * (H * Dh) ** (-0.5))}
    _A_in = _A_setup()

    def _B_setup():
        B, S, D, F = (1, 2048, 448, 1792)
        return {'x': _w((lambda *s: torch.randn(*s, dtype=torch.bfloat16) * 0.1)(B, S, D)), 'w1': _w((lambda *s: torch.randn(*s, dtype=torch.bfloat16) * 3.2)(D, F) * D ** (-0.5)), 'w2': _w((lambda *s: torch.randn(*s, dtype=torch.bfloat16) * 3.2)(F, D) * F ** (-0.5))}
    _B_in = _B_setup()
    return {'A_x': _A_in['x'], 'A_k_cache': _A_in['k_cache'], 'A_v_cache': _A_in['v_cache'], 'A_wq': _A_in['wq'], 'A_wo': _A_in['wo'], 'B_x': _B_in['x'], 'B_w1': _B_in['w1'], 'B_w2': _B_in['w2'], 'c': _w((lambda *s: torch.randn(*s, dtype=torch.bfloat16) * 0.1)(1, 448) * 8.0), 'w_mod': _w((lambda *s: torch.randn(*s, dtype=torch.bfloat16) * 0.1)(448, 6 * 448) * 448 ** (-0.5) * 8.0)}

def reference(A_x, A_k_cache, A_v_cache, A_wq, A_wo, B_x, B_w1, B_w2, c, w_mod):

    def _A_ref(x, k_cache, v_cache, wq, wo):
        B, Sq, D = x.shape
        H, Dh = (16, 256)
        q = (lambda x, *d: x.permute(*d))((x @ wq).reshape(B, Sq, H, Dh), 0, 2, 1, 3)
        scores = torch.einsum('bhqd,bhkd->bhqk', q, k_cache) * Dh ** (-0.5)
        p = _softmax(scores, axis=-1)
        o = torch.einsum('bhqk,bhkd->bhqd', p, v_cache)
        return (lambda x, *d: x.permute(*d))(o, 0, 2, 1, 3).reshape(B, Sq, H * Dh) @ wo

    def _B_ref(x, w1, w2):
        h = torch.einsum('bsd,df->bsf', x, w1)
        h = _silu(h)
        out = torch.einsum('bsf,fd->bsd', h, w2)
        return out
    x = A_x
    mod = (_silu(c) @ w_mod).reshape(c.shape[0], 6, 1, -1)
    sa, ca, ga, sb, cb, gb = (mod[:, 0].clone(), mod[:, 1].clone(), mod[:, 2].clone(), mod[:, 3].clone(), mod[:, 4].clone(), mod[:, 5].clone())
    h = _layernorm(x, axis=-1) * (1 + ca) + sa
    x = x + ga * _A_ref(h, A_k_cache, A_v_cache, A_wq, A_wo)
    h = _layernorm(x, axis=-1) * (1 + cb) + sb
    x = x + gb * _B_ref(h, B_w1, B_w2)
    return x
```

```asm
; @launch grid=(256,1,1) block=(256,1,1) lds=159744
.amdgcn_target "amdgcn-amd-amdhsa--gfx950"
.text
.globl adaLN_cond__mha_block_cached__dense_activation_silu__prompt_kernel
.p2align 8
.type adaLN_cond__mha_block_cached__dense_activation_silu__prompt_kernel,@function
adaLN_cond__mha_block_cached__dense_activation_silu__prompt_kernel:
    s_cmp_ge_u32 s2, 256
    s_cbranch_scc1 L_end
    s_load_dwordx16 s[64:79], s[0:1], 0
    s_load_dwordx8 s[80:87], s[0:1], 64
    s_load_dwordx2 s[88:89], s[0:1], 96
    s_getpc_b64 s[50:51]
L_pc:
    v_and_b32 v1, 63, v0
    v_lshrrev_b32 v36, 6, v0
    s_and_b32 s53, s2, 7
    s_lshl_b32 s53, s53, 1
    s_bfe_u32 s60, s2, 0x10003
    s_or_b32 s53, s53, s60
    s_lshr_b32 s54, s2, 4
    v_readfirstlane_b32 s52, v36
    v_lshrrev_b32 v37, 1, v0
    v_and_b32 v38, 1, v0
    v_mul_u32_u24 v176, 5376, v37
    v_lshl_add_u32 v176, v38, 4, v176
    v_lshlrev_b32 v177, 1, v37
    v_lshlrev_b32 v51, 4, v1
    v_lshrrev_b32 v36, 5, v0
    v_and_b32 v39, 31, v0
    v_mul_u32_u24 v49, 896, v36
    v_lshl_add_u32 v49, v39, 5, v49
    v_lshrrev_b32 v50, 1, v39
    v_lshlrev_b32 v50, 11, v50
    v_lshl_add_u32 v50, v38, 9, v50
    v_lshl_add_u32 v50, v36, 4, v50
    v_cmp_gt_u32 vcc, 28, v39
    v_mov_b32 v39, 0x7ffffff0
    s_lshr_b32 s60, s2, 5
    s_lshl_b32 s60, s60, 3
    s_and_b32 s61, s2, 7
    s_add_u32 s60, s60, s61
    s_lshl_b32 s60, s60, 2
    s_bfe_u32 s61, s2, 0x20003
    s_add_u32 s62, s60, s61
    s_add_u32 s60, s62, 16
    s_and_b32 s60, s60, 63
    s_cmp_ge_u32 s60, 56
    s_cselect_b32 s60, 255, s60
    s_cmp_ge_u32 s62, 192
    s_cselect_b32 s62, s60, s62
    v_cndmask_b32 v49, v39, v49, vcc
    v_cndmask_b32 v50, v39, v50, vcc
    s_lshl_b32 s58, s54, 4
    s_add_u32 s58, s58, s53
    s_mul_i32 s58, s58, 7168
    s_waitcnt lgkmcnt(0)
    s_mov_b32 s24, s64
    s_and_b32 s25, s65, 0xffff
    s_mov_b32 s26, 0x1c0000
    s_mov_b32 s27, 0x20000
    buffer_load_dwordx4 v[64:67], v49, s[24:27], s58 offen offset:0
    buffer_load_dwordx4 v[68:71], v49, s[24:27], s58 offen offset:16
    s_mov_b32 s20, s88
    s_and_b32 s21, s89, 0xffff
    s_mov_b32 s22, 0x10000000
    s_mov_b32 s23, 0x20000
    v_mov_b32 v56, 12288
    buffer_load_dword v55, v56, s[20:23], 0 offen sc1
    s_mov_b32 s44, s82
    s_and_b32 s45, s83, 0xffff
    s_mov_b32 s46, 0x24c000
    s_mov_b32 s47, 0x20000
    s_mov_b32 s4, s80
    s_and_b32 s5, s81, 0xffff
    s_mov_b32 s6, 0x380
    s_mov_b32 s7, 0x20000
    s_cmp_ge_u32 s62, 168
    s_cbranch_scc1 L_nogemv1
    buffer_load_ushort v180, v177, s[4:7], 0 offen offset:0
    buffer_load_ushort v181, v177, s[4:7], 0 offen offset:256
    buffer_load_ushort v182, v177, s[4:7], 0 offen offset:512
    buffer_load_ushort v183, v177, s[4:7], 0 offen offset:768
    s_lshl_b32 s60, s62, 5
    buffer_load_dwordx4 v[184:187], v176, s[44:47], s60 offen
    s_add_u32 s60, s60, 688128
    buffer_load_dwordx4 v[188:191], v176, s[44:47], s60 offen
    s_add_u32 s60, s60, 688128
    buffer_load_dwordx4 v[192:195], v176, s[44:47], s60 offen
    s_add_u32 s60, s60, 688128
    buffer_load_dwordx4 v[196:199], v176, s[44:47], s60 offen
    s_add_u32 s60, s60, 688128
L_nogemv1:
    s_bfe_u32 s60, s2, 0x10003
    s_lshl_b32 s60, s60, 14
    v_lshlrev_b32 v36, 6, v0
    v_add_u32 v36, s60, v36
    global_load_dword v52, v36, s[50:51]
    s_lshl_b32 s61, s54, 2
    s_add_u32 s61, s61, s52
    s_mul_i32 s63, s61, 28672
    s_lshl_b32 s60, s53, 20
    s_sub_u32 s60, s60, 4096
    s_subb_u32 s61, 0, 0
    s_add_u32 s66, s66, s60
    s_addc_u32 s67, s67, s61
    s_mov_b32 s4, s66
    s_and_b32 s5, s67, 0xffff
    s_mov_b32 s6, 0x101000
    s_mov_b32 s7, 0x20000
    s_add_u32 s68, s68, s60
    s_addc_u32 s69, s69, s61
    s_mov_b32 s8, s68
    s_and_b32 s9, s69, 0xffff
    s_mov_b32 s10, 0x101000
    s_mov_b32 s11, 0x20000
    s_sub_u32 s70, s70, 4096
    s_subb_u32 s71, s71, 0
    s_mov_b32 s12, s70
    s_and_b32 s13, s71, 0xffff
    s_mov_b32 s14, 0x381000
    s_mov_b32 s15, 0x20000
    s_mul_i32 s60, s53, 229376
    s_add_u32 s72, s72, s60
    s_addc_u32 s73, s73, 0
    s_mov_b32 s16, s72
    s_and_b32 s17, s73, 0xffff
    s_mov_b32 s18, 0x38000
    s_mov_b32 s19, 0x20000
    s_mov_b32 s28, s84
    s_and_b32 s29, s85, 0xffff
    s_mov_b32 s30, 0x1c0000
    s_mov_b32 s31, 0x20000
    s_mov_b32 s40, s86
    s_and_b32 s41, s87, 0xffff
    s_mov_b32 s42, 0x100
    s_mov_b32 s43, 0x20000
    s_mov_b32 s32, s76
    s_and_b32 s33, s77, 0xffff
    s_mov_b32 s34, 0x188000
    s_mov_b32 s35, 0x20000
    s_min_u32 s61, s53, 13
    s_lshr_b32 s61, s61, 1
    s_mul_i32 s60, s61, 229376
    s_add_u32 s78, s78, s60
    s_addc_u32 s79, s79, 0
    s_mov_b32 s36, s78
    s_and_b32 s37, s79, 0xffff
    s_mov_b32 s38, 0x38000
    s_mov_b32 s39, 0x20000
    s_cmp_lt_u32 s53, 14
    s_cselect_b32 s34, s34, 0
    s_cselect_b32 s38, s38, 0
    v_lshrrev_b32 v36, 5, v1
    v_lshlrev_b32 v36, 15, v36
    v_and_b32 v37, 31, v1
    v_lshl_add_u32 v36, v37, 4, v36
    s_lshl_b32 s60, s52, 16
    s_lshl_b32 s61, s53, 9
    s_add_u32 s60, s60, s61
    s_add_u32 s60, s60, 4096
    v_add_u32 v22, s60, v36
    v_add_u32 v23, 7136, v22
    v_add_u32 v24, 14272, v22
    v_add_u32 v25, 21408, v22
    s_mul_i32 s57, s52, 4224
    s_add_u32 m0, s57, 0
    s_mov_b32 s91, 0
    buffer_load_dwordx4 v22, s[12:15], s91 offen offset:0 lds
    buffer_load_dwordx4 v23, s[12:15], s91 offen offset:1056 lds
    buffer_load_dwordx4 v24, s[12:15], s91 offen offset:2112 lds
    buffer_load_dwordx4 v25, s[12:15], s91 offen offset:3168 lds
    s_add_u32 m0, s57, 16896
    s_mov_b32 s91, 262144
    buffer_load_dwordx4 v22, s[12:15], s91 offen offset:0 lds
    buffer_load_dwordx4 v23, s[12:15], s91 offen offset:1056 lds
    buffer_load_dwordx4 v24, s[12:15], s91 offen offset:2112 lds
    buffer_load_dwordx4 v25, s[12:15], s91 offen offset:3168 lds
    s_mul_i32 s60, s54, 229376
    s_lshl_b32 s61, s53, 9
    s_add_u32 s60, s60, s61
    s_add_u32 s60, s60, 4096
    v_lshrrev_b32 v36, 3, v0
    v_min_u32 v36, 27, v36
    v_lshlrev_b32 v36, 13, v36
    v_and_b32 v37, 7, v0
    v_lshl_add_u32 v36, v37, 6, v36
    buffer_load_dword v52, v36, s[12:15], s60 offen
    s_lshl_b32 s92, s54, 7
    s_lshl_b32 s60, s53, 2
    s_add_u32 s92, s92, s60
    s_add_u32 s92, s92, 0x4000
    v_and_b32 v36, 3, v1
    v_bfe_u32 v37, v1, 2, 2
    v_lshrrev_b32 v38, 4, v1
    v_mul_u32_u24 v3, 4224, v38
    v_mul_u32_u24 v39, 1056, v37
    v_add_u32 v3, v3, v39
    v_lshl_add_u32 v3, v36, 3, v3
    v_lshrrev_b32 v39, 2, v1
    v_lshlrev_b32 v4, 7, v39
    v_lshl_add_u32 v4, v36, 3, v4
    v_bfe_u32 v39, v1, 3, 2
    v_lshl_add_u32 v4, v39, 5, v4
    v_xor_b32 v5, 32, v4
    v_xor_b32 v6, 64, v4
    v_xor_b32 v7, 96, v4
    v_bfe_u32 v39, v1, 3, 1
    v_mul_u32_u24 v2, 4224, v39
    v_mul_u32_u24 v36, 1056, v36
    v_add_u32 v2, v2, v36
    v_lshl_add_u32 v2, v38, 4, v2
    v_bfe_u32 v36, v1, 2, 1
    v_xor_b32 v36, v36, v39
    v_lshl_add_u32 v2, v36, 9, v2
    v_add_u32 v8, 67584, v2
    v_add_u32 v9, 67584, v3
    v_add_u32 v10, 67584, v4
    v_add_u32 v11, 67584, v5
    v_add_u32 v12, 67584, v6
    v_add_u32 v13, 67584, v7
    v_lshlrev_b32 v48, 6, v38
    v_add_u32 v48, 135168, v48
    s_mov_b32 s97, 0x3f803f80
    s_waitcnt vmcnt(9)
    v_lshlrev_b32 v80, 16, v64
    v_and_b32 v81, 0xffff0000, v64
    v_lshlrev_b32 v82, 16, v65
    v_and_b32 v83, 0xffff0000, v65
    v_lshlrev_b32 v84, 16, v66
    v_and_b32 v85, 0xffff0000, v66
    v_lshlrev_b32 v86, 16, v67
    v_and_b32 v87, 0xffff0000, v67
    v_lshlrev_b32 v88, 16, v68
    v_and_b32 v89, 0xffff0000, v68
    v_lshlrev_b32 v90, 16, v69
    v_and_b32 v91, 0xffff0000, v69
    v_lshlrev_b32 v92, 16, v70
    v_and_b32 v93, 0xffff0000, v70
    v_lshlrev_b32 v94, 16, v71
    v_and_b32 v95, 0xffff0000, v71
    v_add_f32 v96, v80, v81
    v_add_f32 v97, v82, v83
    v_add_f32 v96, v96, v84
    v_add_f32 v97, v97, v85
    v_add_f32 v96, v96, v86
    v_add_f32 v97, v97, v87
    v_add_f32 v96, v96, v88
    v_add_f32 v97, v97, v89
    v_add_f32 v96, v96, v90
    v_add_f32 v97, v97, v91
    v_add_f32 v96, v96, v92
    v_add_f32 v97, v97, v93
    v_add_f32 v96, v96, v94
    v_add_f32 v97, v97, v95
    v_add_f32 v96, v96, v97
    s_nop 1
    v_add_f32_dpp v96, v96, v96 quad_perm:[1,0,3,2] row_mask:0xf bank_mask:0xf
    s_nop 1
    v_add_f32_dpp v96, v96, v96 quad_perm:[2,3,0,1] row_mask:0xf bank_mask:0xf
    s_nop 1
    v_add_f32_dpp v96, v96, v96 row_half_mirror row_mask:0xf bank_mask:0xf
    s_nop 1
    v_add_f32_dpp v96, v96, v96 row_mirror row_mask:0xf bank_mask:0xf
    v_mov_b32 v99, v96
    s_nop 1
    v_permlane16_swap_b32 v96, v99
    s_nop 1
    v_add_f32 v96, v96, v99
    v_mul_f32 v96, 0x3b124925, v96
    v_mov_b32 v97, 0
    v_mov_b32 v98, 0
    v_sub_f32 v99, v80, v96
    v_sub_f32 v100, v81, v96
    v_fmac_f32 v97, v99, v99
    v_fmac_f32 v98, v100, v100
    v_sub_f32 v99, v82, v96
    v_sub_f32 v100, v83, v96
    v_fmac_f32 v97, v99, v99
    v_fmac_f32 v98, v100, v100
    v_sub_f32 v99, v84, v96
    v_sub_f32 v100, v85, v96
    v_fmac_f32 v97, v99, v99
    v_fmac_f32 v98, v100, v100
    v_sub_f32 v99, v86, v96
    v_sub_f32 v100, v87, v96
    v_fmac_f32 v97, v99, v99
    v_fmac_f32 v98, v100, v100
    v_sub_f32 v99, v88, v96
    v_sub_f32 v100, v89, v96
    v_fmac_f32 v97, v99, v99
    v_fmac_f32 v98, v100, v100
    v_sub_f32 v99, v90, v96
    v_sub_f32 v100, v91, v96
    v_fmac_f32 v97, v99, v99
    v_fmac_f32 v98, v100, v100
    v_sub_f32 v99, v92, v96
    v_sub_f32 v100, v93, v96
    v_fmac_f32 v97, v99, v99
    v_fmac_f32 v98, v100, v100
    v_sub_f32 v99, v94, v96
    v_sub_f32 v100, v95, v96
    v_fmac_f32 v97, v99, v99
    v_fmac_f32 v98, v100, v100
    v_cmp_ne_u32 vcc, 0x7ffffff0, v49
    v_add_f32 v97, v97, v98
    s_nop 0
    v_cndmask_b32 v97, 0, v97, vcc
    s_nop 1
    v_add_f32_dpp v97, v97, v97 quad_perm:[1,0,3,2] row_mask:0xf bank_mask:0xf
    s_nop 1
    v_add_f32_dpp v97, v97, v97 quad_perm:[2,3,0,1] row_mask:0xf bank_mask:0xf
    s_nop 1
    v_add_f32_dpp v97, v97, v97 row_half_mirror row_mask:0xf bank_mask:0xf
    s_nop 1
    v_add_f32_dpp v97, v97, v97 row_mirror row_mask:0xf bank_mask:0xf
    v_mov_b32 v99, v97
    s_nop 1
    v_permlane16_swap_b32 v97, v99
    s_nop 1
    v_add_f32 v97, v97, v99
    v_mul_f32 v97, 0x3b124925, v97
    v_cvt_pk_bf16_f32 v96, v96, v96
    v_lshlrev_b32 v96, 16, v96
    v_cvt_pk_bf16_f32 v97, v97, v97
    v_lshlrev_b32 v97, 16, v97
    v_add_f32 v97, 0x3727c5ac, v97
    v_cvt_pk_bf16_f32 v97, v97, v97
    v_lshlrev_b32 v97, 16, v97
    v_sqrt_f32 v97, v97
    s_nop 0
    v_cvt_pk_bf16_f32 v97, v97, v97
    v_lshlrev_b32 v97, 16, v97
    v_rcp_f32 v98, v97
    s_nop 0
    v_sub_f32 v80, v80, v96
    v_sub_f32 v81, v81, v96
    v_sub_f32 v82, v82, v96
    v_sub_f32 v83, v83, v96
    v_sub_f32 v84, v84, v96
    v_sub_f32 v85, v85, v96
    v_sub_f32 v86, v86, v96
    v_sub_f32 v87, v87, v96
    v_sub_f32 v88, v88, v96
    v_sub_f32 v89, v89, v96
    v_sub_f32 v90, v90, v96
    v_sub_f32 v91, v91, v96
    v_sub_f32 v92, v92, v96
    v_sub_f32 v93, v93, v96
    v_sub_f32 v94, v94, v96
    v_sub_f32 v95, v95, v96
    v_cvt_pk_bf16_f32 v104, v80, v81
    v_cvt_pk_bf16_f32 v105, v82, v83
    v_cvt_pk_bf16_f32 v106, v84, v85
    v_cvt_pk_bf16_f32 v107, v86, v87
    v_cvt_pk_bf16_f32 v108, v88, v89
    v_cvt_pk_bf16_f32 v109, v90, v91
    v_cvt_pk_bf16_f32 v110, v92, v93
    v_cvt_pk_bf16_f32 v111, v94, v95
    v_lshlrev_b32 v80, 16, v104
    v_and_b32 v81, 0xffff0000, v104
    v_lshlrev_b32 v82, 16, v105
    v_and_b32 v83, 0xffff0000, v105
    v_lshlrev_b32 v84, 16, v106
    v_and_b32 v85, 0xffff0000, v106
    v_lshlrev_b32 v86, 16, v107
    v_and_b32 v87, 0xffff0000, v107
    v_lshlrev_b32 v88, 16, v108
    v_and_b32 v89, 0xffff0000, v108
    v_lshlrev_b32 v90, 16, v109
    v_and_b32 v91, 0xffff0000, v109
    v_lshlrev_b32 v92, 16, v110
    v_and_b32 v93, 0xffff0000, v110
    v_lshlrev_b32 v94, 16, v111
    v_and_b32 v95, 0xffff0000, v111
    v_mul_f32 v80, v80, v98
    v_mul_f32 v81, v81, v98
    v_mul_f32 v82, v82, v98
    v_mul_f32 v83, v83, v98
    v_mul_f32 v84, v84, v98
    v_mul_f32 v85, v85, v98
    v_mul_f32 v86, v86, v98
    v_mul_f32 v87, v87, v98
    v_mul_f32 v88, v88, v98
    v_mul_f32 v89, v89, v98
    v_mul_f32 v90, v90, v98
    v_mul_f32 v91, v91, v98
    v_mul_f32 v92, v92, v98
    v_mul_f32 v93, v93, v98
    v_mul_f32 v94, v94, v98
    v_mul_f32 v95, v95, v98
    v_cvt_pk_bf16_f32 v104, v80, v81
    v_cvt_pk_bf16_f32 v105, v82, v83
    v_cvt_pk_bf16_f32 v106, v84, v85
    v_cvt_pk_bf16_f32 v107, v86, v87
    v_cvt_pk_bf16_f32 v108, v88, v89
    v_cvt_pk_bf16_f32 v109, v90, v91
    v_cvt_pk_bf16_f32 v110, v92, v93
    v_cvt_pk_bf16_f32 v111, v94, v95
    v_lshlrev_b32 v80, 16, v104
    v_and_b32 v81, 0xffff0000, v104
    v_lshlrev_b32 v82, 16, v105
    v_and_b32 v83, 0xffff0000, v105
    v_lshlrev_b32 v84, 16, v106
    v_and_b32 v85, 0xffff0000, v106
    v_lshlrev_b32 v86, 16, v107
    v_and_b32 v87, 0xffff0000, v107
    v_lshlrev_b32 v88, 16, v108
    v_and_b32 v89, 0xffff0000, v108
    v_lshlrev_b32 v90, 16, v109
    v_and_b32 v91, 0xffff0000, v109
    v_lshlrev_b32 v92, 16, v110
    v_and_b32 v93, 0xffff0000, v110
    v_lshlrev_b32 v94, 16, v111
    v_and_b32 v95, 0xffff0000, v111
    v_cvt_pkrtz_f16_f32 v64, v80, v81
    v_cvt_pkrtz_f16_f32 v65, v82, v83
    v_cvt_pkrtz_f16_f32 v66, v84, v85
    v_cvt_pkrtz_f16_f32 v67, v86, v87
    v_cvt_pkrtz_f16_f32 v68, v88, v89
    v_cvt_pkrtz_f16_f32 v69, v90, v91
    v_cvt_pkrtz_f16_f32 v70, v92, v93
    v_cvt_pkrtz_f16_f32 v71, v94, v95
    s_lshl_b32 s60, s54, 2
    s_lshr_b32 s61, s53, 2
    s_add_u32 s60, s60, s61
    s_mul_i32 s60, s60, 28672
    s_bfe_u32 s61, s53, 0x10001
    s_lshl_b32 s61, s61, 10
    s_add_u32 s60, s60, s61
    s_and_b32 s61, s53, 1
    s_lshl_b32 s61, s61, 7
    s_add_u32 s60, s60, s61
    s_add_u32 s60, s60, 0x10000
    buffer_store_dwordx4 v[64:67], v50, s[20:23], s60 offen offset:0 sc1
    buffer_store_dwordx4 v[68:71], v50, s[20:23], s60 offen offset:256 sc1
    s_cmp_ge_u32 s62, 168
    s_cbranch_scc1 L_nogemv2
    s_waitcnt vmcnt(16)
    v_lshlrev_b32 v180, 16, v180
    v_lshlrev_b32 v181, 16, v181
    v_lshlrev_b32 v182, 16, v182
    v_lshlrev_b32 v183, 16, v183
    v_mul_f32 v200, 0xbfb8aa3b, v180
    v_mul_f32 v201, 0xbfb8aa3b, v181
    v_mul_f32 v202, 0xbfb8aa3b, v182
    v_mul_f32 v203, 0xbfb8aa3b, v183
    v_exp_f32 v200, v200
    v_exp_f32 v201, v201
    v_exp_f32 v202, v202
    v_exp_f32 v203, v203
    v_add_f32 v200, 1.0, v200
    v_add_f32 v201, 1.0, v201
    v_add_f32 v202, 1.0, v202
    v_add_f32 v203, 1.0, v203
    v_rcp_f32 v200, v200
    v_rcp_f32 v201, v201
    v_rcp_f32 v202, v202
    v_rcp_f32 v203, v203
    v_mul_f32 v180, v180, v200
    v_mul_f32 v181, v181, v201
    v_mul_f32 v182, v182, v202
    v_mul_f32 v183, v183, v203
    v_cvt_pk_bf16_f32 v200, v180, v181
    v_cvt_pk_bf16_f32 v201, v182, v183
    v_lshlrev_b32 v180, 16, v200
    v_and_b32 v181, 0xffff0000, v200
    v_lshlrev_b32 v182, 16, v201
    v_and_b32 v183, 0xffff0000, v201
    s_waitcnt vmcnt(15)
    v_lshlrev_b32 v200, 16, v184
    v_and_b32 v201, 0xffff0000, v184
    v_mul_f32 v208, v180, v200
    v_mul_f32 v209, v180, v201
    v_lshlrev_b32 v200, 16, v185
    v_and_b32 v201, 0xffff0000, v185
    v_mul_f32 v210, v180, v200
    v_mul_f32 v211, v180, v201
    v_lshlrev_b32 v200, 16, v186
    v_and_b32 v201, 0xffff0000, v186
    v_mul_f32 v212, v180, v200
    v_mul_f32 v213, v180, v201
    v_lshlrev_b32 v200, 16, v187
    v_and_b32 v201, 0xffff0000, v187
    v_mul_f32 v214, v180, v200
    v_mul_f32 v215, v180, v201
    s_waitcnt vmcnt(14)
    v_lshlrev_b32 v200, 16, v188
    v_and_b32 v201, 0xffff0000, v188
    v_fmac_f32 v208, v181, v200
    v_fmac_f32 v209, v181, v201
    v_lshlrev_b32 v200, 16, v189
    v_and_b32 v201, 0xffff0000, v189
    v_fmac_f32 v210, v181, v200
    v_fmac_f32 v211, v181, v201
    v_lshlrev_b32 v200, 16, v190
    v_and_b32 v201, 0xffff0000, v190
    v_fmac_f32 v212, v181, v200
    v_fmac_f32 v213, v181, v201
    v_lshlrev_b32 v200, 16, v191
    v_and_b32 v201, 0xffff0000, v191
    v_fmac_f32 v214, v181, v200
    v_fmac_f32 v215, v181, v201
    s_waitcnt vmcnt(13)
    v_lshlrev_b32 v200, 16, v192
    v_and_b32 v201, 0xffff0000, v192
    v_fmac_f32 v208, v182, v200
    v_fmac_f32 v209, v182, v201
    v_lshlrev_b32 v200, 16, v193
    v_and_b32 v201, 0xffff0000, v193
    v_fmac_f32 v210, v182, v200
    v_fmac_f32 v211, v182, v201
    v_lshlrev_b32 v200, 16, v194
    v_and_b32 v201, 0xffff0000, v194
    v_fmac_f32 v212, v182, v200
    v_fmac_f32 v213, v182, v201
    v_lshlrev_b32 v200, 16, v195
    v_and_b32 v201, 0xffff0000, v195
    v_fmac_f32 v214, v182, v200
    v_fmac_f32 v215, v182, v201
    s_waitcnt vmcnt(12)
    v_lshlrev_b32 v200, 16, v196
    v_and_b32 v201, 0xffff0000, v196
    v_fmac_f32 v208, v183, v200
    v_fmac_f32 v209, v183, v201
    v_lshlrev_b32 v200, 16, v197
    v_and_b32 v201, 0xffff0000, v197
    v_fmac_f32 v210, v183, v200
    v_fmac_f32 v211, v183, v201
    v_lshlrev_b32 v200, 16, v198
    v_and_b32 v201, 0xffff0000, v198
    v_fmac_f32 v212, v183, v200
    v_fmac_f32 v213, v183, v201
    v_lshlrev_b32 v200, 16, v199
    v_and_b32 v201, 0xffff0000, v199
    v_fmac_f32 v214, v183, v200
    v_fmac_f32 v215, v183, v201
    v_add_f32_dpp v208, v208, v208 quad_perm:[2,3,0,1] row_mask:0xf bank_mask:0xf
    v_add_f32_dpp v209, v209, v209 quad_perm:[2,3,0,1] row_mask:0xf bank_mask:0xf
    v_add_f32_dpp v210, v210, v210 quad_perm:[2,3,0,1] row_mask:0xf bank_mask:0xf
    v_add_f32_dpp v211, v211, v211 quad_perm:[2,3,0,1] row_mask:0xf bank_mask:0xf
    v_add_f32_dpp v212, v212, v212 quad_perm:[2,3,0,1] row_mask:0xf bank_mask:0xf
    v_add_f32_dpp v213, v213, v213 quad_perm:[2,3,0,1] row_mask:0xf bank_mask:0xf
    v_add_f32_dpp v214, v214, v214 quad_perm:[2,3,0,1] row_mask:0xf bank_mask:0xf
    v_add_f32_dpp v215, v215, v215 quad_perm:[2,3,0,1] row_mask:0xf bank_mask:0xf
    v_add_f32_dpp v208, v208, v208 row_ror:4 row_mask:0xf bank_mask:0xf
    v_add_f32_dpp v209, v209, v209 row_ror:4 row_mask:0xf bank_mask:0xf
    v_add_f32_dpp v210, v210, v210 row_ror:4 row_mask:0xf bank_mask:0xf
    v_add_f32_dpp v211, v211, v211 row_ror:4 row_mask:0xf bank_mask:0xf
    v_add_f32_dpp v212, v212, v212 row_ror:4 row_mask:0xf bank_mask:0xf
    v_add_f32_dpp v213, v213, v213 row_ror:4 row_mask:0xf bank_mask:0xf
    v_add_f32_dpp v214, v214, v214 row_ror:4 row_mask:0xf bank_mask:0xf
    v_add_f32_dpp v215, v215, v215 row_ror:4 row_mask:0xf bank_mask:0xf
    v_add_f32_dpp v208, v208, v208 row_ror:8 row_mask:0xf bank_mask:0xf
    v_add_f32_dpp v209, v209, v209 row_ror:8 row_mask:0xf bank_mask:0xf
    v_add_f32_dpp v210, v210, v210 row_ror:8 row_mask:0xf bank_mask:0xf
    v_add_f32_dpp v211, v211, v211 row_ror:8 row_mask:0xf bank_mask:0xf
    v_add_f32_dpp v212, v212, v212 row_ror:8 row_mask:0xf bank_mask:0xf
    v_add_f32_dpp v213, v213, v213 row_ror:8 row_mask:0xf bank_mask:0xf
    v_add_f32_dpp v214, v214, v214 row_ror:8 row_mask:0xf bank_mask:0xf
    v_add_f32_dpp v215, v215, v215 row_ror:8 row_mask:0xf bank_mask:0xf
    v_mov_b32 v216, v208
    v_mov_b32 v217, v209
    v_mov_b32 v218, v210
    v_mov_b32 v219, v211
    v_mov_b32 v220, v212
    v_mov_b32 v221, v213
    v_mov_b32 v222, v214
    v_mov_b32 v223, v215
    v_permlane16_swap_b32 v208, v216
    v_permlane16_swap_b32 v209, v217
    v_permlane16_swap_b32 v210, v218
    v_permlane16_swap_b32 v211, v219
    v_permlane16_swap_b32 v212, v220
    v_permlane16_swap_b32 v213, v221
    v_permlane16_swap_b32 v214, v222
    v_permlane16_swap_b32 v215, v223
    v_add_f32 v208, v208, v216
    v_add_f32 v209, v209, v217
    v_add_f32 v210, v210, v218
    v_add_f32 v211, v211, v219
    v_add_f32 v212, v212, v220
    v_add_f32 v213, v213, v221
    v_add_f32 v214, v214, v222
    v_add_f32 v215, v215, v223
    v_mov_b32 v216, v208
    v_mov_b32 v217, v209
    v_mov_b32 v218, v210
    v_mov_b32 v219, v211
    v_mov_b32 v220, v212
    v_mov_b32 v221, v213
    v_mov_b32 v222, v214
    v_mov_b32 v223, v215
    v_permlane32_swap_b32 v208, v216
    v_permlane32_swap_b32 v209, v217
    v_permlane32_swap_b32 v210, v218
    v_permlane32_swap_b32 v211, v219
    v_permlane32_swap_b32 v212, v220
    v_permlane32_swap_b32 v213, v221
    v_permlane32_swap_b32 v214, v222
    v_permlane32_swap_b32 v215, v223
    v_add_f32 v208, v208, v216
    v_add_f32 v209, v209, v217
    v_add_f32 v210, v210, v218
    v_add_f32 v211, v211, v219
    v_add_f32 v212, v212, v220
    v_add_f32 v213, v213, v221
    v_add_f32 v214, v214, v222
    v_add_f32 v215, v215, v223
    v_and_b32 v200, 1, v0
    v_lshlrev_b32 v200, 5, v200
    s_lshl_b32 s60, s52, 6
    s_add_u32 s60, s60, 139264
    v_add_u32 v200, s60, v200
    ds_write_b128 v200, v[208:211]
    ds_write_b128 v200, v[212:215] offset:16
L_nogemv2:
    s_waitcnt lgkmcnt(0)
    s_waitcnt vmcnt(0)
    v_readfirstlane_b32 s49, v55
    s_mul_i32 s49, s49, 0x9e3779b1
    s_add_u32 s49, s49, 0x7f4a7c15
    s_barrier
    s_cmp_lg_u32 s52, 0
    s_cbranch_scc1 L_pub_done
    s_mov_b64 exec, 1
    v_mov_b32 v202, s49
    v_mov_b32 v203, 0
    buffer_store_dword v202, v203, s[20:23], s92 offen sc1
    s_mov_b64 exec, -1
    s_cmp_ge_u32 s62, 168
    s_cbranch_scc1 L_pub_done
    v_and_b32 v200, 15, v0
    v_lshlrev_b32 v201, 2, v200
    v_add_u32 v201, 139264, v201
    ds_read_b32 v208, v201 offset:0
    ds_read_b32 v209, v201 offset:64
    ds_read_b32 v210, v201 offset:128
    ds_read_b32 v211, v201 offset:192
    s_mul_i32 s60, s62, 147
    s_lshr_b32 s60, s60, 12
    s_mul_i32 s61, s60, 28
    s_sub_u32 s61, s62, s61
    s_lshl_b32 s61, s61, 4
    v_add_u32 v200, s61, v200
    s_waitcnt lgkmcnt(0)
    v_add_f32 v208, v208, v209
    v_add_f32 v210, v210, v211
    v_add_f32 v208, v208, v210
    v_cvt_pk_bf16_f32 v208, v208, v208
    v_lshlrev_b32 v208, 16, v208
    s_cmp_eq_u32 s60, 1
    s_cbranch_scc1 L_plus1
    s_cmp_eq_u32 s60, 4
    s_cbranch_scc0 L_noplus
L_plus1:
    v_add_f32 v208, 1.0, v208
    v_cvt_pk_bf16_f32 v208, v208, v208
    v_lshlrev_b32 v208, 16, v208
L_noplus:
    s_mov_b64 exec, 0xffff
    s_cmp_ge_u32 s60, 2
    s_cbranch_scc1 L_plain
    v_mul_f32 v208, 0x3db8aa3b, v208
    v_mov_b32 v209, s49
    v_lshrrev_b32 v201, 3, v200
    v_lshlrev_b32 v201, 7, v201
    v_and_b32 v200, 7, v200
    v_lshl_add_u32 v201, v200, 3, v201
    s_cmp_eq_u32 s60, 0
    s_cselect_b32 s61, 64, 0
    s_add_u32 s61, s61, 32768
    buffer_store_dwordx2 v[208:209], v201, s[20:23], s61 offen sc1
    s_branch L_gdone
L_plain:
    s_lshl_b32 s61, s60, 11
    v_lshlrev_b32 v201, 2, v200
    buffer_store_dword v208, v201, s[20:23], s61 offen sc1
L_gdone:
    s_mov_b64 exec, -1
L_pub_done:
    s_add_u32 m0, s57, 33792
    s_mov_b32 s91, 524288
    buffer_load_dwordx4 v22, s[12:15], s91 offen offset:0 lds
    buffer_load_dwordx4 v23, s[12:15], s91 offen offset:1056 lds
    buffer_load_dwordx4 v24, s[12:15], s91 offen offset:2112 lds
    buffer_load_dwordx4 v25, s[12:15], s91 offen offset:3168 lds
    s_add_u32 m0, s57, 50688
    s_mov_b32 s91, 786432
    buffer_load_dwordx4 v22, s[12:15], s91 offen offset:0 lds
    buffer_load_dwordx4 v23, s[12:15], s91 offen offset:1056 lds
    buffer_load_dwordx4 v24, s[12:15], s91 offen offset:2112 lds
    buffer_load_dwordx4 v25, s[12:15], s91 offen offset:3168 lds
    s_add_u32 m0, s57, 67584
    s_mov_b32 s91, 1048576
    buffer_load_dwordx4 v22, s[12:15], s91 offen offset:0 lds
    buffer_load_dwordx4 v23, s[12:15], s91 offen offset:1056 lds
    buffer_load_dwordx4 v24, s[12:15], s91 offen offset:2112 lds
    buffer_load_dwordx4 v25, s[12:15], s91 offen offset:3168 lds
    s_add_u32 m0, s57, 84480
    s_mov_b32 s91, 1310720
    buffer_load_dwordx4 v22, s[12:15], s91 offen offset:0 lds
    buffer_load_dwordx4 v23, s[12:15], s91 offen offset:1056 lds
    buffer_load_dwordx4 v24, s[12:15], s91 offen offset:2112 lds
    buffer_load_dwordx4 v25, s[12:15], s91 offen offset:3168 lds
    s_add_u32 m0, s57, 101376
    s_mov_b32 s91, 1572864
    buffer_load_dwordx4 v22, s[12:15], s91 offen offset:0 lds
    buffer_load_dwordx4 v23, s[12:15], s91 offen offset:1056 lds
    buffer_load_dwordx4 v24, s[12:15], s91 offen offset:2112 lds
    buffer_load_dwordx4 v25, s[12:15], s91 offen offset:3168 lds
    s_add_u32 m0, s57, 118272
    s_mov_b32 s91, 1835008
    buffer_load_dwordx4 v22, s[12:15], s91 offen offset:0 lds
    buffer_load_dwordx4 v23, s[12:15], s91 offen offset:1056 lds
    buffer_load_dwordx4 v24, s[12:15], s91 offen offset:2112 lds
    buffer_load_dwordx4 v25, s[12:15], s91 offen offset:3168 lds
    s_lshl_b32 s60, s52, 12
    s_add_u32 s60, s60, 4096
    v_add_u32 v14, s60, v51
    v_subrev_u32 v15, 32, v14
    v_subrev_u32 v16, 64, v14
    v_subrev_u32 v17, 96, v14
    s_lshr_b32 s60, s52, 1
    s_xor_b32 s61, s60, s52
    s_and_b32 s61, s61, 1
    s_lshl_b32 s60, s60, 3
    s_add_u32 s60, s60, s61
    s_lshl_b32 s60, s60, 9
    s_add_u32 s60, s60, 4096
    v_lshrrev_b32 v36, 5, v1
    v_lshlrev_b32 v36, 13, v36
    v_and_b32 v37, 31, v1
    v_lshl_add_u32 v36, v37, 4, v36
    v_add_u32 v18, s60, v36
    v_subrev_u32 v19, 32, v18
    v_subrev_u32 v20, 64, v18
    v_subrev_u32 v21, 96, v18
    v_lshrrev_b32 v36, 3, v1
    s_lshl_b32 s60, s52, 5
    v_add_u32 v36, s60, v36
    v_mul_u32_u24 v36, 896, v36
    v_bfe_u32 v37, v1, 1, 2
    v_lshrrev_b32 v26, 4, v1
    v_xor_b32 v37, v37, v26
    v_lshl_add_u32 v36, v37, 5, v36
    v_and_b32 v37, 1, v1
    v_lshl_add_u32 v26, v37, 4, v36
    v_add_u32 v27, 6144, v26
    v_add_u32 v28, 12288, v26
    v_add_u32 v29, 18432, v26
    s_mov_b32 s90, 0x44800000
    v_mov_b32 v30, 0
    v_mov_b32 v31, 0
    v_and_b32 v36, 3, v1
    v_lshlrev_b32 v36, 2, v36
    s_and_b32 s61, s92, 0xffffff80
    s_lshl_b32 s60, s52, 4
    s_add_u32 s59, s61, s60
    v_lshlrev_b32 v37, 4, v0
    s_cmp_eq_u32 s52, 3
    s_cselect_b32 s62, 0, 4096
    s_add_u32 s62, s62, 32768
    s_mov_b32 s91, 32768
    s_mov_b32 s96, 400000
    s_add_u32 s93, s63, 0x10000
L_pl_x:
    buffer_load_dword v38, v36, s[20:23], s59 offen sc1
    buffer_load_dwordx4 v[176:179], v37, s[20:23], s91 offen sc1
    buffer_load_dwordx4 v[180:183], v37, s[20:23], s62 offen sc1
    s_waitcnt vmcnt(2)
    v_cmp_eq_u32 vcc, s49, v38
    s_cmp_eq_u64 vcc, exec
    s_cbranch_scc1 L_px_x
    s_sleep 4
    s_sub_u32 s96, s96, 1
    s_cmp_lg_u32 s96, 0
    s_cbranch_scc1 L_pl_x
    s_mov_b32 s96, 1
L_px_x:
    buffer_load_dwordx4 a[0:3], v51, s[20:23], s93 offen offset:0 sc1
    buffer_load_dwordx4 a[4:7], v51, s[20:23], s93 offen offset:1024 sc1
    buffer_load_dwordx4 a[8:11], v51, s[20:23], s93 offen offset:2048 sc1
    buffer_load_dwordx4 a[12:15], v51, s[20:23], s93 offen offset:3072 sc1
    s_add_u32 s93, s93, 4096
    buffer_load_dwordx4 a[16:19], v51, s[20:23], s93 offen offset:0 sc1
    buffer_load_dwordx4 a[20:23], v51, s[20:23], s93 offen offset:1024 sc1
    buffer_load_dwordx4 a[24:27], v51, s[20:23], s93 offen offset:2048 sc1
    buffer_load_dwordx4 a[28:31], v51, s[20:23], s93 offen offset:3072 sc1
    s_add_u32 s93, s93, 4096
    s_waitcnt vmcnt(8)
L_ck_mod:
    v_xor_b32 v177, s49, v177
    v_xor_b32 v179, s49, v179
    v_xor_b32 v181, s49, v181
    v_xor_b32 v183, s49, v183
    v_or3_b32 v38, v177, v179, v181
    v_or_b32 v38, v38, v183
    v_cmp_eq_u32 vcc, 0, v38
    s_cmp_eq_u64 vcc, exec
    s_cbranch_scc1 L_px_mod
    s_sub_u32 s96, s96, 1
    s_cmp_eq_u32 s96, 0
    s_cbranch_scc1 L_px_mod
    s_sleep 4
    buffer_load_dwordx4 v[176:179], v37, s[20:23], s91 offen sc1
    buffer_load_dwordx4 v[180:183], v37, s[20:23], s62 offen sc1
    s_waitcnt vmcnt(0)
    s_branch L_ck_mod
L_px_mod:
    s_cmp_lg_u32 s52, 0
    s_cbranch_scc1 L_noz
    s_mov_b64 exec, 1
    v_mov_b32 v38, s49
    v_mov_b32 v39, 8192
    buffer_store_dword v38, v39, s[20:23], s92 offen sc1
    s_mov_b64 exec, -1
L_noz:
    v_mov_b32 v177, v178
    v_mov_b32 v181, v182
    v_lshrrev_b32 v37, 1, v37
    v_add_u32 v37, 135168, v37
    s_sub_u32 s60, s62, 32768
    s_lshr_b32 s60, s60, 1
    v_add_u32 v38, s60, v37
    ds_write_b64 v37, v[176:177]
    ds_write_b64 v38, v[180:181]
    s_waitcnt lgkmcnt(0)
    s_barrier
    ds_read_b64_tr_b16 a[128:129], v3 offset:0
    ds_read_b64_tr_b16 a[130:131], v3 offset:512
    ds_read_b64_tr_b16 a[132:133], v3 offset:32
    ds_read_b64_tr_b16 a[134:135], v3 offset:544
    ds_read_b64_tr_b16 a[136:137], v3 offset:64
    ds_read_b64_tr_b16 a[138:139], v3 offset:576
    ds_read_b64_tr_b16 a[140:141], v3 offset:96
    ds_read_b64_tr_b16 a[142:143], v3 offset:608
    ds_read_b64_tr_b16 a[144:145], v3 offset:128
    ds_read_b64_tr_b16 a[146:147], v3 offset:640
    ds_read_b64_tr_b16 a[148:149], v3 offset:160
    ds_read_b64_tr_b16 a[150:151], v3 offset:672
    ds_read_b64_tr_b16 a[152:153], v3 offset:192
    ds_read_b64_tr_b16 a[154:155], v3 offset:704
    ds_read_b64_tr_b16 a[156:157], v3 offset:224
    s_waitcnt lgkmcnt(14)
    ds_read_b64_tr_b16 a[158:159], v3 offset:736
    s_waitcnt lgkmcnt(14)
    ds_read_b128 v[64:67], v48 offset:0
    s_waitcnt lgkmcnt(14)
    ds_read_b128 v[68:71], v48 offset:16
    s_waitcnt lgkmcnt(14)
    ds_read_b128 v[72:75], v48 offset:32
    s_waitcnt lgkmcnt(14)
    ds_read_b128 v[76:79], v48 offset:48
    s_waitcnt lgkmcnt(14)
    ds_read_b128 v[80:83], v48 offset:256
    s_waitcnt lgkmcnt(14)
    ds_read_b128 v[84:87], v48 offset:272
    s_waitcnt lgkmcnt(14)
    ds_read_b128 v[88:91], v48 offset:288
    s_waitcnt lgkmcnt(14)
    ds_read_b128 v[92:95], v48 offset:304
    s_waitcnt vmcnt(7) lgkmcnt(4)
    v_accvgpr_read_b32 v112, a0
    v_fma_mix_f32 v113, v112, v64, v72 op_sel:[0,0,0] op_sel_hi:[1,0,0]
    v_fma_mix_f32 v114, v112, v65, v73 op_sel:[1,0,0] op_sel_hi:[1,0,0]
    v_cvt_pk_bf16_f32 v96, v113, v114
    v_accvgpr_read_b32 v116, a1
    v_fma_mix_f32 v117, v116, v66, v74 op_sel:[0,0,0] op_sel_hi:[1,0,0]
    v_fma_mix_f32 v118, v116, v67, v75 op_sel:[1,0,0] op_sel_hi:[1,0,0]
    v_cvt_pk_bf16_f32 v97, v117, v118
    v_accvgpr_read_b32 v112, a2
    v_fma_mix_f32 v113, v112, v68, v76 op_sel:[0,0,0] op_sel_hi:[1,0,0]
    v_fma_mix_f32 v114, v112, v69, v77 op_sel:[1,0,0] op_sel_hi:[1,0,0]
    v_cvt_pk_bf16_f32 v98, v113, v114
    v_accvgpr_read_b32 v116, a3
    v_fma_mix_f32 v117, v116, v70, v78 op_sel:[0,0,0] op_sel_hi:[1,0,0]
    v_fma_mix_f32 v118, v116, v71, v79 op_sel:[1,0,0] op_sel_hi:[1,0,0]
    v_cvt_pk_bf16_f32 v99, v117, v118
    s_waitcnt vmcnt(6)
    v_accvgpr_read_b32 v112, a4
    v_fma_mix_f32 v113, v112, v64, v72 op_sel:[0,0,0] op_sel_hi:[1,0,0]
    v_fma_mix_f32 v114, v112, v65, v73 op_sel:[1,0,0] op_sel_hi:[1,0,0]
    v_cvt_pk_bf16_f32 v100, v113, v114
    v_accvgpr_read_b32 v116, a5
    v_fma_mix_f32 v117, v116, v66, v74 op_sel:[0,0,0] op_sel_hi:[1,0,0]
    v_fma_mix_f32 v118, v116, v67, v75 op_sel:[1,0,0] op_sel_hi:[1,0,0]
    v_cvt_pk_bf16_f32 v101, v117, v118
    v_accvgpr_read_b32 v112, a6
    v_fma_mix_f32 v113, v112, v68, v76 op_sel:[0,0,0] op_sel_hi:[1,0,0]
    v_fma_mix_f32 v114, v112, v69, v77 op_sel:[1,0,0] op_sel_hi:[1,0,0]
    v_cvt_pk_bf16_f32 v102, v113, v114
    v_accvgpr_read_b32 v116, a7
    v_fma_mix_f32 v117, v116, v70, v78 op_sel:[0,0,0] op_sel_hi:[1,0,0]
    v_fma_mix_f32 v118, v116, v71, v79 op_sel:[1,0,0] op_sel_hi:[1,0,0]
    v_cvt_pk_bf16_f32 v103, v117, v118
    s_nop 1
    v_mfma_f32_16x16x32_bf16 v[128:131], a[128:131], v[96:99], 0
    ds_read_b64_tr_b16 a[160:161], v3 offset:256
    s_waitcnt vmcnt(5) lgkmcnt(1)
    v_accvgpr_read_b32 v112, a8
    v_mfma_f32_16x16x32_bf16 v[132:135], a[128:131], v[100:103], 0
    ds_read_b64_tr_b16 a[162:163], v3 offset:768
    v_fma_mix_f32 v113, v112, v80, v88 op_sel:[0,0,0] op_sel_hi:[1,0,0]
    v_mfma_f32_16x16x32_bf16 v[136:139], a[132:135], v[96:99], 0
    ds_read_b64_tr_b16 a[164:165], v3 offset:288
    v_fma_mix_f32 v114, v112, v81, v89 op_sel:[1,0,0] op_sel_hi:[1,0,0]
    v_mfma_f32_16x16x32_bf16 v[140:143], a[132:135], v[100:103], 0
    ds_read_b64_tr_b16 a[166:167], v3 offset:800
    v_cvt_pk_bf16_f32 v104, v113, v114
    v_mfma_f32_16x16x32_bf16 v[144:147], a[136:139], v[96:99], 0
    ds_read_b64_tr_b16 a[168:169], v3 offset:320
    v_accvgpr_read_b32 v116, a9
    v_mfma_f32_16x16x32_bf16 v[148:151], a[136:139], v[100:103], 0
    ds_read_b64_tr_b16 a[170:171], v3 offset:832
    buffer_load_dwordx4 a[32:35], v51, s[20:23], s93 offen offset:0 sc1
    v_mfma_f32_16x16x32_bf16 v[152:155], a[140:143], v[96:99], 0
    ds_read_b64_tr_b16 a[172:173], v3 offset:352
    v_fma_mix_f32 v117, v116, v82, v90 op_sel:[0,0,0] op_sel_hi:[1,0,0]
    v_mfma_f32_16x16x32_bf16 v[156:159], a[140:143], v[100:103], 0
    ds_read_b64_tr_b16 a[174:175], v3 offset:864
    v_fma_mix_f32 v118, v116, v83, v91 op_sel:[1,0,0] op_sel_hi:[1,0,0]
    v_mfma_f32_16x16x32_bf16 v[160:163], a[144:147], v[96:99], 0
    ds_read_b64_tr_b16 a[176:177], v3 offset:384
    v_cvt_pk_bf16_f32 v105, v117, v118
    v_mfma_f32_16x16x32_bf16 v[164:167], a[144:147], v[100:103], 0
    ds_read_b64_tr_b16 a[178:179], v3 offset:896
    v_accvgpr_read_b32 v112, a10
    v_mfma_f32_16x16x32_bf16 v[168:171], a[148:151], v[96:99], 0
    ds_read_b64_tr_b16 a[180:181], v3 offset:416
    ds_read_b64_tr_b16 a[182:183], v3 offset:928
    ds_read_b64_tr_b16 a[184:185], v3 offset:448
    ds_read_b64_tr_b16 a[186:187], v3 offset:960
    ds_read_b64_tr_b16 a[188:189], v3 offset:480
    ds_read_b64_tr_b16 a[190:191], v3 offset:992
    v_mfma_f32_16x16x32_bf16 v[172:175], a[148:151], v[100:103], 0
    ds_read_b64_tr_b16 a[192:193], v3 offset:16896
    v_fma_mix_f32 v113, v112, v84, v92 op_sel:[0,0,0] op_sel_hi:[1,0,0]
    v_mfma_f32_16x16x32_bf16 v[176:179], a[152:155], v[96:99], 0
    ds_read_b64_tr_b16 a[194:195], v3 offset:17408
    v_fma_mix_f32 v114, v112, v85, v93 op_sel:[1,0,0] op_sel_hi:[1,0,0]
    v_mfma_f32_16x16x32_bf16 v[180:183], a[152:155], v[100:103], 0
    ds_read_b64_tr_b16 a[196:197], v3 offset:16928
    buffer_load_dwordx4 a[36:39], v51, s[20:23], s93 offen offset:1024 sc1
    s_waitcnt lgkmcnt(14)
    ds_read_b128 v[64:67], v48 offset:512
    s_waitcnt lgkmcnt(14)
    ds_read_b128 v[68:71], v48 offset:528
    s_waitcnt lgkmcnt(14)
    ds_read_b128 v[72:75], v48 offset:544
    s_waitcnt lgkmcnt(14)
    ds_read_b128 v[76:79], v48 offset:560
    v_mfma_f32_16x16x32_bf16 v[184:187], a[156:159], v[96:99], 0
    ds_read_b64_tr_b16 a[198:199], v3 offset:17440
    v_cvt_pk_bf16_f32 v106, v113, v114
    v_mfma_f32_16x16x32_bf16 v[188:191], a[156:159], v[100:103], 0
    ds_read_b64_tr_b16 a[200:201], v3 offset:16960
    s_waitcnt lgkmcnt(9)
    v_mfma_f32_16x16x32_bf16 v[192:195], a[160:163], v[96:99], 0
    ds_read_b64_tr_b16 a[202:203], v3 offset:17472
    v_accvgpr_read_b32 v116, a11
    v_mfma_f32_16x16x32_bf16 v[196:199], a[160:163], v[100:103], 0
    ds_read_b64_tr_b16 a[204:205], v3 offset:16992
    v_fma_mix_f32 v117, v116, v86, v94 op_sel:[0,0,0] op_sel_hi:[1,0,0]
    v_mfma_f32_16x16x32_bf16 v[200:203], a[164:167], v[96:99], 0
    ds_read_b64_tr_b16 a[206:207], v3 offset:17504
    v_fma_mix_f32 v118, v116, v87, v95 op_sel:[1,0,0] op_sel_hi:[1,0,0]
    v_mfma_f32_16x16x32_bf16 v[204:207], a[164:167], v[100:103], 0
    ds_read_b64_tr_b16 a[208:209], v3 offset:17024
    v_cvt_pk_bf16_f32 v107, v117, v118
    v_mfma_f32_16x16x32_bf16 v[208:211], a[168:171], v[96:99], 0
    ds_read_b64_tr_b16 a[210:211], v3 offset:17536
    s_waitcnt vmcnt(6)
    v_accvgpr_read_b32 v112, a12
    v_mfma_f32_16x16x32_bf16 v[212:215], a[168:171], v[100:103], 0
    ds_read_b64_tr_b16 a[212:213], v3 offset:17056
    v_fma_mix_f32 v113, v112, v80, v88 op_sel:[0,0,0] op_sel_hi:[1,0,0]
    v_mfma_f32_16x16x32_bf16 v[216:219], a[172:175], v[96:99], 0
    ds_read_b64_tr_b16 a[214:215], v3 offset:17568
    v_fma_mix_f32 v114, v112, v81, v89 op_sel:[1,0,0] op_sel_hi:[1,0,0]
    v_mfma_f32_16x16x32_bf16 v[220:223], a[172:175], v[100:103], 0
    ds_read_b64_tr_b16 a[216:217], v3 offset:17088
    v_cvt_pk_bf16_f32 v108, v113, v114
    v_mfma_f32_16x16x32_bf16 v[224:227], a[176:179], v[96:99], 0
    ds_read_b64_tr_b16 a[218:219], v3 offset:17600
    v_accvgpr_read_b32 v116, a13
    v_mfma_f32_16x16x32_bf16 v[228:231], a[176:179], v[100:103], 0
    ds_read_b64_tr_b16 a[220:221], v3 offset:17120
    v_fma_mix_f32 v117, v116, v82, v90 op_sel:[0,0,0] op_sel_hi:[1,0,0]
    v_mfma_f32_16x16x32_bf16 v[232:235], a[180:183], v[96:99], 0
    ds_read_b64_tr_b16 a[222:223], v3 offset:17632
    v_fma_mix_f32 v118, v116, v83, v91 op_sel:[1,0,0] op_sel_hi:[1,0,0]
    v_mfma_f32_16x16x32_bf16 v[236:239], a[180:183], v[100:103], 0
    ds_read_b64_tr_b16 a[224:225], v3 offset:17152
    v_cvt_pk_bf16_f32 v109, v117, v118
    v_mfma_f32_16x16x32_bf16 v[240:243], a[184:187], v[96:99], 0
    ds_read_b64_tr_b16 a[226:227], v3 offset:17664
    v_accvgpr_read_b32 v112, a14
    v_mfma_f32_16x16x32_bf16 v[244:247], a[184:187], v[100:103], 0
    ds_read_b64_tr_b16 a[228:229], v3 offset:17184
    v_fma_mix_f32 v113, v112, v84, v92 op_sel:[0,0,0] op_sel_hi:[1,0,0]
    v_fma_mix_f32 v114, v112, v85, v93 op_sel:[1,0,0] op_sel_hi:[1,0,0]
    v_cvt_pk_bf16_f32 v110, v113, v114
    v_accvgpr_read_b32 v116, a15
    v_fma_mix_f32 v117, v116, v86, v94 op_sel:[0,0,0] op_sel_hi:[1,0,0]
    v_fma_mix_f32 v118, v116, v87, v95 op_sel:[1,0,0] op_sel_hi:[1,0,0]
    v_cvt_pk_bf16_f32 v111, v117, v118
    v_mfma_f32_16x16x32_bf16 v[248:251], a[188:191], v[96:99], 0
    ds_read_b64_tr_b16 a[230:231], v3 offset:17696
    v_mfma_f32_16x16x32_bf16 v[252:255], a[188:191], v[100:103], 0
    ds_read_b64_tr_b16 a[232:233], v3 offset:17216
    s_waitcnt lgkmcnt(5)
    v_mfma_f32_16x16x32_bf16 v[128:131], a[192:195], v[104:107], v[128:131]
    ds_read_b64_tr_b16 a[234:235], v3 offset:17728
    s_waitcnt vmcnt(5)
    v_accvgpr_read_b32 v112, a16
    v_mfma_f32_16x16x32_bf16 v[132:135], a[192:195], v[108:111], v[132:135]
    ds_read_b64_tr_b16 a[236:237], v3 offset:17248
    v_fma_mix_f32 v113, v112, v64, v72 op_sel:[0,0,0] op_sel_hi:[1,0,0]
    v_mfma_f32_16x16x32_bf16 v[136:139], a[196:199], v[104:107], v[136:139]
    ds_read_b64_tr_b16 a[238:239], v3 offset:17760
    v_fma_mix_f32 v114, v112, v65, v73 op_sel:[1,0,0] op_sel_hi:[1,0,0]
    v_mfma_f32_16x16x32_bf16 v[140:143], a[196:199], v[108:111], v[140:143]
    ds_read_b64_tr_b16 a[240:241], v3 offset:17280
    v_cvt_pk_bf16_f32 v96, v113, v114
    v_mfma_f32_16x16x32_bf16 v[144:147], a[200:203], v[104:107], v[144:147]
    ds_read_b64_tr_b16 a[242:243], v3 offset:17792
    v_accvgpr_read_b32 v116, a17
    v_mfma_f32_16x16x32_bf16 v[148:151], a[200:203], v[108:111], v[148:151]
    ds_read_b64_tr_b16 a[244:245], v3 offset:17312
    buffer_load_dwordx4 a[40:43], v51, s[20:23], s93 offen offset:2048 sc1
    v_mfma_f32_16x16x32_bf16 v[152:155], a[204:207], v[104:107], v[152:155]
    ds_read_b64_tr_b16 a[246:247], v3 offset:17824
    v_fma_mix_f32 v117, v116, v66, v74 op_sel:[0,0,0] op_sel_hi:[1,0,0]
    v_mfma_f32_16x16x32_bf16 v[156:159], a[204:207], v[108:111], v[156:159]
    ds_read_b64_tr_b16 a[248:249], v3 offset:17344
    v_fma_mix_f32 v118, v116, v67, v75 op_sel:[1,0,0] op_sel_hi:[1,0,0]
    v_mfma_f32_16x16x32_bf16 v[160:163], a[208:211], v[104:107], v[160:163]
    ds_read_b64_tr_b16 a[250:251], v3 offset:17856
    v_cvt_pk_bf16_f32 v97, v117, v118
    v_mfma_f32_16x16x32_bf16 v[164:167], a[208:211], v[108:111], v[164:167]
    ds_read_b64_tr_b16 a[252:253], v3 offset:17376
    v_accvgpr_read_b32 v112, a18
    v_mfma_f32_16x16x32_bf16 v[168:171], a[212:215], v[104:107], v[168:171]
    ds_read_b64_tr_b16 a[254:255], v3 offset:17888
    v_fma_mix_f32 v113, v112, v68, v76 op_sel:[0,0,0] op_sel_hi:[1,0,0]
    v_mfma_f32_16x16x32_bf16 v[172:175], a[212:215], v[108:111], v[172:175]
    s_barrier
    ds_read_b64_tr_b16 a[128:129], v3 offset:33792
    v_mfma_f32_16x16x32_bf16 v[176:179], a[216:219], v[104:107], v[176:179]
    ds_read_b64_tr_b16 a[130:131], v3 offset:34304
    v_fma_mix_f32 v114, v112, v69, v77 op_sel:[1,0,0] op_sel_hi:[1,0,0]
    v_mfma_f32_16x16x32_bf16 v[180:183], a[216:219], v[108:111], v[180:183]
    ds_read_b64_tr_b16 a[132:133], v3 offset:33824
    buffer_load_dwordx4 a[44:47], v51, s[20:23], s93 offen offset:3072 sc1
    s_waitcnt lgkmcnt(14)
    ds_read_b128 v[80:83], v48 offset:768
    s_waitcnt lgkmcnt(14)
    ds_read_b128 v[84:87], v48 offset:784
    s_waitcnt lgkmcnt(14)
    ds_read_b128 v[88:91], v48 offset:800
    s_waitcnt lgkmcnt(14)
    ds_read_b128 v[92:95], v48 offset:816
    v_mfma_f32_16x16x32_bf16 v[184:187], a[220:223], v[104:107], v[184:187]
    ds_read_b64_tr_b16 a[134:135], v3 offset:34336
    v_cvt_pk_bf16_f32 v98, v113, v114
    v_mfma_f32_16x16x32_bf16 v[188:191], a[220:223], v[108:111], v[188:191]
    ds_read_b64_tr_b16 a[136:137], v3 offset:33856
    s_add_u32 s93, s93, 4096
    s_waitcnt lgkmcnt(9)
    v_mfma_f32_16x16x32_bf16 v[192:195], a[224:227], v[104:107], v[192:195]
    ds_read_b64_tr_b16 a[138:139], v3 offset:34368
    v_accvgpr_read_b32 v116, a19
    v_mfma_f32_16x16x32_bf16 v[196:199], a[224:227], v[108:111], v[196:199]
    ds_read_b64_tr_b16 a[140:141], v3 offset:33888
    v_fma_mix_f32 v117, v116, v70, v78 op_sel:[0,0,0] op_sel_hi:[1,0,0]
    v_mfma_f32_16x16x32_bf16 v[200:203], a[228:231], v[104:107], v[200:203]
    ds_read_b64_tr_b16 a[142:143], v3 offset:34400
    v_fma_mix_f32 v118, v116, v71, v79 op_sel:[1,0,0] op_sel_hi:[1,0,0]
    v_mfma_f32_16x16x32_bf16 v[204:207], a[228:231], v[108:111], v[204:207]
    ds_read_b64_tr_b16 a[144:145], v3 offset:33920
    v_cvt_pk_bf16_f32 v99, v117, v118
    v_mfma_f32_16x16x32_bf16 v[208:211], a[232:235], v[104:107], v[208:211]
    ds_read_b64_tr_b16 a[146:147], v3 offset:34432
    s_waitcnt vmcnt(6)
    v_accvgpr_read_b32 v112, a20
    v_mfma_f32_16x16x32_bf16 v[212:215], a[232:235], v[108:111], v[212:215]
    ds_read_b64_tr_b16 a[148:149], v3 offset:33952
    v_fma_mix_f32 v113, v112, v64, v72 op_sel:[0,0,0] op_sel_hi:[1,0,0]
    v_mfma_f32_16x16x32_bf16 v[216:219], a[236:239], v[104:107], v[216:219]
    ds_read_b64_tr_b16 a[150:151], v3 offset:34464
    v_fma_mix_f32 v114, v112, v65, v73 op_sel:[1,0,0] op_sel_hi:[1,0,0]
    v_mfma_f32_16x16x32_bf16 v[220:223], a[236:239], v[108:111], v[220:223]
    ds_read_b64_tr_b16 a[152:153], v3 offset:33984
    v_cvt_pk_bf16_f32 v100, v113, v114
    v_mfma_f32_16x16x32_bf16 v[224:227], a[240:243], v[104:107], v[224:227]
    ds_read_b64_tr_b16 a[154:155], v3 offset:34496
    v_accvgpr_read_b32 v116, a21
    v_mfma_f32_16x16x32_bf16 v[228:231], a[240:243], v[108:111], v[228:231]
    ds_read_b64_tr_b16 a[156:157], v3 offset:34016
    v_fma_mix_f32 v117, v116, v66, v74 op_sel:[0,0,0] op_sel_hi:[1,0,0]
    v_mfma_f32_16x16x32_bf16 v[232:235], a[244:247], v[104:107], v[232:235]
    ds_read_b64_tr_b16 a[158:159], v3 offset:34528
    v_fma_mix_f32 v118, v116, v67, v75 op_sel:[1,0,0] op_sel_hi:[1,0,0]
    v_mfma_f32_16x16x32_bf16 v[236:239], a[244:247], v[108:111], v[236:239]
    ds_read_b64_tr_b16 a[160:161], v3 offset:34048
    v_cvt_pk_bf16_f32 v101, v117, v118
    v_mfma_f32_16x16x32_bf16 v[240:243], a[248:251], v[104:107], v[240:243]
    ds_read_b64_tr_b16 a[162:163], v3 offset:34560
    v_accvgpr_read_b32 v112, a22
    s_add_u32 m0, s57, 0
    v_mfma_f32_16x16x32_bf16 v[244:247], a[248:251], v[108:111], v[244:247]
    ds_read_b64_tr_b16 a[164:165], v3 offset:34080
    v_fma_mix_f32 v113, v112, v68, v76 op_sel:[0,0,0] op_sel_hi:[1,0,0]
    v_fma_mix_f32 v114, v112, v69, v77 op_sel:[1,0,0] op_sel_hi:[1,0,0]
    v_cvt_pk_bf16_f32 v102, v113, v114
    v_accvgpr_read_b32 v116, a23
    v_fma_mix_f32 v117, v116, v70, v78 op_sel:[0,0,0] op_sel_hi:[1,0,0]
    v_fma_mix_f32 v118, v116, v71, v79 op_sel:[1,0,0] op_sel_hi:[1,0,0]
    v_cvt_pk_bf16_f32 v103, v117, v118
    v_mfma_f32_16x16x32_bf16 v[248:251], a[252:255], v[104:107], v[248:251]
    ds_read_b64_tr_b16 a[166:167], v3 offset:34592
    s_mov_b32 s91, 2097152
    v_mfma_f32_16x16x32_bf16 v[252:255], a[252:255], v[108:111], v[252:255]
    ds_read_b64_tr_b16 a[168:169], v3 offset:34112
    s_waitcnt lgkmcnt(5)
    v_mfma_f32_16x16x32_bf16 v[128:131], a[128:131], v[96:99], v[128:131]
    ds_read_b64_tr_b16 a[170:171], v3 offset:34624
    s_waitcnt vmcnt(5)
    v_accvgpr_read_b32 v112, a24
    v_mfma_f32_16x16x32_bf16 v[132:135], a[128:131], v[100:103], v[132:135]
    ds_read_b64_tr_b16 a[172:173], v3 offset:34144
    v_fma_mix_f32 v113, v112, v80, v88 op_sel:[0,0,0] op_sel_hi:[1,0,0]
    v_mfma_f32_16x16x32_bf16 v[136:139], a[132:135], v[96:99], v[136:139]
    ds_read_b64_tr_b16 a[174:175], v3 offset:34656
    v_fma_mix_f32 v114, v112, v81, v89 op_sel:[1,0,0] op_sel_hi:[1,0,0]
    v_mfma_f32_16x16x32_bf16 v[140:143], a[132:135], v[100:103], v[140:143]
    ds_read_b64_tr_b16 a[176:177], v3 offset:34176
    v_cvt_pk_bf16_f32 v104, v113, v114
    v_mfma_f32_16x16x32_bf16 v[144:147], a[136:139], v[96:99], v[144:147]
    ds_read_b64_tr_b16 a[178:179], v3 offset:34688
    v_accvgpr_read_b32 v116, a25
    v_mfma_f32_16x16x32_bf16 v[148:151], a[136:139], v[100:103], v[148:151]
    ds_read_b64_tr_b16 a[180:181], v3 offset:34208
    buffer_load_dwordx4 a[48:51], v51, s[20:23], s93 offen offset:0 sc1
    v_mfma_f32_16x16x32_bf16 v[152:155], a[140:143], v[96:99], v[152:155]
    ds_read_b64_tr_b16 a[182:183], v3 offset:34720
    v_fma_mix_f32 v117, v116, v82, v90 op_sel:[0,0,0] op_sel_hi:[1,0,0]
    v_mfma_f32_16x16x32_bf16 v[156:159], a[140:143], v[100:103], v[156:159]
    ds_read_b64_tr_b16 a[184:185], v3 offset:34240
    v_fma_mix_f32 v118, v116, v83, v91 op_sel:[1,0,0] op_sel_hi:[1,0,0]
    v_mfma_f32_16x16x32_bf16 v[160:163], a[144:147], v[96:99], v[160:163]
    ds_read_b64_tr_b16 a[186:187], v3 offset:34752
    v_cvt_pk_bf16_f32 v105, v117, v118
    v_mfma_f32_16x16x32_bf16 v[164:167], a[144:147], v[100:103], v[164:167]
    ds_read_b64_tr_b16 a[188:189], v3 offset:34272
    v_accvgpr_read_b32 v112, a26
    v_mfma_f32_16x16x32_bf16 v[168:171], a[148:151], v[96:99], v[168:171]
    ds_read_b64_tr_b16 a[190:191], v3 offset:34784
    v_fma_mix_f32 v113, v112, v84, v92 op_sel:[0,0,0] op_sel_hi:[1,0,0]
    v_mfma_f32_16x16x32_bf16 v[172:175], a[148:151], v[100:103], v[172:175]
    ds_read_b64_tr_b16 a[192:193], v3 offset:50688
    v_fma_mix_f32 v114, v112, v85, v93 op_sel:[1,0,0] op_sel_hi:[1,0,0]
    v_mfma_f32_16x16x32_bf16 v[176:179], a[152:155], v[96:99], v[176:179]
    ds_read_b64_tr_b16 a[194:195], v3 offset:51200
    v_cvt_pk_bf16_f32 v106, v113, v114
    v_mfma_f32_16x16x32_bf16 v[180:183], a[152:155], v[100:103], v[180:183]
    ds_read_b64_tr_b16 a[196:197], v3 offset:50720
    buffer_load_dwordx4 a[52:55], v51, s[20:23], s93 offen offset:1024 sc1
    s_waitcnt lgkmcnt(14)
    ds_read_b128 v[64:67], v48 offset:1024
    s_waitcnt lgkmcnt(14)
    ds_read_b128 v[68:71], v48 offset:1040
    s_waitcnt lgkmcnt(14)
    ds_read_b128 v[72:75], v48 offset:1056
    s_waitcnt lgkmcnt(14)
    ds_read_b128 v[76:79], v48 offset:1072
    v_mfma_f32_16x16x32_bf16 v[184:187], a[156:159], v[96:99], v[184:187]
    ds_read_b64_tr_b16 a[198:199], v3 offset:51232
    v_accvgpr_read_b32 v116, a27
    v_mfma_f32_16x16x32_bf16 v[188:191], a[156:159], v[100:103], v[188:191]
    ds_read_b64_tr_b16 a[200:201], v3 offset:50752
    s_waitcnt lgkmcnt(9)
    v_mfma_f32_16x16x32_bf16 v[192:195], a[160:163], v[96:99], v[192:195]
    ds_read_b64_tr_b16 a[202:203], v3 offset:51264
    buffer_load_dwordx4 v22, s[12:15], s91 offen offset:0 lds
    v_mfma_f32_16x16x32_bf16 v[196:199], a[160:163], v[100:103], v[196:199]
    ds_read_b64_tr_b16 a[204:205], v3 offset:50784
    v_fma_mix_f32 v117, v116, v86, v94 op_sel:[0,0,0] op_sel_hi:[1,0,0]
    v_mfma_f32_16x16x32_bf16 v[200:203], a[164:167], v[96:99], v[200:203]
    ds_read_b64_tr_b16 a[206:207], v3 offset:51296
    v_fma_mix_f32 v118, v116, v87, v95 op_sel:[1,0,0] op_sel_hi:[1,0,0]
    v_mfma_f32_16x16x32_bf16 v[204:207], a[164:167], v[100:103], v[204:207]
    ds_read_b64_tr_b16 a[208:209], v3 offset:50816
    v_cvt_pk_bf16_f32 v107, v117, v118
    v_mfma_f32_16x16x32_bf16 v[208:211], a[168:171], v[96:99], v[208:211]
    ds_read_b64_tr_b16 a[210:211], v3 offset:51328
    s_waitcnt vmcnt(7)
    v_accvgpr_read_b32 v112, a28
    v_mfma_f32_16x16x32_bf16 v[212:215], a[168:171], v[100:103], v[212:215]
    ds_read_b64_tr_b16 a[212:213], v3 offset:50848
    v_fma_mix_f32 v113, v112, v80, v88 op_sel:[0,0,0] op_sel_hi:[1,0,0]
    v_mfma_f32_16x16x32_bf16 v[216:219], a[172:175], v[96:99], v[216:219]
    ds_read_b64_tr_b16 a[214:215], v3 offset:51360
    v_fma_mix_f32 v114, v112, v81, v89 op_sel:[1,0,0] op_sel_hi:[1,0,0]
    v_mfma_f32_16x16x32_bf16 v[220:223], a[172:175], v[100:103], v[220:223]
    ds_read_b64_tr_b16 a[216:217], v3 offset:50880
    v_cvt_pk_bf16_f32 v108, v113, v114
    v_mfma_f32_16x16x32_bf16 v[224:227], a[176:179], v[96:99], v[224:227]
    ds_read_b64_tr_b16 a[218:219], v3 offset:51392
    v_accvgpr_read_b32 v116, a29
    v_mfma_f32_16x16x32_bf16 v[228:231], a[176:179], v[100:103], v[228:231]
    ds_read_b64_tr_b16 a[220:221], v3 offset:50912
    v_fma_mix_f32 v117, v116, v82, v90 op_sel:[0,0,0] op_sel_hi:[1,0,0]
    v_mfma_f32_16x16x32_bf16 v[232:235], a[180:183], v[96:99], v[232:235]
    ds_read_b64_tr_b16 a[222:223], v3 offset:51424
    v_fma_mix_f32 v118, v116, v83, v91 op_sel:[1,0,0] op_sel_hi:[1,0,0]
    buffer_load_dwordx4 v23, s[12:15], s91 offen offset:1056 lds
    v_mfma_f32_16x16x32_bf16 v[236:239], a[180:183], v[100:103], v[236:239]
    ds_read_b64_tr_b16 a[224:225], v3 offset:50944
    v_cvt_pk_bf16_f32 v109, v117, v118
    v_mfma_f32_16x16x32_bf16 v[240:243], a[184:187], v[96:99], v[240:243]
    ds_read_b64_tr_b16 a[226:227], v3 offset:51456
    v_accvgpr_read_b32 v112, a30
    v_mfma_f32_16x16x32_bf16 v[244:247], a[184:187], v[100:103], v[244:247]
    ds_read_b64_tr_b16 a[228:229], v3 offset:50976
    v_fma_mix_f32 v113, v112, v84, v92 op_sel:[0,0,0] op_sel_hi:[1,0,0]
    v_fma_mix_f32 v114, v112, v85, v93 op_sel:[1,0,0] op_sel_hi:[1,0,0]
    v_cvt_pk_bf16_f32 v110, v113, v114
    v_accvgpr_read_b32 v116, a31
    v_fma_mix_f32 v117, v116, v86, v94 op_sel:[0,0,0] op_sel_hi:[1,0,0]
    v_fma_mix_f32 v118, v116, v87, v95 op_sel:[1,0,0] op_sel_hi:[1,0,0]
    v_cvt_pk_bf16_f32 v111, v117, v118
    v_mfma_f32_16x16x32_bf16 v[248:251], a[188:191], v[96:99], v[248:251]
    ds_read_b64_tr_b16 a[230:231], v3 offset:51488
    buffer_load_dwordx4 v24, s[12:15], s91 offen offset:2112 lds
    v_mfma_f32_16x16x32_bf16 v[252:255], a[188:191], v[100:103], v[252:255]
    ds_read_b64_tr_b16 a[232:233], v3 offset:51008
    s_waitcnt lgkmcnt(5)
    v_mfma_f32_16x16x32_bf16 v[128:131], a[192:195], v[104:107], v[128:131]
    ds_read_b64_tr_b16 a[234:235], v3 offset:51520
    s_waitcnt vmcnt(8)
    v_accvgpr_read_b32 v112, a32
    v_mfma_f32_16x16x32_bf16 v[132:135], a[192:195], v[108:111], v[132:135]
    ds_read_b64_tr_b16 a[236:237], v3 offset:51040
    v_fma_mix_f32 v113, v112, v64, v72 op_sel:[0,0,0] op_sel_hi:[1,0,0]
    v_mfma_f32_16x16x32_bf16 v[136:139], a[196:199], v[104:107], v[136:139]
    ds_read_b64_tr_b16 a[238:239], v3 offset:51552
    v_fma_mix_f32 v114, v112, v65, v73 op_sel:[1,0,0] op_sel_hi:[1,0,0]
    v_mfma_f32_16x16x32_bf16 v[140:143], a[196:199], v[108:111], v[140:143]
    ds_read_b64_tr_b16 a[240:241], v3 offset:51072
    v_cvt_pk_bf16_f32 v96, v113, v114
    v_mfma_f32_16x16x32_bf16 v[144:147], a[200:203], v[104:107], v[144:147]
    ds_read_b64_tr_b16 a[242:243], v3 offset:51584
    v_accvgpr_read_b32 v116, a33
    v_mfma_f32_16x16x32_bf16 v[148:151], a[200:203], v[108:111], v[148:151]
    ds_read_b64_tr_b16 a[244:245], v3 offset:51104
    buffer_load_dwordx4 a[56:59], v51, s[20:23], s93 offen offset:2048 sc1
    v_mfma_f32_16x16x32_bf16 v[152:155], a[204:207], v[104:107], v[152:155]
    ds_read_b64_tr_b16 a[246:247], v3 offset:51616
    v_fma_mix_f32 v117, v116, v66, v74 op_sel:[0,0,0] op_sel_hi:[1,0,0]
    v_mfma_f32_16x16x32_bf16 v[156:159], a[204:207], v[108:111], v[156:159]
    ds_read_b64_tr_b16 a[248:249], v3 offset:51136
    v_fma_mix_f32 v118, v116, v67, v75 op_sel:[1,0,0] op_sel_hi:[1,0,0]
    v_mfma_f32_16x16x32_bf16 v[160:163], a[208:211], v[104:107], v[160:163]
    ds_read_b64_tr_b16 a[250:251], v3 offset:51648
    v_cvt_pk_bf16_f32 v97, v117, v118
    v_mfma_f32_16x16x32_bf16 v[164:167], a[208:211], v[108:111], v[164:167]
    ds_read_b64_tr_b16 a[252:253], v3 offset:51168
    buffer_load_dwordx4 v25, s[12:15], s91 offen offset:3168 lds
    v_mfma_f32_16x16x32_bf16 v[168:171], a[212:215], v[104:107], v[168:171]
    ds_read_b64_tr_b16 a[254:255], v3 offset:51680
    v_accvgpr_read_b32 v112, a34
    v_mfma_f32_16x16x32_bf16 v[172:175], a[212:215], v[108:111], v[172:175]
    s_barrier
    ds_read_b64_tr_b16 a[128:129], v9 offset:0
    v_mfma_f32_16x16x32_bf16 v[176:179], a[216:219], v[104:107], v[176:179]
    ds_read_b64_tr_b16 a[130:131], v9 offset:512
    v_fma_mix_f32 v113, v112, v68, v76 op_sel:[0,0,0] op_sel_hi:[1,0,0]
    v_mfma_f32_16x16x32_bf16 v[180:183], a[216:219], v[108:111], v[180:183]
    ds_read_b64_tr_b16 a[132:133], v9 offset:32
    buffer_load_dwordx4 a[60:63], v51, s[20:23], s93 offen offset:3072 sc1
    s_waitcnt lgkmcnt(14)
    ds_read_b128 v[80:83], v48 offset:1280
    s_waitcnt lgkmcnt(14)
    ds_read_b128 v[84:87], v48 offset:1296
    s_waitcnt lgkmcnt(14)
    ds_read_b128 v[88:91], v48 offset:1312
    s_waitcnt lgkmcnt(14)
    ds_read_b128 v[92:95], v48 offset:1328
    v_mfma_f32_16x16x32_bf16 v[184:187], a[220:223], v[104:107], v[184:187]
    ds_read_b64_tr_b16 a[134:135], v9 offset:544
    v_fma_mix_f32 v114, v112, v69, v77 op_sel:[1,0,0] op_sel_hi:[1,0,0]
    v_mfma_f32_16x16x32_bf16 v[188:191], a[220:223], v[108:111], v[188:191]
    ds_read_b64_tr_b16 a[136:137], v9 offset:64
    s_add_u32 s93, s93, 4096
    s_waitcnt lgkmcnt(9)
    v_mfma_f32_16x16x32_bf16 v[192:195], a[224:227], v[104:107], v[192:195]
    ds_read_b64_tr_b16 a[138:139], v9 offset:576
    v_cvt_pk_bf16_f32 v98, v113, v114
    v_mfma_f32_16x16x32_bf16 v[196:199], a[224:227], v[108:111], v[196:199]
    ds_read_b64_tr_b16 a[140:141], v9 offset:96
    v_accvgpr_read_b32 v116, a35
    v_mfma_f32_16x16x32_bf16 v[200:203], a[228:231], v[104:107], v[200:203]
    ds_read_b64_tr_b16 a[142:143], v9 offset:608
    v_fma_mix_f32 v117, v116, v70, v78 op_sel:[0,0,0] op_sel_hi:[1,0,0]
    v_mfma_f32_16x16x32_bf16 v[204:207], a[228:231], v[108:111], v[204:207]
    ds_read_b64_tr_b16 a[144:145], v9 offset:128
    v_fma_mix_f32 v118, v116, v71, v79 op_sel:[1,0,0] op_sel_hi:[1,0,0]
    v_mfma_f32_16x16x32_bf16 v[208:211], a[232:235], v[104:107], v[208:211]
    ds_read_b64_tr_b16 a[146:147], v9 offset:640
    v_cvt_pk_bf16_f32 v99, v117, v118
    s_waitcnt vmcnt(10)
    v_accvgpr_read_b32 v112, a36
    v_mfma_f32_16x16x32_bf16 v[212:215], a[232:235], v[108:111], v[212:215]
    ds_read_b64_tr_b16 a[148:149], v9 offset:160
    v_fma_mix_f32 v113, v112, v64, v72 op_sel:[0,0,0] op_sel_hi:[1,0,0]
    v_mfma_f32_16x16x32_bf16 v[216:219], a[236:239], v[104:107], v[216:219]
    ds_read_b64_tr_b16 a[150:151], v9 offset:672
    v_fma_mix_f32 v114, v112, v65, v73 op_sel:[1,0,0] op_sel_hi:[1,0,0]
    v_mfma_f32_16x16x32_bf16 v[220:223], a[236:239], v[108:111], v[220:223]
    ds_read_b64_tr_b16 a[152:153], v9 offset:192
    v_cvt_pk_bf16_f32 v100, v113, v114
    s_add_u32 m0, s57, 16896
    v_mfma_f32_16x16x32_bf16 v[224:227], a[240:243], v[104:107], v[224:227]
    ds_read_b64_tr_b16 a[154:155], v9 offset:704
    v_accvgpr_read_b32 v116, a37
    v_mfma_f32_16x16x32_bf16 v[228:231], a[240:243], v[108:111], v[228:231]
    ds_read_b64_tr_b16 a[156:157], v9 offset:224
    v_fma_mix_f32 v117, v116, v66, v74 op_sel:[0,0,0] op_sel_hi:[1,0,0]
    v_mfma_f32_16x16x32_bf16 v[232:235], a[244:247], v[104:107], v[232:235]
    ds_read_b64_tr_b16 a[158:159], v9 offset:736
    v_fma_mix_f32 v118, v116, v67, v75 op_sel:[1,0,0] op_sel_hi:[1,0,0]
    v_mfma_f32_16x16x32_bf16 v[236:239], a[244:247], v[108:111], v[236:239]
    ds_read_b64_tr_b16 a[160:161], v9 offset:256
    v_cvt_pk_bf16_f32 v101, v117, v118
    v_mfma_f32_16x16x32_bf16 v[240:243], a[248:251], v[104:107], v[240:243]
    ds_read_b64_tr_b16 a[162:163], v9 offset:768
    v_accvgpr_read_b32 v112, a38
    s_mov_b32 s91, 2359296
    v_mfma_f32_16x16x32_bf16 v[244:247], a[248:251], v[108:111], v[244:247]
    ds_read_b64_tr_b16 a[164:165], v9 offset:288
    v_fma_mix_f32 v113, v112, v68, v76 op_sel:[0,0,0] op_sel_hi:[1,0,0]
    v_fma_mix_f32 v114, v112, v69, v77 op_sel:[1,0,0] op_sel_hi:[1,0,0]
    v_cvt_pk_bf16_f32 v102, v113, v114
    v_accvgpr_read_b32 v116, a39
    v_fma_mix_f32 v117, v116, v70, v78 op_sel:[0,0,0] op_sel_hi:[1,0,0]
    v_fma_mix_f32 v118, v116, v71, v79 op_sel:[1,0,0] op_sel_hi:[1,0,0]
    v_cvt_pk_bf16_f32 v103, v117, v118
    v_mfma_f32_16x16x32_bf16 v[248:251], a[252:255], v[104:107], v[248:251]
    ds_read_b64_tr_b16 a[166:167], v9 offset:800
    buffer_load_dwordx4 v22, s[12:15], s91 offen offset:0 lds
    v_mfma_f32_16x16x32_bf16 v[252:255], a[252:255], v[108:111], v[252:255]
    ds_read_b64_tr_b16 a[168:169], v9 offset:320
    s_waitcnt lgkmcnt(5)
    v_mfma_f32_16x16x32_bf16 v[128:131], a[128:131], v[96:99], v[128:131]
    ds_read_b64_tr_b16 a[170:171], v9 offset:832
    s_waitcnt vmcnt(10)
    v_accvgpr_read_b32 v112, a40
    v_mfma_f32_16x16x32_bf16 v[132:135], a[128:131], v[100:103], v[132:135]
    ds_read_b64_tr_b16 a[172:173], v9 offset:352
    v_fma_mix_f32 v113, v112, v80, v88 op_sel:[0,0,0] op_sel_hi:[1,0,0]
    v_mfma_f32_16x16x32_bf16 v[136:139], a[132:135], v[96:99], v[136:139]
    ds_read_b64_tr_b16 a[174:175], v9 offset:864
    v_fma_mix_f32 v114, v112, v81, v89 op_sel:[1,0,0] op_sel_hi:[1,0,0]
    v_mfma_f32_16x16x32_bf16 v[140:143], a[132:135], v[100:103], v[140:143]
    ds_read_b64_tr_b16 a[176:177], v9 offset:384
    v_cvt_pk_bf16_f32 v104, v113, v114
    v_mfma_f32_16x16x32_bf16 v[144:147], a[136:139], v[96:99], v[144:147]
    ds_read_b64_tr_b16 a[178:179], v9 offset:896
    v_accvgpr_read_b32 v116, a41
    v_mfma_f32_16x16x32_bf16 v[148:151], a[136:139], v[100:103], v[148:151]
    ds_read_b64_tr_b16 a[180:181], v9 offset:416
    buffer_load_dwordx4 a[64:67], v51, s[20:23], s93 offen offset:0 sc1
    v_mfma_f32_16x16x32_bf16 v[152:155], a[140:143], v[96:99], v[152:155]
    ds_read_b64_tr_b16 a[182:183], v9 offset:928
    buffer_load_dwordx4 v23, s[12:15], s91 offen offset:1056 lds
    v_mfma_f32_16x16x32_bf16 v[156:159], a[140:143], v[100:103], v[156:159]
    ds_read_b64_tr_b16 a[184:185], v9 offset:448
    v_fma_mix_f32 v117, v116, v82, v90 op_sel:[0,0,0] op_sel_hi:[1,0,0]
    v_mfma_f32_16x16x32_bf16 v[160:163], a[144:147], v[96:99], v[160:163]
    ds_read_b64_tr_b16 a[186:187], v9 offset:960
    v_fma_mix_f32 v118, v116, v83, v91 op_sel:[1,0,0] op_sel_hi:[1,0,0]
    v_mfma_f32_16x16x32_bf16 v[164:167], a[144:147], v[100:103], v[164:167]
    ds_read_b64_tr_b16 a[188:189], v9 offset:480
    v_cvt_pk_bf16_f32 v105, v117, v118
    v_mfma_f32_16x16x32_bf16 v[168:171], a[148:151], v[96:99], v[168:171]
    ds_read_b64_tr_b16 a[190:191], v9 offset:992
    v_accvgpr_read_b32 v112, a42
    v_mfma_f32_16x16x32_bf16 v[172:175], a[148:151], v[100:103], v[172:175]
    ds_read_b64_tr_b16 a[192:193], v9 offset:16896
    buffer_load_dwordx4 v24, s[12:15], s91 offen offset:2112 lds
    v_mfma_f32_16x16x32_bf16 v[176:179], a[152:155], v[96:99], v[176:179]
    ds_read_b64_tr_b16 a[194:195], v9 offset:17408
    v_fma_mix_f32 v113, v112, v84, v92 op_sel:[0,0,0] op_sel_hi:[1,0,0]
    v_mfma_f32_16x16x32_bf16 v[180:183], a[152:155], v[100:103], v[180:183]
    ds_read_b64_tr_b16 a[196:197], v9 offset:16928
    buffer_load_dwordx4 a[68:71], v51, s[20:23], s93 offen offset:1024 sc1
    s_waitcnt lgkmcnt(14)
    ds_read_b128 v[64:67], v48 offset:1536
    s_waitcnt lgkmcnt(14)
    ds_read_b128 v[68:71], v48 offset:1552
    s_waitcnt lgkmcnt(14)
    ds_read_b128 v[72:75], v48 offset:1568
    s_waitcnt lgkmcnt(14)
    ds_read_b128 v[76:79], v48 offset:1584
    v_mfma_f32_16x16x32_bf16 v[184:187], a[156:159], v[96:99], v[184:187]
    ds_read_b64_tr_b16 a[198:199], v9 offset:17440
    v_fma_mix_f32 v114, v112, v85, v93 op_sel:[1,0,0] op_sel_hi:[1,0,0]
    v_mfma_f32_16x16x32_bf16 v[188:191], a[156:159], v[100:103], v[188:191]
    ds_read_b64_tr_b16 a[200:201], v9 offset:16960
    s_waitcnt lgkmcnt(9)
    v_mfma_f32_16x16x32_bf16 v[192:195], a[160:163], v[96:99], v[192:195]
    ds_read_b64_tr_b16 a[202:203], v9 offset:17472
    v_cvt_pk_bf16_f32 v106, v113, v114
    buffer_load_dwordx4 v25, s[12:15], s91 offen offset:3168 lds
    v_mfma_f32_16x16x32_bf16 v[196:199], a[160:163], v[100:103], v[196:199]
    ds_read_b64_tr_b16 a[204:205], v9 offset:16992
    v_accvgpr_read_b32 v116, a43
    v_mfma_f32_16x16x32_bf16 v[200:203], a[164:167], v[96:99], v[200:203]
    ds_read_b64_tr_b16 a[206:207], v9 offset:17504
    v_fma_mix_f32 v117, v116, v86, v94 op_sel:[0,0,0] op_sel_hi:[1,0,0]
    v_mfma_f32_16x16x32_bf16 v[204:207], a[164:167], v[100:103], v[204:207]
    ds_read_b64_tr_b16 a[208:209], v9 offset:17024
    v_fma_mix_f32 v118, v116, v87, v95 op_sel:[1,0,0] op_sel_hi:[1,0,0]
    v_mfma_f32_16x16x32_bf16 v[208:211], a[168:171], v[96:99], v[208:211]
    ds_read_b64_tr_b16 a[210:211], v9 offset:17536
    v_cvt_pk_bf16_f32 v107, v117, v118
    s_waitcnt vmcnt(14)
    v_accvgpr_read_b32 v112, a44
    v_mfma_f32_16x16x32_bf16 v[212:215], a[168:171], v[100:103], v[212:215]
    ds_read_b64_tr_b16 a[212:213], v9 offset:17056
    v_fma_mix_f32 v113, v112, v80, v88 op_sel:[0,0,0] op_sel_hi:[1,0,0]
    s_add_u32 m0, s57, 33792
    v_mfma_f32_16x16x32_bf16 v[216:219], a[172:175], v[96:99], v[216:219]
    ds_read_b64_tr_b16 a[214:215], v9 offset:17568
    v_fma_mix_f32 v114, v112, v81, v89 op_sel:[1,0,0] op_sel_hi:[1,0,0]
    v_mfma_f32_16x16x32_bf16 v[220:223], a[172:175], v[100:103], v[220:223]
    ds_read_b64_tr_b16 a[216:217], v9 offset:17088
    v_cvt_pk_bf16_f32 v108, v113, v114
    v_mfma_f32_16x16x32_bf16 v[224:227], a[176:179], v[96:99], v[224:227]
    ds_read_b64_tr_b16 a[218:219], v9 offset:17600
    v_accvgpr_read_b32 v116, a45
    v_mfma_f32_16x16x32_bf16 v[228:231], a[176:179], v[100:103], v[228:231]
    ds_read_b64_tr_b16 a[220:221], v9 offset:17120
    v_fma_mix_f32 v117, v116, v82, v90 op_sel:[0,0,0] op_sel_hi:[1,0,0]
    v_mfma_f32_16x16x32_bf16 v[232:235], a[180:183], v[96:99], v[232:235]
    ds_read_b64_tr_b16 a[222:223], v9 offset:17632
    v_fma_mix_f32 v118, v116, v83, v91 op_sel:[1,0,0] op_sel_hi:[1,0,0]
    s_mov_b32 s91, 2621440
    v_mfma_f32_16x16x32_bf16 v[236:239], a[180:183], v[100:103], v[236:239]
    ds_read_b64_tr_b16 a[224:225], v9 offset:17152
    v_cvt_pk_bf16_f32 v109, v117, v118
    v_mfma_f32_16x16x32_bf16 v[240:243], a[184:187], v[96:99], v[240:243]
    ds_read_b64_tr_b16 a[226:227], v9 offset:17664
    v_accvgpr_read_b32 v112, a46
    v_mfma_f32_16x16x32_bf16 v[244:247], a[184:187], v[100:103], v[244:247]
    ds_read_b64_tr_b16 a[228:229], v9 offset:17184
    v_fma_mix_f32 v113, v112, v84, v92 op_sel:[0,0,0] op_sel_hi:[1,0,0]
    v_fma_mix_f32 v114, v112, v85, v93 op_sel:[1,0,0] op_sel_hi:[1,0,0]
    v_cvt_pk_bf16_f32 v110, v113, v114
    v_accvgpr_read_b32 v116, a47
    v_fma_mix_f32 v117, v116, v86, v94 op_sel:[0,0,0] op_sel_hi:[1,0,0]
    v_fma_mix_f32 v118, v116, v87, v95 op_sel:[1,0,0] op_sel_hi:[1,0,0]
    v_cvt_pk_bf16_f32 v111, v117, v118
    v_mfma_f32_16x16x32_bf16 v[248:251], a[188:191], v[96:99], v[248:251]
    ds_read_b64_tr_b16 a[230:231], v9 offset:17696
    buffer_load_dwordx4 v22, s[12:15], s91 offen offset:0 lds
    v_mfma_f32_16x16x32_bf16 v[252:255], a[188:191], v[100:103], v[252:255]
    ds_read_b64_tr_b16 a[232:233], v9 offset:17216
    s_waitcnt lgkmcnt(5)
    v_mfma_f32_16x16x32_bf16 v[128:131], a[192:195], v[104:107], v[128:131]
    ds_read_b64_tr_b16 a[234:235], v9 offset:17728
    s_waitcnt vmcnt(14)
    v_accvgpr_read_b32 v112, a48
    v_mfma_f32_16x16x32_bf16 v[132:135], a[192:195], v[108:111], v[132:135]
    ds_read_b64_tr_b16 a[236:237], v9 offset:17248
    v_fma_mix_f32 v113, v112, v64, v72 op_sel:[0,0,0] op_sel_hi:[1,0,0]
    v_mfma_f32_16x16x32_bf16 v[136:139], a[196:199], v[104:107], v[136:139]
    ds_read_b64_tr_b16 a[238:239], v9 offset:17760
    v_fma_mix_f32 v114, v112, v65, v73 op_sel:[1,0,0] op_sel_hi:[1,0,0]
    v_mfma_f32_16x16x32_bf16 v[140:143], a[196:199], v[108:111], v[140:143]
    ds_read_b64_tr_b16 a[240:241], v9 offset:17280
    v_cvt_pk_bf16_f32 v96, v113, v114
    v_mfma_f32_16x16x32_bf16 v[144:147], a[200:203], v[104:107], v[144:147]
    ds_read_b64_tr_b16 a[242:243], v9 offset:17792
    buffer_load_dwordx4 v23, s[12:15], s91 offen offset:1056 lds
    v_mfma_f32_16x16x32_bf16 v[148:151], a[200:203], v[108:111], v[148:151]
    ds_read_b64_tr_b16 a[244:245], v9 offset:17312
    buffer_load_dwordx4 a[72:75], v51, s[20:23], s93 offen offset:2048 sc1
    v_mfma_f32_16x16x32_bf16 v[152:155], a[204:207], v[104:107], v[152:155]
    ds_read_b64_tr_b16 a[246:247], v9 offset:17824
    v_accvgpr_read_b32 v116, a49
    v_mfma_f32_16x16x32_bf16 v[156:159], a[204:207], v[108:111], v[156:159]
    ds_read_b64_tr_b16 a[248:249], v9 offset:17344
    v_fma_mix_f32 v117, v116, v66, v74 op_sel:[0,0,0] op_sel_hi:[1,0,0]
    v_mfma_f32_16x16x32_bf16 v[160:163], a[208:211], v[104:107], v[160:163]
    ds_read_b64_tr_b16 a[250:251], v9 offset:17856
    v_fma_mix_f32 v118, v116, v67, v75 op_sel:[1,0,0] op_sel_hi:[1,0,0]
    v_mfma_f32_16x16x32_bf16 v[164:167], a[208:211], v[108:111], v[164:167]
    ds_read_b64_tr_b16 a[252:253], v9 offset:17376
    buffer_load_dwordx4 v24, s[12:15], s91 offen offset:2112 lds
    buffer_load_dwordx4 v25, s[12:15], s91 offen offset:3168 lds
    v_mfma_f32_16x16x32_bf16 v[168:171], a[212:215], v[104:107], v[168:171]
    ds_read_b64_tr_b16 a[254:255], v9 offset:17888
    v_cvt_pk_bf16_f32 v97, v117, v118
    v_mfma_f32_16x16x32_bf16 v[172:175], a[212:215], v[108:111], v[172:175]
    s_barrier
    ds_read_b64_tr_b16 a[128:129], v9 offset:33792
    v_mfma_f32_16x16x32_bf16 v[176:179], a[216:219], v[104:107], v[176:179]
    ds_read_b64_tr_b16 a[130:131], v9 offset:34304
    v_accvgpr_read_b32 v112, a50
    v_mfma_f32_16x16x32_bf16 v[180:183], a[216:219], v[108:111], v[180:183]
    ds_read_b64_tr_b16 a[132:133], v9 offset:33824
    buffer_load_dwordx4 a[76:79], v51, s[20:23], s93 offen offset:3072 sc1
    s_waitcnt lgkmcnt(14)
    ds_read_b128 v[80:83], v48 offset:1792
    s_waitcnt lgkmcnt(14)
    ds_read_b128 v[84:87], v48 offset:1808
    s_waitcnt lgkmcnt(14)
    ds_read_b128 v[88:91], v48 offset:1824
    s_waitcnt lgkmcnt(14)
    ds_read_b128 v[92:95], v48 offset:1840
    v_mfma_f32_16x16x32_bf16 v[184:187], a[220:223], v[104:107], v[184:187]
    ds_read_b64_tr_b16 a[134:135], v9 offset:34336
    v_fma_mix_f32 v113, v112, v68, v76 op_sel:[0,0,0] op_sel_hi:[1,0,0]
    v_mfma_f32_16x16x32_bf16 v[188:191], a[220:223], v[108:111], v[188:191]
    ds_read_b64_tr_b16 a[136:137], v9 offset:33856
    s_add_u32 s93, s93, 4096
    v_fma_mix_f32 v114, v112, v69, v77 op_sel:[1,0,0] op_sel_hi:[1,0,0]
    s_waitcnt lgkmcnt(9)
    v_mfma_f32_16x16x32_bf16 v[192:195], a[224:227], v[104:107], v[192:195]
    ds_read_b64_tr_b16 a[138:139], v9 offset:34368
    v_cvt_pk_bf16_f32 v98, v113, v114
    v_mfma_f32_16x16x32_bf16 v[196:199], a[224:227], v[108:111], v[196:199]
    ds_read_b64_tr_b16 a[140:141], v9 offset:33888
    v_accvgpr_read_b32 v116, a51
    v_mfma_f32_16x16x32_bf16 v[200:203], a[228:231], v[104:107], v[200:203]
    ds_read_b64_tr_b16 a[142:143], v9 offset:34400
    v_fma_mix_f32 v117, v116, v70, v78 op_sel:[0,0,0] op_sel_hi:[1,0,0]
    v_mfma_f32_16x16x32_bf16 v[204:207], a[228:231], v[108:111], v[204:207]
    ds_read_b64_tr_b16 a[144:145], v9 offset:33920
    v_fma_mix_f32 v118, v116, v71, v79 op_sel:[1,0,0] op_sel_hi:[1,0,0]
    v_mfma_f32_16x16x32_bf16 v[208:211], a[232:235], v[104:107], v[208:211]
    ds_read_b64_tr_b16 a[146:147], v9 offset:34432
    v_cvt_pk_bf16_f32 v99, v117, v118
    s_waitcnt vmcnt(18)
    v_accvgpr_read_b32 v112, a52
    v_mfma_f32_16x16x32_bf16 v[212:215], a[232:235], v[108:111], v[212:215]
    ds_read_b64_tr_b16 a[148:149], v9 offset:33952
    v_fma_mix_f32 v113, v112, v64, v72 op_sel:[0,0,0] op_sel_hi:[1,0,0]
    v_mfma_f32_16x16x32_bf16 v[216:219], a[236:239], v[104:107], v[216:219]
    ds_read_b64_tr_b16 a[150:151], v9 offset:34464
    v_fma_mix_f32 v114, v112, v65, v73 op_sel:[1,0,0] op_sel_hi:[1,0,0]
    v_mfma_f32_16x16x32_bf16 v[220:223], a[236:239], v[108:111], v[220:223]
    ds_read_b64_tr_b16 a[152:153], v9 offset:33984
    v_cvt_pk_bf16_f32 v100, v113, v114
    s_add_u32 m0, s57, 50688
    v_mfma_f32_16x16x32_bf16 v[224:227], a[240:243], v[104:107], v[224:227]
    ds_read_b64_tr_b16 a[154:155], v9 offset:34496
    v_accvgpr_read_b32 v116, a53
    v_mfma_f32_16x16x32_bf16 v[228:231], a[240:243], v[108:111], v[228:231]
    ds_read_b64_tr_b16 a[156:157], v9 offset:34016
    v_fma_mix_f32 v117, v116, v66, v74 op_sel:[0,0,0] op_sel_hi:[1,0,0]
    v_mfma_f32_16x16x32_bf16 v[232:235], a[244:247], v[104:107], v[232:235]
    ds_read_b64_tr_b16 a[158:159], v9 offset:34528
    v_fma_mix_f32 v118, v116, v67, v75 op_sel:[1,0,0] op_sel_hi:[1,0,0]
    v_mfma_f32_16x16x32_bf16 v[236:239], a[244:247], v[108:111], v[236:239]
    ds_read_b64_tr_b16 a[160:161], v9 offset:34048
    v_cvt_pk_bf16_f32 v101, v117, v118
    v_mfma_f32_16x16x32_bf16 v[240:243], a[248:251], v[104:107], v[240:243]
    ds_read_b64_tr_b16 a[162:163], v9 offset:34560
    v_accvgpr_read_b32 v112, a54
    s_mov_b32 s91, 2883584
    v_mfma_f32_16x16x32_bf16 v[244:247], a[248:251], v[108:111], v[244:247]
    ds_read_b64_tr_b16 a[164:165], v9 offset:34080
    v_fma_mix_f32 v113, v112, v68, v76 op_sel:[0,0,0] op_sel_hi:[1,0,0]
    v_fma_mix_f32 v114, v112, v69, v77 op_sel:[1,0,0] op_sel_hi:[1,0,0]
    v_cvt_pk_bf16_f32 v102, v113, v114
    v_accvgpr_read_b32 v116, a55
    v_fma_mix_f32 v117, v116, v70, v78 op_sel:[0,0,0] op_sel_hi:[1,0,0]
    v_fma_mix_f32 v118, v116, v71, v79 op_sel:[1,0,0] op_sel_hi:[1,0,0]
    v_cvt_pk_bf16_f32 v103, v117, v118
    v_mfma_f32_16x16x32_bf16 v[248:251], a[252:255], v[104:107], v[248:251]
    ds_read_b64_tr_b16 a[166:167], v9 offset:34592
    buffer_load_dwordx4 v22, s[12:15], s91 offen offset:0 lds
    v_mfma_f32_16x16x32_bf16 v[252:255], a[252:255], v[108:111], v[252:255]
    ds_read_b64_tr_b16 a[168:169], v9 offset:34112
    s_waitcnt lgkmcnt(5)
    v_mfma_f32_16x16x32_bf16 v[128:131], a[128:131], v[96:99], v[128:131]
    ds_read_b64_tr_b16 a[170:171], v9 offset:34624
    s_waitcnt vmcnt(15)
    v_accvgpr_read_b32 v112, a56
    v_mfma_f32_16x16x32_bf16 v[132:135], a[128:131], v[100:103], v[132:135]
    ds_read_b64_tr_b16 a[172:173], v9 offset:34144
    v_fma_mix_f32 v113, v112, v80, v88 op_sel:[0,0,0] op_sel_hi:[1,0,0]
    v_mfma_f32_16x16x32_bf16 v[136:139], a[132:135], v[96:99], v[136:139]
    ds_read_b64_tr_b16 a[174:175], v9 offset:34656
    v_fma_mix_f32 v114, v112, v81, v89 op_sel:[1,0,0] op_sel_hi:[1,0,0]
    v_mfma_f32_16x16x32_bf16 v[140:143], a[132:135], v[100:103], v[140:143]
    ds_read_b64_tr_b16 a[176:177], v9 offset:34176
    v_cvt_pk_bf16_f32 v104, v113, v114
    v_mfma_f32_16x16x32_bf16 v[144:147], a[136:139], v[96:99], v[144:147]
    ds_read_b64_tr_b16 a[178:179], v9 offset:34688
    v_accvgpr_read_b32 v116, a57
    v_mfma_f32_16x16x32_bf16 v[148:151], a[136:139], v[100:103], v[148:151]
    ds_read_b64_tr_b16 a[180:181], v9 offset:34208
    buffer_load_dwordx4 a[80:83], v51, s[20:23], s93 offen offset:0 sc1
    v_mfma_f32_16x16x32_bf16 v[152:155], a[140:143], v[96:99], v[152:155]
    ds_read_b64_tr_b16 a[182:183], v9 offset:34720
    buffer_load_dwordx4 v23, s[12:15], s91 offen offset:1056 lds
    v_mfma_f32_16x16x32_bf16 v[156:159], a[140:143], v[100:103], v[156:159]
    ds_read_b64_tr_b16 a[184:185], v9 offset:34240
    v_fma_mix_f32 v117, v116, v82, v90 op_sel:[0,0,0] op_sel_hi:[1,0,0]
    v_mfma_f32_16x16x32_bf16 v[160:163], a[144:147], v[96:99], v[160:163]
    ds_read_b64_tr_b16 a[186:187], v9 offset:34752
    v_fma_mix_f32 v118, v116, v83, v91 op_sel:[1,0,0] op_sel_hi:[1,0,0]
    v_mfma_f32_16x16x32_bf16 v[164:167], a[144:147], v[100:103], v[164:167]
    ds_read_b64_tr_b16 a[188:189], v9 offset:34272
    v_cvt_pk_bf16_f32 v105, v117, v118
    v_mfma_f32_16x16x32_bf16 v[168:171], a[148:151], v[96:99], v[168:171]
    ds_read_b64_tr_b16 a[190:191], v9 offset:34784
    v_accvgpr_read_b32 v112, a58
    v_mfma_f32_16x16x32_bf16 v[172:175], a[148:151], v[100:103], v[172:175]
    ds_read_b64_tr_b16 a[192:193], v9 offset:50688
    buffer_load_dwordx4 v24, s[12:15], s91 offen offset:2112 lds
    v_mfma_f32_16x16x32_bf16 v[176:179], a[152:155], v[96:99], v[176:179]
    ds_read_b64_tr_b16 a[194:195], v9 offset:51200
    v_fma_mix_f32 v113, v112, v84, v92 op_sel:[0,0,0] op_sel_hi:[1,0,0]
    v_mfma_f32_16x16x32_bf16 v[180:183], a[152:155], v[100:103], v[180:183]
    ds_read_b64_tr_b16 a[196:197], v9 offset:50720
    buffer_load_dwordx4 a[84:87], v51, s[20:23], s93 offen offset:1024 sc1
    s_waitcnt lgkmcnt(14)
    ds_read_b128 v[64:67], v48 offset:2048
    s_waitcnt lgkmcnt(14)
    ds_read_b128 v[68:71], v48 offset:2064
    s_waitcnt lgkmcnt(14)
    ds_read_b128 v[72:75], v48 offset:2080
    s_waitcnt lgkmcnt(14)
    ds_read_b128 v[76:79], v48 offset:2096
    v_mfma_f32_16x16x32_bf16 v[184:187], a[156:159], v[96:99], v[184:187]
    ds_read_b64_tr_b16 a[198:199], v9 offset:51232
    v_fma_mix_f32 v114, v112, v85, v93 op_sel:[1,0,0] op_sel_hi:[1,0,0]
    v_mfma_f32_16x16x32_bf16 v[188:191], a[156:159], v[100:103], v[188:191]
    ds_read_b64_tr_b16 a[200:201], v9 offset:50752
    s_waitcnt lgkmcnt(9)
    v_mfma_f32_16x16x32_bf16 v[192:195], a[160:163], v[96:99], v[192:195]
    ds_read_b64_tr_b16 a[202:203], v9 offset:51264
    v_cvt_pk_bf16_f32 v106, v113, v114
    buffer_load_dwordx4 v25, s[12:15], s91 offen offset:3168 lds
    v_mfma_f32_16x16x32_bf16 v[196:199], a[160:163], v[100:103], v[196:199]
    ds_read_b64_tr_b16 a[204:205], v9 offset:50784
    v_accvgpr_read_b32 v116, a59
    v_mfma_f32_16x16x32_bf16 v[200:203], a[164:167], v[96:99], v[200:203]
    ds_read_b64_tr_b16 a[206:207], v9 offset:51296
    v_fma_mix_f32 v117, v116, v86, v94 op_sel:[0,0,0] op_sel_hi:[1,0,0]
    v_mfma_f32_16x16x32_bf16 v[204:207], a[164:167], v[100:103], v[204:207]
    ds_read_b64_tr_b16 a[208:209], v9 offset:50816
    v_fma_mix_f32 v118, v116, v87, v95 op_sel:[1,0,0] op_sel_hi:[1,0,0]
    v_mfma_f32_16x16x32_bf16 v[208:211], a[168:171], v[96:99], v[208:211]
    ds_read_b64_tr_b16 a[210:211], v9 offset:51328
    v_cvt_pk_bf16_f32 v107, v117, v118
    s_waitcnt vmcnt(18)
    v_accvgpr_read_b32 v112, a60
    v_mfma_f32_16x16x32_bf16 v[212:215], a[168:171], v[100:103], v[212:215]
    ds_read_b64_tr_b16 a[212:213], v9 offset:50848
    v_fma_mix_f32 v113, v112, v80, v88 op_sel:[0,0,0] op_sel_hi:[1,0,0]
    s_add_u32 m0, s57, 67584
    v_mfma_f32_16x16x32_bf16 v[216:219], a[172:175], v[96:99], v[216:219]
    ds_read_b64_tr_b16 a[214:215], v9 offset:51360
    v_fma_mix_f32 v114, v112, v81, v89 op_sel:[1,0,0] op_sel_hi:[1,0,0]
    v_mfma_f32_16x16x32_bf16 v[220:223], a[172:175], v[100:103], v[220:223]
    ds_read_b64_tr_b16 a[216:217], v9 offset:50880
    v_cvt_pk_bf16_f32 v108, v113, v114
    v_mfma_f32_16x16x32_bf16 v[224:227], a[176:179], v[96:99], v[224:227]
    ds_read_b64_tr_b16 a[218:219], v9 offset:51392
    v_accvgpr_read_b32 v116, a61
    v_mfma_f32_16x16x32_bf16 v[228:231], a[176:179], v[100:103], v[228:231]
    ds_read_b64_tr_b16 a[220:221], v9 offset:50912
    v_fma_mix_f32 v117, v116, v82, v90 op_sel:[0,0,0] op_sel_hi:[1,0,0]
    v_mfma_f32_16x16x32_bf16 v[232:235], a[180:183], v[96:99], v[232:235]
    ds_read_b64_tr_b16 a[222:223], v9 offset:51424
    v_fma_mix_f32 v118, v116, v83, v91 op_sel:[1,0,0] op_sel_hi:[1,0,0]
    s_mov_b32 s91, 3145728
    v_mfma_f32_16x16x32_bf16 v[236:239], a[180:183], v[100:103], v[236:239]
    ds_read_b64_tr_b16 a[224:225], v9 offset:50944
    v_cvt_pk_bf16_f32 v109, v117, v118
    v_mfma_f32_16x16x32_bf16 v[240:243], a[184:187], v[96:99], v[240:243]
    ds_read_b64_tr_b16 a[226:227], v9 offset:51456
    v_accvgpr_read_b32 v112, a62
    v_mfma_f32_16x16x32_bf16 v[244:247], a[184:187], v[100:103], v[244:247]
    ds_read_b64_tr_b16 a[228:229], v9 offset:50976
    v_fma_mix_f32 v113, v112, v84, v92 op_sel:[0,0,0] op_sel_hi:[1,0,0]
    v_fma_mix_f32 v114, v112, v85, v93 op_sel:[1,0,0] op_sel_hi:[1,0,0]
    v_cvt_pk_bf16_f32 v110, v113, v114
    v_accvgpr_read_b32 v116, a63
    v_fma_mix_f32 v117, v116, v86, v94 op_sel:[0,0,0] op_sel_hi:[1,0,0]
    v_fma_mix_f32 v118, v116, v87, v95 op_sel:[1,0,0] op_sel_hi:[1,0,0]
    v_cvt_pk_bf16_f32 v111, v117, v118
    v_mfma_f32_16x16x32_bf16 v[248:251], a[188:191], v[96:99], v[248:251]
    ds_read_b64_tr_b16 a[230:231], v9 offset:51488
    buffer_load_dwordx4 v22, s[12:15], s91 offen offset:0 lds
    v_mfma_f32_16x16x32_bf16 v[252:255], a[188:191], v[100:103], v[252:255]
    ds_read_b64_tr_b16 a[232:233], v9 offset:51008
    s_waitcnt lgkmcnt(5)
    v_mfma_f32_16x16x32_bf16 v[128:131], a[192:195], v[104:107], v[128:131]
    ds_read_b64_tr_b16 a[234:235], v9 offset:51520
    s_waitcnt vmcnt(17)
    v_accvgpr_read_b32 v112, a64
    v_mfma_f32_16x16x32_bf16 v[132:135], a[192:195], v[108:111], v[132:135]
    ds_read_b64_tr_b16 a[236:237], v9 offset:51040
    v_fma_mix_f32 v113, v112, v64, v72 op_sel:[0,0,0] op_sel_hi:[1,0,0]
    v_mfma_f32_16x16x32_bf16 v[136:139], a[196:199], v[104:107], v[136:139]
    ds_read_b64_tr_b16 a[238:239], v9 offset:51552
    v_fma_mix_f32 v114, v112, v65, v73 op_sel:[1,0,0] op_sel_hi:[1,0,0]
    v_mfma_f32_16x16x32_bf16 v[140:143], a[196:199], v[108:111], v[140:143]
    ds_read_b64_tr_b16 a[240:241], v9 offset:51072
    v_cvt_pk_bf16_f32 v96, v113, v114
    v_mfma_f32_16x16x32_bf16 v[144:147], a[200:203], v[104:107], v[144:147]
    ds_read_b64_tr_b16 a[242:243], v9 offset:51584
    buffer_load_dwordx4 v23, s[12:15], s91 offen offset:1056 lds
    v_mfma_f32_16x16x32_bf16 v[148:151], a[200:203], v[108:111], v[148:151]
    ds_read_b64_tr_b16 a[244:245], v9 offset:51104
    buffer_load_dwordx4 a[88:91], v51, s[20:23], s93 offen offset:2048 sc1
    v_mfma_f32_16x16x32_bf16 v[152:155], a[204:207], v[104:107], v[152:155]
    ds_read_b64_tr_b16 a[246:247], v9 offset:51616
    v_accvgpr_read_b32 v116, a65
    v_mfma_f32_16x16x32_bf16 v[156:159], a[204:207], v[108:111], v[156:159]
    ds_read_b64_tr_b16 a[248:249], v9 offset:51136
    v_fma_mix_f32 v117, v116, v66, v74 op_sel:[0,0,0] op_sel_hi:[1,0,0]
    v_mfma_f32_16x16x32_bf16 v[160:163], a[208:211], v[104:107], v[160:163]
    ds_read_b64_tr_b16 a[250:251], v9 offset:51648
    v_fma_mix_f32 v118, v116, v67, v75 op_sel:[1,0,0] op_sel_hi:[1,0,0]
    v_mfma_f32_16x16x32_bf16 v[164:167], a[208:211], v[108:111], v[164:167]
    ds_read_b64_tr_b16 a[252:253], v9 offset:51168
    buffer_load_dwordx4 v24, s[12:15], s91 offen offset:2112 lds
    buffer_load_dwordx4 v25, s[12:15], s91 offen offset:3168 lds
    v_mfma_f32_16x16x32_bf16 v[168:171], a[212:215], v[104:107], v[168:171]
    ds_read_b64_tr_b16 a[254:255], v9 offset:51680
    v_cvt_pk_bf16_f32 v97, v117, v118
    v_mfma_f32_16x16x32_bf16 v[172:175], a[212:215], v[108:111], v[172:175]
    s_waitcnt vmcnt(17)
    s_barrier
    ds_read_b64_tr_b16 a[128:129], v3 offset:0
    v_mfma_f32_16x16x32_bf16 v[176:179], a[216:219], v[104:107], v[176:179]
    ds_read_b64_tr_b16 a[130:131], v3 offset:512
    v_accvgpr_read_b32 v112, a66
    v_mfma_f32_16x16x32_bf16 v[180:183], a[216:219], v[108:111], v[180:183]
    ds_read_b64_tr_b16 a[132:133], v3 offset:32
    buffer_load_dwordx4 a[92:95], v51, s[20:23], s93 offen offset:3072 sc1
    s_waitcnt lgkmcnt(14)
    ds_read_b128 v[80:83], v48 offset:2304
    s_waitcnt lgkmcnt(14)
    ds_read_b128 v[84:87], v48 offset:2320
    s_waitcnt lgkmcnt(14)
    ds_read_b128 v[88:91], v48 offset:2336
    s_waitcnt lgkmcnt(14)
    ds_read_b128 v[92:95], v48 offset:2352
    v_mfma_f32_16x16x32_bf16 v[184:187], a[220:223], v[104:107], v[184:187]
    ds_read_b64_tr_b16 a[134:135], v3 offset:544
    v_fma_mix_f32 v113, v112, v68, v76 op_sel:[0,0,0] op_sel_hi:[1,0,0]
    v_mfma_f32_16x16x32_bf16 v[188:191], a[220:223], v[108:111], v[188:191]
    ds_read_b64_tr_b16 a[136:137], v3 offset:64
    s_add_u32 s93, s93, 4096
    v_fma_mix_f32 v114, v112, v69, v77 op_sel:[1,0,0] op_sel_hi:[1,0,0]
    s_waitcnt lgkmcnt(9)
    v_mfma_f32_16x16x32_bf16 v[192:195], a[224:227], v[104:107], v[192:195]
    ds_read_b64_tr_b16 a[138:139], v3 offset:576
    v_cvt_pk_bf16_f32 v98, v113, v114
    v_mfma_f32_16x16x32_bf16 v[196:199], a[224:227], v[108:111], v[196:199]
    ds_read_b64_tr_b16 a[140:141], v3 offset:96
    v_accvgpr_read_b32 v116, a67
    v_mfma_f32_16x16x32_bf16 v[200:203], a[228:231], v[104:107], v[200:203]
    ds_read_b64_tr_b16 a[142:143], v3 offset:608
    v_fma_mix_f32 v117, v116, v70, v78 op_sel:[0,0,0] op_sel_hi:[1,0,0]
    v_mfma_f32_16x16x32_bf16 v[204:207], a[228:231], v[108:111], v[204:207]
    ds_read_b64_tr_b16 a[144:145], v3 offset:128
    v_fma_mix_f32 v118, v116, v71, v79 op_sel:[1,0,0] op_sel_hi:[1,0,0]
    v_mfma_f32_16x16x32_bf16 v[208:211], a[232:235], v[104:107], v[208:211]
    ds_read_b64_tr_b16 a[146:147], v3 offset:640
    v_cvt_pk_bf16_f32 v99, v117, v118
    v_accvgpr_read_b32 v112, a68
    v_mfma_f32_16x16x32_bf16 v[212:215], a[232:235], v[108:111], v[212:215]
    ds_read_b64_tr_b16 a[148:149], v3 offset:160
    v_fma_mix_f32 v113, v112, v64, v72 op_sel:[0,0,0] op_sel_hi:[1,0,0]
    v_mfma_f32_16x16x32_bf16 v[216:219], a[236:239], v[104:107], v[216:219]
    ds_read_b64_tr_b16 a[150:151], v3 offset:672
    v_fma_mix_f32 v114, v112, v65, v73 op_sel:[1,0,0] op_sel_hi:[1,0,0]
    v_mfma_f32_16x16x32_bf16 v[220:223], a[236:239], v[108:111], v[220:223]
    ds_read_b64_tr_b16 a[152:153], v3 offset:192
    v_cvt_pk_bf16_f32 v100, v113, v114
    s_add_u32 m0, s57, 84480
    v_mfma_f32_16x16x32_bf16 v[224:227], a[240:243], v[104:107], v[224:227]
    ds_read_b64_tr_b16 a[154:155], v3 offset:704
    v_accvgpr_read_b32 v116, a69
    v_mfma_f32_16x16x32_bf16 v[228:231], a[240:243], v[108:111], v[228:231]
    ds_read_b64_tr_b16 a[156:157], v3 offset:224
    v_fma_mix_f32 v117, v116, v66, v74 op_sel:[0,0,0] op_sel_hi:[1,0,0]
    v_mfma_f32_16x16x32_bf16 v[232:235], a[244:247], v[104:107], v[232:235]
    ds_read_b64_tr_b16 a[158:159], v3 offset:736
    v_fma_mix_f32 v118, v116, v67, v75 op_sel:[1,0,0] op_sel_hi:[1,0,0]
    v_mfma_f32_16x16x32_bf16 v[236:239], a[244:247], v[108:111], v[236:239]
    ds_read_b64_tr_b16 a[160:161], v3 offset:256
    v_cvt_pk_bf16_f32 v101, v117, v118
    v_mfma_f32_16x16x32_bf16 v[240:243], a[248:251], v[104:107], v[240:243]
    ds_read_b64_tr_b16 a[162:163], v3 offset:768
    v_accvgpr_read_b32 v112, a70
    s_mov_b32 s91, 3407872
    v_mfma_f32_16x16x32_bf16 v[244:247], a[248:251], v[108:111], v[244:247]
    ds_read_b64_tr_b16 a[164:165], v3 offset:288
    v_fma_mix_f32 v113, v112, v68, v76 op_sel:[0,0,0] op_sel_hi:[1,0,0]
    v_fma_mix_f32 v114, v112, v69, v77 op_sel:[1,0,0] op_sel_hi:[1,0,0]
    v_cvt_pk_bf16_f32 v102, v113, v114
    v_accvgpr_read_b32 v116, a71
    v_fma_mix_f32 v117, v116, v70, v78 op_sel:[0,0,0] op_sel_hi:[1,0,0]
    v_fma_mix_f32 v118, v116, v71, v79 op_sel:[1,0,0] op_sel_hi:[1,0,0]
    v_cvt_pk_bf16_f32 v103, v117, v118
    v_mfma_f32_16x16x32_bf16 v[248:251], a[252:255], v[104:107], v[248:251]
    ds_read_b64_tr_b16 a[166:167], v3 offset:800
    buffer_load_dwordx4 v22, s[12:15], s91 offen offset:0 lds
    v_mfma_f32_16x16x32_bf16 v[252:255], a[252:255], v[108:111], v[252:255]
    ds_read_b64_tr_b16 a[168:169], v3 offset:320
    s_waitcnt lgkmcnt(5)
    v_mfma_f32_16x16x32_bf16 v[128:131], a[128:131], v[96:99], v[128:131]
    ds_read_b64_tr_b16 a[170:171], v3 offset:832
    s_waitcnt vmcnt(16)
    v_accvgpr_read_b32 v112, a72
    v_mfma_f32_16x16x32_bf16 v[132:135], a[128:131], v[100:103], v[132:135]
    ds_read_b64_tr_b16 a[172:173], v3 offset:352
    v_fma_mix_f32 v113, v112, v80, v88 op_sel:[0,0,0] op_sel_hi:[1,0,0]
    v_mfma_f32_16x16x32_bf16 v[136:139], a[132:135], v[96:99], v[136:139]
    ds_read_b64_tr_b16 a[174:175], v3 offset:864
    v_fma_mix_f32 v114, v112, v81, v89 op_sel:[1,0,0] op_sel_hi:[1,0,0]
    v_mfma_f32_16x16x32_bf16 v[140:143], a[132:135], v[100:103], v[140:143]
    ds_read_b64_tr_b16 a[176:177], v3 offset:384
    v_cvt_pk_bf16_f32 v104, v113, v114
    v_mfma_f32_16x16x32_bf16 v[144:147], a[136:139], v[96:99], v[144:147]
    ds_read_b64_tr_b16 a[178:179], v3 offset:896
    v_accvgpr_read_b32 v116, a73
    v_mfma_f32_16x16x32_bf16 v[148:151], a[136:139], v[100:103], v[148:151]
    ds_read_b64_tr_b16 a[180:181], v3 offset:416
    buffer_load_dwordx4 a[96:99], v51, s[20:23], s93 offen offset:0 sc1
    v_mfma_f32_16x16x32_bf16 v[152:155], a[140:143], v[96:99], v[152:155]
    ds_read_b64_tr_b16 a[182:183], v3 offset:928
    buffer_load_dwordx4 v23, s[12:15], s91 offen offset:1056 lds
    v_mfma_f32_16x16x32_bf16 v[156:159], a[140:143], v[100:103], v[156:159]
    ds_read_b64_tr_b16 a[184:185], v3 offset:448
    v_fma_mix_f32 v117, v116, v82, v90 op_sel:[0,0,0] op_sel_hi:[1,0,0]
    v_mfma_f32_16x16x32_bf16 v[160:163], a[144:147], v[96:99], v[160:163]
    ds_read_b64_tr_b16 a[186:187], v3 offset:960
    v_fma_mix_f32 v118, v116, v83, v91 op_sel:[1,0,0] op_sel_hi:[1,0,0]
    v_mfma_f32_16x16x32_bf16 v[164:167], a[144:147], v[100:103], v[164:167]
    ds_read_b64_tr_b16 a[188:189], v3 offset:480
    v_cvt_pk_bf16_f32 v105, v117, v118
    v_mfma_f32_16x16x32_bf16 v[168:171], a[148:151], v[96:99], v[168:171]
    ds_read_b64_tr_b16 a[190:191], v3 offset:992
    v_accvgpr_read_b32 v112, a74
    v_mfma_f32_16x16x32_bf16 v[172:175], a[148:151], v[100:103], v[172:175]
    ds_read_b64_tr_b16 a[192:193], v3 offset:16896
    buffer_load_dwordx4 v24, s[12:15], s91 offen offset:2112 lds
    v_mfma_f32_16x16x32_bf16 v[176:179], a[152:155], v[96:99], v[176:179]
    ds_read_b64_tr_b16 a[194:195], v3 offset:17408
    v_fma_mix_f32 v113, v112, v84, v92 op_sel:[0,0,0] op_sel_hi:[1,0,0]
    v_mfma_f32_16x16x32_bf16 v[180:183], a[152:155], v[100:103], v[180:183]
    ds_read_b64_tr_b16 a[196:197], v3 offset:16928
    buffer_load_dwordx4 a[100:103], v51, s[20:23], s93 offen offset:1024 sc1
    s_waitcnt lgkmcnt(14)
    ds_read_b128 v[64:67], v48 offset:2560
    s_waitcnt lgkmcnt(14)
    ds_read_b128 v[68:71], v48 offset:2576
    s_waitcnt lgkmcnt(14)
    ds_read_b128 v[72:75], v48 offset:2592
    s_waitcnt lgkmcnt(14)
    ds_read_b128 v[76:79], v48 offset:2608
    v_mfma_f32_16x16x32_bf16 v[184:187], a[156:159], v[96:99], v[184:187]
    ds_read_b64_tr_b16 a[198:199], v3 offset:17440
    v_fma_mix_f32 v114, v112, v85, v93 op_sel:[1,0,0] op_sel_hi:[1,0,0]
    v_mfma_f32_16x16x32_bf16 v[188:191], a[156:159], v[100:103], v[188:191]
    ds_read_b64_tr_b16 a[200:201], v3 offset:16960
    s_waitcnt lgkmcnt(9)
    v_mfma_f32_16x16x32_bf16 v[192:195], a[160:163], v[96:99], v[192:195]
    ds_read_b64_tr_b16 a[202:203], v3 offset:17472
    v_cvt_pk_bf16_f32 v106, v113, v114
    buffer_load_dwordx4 v25, s[12:15], s91 offen offset:3168 lds
    v_mfma_f32_16x16x32_bf16 v[196:199], a[160:163], v[100:103], v[196:199]
    ds_read_b64_tr_b16 a[204:205], v3 offset:16992
    v_accvgpr_read_b32 v116, a75
    v_mfma_f32_16x16x32_bf16 v[200:203], a[164:167], v[96:99], v[200:203]
    ds_read_b64_tr_b16 a[206:207], v3 offset:17504
    v_fma_mix_f32 v117, v116, v86, v94 op_sel:[0,0,0] op_sel_hi:[1,0,0]
    v_mfma_f32_16x16x32_bf16 v[204:207], a[164:167], v[100:103], v[204:207]
    ds_read_b64_tr_b16 a[208:209], v3 offset:17024
    v_fma_mix_f32 v118, v116, v87, v95 op_sel:[1,0,0] op_sel_hi:[1,0,0]
    v_mfma_f32_16x16x32_bf16 v[208:211], a[168:171], v[96:99], v[208:211]
    ds_read_b64_tr_b16 a[210:211], v3 offset:17536
    v_cvt_pk_bf16_f32 v107, v117, v118
    s_waitcnt vmcnt(18)
    v_accvgpr_read_b32 v112, a76
    v_mfma_f32_16x16x32_bf16 v[212:215], a[168:171], v[100:103], v[212:215]
    ds_read_b64_tr_b16 a[212:213], v3 offset:17056
    v_fma_mix_f32 v113, v112, v80, v88 op_sel:[0,0,0] op_sel_hi:[1,0,0]
    s_add_u32 m0, s57, 101376
    v_mfma_f32_16x16x32_bf16 v[216:219], a[172:175], v[96:99], v[216:219]
    ds_read_b64_tr_b16 a[214:215], v3 offset:17568
    v_fma_mix_f32 v114, v112, v81, v89 op_sel:[1,0,0] op_sel_hi:[1,0,0]
    v_mfma_f32_16x16x32_bf16 v[220:223], a[172:175], v[100:103], v[220:223]
    ds_read_b64_tr_b16 a[216:217], v3 offset:17088
    v_cvt_pk_bf16_f32 v108, v113, v114
    v_mfma_f32_16x16x32_bf16 v[224:227], a[176:179], v[96:99], v[224:227]
    ds_read_b64_tr_b16 a[218:219], v3 offset:17600
    v_accvgpr_read_b32 v116, a77
    v_mfma_f32_16x16x32_bf16 v[228:231], a[176:179], v[100:103], v[228:231]
    ds_read_b64_tr_b16 a[220:221], v3 offset:17120
    v_fma_mix_f32 v117, v116, v82, v90 op_sel:[0,0,0] op_sel_hi:[1,0,0]
    v_mfma_f32_16x16x32_bf16 v[232:235], a[180:183], v[96:99], v[232:235]
    ds_read_b64_tr_b16 a[222:223], v3 offset:17632
    v_fma_mix_f32 v118, v116, v83, v91 op_sel:[1,0,0] op_sel_hi:[1,0,0]
    s_mov_b32 s58, 0
    v_mfma_f32_16x16x32_bf16 v[236:239], a[180:183], v[100:103], v[236:239]
    ds_read_b64_tr_b16 a[224:225], v3 offset:17152
    v_cvt_pk_bf16_f32 v109, v117, v118
    v_mfma_f32_16x16x32_bf16 v[240:243], a[184:187], v[96:99], v[240:243]
    ds_read_b64_tr_b16 a[226:227], v3 offset:17664
    v_accvgpr_read_b32 v112, a78
    v_mfma_f32_16x16x32_bf16 v[244:247], a[184:187], v[100:103], v[244:247]
    ds_read_b64_tr_b16 a[228:229], v3 offset:17184
    v_fma_mix_f32 v113, v112, v84, v92 op_sel:[0,0,0] op_sel_hi:[1,0,0]
    v_fma_mix_f32 v114, v112, v85, v93 op_sel:[1,0,0] op_sel_hi:[1,0,0]
    v_cvt_pk_bf16_f32 v110, v113, v114
    v_accvgpr_read_b32 v116, a79
    v_fma_mix_f32 v117, v116, v86, v94 op_sel:[0,0,0] op_sel_hi:[1,0,0]
    v_fma_mix_f32 v118, v116, v87, v95 op_sel:[1,0,0] op_sel_hi:[1,0,0]
    v_cvt_pk_bf16_f32 v111, v117, v118
    v_mfma_f32_16x16x32_bf16 v[248:251], a[188:191], v[96:99], v[248:251]
    ds_read_b64_tr_b16 a[230:231], v3 offset:17696
    buffer_load_dwordx4 v14, s[4:7], s58 offen offset:0 lds
    v_mfma_f32_16x16x32_bf16 v[252:255], a[188:191], v[100:103], v[252:255]
    ds_read_b64_tr_b16 a[232:233], v3 offset:17216
    s_waitcnt lgkmcnt(5)
    v_mfma_f32_16x16x32_bf16 v[128:131], a[192:195], v[104:107], v[128:131]
    ds_read_b64_tr_b16 a[234:235], v3 offset:17728
    s_waitcnt vmcnt(17)
    v_accvgpr_read_b32 v112, a80
    v_mfma_f32_16x16x32_bf16 v[132:135], a[192:195], v[108:111], v[132:135]
    ds_read_b64_tr_b16 a[236:237], v3 offset:17248
    v_fma_mix_f32 v113, v112, v64, v72 op_sel:[0,0,0] op_sel_hi:[1,0,0]
    v_mfma_f32_16x16x32_bf16 v[136:139], a[196:199], v[104:107], v[136:139]
    ds_read_b64_tr_b16 a[238:239], v3 offset:17760
    v_fma_mix_f32 v114, v112, v65, v73 op_sel:[1,0,0] op_sel_hi:[1,0,0]
    v_mfma_f32_16x16x32_bf16 v[140:143], a[196:199], v[108:111], v[140:143]
    ds_read_b64_tr_b16 a[240:241], v3 offset:17280
    v_cvt_pk_bf16_f32 v96, v113, v114
    v_mfma_f32_16x16x32_bf16 v[144:147], a[200:203], v[104:107], v[144:147]
    ds_read_b64_tr_b16 a[242:243], v3 offset:17792
    buffer_load_dwordx4 v15, s[4:7], s58 offen offset:1056 lds
    v_mfma_f32_16x16x32_bf16 v[148:151], a[200:203], v[108:111], v[148:151]
    ds_read_b64_tr_b16 a[244:245], v3 offset:17312
    buffer_load_dwordx4 a[104:107], v51, s[20:23], s93 offen offset:2048 sc1
    v_mfma_f32_16x16x32_bf16 v[152:155], a[204:207], v[104:107], v[152:155]
    ds_read_b64_tr_b16 a[246:247], v3 offset:17824
    v_accvgpr_read_b32 v116, a81
    v_mfma_f32_16x16x32_bf16 v[156:159], a[204:207], v[108:111], v[156:159]
    ds_read_b64_tr_b16 a[248:249], v3 offset:17344
    v_fma_mix_f32 v117, v116, v66, v74 op_sel:[0,0,0] op_sel_hi:[1,0,0]
    v_mfma_f32_16x16x32_bf16 v[160:163], a[208:211], v[104:107], v[160:163]
    ds_read_b64_tr_b16 a[250:251], v3 offset:17856
    v_fma_mix_f32 v118, v116, v67, v75 op_sel:[1,0,0] op_sel_hi:[1,0,0]
    v_mfma_f32_16x16x32_bf16 v[164:167], a[208:211], v[108:111], v[164:167]
    ds_read_b64_tr_b16 a[252:253], v3 offset:17376
    buffer_load_dwordx4 v16, s[4:7], s58 offen offset:2112 lds
    buffer_load_dwordx4 v17, s[4:7], s58 offen offset:3168 lds
    v_mfma_f32_16x16x32_bf16 v[168:171], a[212:215], v[104:107], v[168:171]
    ds_read_b64_tr_b16 a[254:255], v3 offset:17888
    v_cvt_pk_bf16_f32 v97, v117, v118
    v_mfma_f32_16x16x32_bf16 v[172:175], a[212:215], v[108:111], v[172:175]
    s_waitcnt vmcnt(17)
    s_barrier
    ds_read_b64_tr_b16 a[128:129], v3 offset:33792
    v_mfma_f32_16x16x32_bf16 v[176:179], a[216:219], v[104:107], v[176:179]
    ds_read_b64_tr_b16 a[130:131], v3 offset:34304
    v_accvgpr_read_b32 v112, a82
    v_mfma_f32_16x16x32_bf16 v[180:183], a[216:219], v[108:111], v[180:183]
    ds_read_b64_tr_b16 a[132:133], v3 offset:33824
    buffer_load_dwordx4 a[108:111], v51, s[20:23], s93 offen offset:3072 sc1
    s_waitcnt lgkmcnt(14)
    ds_read_b128 v[80:83], v48 offset:2816
    s_waitcnt lgkmcnt(14)
    ds_read_b128 v[84:87], v48 offset:2832
    s_waitcnt lgkmcnt(14)
    ds_read_b128 v[88:91], v48 offset:2848
    s_waitcnt lgkmcnt(14)
    ds_read_b128 v[92:95], v48 offset:2864
    v_mfma_f32_16x16x32_bf16 v[184:187], a[220:223], v[104:107], v[184:187]
    ds_read_b64_tr_b16 a[134:135], v3 offset:34336
    v_fma_mix_f32 v113, v112, v68, v76 op_sel:[0,0,0] op_sel_hi:[1,0,0]
    v_mfma_f32_16x16x32_bf16 v[188:191], a[220:223], v[108:111], v[188:191]
    ds_read_b64_tr_b16 a[136:137], v3 offset:33856
    s_add_u32 s93, s93, 4096
    v_fma_mix_f32 v114, v112, v69, v77 op_sel:[1,0,0] op_sel_hi:[1,0,0]
    s_waitcnt lgkmcnt(9)
    v_mfma_f32_16x16x32_bf16 v[192:195], a[224:227], v[104:107], v[192:195]
    ds_read_b64_tr_b16 a[138:139], v3 offset:34368
    v_cvt_pk_bf16_f32 v98, v113, v114
    v_mfma_f32_16x16x32_bf16 v[196:199], a[224:227], v[108:111], v[196:199]
    ds_read_b64_tr_b16 a[140:141], v3 offset:33888
    v_accvgpr_read_b32 v116, a83
    v_mfma_f32_16x16x32_bf16 v[200:203], a[228:231], v[104:107], v[200:203]
    ds_read_b64_tr_b16 a[142:143], v3 offset:34400
    v_fma_mix_f32 v117, v116, v70, v78 op_sel:[0,0,0] op_sel_hi:[1,0,0]
    v_mfma_f32_16x16x32_bf16 v[204:207], a[228:231], v[108:111], v[204:207]
    ds_read_b64_tr_b16 a[144:145], v3 offset:33920
    v_fma_mix_f32 v118, v116, v71, v79 op_sel:[1,0,0] op_sel_hi:[1,0,0]
    v_mfma_f32_16x16x32_bf16 v[208:211], a[232:235], v[104:107], v[208:211]
    ds_read_b64_tr_b16 a[146:147], v3 offset:34432
    v_cvt_pk_bf16_f32 v99, v117, v118
    v_accvgpr_read_b32 v112, a84
    v_mfma_f32_16x16x32_bf16 v[212:215], a[232:235], v[108:111], v[212:215]
    ds_read_b64_tr_b16 a[148:149], v3 offset:33952
    v_fma_mix_f32 v113, v112, v64, v72 op_sel:[0,0,0] op_sel_hi:[1,0,0]
    v_mfma_f32_16x16x32_bf16 v[216:219], a[236:239], v[104:107], v[216:219]
    ds_read_b64_tr_b16 a[150:151], v3 offset:34464
    v_fma_mix_f32 v114, v112, v65, v73 op_sel:[1,0,0] op_sel_hi:[1,0,0]
    v_mfma_f32_16x16x32_bf16 v[220:223], a[236:239], v[108:111], v[220:223]
    ds_read_b64_tr_b16 a[152:153], v3 offset:33984
    v_cvt_pk_bf16_f32 v100, v113, v114
    s_add_u32 m0, s57, 118272
    v_mfma_f32_16x16x32_bf16 v[224:227], a[240:243], v[104:107], v[224:227]
    ds_read_b64_tr_b16 a[154:155], v3 offset:34496
    v_accvgpr_read_b32 v116, a85
    v_mfma_f32_16x16x32_bf16 v[228:231], a[240:243], v[108:111], v[228:231]
    ds_read_b64_tr_b16 a[156:157], v3 offset:34016
    v_fma_mix_f32 v117, v116, v66, v74 op_sel:[0,0,0] op_sel_hi:[1,0,0]
    v_mfma_f32_16x16x32_bf16 v[232:235], a[244:247], v[104:107], v[232:235]
    ds_read_b64_tr_b16 a[158:159], v3 offset:34528
    v_fma_mix_f32 v118, v116, v67, v75 op_sel:[1,0,0] op_sel_hi:[1,0,0]
    v_mfma_f32_16x16x32_bf16 v[236:239], a[244:247], v[108:111], v[236:239]
    ds_read_b64_tr_b16 a[160:161], v3 offset:34048
    v_cvt_pk_bf16_f32 v101, v117, v118
    v_mfma_f32_16x16x32_bf16 v[240:243], a[248:251], v[104:107], v[240:243]
    ds_read_b64_tr_b16 a[162:163], v3 offset:34560
    v_accvgpr_read_b32 v112, a86
    s_add_u32 s58, s58, 16384
    v_mfma_f32_16x16x32_bf16 v[244:247], a[248:251], v[108:111], v[244:247]
    ds_read_b64_tr_b16 a[164:165], v3 offset:34080
    v_fma_mix_f32 v113, v112, v68, v76 op_sel:[0,0,0] op_sel_hi:[1,0,0]
    v_fma_mix_f32 v114, v112, v69, v77 op_sel:[1,0,0] op_sel_hi:[1,0,0]
    v_cvt_pk_bf16_f32 v102, v113, v114
    v_accvgpr_read_b32 v116, a87
    v_fma_mix_f32 v117, v116, v70, v78 op_sel:[0,0,0] op_sel_hi:[1,0,0]
    v_fma_mix_f32 v118, v116, v71, v79 op_sel:[1,0,0] op_sel_hi:[1,0,0]
    v_cvt_pk_bf16_f32 v103, v117, v118
    v_mfma_f32_16x16x32_bf16 v[248:251], a[252:255], v[104:107], v[248:251]
    ds_read_b64_tr_b16 a[166:167], v3 offset:34592
    buffer_load_dwordx4 v14, s[4:7], s58 offen offset:0 lds
    v_mfma_f32_16x16x32_bf16 v[252:255], a[252:255], v[108:111], v[252:255]
    ds_read_b64_tr_b16 a[168:169], v3 offset:34112
    s_waitcnt lgkmcnt(5)
    v_mfma_f32_16x16x32_bf16 v[128:131], a[128:131], v[96:99], v[128:131]
    ds_read_b64_tr_b16 a[170:171], v3 offset:34624
    s_waitcnt vmcnt(16)
    v_accvgpr_read_b32 v112, a88
    v_mfma_f32_16x16x32_bf16 v[132:135], a[128:131], v[100:103], v[132:135]
    ds_read_b64_tr_b16 a[172:173], v3 offset:34144
    v_fma_mix_f32 v113, v112, v80, v88 op_sel:[0,0,0] op_sel_hi:[1,0,0]
    v_mfma_f32_16x16x32_bf16 v[136:139], a[132:135], v[96:99], v[136:139]
    ds_read_b64_tr_b16 a[174:175], v3 offset:34656
    v_fma_mix_f32 v114, v112, v81, v89 op_sel:[1,0,0] op_sel_hi:[1,0,0]
    v_mfma_f32_16x16x32_bf16 v[140:143], a[132:135], v[100:103], v[140:143]
    ds_read_b64_tr_b16 a[176:177], v3 offset:34176
    v_cvt_pk_bf16_f32 v104, v113, v114
    v_mfma_f32_16x16x32_bf16 v[144:147], a[136:139], v[96:99], v[144:147]
    ds_read_b64_tr_b16 a[178:179], v3 offset:34688
    v_accvgpr_read_b32 v116, a89
    v_mfma_f32_16x16x32_bf16 v[148:151], a[136:139], v[100:103], v[148:151]
    ds_read_b64_tr_b16 a[180:181], v3 offset:34208
    v_fma_mix_f32 v117, v116, v82, v90 op_sel:[0,0,0] op_sel_hi:[1,0,0]
    v_mfma_f32_16x16x32_bf16 v[152:155], a[140:143], v[96:99], v[152:155]
    ds_read_b64_tr_b16 a[182:183], v3 offset:34720
    buffer_load_dwordx4 v15, s[4:7], s58 offen offset:1056 lds
    v_mfma_f32_16x16x32_bf16 v[156:159], a[140:143], v[100:103], v[156:159]
    ds_read_b64_tr_b16 a[184:185], v3 offset:34240
    v_fma_mix_f32 v118, v116, v83, v91 op_sel:[1,0,0] op_sel_hi:[1,0,0]
    v_mfma_f32_16x16x32_bf16 v[160:163], a[144:147], v[96:99], v[160:163]
    ds_read_b64_tr_b16 a[186:187], v3 offset:34752
    v_cvt_pk_bf16_f32 v105, v117, v118
    v_mfma_f32_16x16x32_bf16 v[164:167], a[144:147], v[100:103], v[164:167]
    ds_read_b64_tr_b16 a[188:189], v3 offset:34272
    v_accvgpr_read_b32 v112, a90
    v_mfma_f32_16x16x32_bf16 v[168:171], a[148:151], v[96:99], v[168:171]
    ds_read_b64_tr_b16 a[190:191], v3 offset:34784
    v_fma_mix_f32 v113, v112, v84, v92 op_sel:[0,0,0] op_sel_hi:[1,0,0]
    v_mfma_f32_16x16x32_bf16 v[172:175], a[148:151], v[100:103], v[172:175]
    ds_read_b64_tr_b16 a[192:193], v3 offset:50688
    buffer_load_dwordx4 v16, s[4:7], s58 offen offset:2112 lds
    v_mfma_f32_16x16x32_bf16 v[176:179], a[152:155], v[96:99], v[176:179]
    ds_read_b64_tr_b16 a[194:195], v3 offset:51200
    v_fma_mix_f32 v114, v112, v85, v93 op_sel:[1,0,0] op_sel_hi:[1,0,0]
    v_mfma_f32_16x16x32_bf16 v[180:183], a[152:155], v[100:103], v[180:183]
    ds_read_b64_tr_b16 a[196:197], v3 offset:50720
    s_waitcnt lgkmcnt(14)
    ds_read_b128 v[64:67], v48 offset:3072
    s_waitcnt lgkmcnt(14)
    ds_read_b128 v[68:71], v48 offset:3088
    s_waitcnt lgkmcnt(14)
    ds_read_b128 v[72:75], v48 offset:3104
    s_waitcnt lgkmcnt(14)
    ds_read_b128 v[76:79], v48 offset:3120
    v_mfma_f32_16x16x32_bf16 v[184:187], a[156:159], v[96:99], v[184:187]
    ds_read_b64_tr_b16 a[198:199], v3 offset:51232
    v_cvt_pk_bf16_f32 v106, v113, v114
    v_mfma_f32_16x16x32_bf16 v[188:191], a[156:159], v[100:103], v[188:191]
    ds_read_b64_tr_b16 a[200:201], v3 offset:50752
    s_waitcnt lgkmcnt(9)
    v_mfma_f32_16x16x32_bf16 v[192:195], a[160:163], v[96:99], v[192:195]
    ds_read_b64_tr_b16 a[202:203], v3 offset:51264
    buffer_load_dwordx4 v17, s[4:7], s58 offen offset:3168 lds
    v_mfma_f32_16x16x32_bf16 v[196:199], a[160:163], v[100:103], v[196:199]
    ds_read_b64_tr_b16 a[204:205], v3 offset:50784
    v_accvgpr_read_b32 v116, a91
    v_mfma_f32_16x16x32_bf16 v[200:203], a[164:167], v[96:99], v[200:203]
    ds_read_b64_tr_b16 a[206:207], v3 offset:51296
    v_fma_mix_f32 v117, v116, v86, v94 op_sel:[0,0,0] op_sel_hi:[1,0,0]
    v_mfma_f32_16x16x32_bf16 v[204:207], a[164:167], v[100:103], v[204:207]
    ds_read_b64_tr_b16 a[208:209], v3 offset:50816
    v_fma_mix_f32 v118, v116, v87, v95 op_sel:[1,0,0] op_sel_hi:[1,0,0]
    v_mfma_f32_16x16x32_bf16 v[208:211], a[168:171], v[96:99], v[208:211]
    ds_read_b64_tr_b16 a[210:211], v3 offset:51328
    v_cvt_pk_bf16_f32 v107, v117, v118
    s_waitcnt vmcnt(16)
    v_accvgpr_read_b32 v112, a92
    v_mfma_f32_16x16x32_bf16 v[212:215], a[168:171], v[100:103], v[212:215]
    ds_read_b64_tr_b16 a[212:213], v3 offset:50848
    v_fma_mix_f32 v113, v112, v80, v88 op_sel:[0,0,0] op_sel_hi:[1,0,0]
    s_add_u32 m0, s57, 0
    v_mfma_f32_16x16x32_bf16 v[216:219], a[172:175], v[96:99], v[216:219]
    ds_read_b64_tr_b16 a[214:215], v3 offset:51360
    v_fma_mix_f32 v114, v112, v81, v89 op_sel:[1,0,0] op_sel_hi:[1,0,0]
    v_mfma_f32_16x16x32_bf16 v[220:223], a[172:175], v[100:103], v[220:223]
    ds_read_b64_tr_b16 a[216:217], v3 offset:50880
    v_cvt_pk_bf16_f32 v108, v113, v114
    v_mfma_f32_16x16x32_bf16 v[224:227], a[176:179], v[96:99], v[224:227]
    ds_read_b64_tr_b16 a[218:219], v3 offset:51392
    v_accvgpr_read_b32 v116, a93
    v_mfma_f32_16x16x32_bf16 v[228:231], a[176:179], v[100:103], v[228:231]
    ds_read_b64_tr_b16 a[220:221], v3 offset:50912
    v_fma_mix_f32 v117, v116, v82, v90 op_sel:[0,0,0] op_sel_hi:[1,0,0]
    v_mfma_f32_16x16x32_bf16 v[232:235], a[180:183], v[96:99], v[232:235]
    ds_read_b64_tr_b16 a[222:223], v3 offset:51424
    v_fma_mix_f32 v118, v116, v83, v91 op_sel:[1,0,0] op_sel_hi:[1,0,0]
    s_mov_b32 s59, 0
    v_mfma_f32_16x16x32_bf16 v[236:239], a[180:183], v[100:103], v[236:239]
    ds_read_b64_tr_b16 a[224:225], v3 offset:50944
    v_cvt_pk_bf16_f32 v109, v117, v118
    v_mfma_f32_16x16x32_bf16 v[240:243], a[184:187], v[96:99], v[240:243]
    ds_read_b64_tr_b16 a[226:227], v3 offset:51456
    v_accvgpr_read_b32 v112, a94
    v_mfma_f32_16x16x32_bf16 v[244:247], a[184:187], v[100:103], v[244:247]
    ds_read_b64_tr_b16 a[228:229], v3 offset:50976
    v_fma_mix_f32 v113, v112, v84, v92 op_sel:[0,0,0] op_sel_hi:[1,0,0]
    v_fma_mix_f32 v114, v112, v85, v93 op_sel:[1,0,0] op_sel_hi:[1,0,0]
    v_cvt_pk_bf16_f32 v110, v113, v114
    v_accvgpr_read_b32 v116, a95
    v_fma_mix_f32 v117, v116, v86, v94 op_sel:[0,0,0] op_sel_hi:[1,0,0]
    v_fma_mix_f32 v118, v116, v87, v95 op_sel:[1,0,0] op_sel_hi:[1,0,0]
    v_cvt_pk_bf16_f32 v111, v117, v118
    v_mfma_f32_16x16x32_bf16 v[248:251], a[188:191], v[96:99], v[248:251]
    ds_read_b64_tr_b16 a[230:231], v3 offset:51488
    buffer_load_dwordx4 v18, s[8:11], s59 offen offset:0 lds
    v_mfma_f32_16x16x32_bf16 v[252:255], a[188:191], v[100:103], v[252:255]
    ds_read_b64_tr_b16 a[232:233], v3 offset:51008
    s_waitcnt lgkmcnt(5)
    v_mfma_f32_16x16x32_bf16 v[128:131], a[192:195], v[104:107], v[128:131]
    ds_read_b64_tr_b16 a[234:235], v3 offset:51520
    s_waitcnt vmcnt(15)
    v_accvgpr_read_b32 v112, a96
    v_mfma_f32_16x16x32_bf16 v[132:135], a[192:195], v[108:111], v[132:135]
    ds_read_b64_tr_b16 a[236:237], v3 offset:51040
    v_fma_mix_f32 v113, v112, v64, v72 op_sel:[0,0,0] op_sel_hi:[1,0,0]
    v_mfma_f32_16x16x32_bf16 v[136:139], a[196:199], v[104:107], v[136:139]
    ds_read_b64_tr_b16 a[238:239], v3 offset:51552
    v_fma_mix_f32 v114, v112, v65, v73 op_sel:[1,0,0] op_sel_hi:[1,0,0]
    v_mfma_f32_16x16x32_bf16 v[140:143], a[196:199], v[108:111], v[140:143]
    ds_read_b64_tr_b16 a[240:241], v3 offset:51072
    v_cvt_pk_bf16_f32 v96, v113, v114
    v_mfma_f32_16x16x32_bf16 v[144:147], a[200:203], v[104:107], v[144:147]
    ds_read_b64_tr_b16 a[242:243], v3 offset:51584
    buffer_load_dwordx4 v19, s[8:11], s59 offen offset:1056 lds
    v_mfma_f32_16x16x32_bf16 v[148:151], a[200:203], v[108:111], v[148:151]
    ds_read_b64_tr_b16 a[244:245], v3 offset:51104
    v_accvgpr_read_b32 v116, a97
    v_mfma_f32_16x16x32_bf16 v[152:155], a[204:207], v[104:107], v[152:155]
    ds_read_b64_tr_b16 a[246:247], v3 offset:51616
    v_fma_mix_f32 v117, v116, v66, v74 op_sel:[0,0,0] op_sel_hi:[1,0,0]
    v_mfma_f32_16x16x32_bf16 v[156:159], a[204:207], v[108:111], v[156:159]
    ds_read_b64_tr_b16 a[248:249], v3 offset:51136
    v_fma_mix_f32 v118, v116, v67, v75 op_sel:[1,0,0] op_sel_hi:[1,0,0]
    v_mfma_f32_16x16x32_bf16 v[160:163], a[208:211], v[104:107], v[160:163]
    ds_read_b64_tr_b16 a[250:251], v3 offset:51648
    v_cvt_pk_bf16_f32 v97, v117, v118
    v_mfma_f32_16x16x32_bf16 v[164:167], a[208:211], v[108:111], v[164:167]
    ds_read_b64_tr_b16 a[252:253], v3 offset:51168
    buffer_load_dwordx4 v20, s[8:11], s59 offen offset:2112 lds
    buffer_load_dwordx4 v21, s[8:11], s59 offen offset:3168 lds
    v_mfma_f32_16x16x32_bf16 v[168:171], a[212:215], v[104:107], v[168:171]
    ds_read_b64_tr_b16 a[254:255], v3 offset:51680
    v_accvgpr_read_b32 v112, a98
    v_mfma_f32_16x16x32_bf16 v[172:175], a[212:215], v[108:111], v[172:175]
    s_waitcnt vmcnt(14)
    s_barrier
    ds_read_b64_tr_b16 a[128:129], v9 offset:0
    v_mfma_f32_16x16x32_bf16 v[176:179], a[216:219], v[104:107], v[176:179]
    ds_read_b64_tr_b16 a[130:131], v9 offset:512
    v_fma_mix_f32 v113, v112, v68, v76 op_sel:[0,0,0] op_sel_hi:[1,0,0]
    v_mfma_f32_16x16x32_bf16 v[180:183], a[216:219], v[108:111], v[180:183]
    ds_read_b64_tr_b16 a[132:133], v9 offset:32
    s_waitcnt lgkmcnt(14)
    ds_read_b128 v[80:83], v48 offset:3328
    s_waitcnt lgkmcnt(14)
    ds_read_b128 v[84:87], v48 offset:3344
    s_waitcnt lgkmcnt(14)
    ds_read_b128 v[88:91], v48 offset:3360
    s_waitcnt lgkmcnt(14)
    ds_read_b128 v[92:95], v48 offset:3376
    v_mfma_f32_16x16x32_bf16 v[184:187], a[220:223], v[104:107], v[184:187]
    ds_read_b64_tr_b16 a[134:135], v9 offset:544
    v_fma_mix_f32 v114, v112, v69, v77 op_sel:[1,0,0] op_sel_hi:[1,0,0]
    v_mfma_f32_16x16x32_bf16 v[188:191], a[220:223], v[108:111], v[188:191]
    ds_read_b64_tr_b16 a[136:137], v9 offset:64
    s_waitcnt lgkmcnt(9)
    v_mfma_f32_16x16x32_bf16 v[192:195], a[224:227], v[104:107], v[192:195]
    ds_read_b64_tr_b16 a[138:139], v9 offset:576
    v_cvt_pk_bf16_f32 v98, v113, v114
    v_mfma_f32_16x16x32_bf16 v[196:199], a[224:227], v[108:111], v[196:199]
    ds_read_b64_tr_b16 a[140:141], v9 offset:96
    v_accvgpr_read_b32 v116, a99
    v_mfma_f32_16x16x32_bf16 v[200:203], a[228:231], v[104:107], v[200:203]
    ds_read_b64_tr_b16 a[142:143], v9 offset:608
    v_fma_mix_f32 v117, v116, v70, v78 op_sel:[0,0,0] op_sel_hi:[1,0,0]
    v_mfma_f32_16x16x32_bf16 v[204:207], a[228:231], v[108:111], v[204:207]
    ds_read_b64_tr_b16 a[144:145], v9 offset:128
    v_fma_mix_f32 v118, v116, v71, v79 op_sel:[1,0,0] op_sel_hi:[1,0,0]
    v_mfma_f32_16x16x32_bf16 v[208:211], a[232:235], v[104:107], v[208:211]
    ds_read_b64_tr_b16 a[146:147], v9 offset:640
    v_cvt_pk_bf16_f32 v99, v117, v118
    v_accvgpr_read_b32 v112, a100
    v_mfma_f32_16x16x32_bf16 v[212:215], a[232:235], v[108:111], v[212:215]
    ds_read_b64_tr_b16 a[148:149], v9 offset:160
    v_fma_mix_f32 v113, v112, v64, v72 op_sel:[0,0,0] op_sel_hi:[1,0,0]
    v_mfma_f32_16x16x32_bf16 v[216:219], a[236:239], v[104:107], v[216:219]
    ds_read_b64_tr_b16 a[150:151], v9 offset:672
    v_fma_mix_f32 v114, v112, v65, v73 op_sel:[1,0,0] op_sel_hi:[1,0,0]
    v_mfma_f32_16x16x32_bf16 v[220:223], a[236:239], v[108:111], v[220:223]
    ds_read_b64_tr_b16 a[152:153], v9 offset:192
    v_cvt_pk_bf16_f32 v100, v113, v114
    s_add_u32 m0, s57, 16896
    v_mfma_f32_16x16x32_bf16 v[224:227], a[240:243], v[104:107], v[224:227]
    ds_read_b64_tr_b16 a[154:155], v9 offset:704
    v_accvgpr_read_b32 v116, a101
    v_mfma_f32_16x16x32_bf16 v[228:231], a[240:243], v[108:111], v[228:231]
    ds_read_b64_tr_b16 a[156:157], v9 offset:224
    v_fma_mix_f32 v117, v116, v66, v74 op_sel:[0,0,0] op_sel_hi:[1,0,0]
    v_mfma_f32_16x16x32_bf16 v[232:235], a[244:247], v[104:107], v[232:235]
    ds_read_b64_tr_b16 a[158:159], v9 offset:736
    v_fma_mix_f32 v118, v116, v67, v75 op_sel:[1,0,0] op_sel_hi:[1,0,0]
    v_mfma_f32_16x16x32_bf16 v[236:239], a[244:247], v[108:111], v[236:239]
    ds_read_b64_tr_b16 a[160:161], v9 offset:256
    v_cvt_pk_bf16_f32 v101, v117, v118
    v_mfma_f32_16x16x32_bf16 v[240:243], a[248:251], v[104:107], v[240:243]
    ds_read_b64_tr_b16 a[162:163], v9 offset:768
    v_accvgpr_read_b32 v112, a102
    s_add_u32 s58, s58, 16384
    v_mfma_f32_16x16x32_bf16 v[244:247], a[248:251], v[108:111], v[244:247]
    ds_read_b64_tr_b16 a[164:165], v9 offset:288
    v_fma_mix_f32 v113, v112, v68, v76 op_sel:[0,0,0] op_sel_hi:[1,0,0]
    v_fma_mix_f32 v114, v112, v69, v77 op_sel:[1,0,0] op_sel_hi:[1,0,0]
    v_cvt_pk_bf16_f32 v102, v113, v114
    v_accvgpr_read_b32 v116, a103
    v_fma_mix_f32 v117, v116, v70, v78 op_sel:[0,0,0] op_sel_hi:[1,0,0]
    v_fma_mix_f32 v118, v116, v71, v79 op_sel:[1,0,0] op_sel_hi:[1,0,0]
    v_cvt_pk_bf16_f32 v103, v117, v118
    v_mfma_f32_16x16x32_bf16 v[248:251], a[252:255], v[104:107], v[248:251]
    ds_read_b64_tr_b16 a[166:167], v9 offset:800
    buffer_load_dwordx4 v14, s[4:7], s58 offen offset:0 lds
    v_mfma_f32_16x16x32_bf16 v[252:255], a[252:255], v[108:111], v[252:255]
    ds_read_b64_tr_b16 a[168:169], v9 offset:320
    s_waitcnt lgkmcnt(5)
    v_mfma_f32_16x16x32_bf16 v[128:131], a[128:131], v[96:99], v[128:131]
    ds_read_b64_tr_b16 a[170:171], v9 offset:832
    s_waitcnt vmcnt(12)
    v_accvgpr_read_b32 v112, a104
    v_mfma_f32_16x16x32_bf16 v[132:135], a[128:131], v[100:103], v[132:135]
    ds_read_b64_tr_b16 a[172:173], v9 offset:352
    v_fma_mix_f32 v113, v112, v80, v88 op_sel:[0,0,0] op_sel_hi:[1,0,0]
    v_mfma_f32_16x16x32_bf16 v[136:139], a[132:135], v[96:99], v[136:139]
    ds_read_b64_tr_b16 a[174:175], v9 offset:864
    v_fma_mix_f32 v114, v112, v81, v89 op_sel:[1,0,0] op_sel_hi:[1,0,0]
    v_mfma_f32_16x16x32_bf16 v[140:143], a[132:135], v[100:103], v[140:143]
    ds_read_b64_tr_b16 a[176:177], v9 offset:384
    v_cvt_pk_bf16_f32 v104, v113, v114
    v_mfma_f32_16x16x32_bf16 v[144:147], a[136:139], v[96:99], v[144:147]
    ds_read_b64_tr_b16 a[178:179], v9 offset:896
    v_accvgpr_read_b32 v116, a105
    v_mfma_f32_16x16x32_bf16 v[148:151], a[136:139], v[100:103], v[148:151]
    ds_read_b64_tr_b16 a[180:181], v9 offset:416
    v_fma_mix_f32 v117, v116, v82, v90 op_sel:[0,0,0] op_sel_hi:[1,0,0]
    v_mfma_f32_16x16x32_bf16 v[152:155], a[140:143], v[96:99], v[152:155]
    ds_read_b64_tr_b16 a[182:183], v9 offset:928
    buffer_load_dwordx4 v15, s[4:7], s58 offen offset:1056 lds
    v_mfma_f32_16x16x32_bf16 v[156:159], a[140:143], v[100:103], v[156:159]
    ds_read_b64_tr_b16 a[184:185], v9 offset:448
    v_fma_mix_f32 v118, v116, v83, v91 op_sel:[1,0,0] op_sel_hi:[1,0,0]
    v_mfma_f32_16x16x32_bf16 v[160:163], a[144:147], v[96:99], v[160:163]
    ds_read_b64_tr_b16 a[186:187], v9 offset:960
    v_cvt_pk_bf16_f32 v105, v117, v118
    v_mfma_f32_16x16x32_bf16 v[164:167], a[144:147], v[100:103], v[164:167]
    ds_read_b64_tr_b16 a[188:189], v9 offset:480
    v_accvgpr_read_b32 v112, a106
    v_mfma_f32_16x16x32_bf16 v[168:171], a[148:151], v[96:99], v[168:171]
    ds_read_b64_tr_b16 a[190:191], v9 offset:992
    v_fma_mix_f32 v113, v112, v84, v92 op_sel:[0,0,0] op_sel_hi:[1,0,0]
    v_mfma_f32_16x16x32_bf16 v[172:175], a[148:151], v[100:103], v[172:175]
    ds_read_b64_tr_b16 a[192:193], v9 offset:16896
    buffer_load_dwordx4 v16, s[4:7], s58 offen offset:2112 lds
    v_mfma_f32_16x16x32_bf16 v[176:179], a[152:155], v[96:99], v[176:179]
    ds_read_b64_tr_b16 a[194:195], v9 offset:17408
    v_fma_mix_f32 v114, v112, v85, v93 op_sel:[1,0,0] op_sel_hi:[1,0,0]
    v_mfma_f32_16x16x32_bf16 v[180:183], a[152:155], v[100:103], v[180:183]
    ds_read_b64_tr_b16 a[196:197], v9 offset:16928
    v_cvt_pk_bf16_f32 v106, v113, v114
    v_mfma_f32_16x16x32_bf16 v[184:187], a[156:159], v[96:99], v[184:187]
    ds_read_b64_tr_b16 a[198:199], v9 offset:17440
    v_accvgpr_read_b32 v116, a107
    v_mfma_f32_16x16x32_bf16 v[188:191], a[156:159], v[100:103], v[188:191]
    ds_read_b64_tr_b16 a[200:201], v9 offset:16960
    s_waitcnt lgkmcnt(5)
    v_mfma_f32_16x16x32_bf16 v[192:195], a[160:163], v[96:99], v[192:195]
    ds_read_b64_tr_b16 a[202:203], v9 offset:17472
    buffer_load_dwordx4 v17, s[4:7], s58 offen offset:3168 lds
    v_mfma_f32_16x16x32_bf16 v[196:199], a[160:163], v[100:103], v[196:199]
    ds_read_b64_tr_b16 a[204:205], v9 offset:16992
    v_fma_mix_f32 v117, v116, v86, v94 op_sel:[0,0,0] op_sel_hi:[1,0,0]
    v_mfma_f32_16x16x32_bf16 v[200:203], a[164:167], v[96:99], v[200:203]
    ds_read_b64_tr_b16 a[206:207], v9 offset:17504
    v_fma_mix_f32 v118, v116, v87, v95 op_sel:[1,0,0] op_sel_hi:[1,0,0]
    v_mfma_f32_16x16x32_bf16 v[204:207], a[164:167], v[100:103], v[204:207]
    ds_read_b64_tr_b16 a[208:209], v9 offset:17024
    v_cvt_pk_bf16_f32 v107, v117, v118
    v_mfma_f32_16x16x32_bf16 v[208:211], a[168:171], v[96:99], v[208:211]
    ds_read_b64_tr_b16 a[210:211], v9 offset:17536
    s_waitcnt vmcnt(12)
    v_accvgpr_read_b32 v112, a108
    v_mfma_f32_16x16x32_bf16 v[212:215], a[168:171], v[100:103], v[212:215]
    ds_read_b64_tr_b16 a[212:213], v9 offset:17056
    v_fma_mix_f32 v113, v112, v80, v88 op_sel:[0,0,0] op_sel_hi:[1,0,0]
    s_add_u32 m0, s57, 33792
    v_mfma_f32_16x16x32_bf16 v[216:219], a[172:175], v[96:99], v[216:219]
    ds_read_b64_tr_b16 a[214:215], v9 offset:17568
    v_fma_mix_f32 v114, v112, v81, v89 op_sel:[1,0,0] op_sel_hi:[1,0,0]
    v_mfma_f32_16x16x32_bf16 v[220:223], a[172:175], v[100:103], v[220:223]
    ds_read_b64_tr_b16 a[216:217], v9 offset:17088
    v_cvt_pk_bf16_f32 v108, v113, v114
    v_mfma_f32_16x16x32_bf16 v[224:227], a[176:179], v[96:99], v[224:227]
    ds_read_b64_tr_b16 a[218:219], v9 offset:17600
    v_accvgpr_read_b32 v116, a109
    v_mfma_f32_16x16x32_bf16 v[228:231], a[176:179], v[100:103], v[228:231]
    ds_read_b64_tr_b16 a[220:221], v9 offset:17120
    v_fma_mix_f32 v117, v116, v82, v90 op_sel:[0,0,0] op_sel_hi:[1,0,0]
    v_mfma_f32_16x16x32_bf16 v[232:235], a[180:183], v[96:99], v[232:235]
    ds_read_b64_tr_b16 a[222:223], v9 offset:17632
    v_fma_mix_f32 v118, v116, v83, v91 op_sel:[1,0,0] op_sel_hi:[1,0,0]
    s_add_u32 s59, s59, 16384
    v_mfma_f32_16x16x32_bf16 v[236:239], a[180:183], v[100:103], v[236:239]
    ds_read_b64_tr_b16 a[224:225], v9 offset:17152
    v_cvt_pk_bf16_f32 v109, v117, v118
    v_mfma_f32_16x16x32_bf16 v[240:243], a[184:187], v[96:99], v[240:243]
    ds_read_b64_tr_b16 a[226:227], v9 offset:17664
    v_accvgpr_read_b32 v112, a110
    v_mfma_f32_16x16x32_bf16 v[244:247], a[184:187], v[100:103], v[244:247]
    ds_read_b64_tr_b16 a[228:229], v9 offset:17184
    v_fma_mix_f32 v113, v112, v84, v92 op_sel:[0,0,0] op_sel_hi:[1,0,0]
    v_fma_mix_f32 v114, v112, v85, v93 op_sel:[1,0,0] op_sel_hi:[1,0,0]
    v_cvt_pk_bf16_f32 v110, v113, v114
    v_accvgpr_read_b32 v116, a111
    v_fma_mix_f32 v117, v116, v86, v94 op_sel:[0,0,0] op_sel_hi:[1,0,0]
    v_fma_mix_f32 v118, v116, v87, v95 op_sel:[1,0,0] op_sel_hi:[1,0,0]
    v_cvt_pk_bf16_f32 v111, v117, v118
    v_mfma_f32_16x16x32_bf16 v[248:251], a[188:191], v[96:99], v[248:251]
    ds_read_b64_tr_b16 a[230:231], v9 offset:17696
    buffer_load_dwordx4 v18, s[8:11], s59 offen offset:0 lds
    v_mfma_f32_16x16x32_bf16 v[252:255], a[188:191], v[100:103], v[252:255]
    ds_read_b64_tr_b16 a[232:233], v9 offset:17216
    s_waitcnt lgkmcnt(5)
    v_mfma_f32_16x16x32_bf16 v[128:131], a[192:195], v[104:107], v[128:131]
    ds_read_b64_tr_b16 a[234:235], v9 offset:17728
    buffer_load_dwordx4 v19, s[8:11], s59 offen offset:1056 lds
    v_mfma_f32_16x16x32_bf16 v[132:135], a[192:195], v[108:111], v[132:135]
    ds_read_b64_tr_b16 a[236:237], v9 offset:17248
    buffer_load_dwordx4 v20, s[8:11], s59 offen offset:2112 lds
    v_mfma_f32_16x16x32_bf16 v[136:139], a[196:199], v[104:107], v[136:139]
    ds_read_b64_tr_b16 a[238:239], v9 offset:17760
    v_mfma_f32_16x16x32_bf16 v[140:143], a[196:199], v[108:111], v[140:143]
    ds_read_b64_tr_b16 a[240:241], v9 offset:17280
    buffer_load_dwordx4 v21, s[8:11], s59 offen offset:3168 lds
    v_mfma_f32_16x16x32_bf16 v[144:147], a[200:203], v[104:107], v[144:147]
    ds_read_b64_tr_b16 a[242:243], v9 offset:17792
    v_mfma_f32_16x16x32_bf16 v[148:151], a[200:203], v[108:111], v[148:151]
    ds_read_b64_tr_b16 a[244:245], v9 offset:17312
    v_mfma_f32_16x16x32_bf16 v[152:155], a[204:207], v[104:107], v[152:155]
    ds_read_b64_tr_b16 a[246:247], v9 offset:17824
    v_cvt_pk_bf16_f32 v64, v128, v129
    v_mfma_f32_16x16x32_bf16 v[156:159], a[204:207], v[108:111], v[156:159]
    ds_read_b64_tr_b16 a[248:249], v9 offset:17344
    v_cvt_pk_bf16_f32 v66, v136, v137
    v_mfma_f32_16x16x32_bf16 v[160:163], a[208:211], v[104:107], v[160:163]
    ds_read_b64_tr_b16 a[250:251], v9 offset:17856
    v_cvt_pk_bf16_f32 v65, v130, v131
    v_mfma_f32_16x16x32_bf16 v[164:167], a[208:211], v[108:111], v[164:167]
    ds_read_b64_tr_b16 a[252:253], v9 offset:17376
    v_cvt_pk_bf16_f32 v67, v138, v139
    v_mfma_f32_16x16x32_bf16 v[168:171], a[212:215], v[104:107], v[168:171]
    ds_read_b64_tr_b16 a[254:255], v9 offset:17888
    v_cvt_pk_bf16_f32 v68, v132, v133
    v_mfma_f32_16x16x32_bf16 v[172:175], a[212:215], v[108:111], v[172:175]
    s_barrier
    ds_read_b128 a[128:131], v8 offset:33792
    v_mfma_f32_16x16x32_bf16 v[176:179], a[216:219], v[104:107], v[176:179]
    ds_read_b128 a[132:135], v8 offset:33856
    v_cvt_pk_bf16_f32 v70, v140, v141
    v_mfma_f32_16x16x32_bf16 v[180:183], a[216:219], v[108:111], v[180:183]
    ds_read_b128 a[136:139], v8 offset:33920
    v_cvt_pk_bf16_f32 v69, v134, v135
    v_mfma_f32_16x16x32_bf16 v[184:187], a[220:223], v[104:107], v[184:187]
    v_cvt_pk_bf16_f32 v71, v142, v143
    v_permlane32_swap_b32 v64, v66
    v_mfma_f32_16x16x32_bf16 v[188:191], a[220:223], v[108:111], v[188:191]
    ds_read_b128 a[140:143], v8 offset:33984
    s_waitcnt lgkmcnt(4)
    v_mfma_f32_16x16x32_bf16 v[192:195], a[224:227], v[104:107], v[192:195]
    v_permlane32_swap_b32 v65, v67
    v_permlane32_swap_b32 v68, v70
    v_mfma_f32_16x16x32_bf16 v[196:199], a[224:227], v[108:111], v[196:199]
    ds_read_b128 a[144:147], v8 offset:34048
    v_permlane32_swap_b32 v69, v71
    v_mfma_f32_16x16x32_bf16 v[200:203], a[228:231], v[104:107], v[200:203]
    v_permlane16_swap_b32 v64, v66
    v_permlane16_swap_b32 v65, v67
    v_mfma_f32_16x16x32_bf16 v[204:207], a[228:231], v[108:111], v[204:207]
    ds_read_b128 a[148:151], v8 offset:34112
    v_permlane16_swap_b32 v68, v70
    v_mfma_f32_16x16x32_bf16 v[208:211], a[232:235], v[104:107], v[208:211]
    s_add_u32 m0, s57, 50688
    v_permlane16_swap_b32 v69, v71
    v_mfma_f32_16x16x32_bf16 v[212:215], a[232:235], v[108:111], v[212:215]
    ds_read_b128 a[152:155], v8 offset:34176
    v_cvt_pk_bf16_f32 v72, v144, v145
    v_mfma_f32_16x16x32_bf16 v[216:219], a[236:239], v[104:107], v[216:219]
    s_add_u32 s58, s58, 16384
    v_cvt_pk_bf16_f32 v74, v152, v153
    v_mfma_f32_16x16x32_bf16 v[220:223], a[236:239], v[108:111], v[220:223]
    ds_read_b128 a[156:159], v8 offset:34240
    v_cvt_pk_bf16_f32 v73, v146, v147
    v_mfma_f32_16x16x32_bf16 v[224:227], a[240:243], v[104:107], v[224:227]
    buffer_load_dwordx4 v14, s[4:7], s58 offen offset:0 lds
    v_cvt_pk_bf16_f32 v75, v154, v155
    v_mfma_f32_16x16x32_bf16 v[228:231], a[240:243], v[108:111], v[228:231]
    ds_read_b128 a[160:163], v8 offset:42240
    v_cvt_pk_bf16_f32 v76, v148, v149
    v_mfma_f32_16x16x32_bf16 v[232:235], a[244:247], v[104:107], v[232:235]
    v_cvt_pk_bf16_f32 v78, v156, v157
    v_cvt_pk_bf16_f32 v77, v150, v151
    v_mfma_f32_16x16x32_bf16 v[236:239], a[244:247], v[108:111], v[236:239]
    ds_read_b128 a[164:167], v8 offset:42304
    buffer_load_dwordx4 v15, s[4:7], s58 offen offset:1056 lds
    v_mfma_f32_16x16x32_bf16 v[240:243], a[248:251], v[104:107], v[240:243]
    v_cvt_pk_bf16_f32 v79, v158, v159
    v_permlane32_swap_b32 v72, v74
    v_mfma_f32_16x16x32_bf16 v[244:247], a[248:251], v[108:111], v[244:247]
    ds_read_b128 a[168:171], v8 offset:42368
    buffer_load_dwordx4 v16, s[4:7], s58 offen offset:2112 lds
    v_mfma_f32_16x16x32_bf16 v[248:251], a[252:255], v[104:107], v[248:251]
    v_permlane32_swap_b32 v73, v75
    v_permlane32_swap_b32 v76, v78
    v_permlane32_swap_b32 v77, v79
    v_permlane16_swap_b32 v72, v74
    v_permlane16_swap_b32 v73, v75
    v_permlane16_swap_b32 v76, v78
    v_permlane16_swap_b32 v77, v79
    v_mfma_f32_16x16x32_bf16 v[252:255], a[252:255], v[108:111], v[252:255]
    ds_read_b128 a[172:175], v8 offset:42432
    v_cvt_pk_bf16_f32 v80, v160, v161
    v_cvt_pk_bf16_f32 v82, v168, v169
    v_cvt_pk_bf16_f32 v81, v162, v163
    v_cvt_pk_bf16_f32 v83, v170, v171
    v_cvt_pk_bf16_f32 v84, v164, v165
    v_cvt_pk_bf16_f32 v86, v172, v173
    v_cvt_pk_bf16_f32 v85, v166, v167
    v_cvt_pk_bf16_f32 v87, v174, v175
    v_permlane32_swap_b32 v80, v82
    v_permlane32_swap_b32 v81, v83
    v_permlane32_swap_b32 v84, v86
    v_permlane32_swap_b32 v85, v87
    v_permlane16_swap_b32 v80, v82
    v_permlane16_swap_b32 v81, v83
    v_permlane16_swap_b32 v84, v86
    v_permlane16_swap_b32 v85, v87
    buffer_load_dwordx4 v17, s[4:7], s58 offen offset:3168 lds
    s_waitcnt lgkmcnt(4)
    v_mfma_f32_16x16x32_bf16 v[128:131], a[128:131], v[64:67], 0
    v_cvt_pk_bf16_f32 v88, v176, v177
    v_cvt_pk_bf16_f32 v90, v184, v185
    v_cvt_pk_bf16_f32 v89, v178, v179
    v_cvt_pk_bf16_f32 v91, v186, v187
    v_cvt_pk_bf16_f32 v92, v180, v181
    v_cvt_pk_bf16_f32 v94, v188, v189
    v_cvt_pk_bf16_f32 v93, v182, v183
    v_cvt_pk_bf16_f32 v95, v190, v191
    v_permlane32_swap_b32 v88, v90
    v_permlane32_swap_b32 v89, v91
    v_permlane32_swap_b32 v92, v94
    v_permlane32_swap_b32 v93, v95
    v_permlane16_swap_b32 v88, v90
    v_permlane16_swap_b32 v89, v91
    v_permlane16_swap_b32 v92, v94
    v_permlane16_swap_b32 v93, v95
    v_mfma_f32_16x16x32_bf16 v[128:131], a[132:135], v[72:75], v[128:131]
    ds_read_b128 a[176:179], v8 offset:42496
    v_cvt_pk_bf16_f32 v96, v192, v193
    v_cvt_pk_bf16_f32 v98, v200, v201
    v_cvt_pk_bf16_f32 v97, v194, v195
    v_cvt_pk_bf16_f32 v99, v202, v203
    v_cvt_pk_bf16_f32 v100, v196, v197
    v_cvt_pk_bf16_f32 v102, v204, v205
    v_cvt_pk_bf16_f32 v101, v198, v199
    v_cvt_pk_bf16_f32 v103, v206, v207
    v_permlane32_swap_b32 v96, v98
    v_permlane32_swap_b32 v97, v99
    v_permlane32_swap_b32 v100, v102
    v_permlane32_swap_b32 v101, v103
    v_permlane16_swap_b32 v96, v98
    v_permlane16_swap_b32 v97, v99
    v_permlane16_swap_b32 v100, v102
    v_permlane16_swap_b32 v101, v103
    s_add_u32 m0, s57, 67584
    v_mfma_f32_16x16x32_bf16 v[128:131], a[136:139], v[80:83], v[128:131]
    v_cvt_pk_bf16_f32 v104, v208, v209
    v_cvt_pk_bf16_f32 v106, v216, v217
    v_cvt_pk_bf16_f32 v105, v210, v211
    v_cvt_pk_bf16_f32 v107, v218, v219
    v_cvt_pk_bf16_f32 v108, v212, v213
    v_cvt_pk_bf16_f32 v110, v220, v221
    v_cvt_pk_bf16_f32 v109, v214, v215
    v_cvt_pk_bf16_f32 v111, v222, v223
    v_permlane32_swap_b32 v104, v106
    v_permlane32_swap_b32 v105, v107
    v_permlane32_swap_b32 v108, v110
    v_permlane32_swap_b32 v109, v111
    v_permlane16_swap_b32 v104, v106
    v_permlane16_swap_b32 v105, v107
    v_permlane16_swap_b32 v108, v110
    v_permlane16_swap_b32 v109, v111
    v_mfma_f32_16x16x32_bf16 v[128:131], a[140:143], v[88:91], v[128:131]
    ds_read_b128 a[180:183], v8 offset:42560
    v_cvt_pk_bf16_f32 v112, v224, v225
    v_cvt_pk_bf16_f32 v114, v232, v233
    v_cvt_pk_bf16_f32 v113, v226, v227
    v_cvt_pk_bf16_f32 v115, v234, v235
    v_cvt_pk_bf16_f32 v116, v228, v229
    v_cvt_pk_bf16_f32 v118, v236, v237
    v_cvt_pk_bf16_f32 v117, v230, v231
    v_cvt_pk_bf16_f32 v119, v238, v239
    v_permlane32_swap_b32 v112, v114
    v_permlane32_swap_b32 v113, v115
    v_permlane32_swap_b32 v116, v118
    v_permlane32_swap_b32 v117, v119
    v_permlane16_swap_b32 v112, v114
    v_permlane16_swap_b32 v113, v115
    v_permlane16_swap_b32 v116, v118
    v_permlane16_swap_b32 v117, v119
    v_mfma_f32_16x16x32_bf16 v[128:131], a[144:147], v[96:99], v[128:131]
    v_cvt_pk_bf16_f32 v120, v240, v241
    v_cvt_pk_bf16_f32 v122, v248, v249
    v_cvt_pk_bf16_f32 v121, v242, v243
    v_cvt_pk_bf16_f32 v123, v250, v251
    v_cvt_pk_bf16_f32 v124, v244, v245
    v_cvt_pk_bf16_f32 v126, v252, v253
    v_cvt_pk_bf16_f32 v125, v246, v247
    v_cvt_pk_bf16_f32 v127, v254, v255
    v_permlane32_swap_b32 v120, v122
    v_permlane32_swap_b32 v121, v123
    v_permlane32_swap_b32 v124, v126
    v_permlane32_swap_b32 v125, v127
    v_permlane16_swap_b32 v120, v122
    v_permlane16_swap_b32 v121, v123
    v_permlane16_swap_b32 v124, v126
    v_permlane16_swap_b32 v125, v127
    s_add_u32 s59, s59, 16384
    v_mfma_f32_16x16x32_bf16 v[128:131], a[148:151], v[104:107], v[128:131]
    ds_read_b128 a[184:187], v8 offset:42624
    buffer_load_dwordx4 v18, s[8:11], s59 offen offset:0 lds
    v_mfma_f32_16x16x32_bf16 v[128:131], a[152:155], v[112:115], v[128:131]
    buffer_load_dwordx4 v19, s[8:11], s59 offen offset:1056 lds
    buffer_load_dwordx4 v20, s[8:11], s59 offen offset:2112 lds
    v_mfma_f32_16x16x32_bf16 v[128:131], a[156:159], v[120:123], v[128:131]
    ds_read_b128 a[188:191], v8 offset:42688
    buffer_load_dwordx4 v21, s[8:11], s59 offen offset:3168 lds
    v_mfma_f32_16x16x32_bf16 v[132:135], a[128:131], v[68:71], 0
    v_mfma_f32_16x16x32_bf16 v[132:135], a[132:135], v[76:79], v[132:135]
    s_waitcnt vmcnt(16)
    s_barrier
    ds_read_b128 a[192:195], v8 offset:50688
    v_mfma_f32_16x16x32_bf16 v[132:135], a[136:139], v[84:87], v[132:135]
    v_lshrrev_b32 v36, 3, v1
    v_mul_u32_u24 v36, 3584, v36
    v_mfma_f32_16x16x32_bf16 v[132:135], a[140:143], v[92:95], v[132:135]
    ds_read_b128 a[196:199], v8 offset:50752
    v_bfe_u32 v37, v1, 1, 2
    v_mfma_f32_16x16x32_bf16 v[132:135], a[144:147], v[100:103], v[132:135]
    v_lshrrev_b32 v22, 4, v1
    s_add_u32 m0, s57, 84480
    v_mfma_f32_16x16x32_bf16 v[132:135], a[148:151], v[108:111], v[132:135]
    ds_read_b128 a[200:203], v8 offset:50816
    v_xor_b32 v37, v37, v22
    v_mfma_f32_16x16x32_bf16 v[132:135], a[152:155], v[116:119], v[132:135]
    v_lshl_add_u32 v36, v37, 5, v36
    v_and_b32 v37, 1, v1
    v_mfma_f32_16x16x32_bf16 v[132:135], a[156:159], v[124:127], v[132:135]
    ds_read_b128 a[204:207], v8 offset:50880
    s_waitcnt lgkmcnt(4)
    v_mfma_f32_16x16x32_bf16 v[136:139], a[160:163], v[64:67], 0
    v_lshl_add_u32 v22, v37, 4, v36
    v_add_u32 v23, 27648, v22
    v_mfma_f32_16x16x32_bf16 v[136:139], a[164:167], v[72:75], v[136:139]
    ds_read_b128 a[208:211], v8 offset:50944
    v_add_u32 v24, 55296, v22
    v_mfma_f32_16x16x32_bf16 v[136:139], a[168:171], v[80:83], v[136:139]
    v_add_u32 v25, 82944, v22
    v_mfma_f32_16x16x32_bf16 v[136:139], a[172:175], v[88:91], v[136:139]
    ds_read_b128 a[212:215], v8 offset:51008
    v_and_b32 v36, 15, v1
    v_mfma_f32_16x16x32_bf16 v[136:139], a[176:179], v[96:99], v[136:139]
    v_lshrrev_b32 v37, 3, v36
    v_mul_u32_u24 v49, 7168, v37
    v_mfma_f32_16x16x32_bf16 v[136:139], a[180:183], v[104:107], v[136:139]
    ds_read_b128 a[216:219], v8 offset:51072
    v_and_b32 v36, 7, v36
    v_mfma_f32_16x16x32_bf16 v[136:139], a[184:187], v[112:115], v[136:139]
    v_lshl_add_u32 v49, v36, 6, v49
    s_add_u32 s58, s58, 16384
    v_mfma_f32_16x16x32_bf16 v[136:139], a[188:191], v[120:123], v[136:139]
    ds_read_b128 a[220:223], v8 offset:51136
    v_lshrrev_b32 v36, 4, v1
    v_mfma_f32_16x16x32_bf16 v[140:143], a[160:163], v[68:71], 0
    v_lshl_add_u32 v49, v36, 4, v49
    v_add_u32 v50, 14336, v49
    v_mfma_f32_16x16x32_bf16 v[140:143], a[164:167], v[76:79], v[140:143]
    ds_read_b128 a[224:227], v8 offset:59136
    s_mul_i32 s60, s53, 1835008
    s_add_u32 s63, s63, s60
    s_add_u32 s63, s63, 0x800000
    v_mfma_f32_16x16x32_bf16 v[140:143], a[168:171], v[84:87], v[140:143]
    s_mul_i32 s48, s52, 114688
    s_lshr_b32 s60, s53, 1
    s_lshl_b32 s60, s60, 9
    s_add_u32 s48, s48, s60
    v_mfma_f32_16x16x32_bf16 v[140:143], a[172:175], v[92:95], v[140:143]
    ds_read_b128 a[228:231], v8 offset:59200
    s_add_u32 s60, s52, 4
    s_lshl_b32 s60, s60, 4
    s_add_u32 s60, s60, s54
    s_lshl_b32 s60, s60, 10
    s_add_u32 s60, s60, 4096
    v_and_b32 v53, 15, v1
    v_lshlrev_b32 v53, 6, v53
    v_add_u32 v53, s60, v53
    v_mfma_f32_16x16x32_bf16 v[140:143], a[176:179], v[100:103], v[140:143]
    v_mfma_f32_16x16x32_bf16 v[140:143], a[180:183], v[108:111], v[140:143]
    ds_read_b128 a[232:235], v8 offset:59264
    v_mfma_f32_16x16x32_bf16 v[140:143], a[184:187], v[116:119], v[140:143]
    buffer_load_dwordx4 v14, s[4:7], s58 offen offset:0 lds
    v_mfma_f32_16x16x32_bf16 v[140:143], a[188:191], v[124:127], v[140:143]
    ds_read_b128 a[236:239], v8 offset:59328
    s_nop 7
    v_max3_f32 v36, v128, v129, v130
    v_max3_f32 v36, v36, v131, v136
    v_max3_f32 v36, v36, v137, v138
    v_max_f32 v36, v36, v139
    v_max3_f32 v37, v132, v133, v134
    v_max3_f32 v37, v37, v135, v140
    v_max3_f32 v37, v37, v141, v142
    v_max_f32 v37, v37, v143
    v_mov_b32 v38, v36
    v_mov_b32 v39, v37
    s_nop 1
    v_permlane16_swap_b32 v36, v38
    v_permlane16_swap_b32 v37, v39
    s_nop 1
    v_max_f32 v36, v36, v38
    v_max_f32 v37, v37, v39
    v_mov_b32 v38, v36
    v_mov_b32 v39, v37
    s_nop 1
    v_permlane32_swap_b32 v36, v38
    v_permlane32_swap_b32 v37, v39
    s_nop 1
    v_max_f32 v36, v36, v38
    v_max_f32 v37, v37, v39
    v_sub_f32 v192, 0, v36
    v_sub_f32 v193, 0, v36
    v_sub_f32 v194, 0, v36
    v_sub_f32 v195, 0, v36
    v_sub_f32 v196, 0, v37
    v_sub_f32 v197, 0, v37
    v_sub_f32 v198, 0, v37
    v_sub_f32 v199, 0, v37
    s_nop 1
    s_waitcnt lgkmcnt(4)
    v_mfma_f32_16x16x32_bf16 v[144:147], a[192:195], v[64:67], v[192:195]
    s_mov_b32 s62, 14
    v_add_f32 v128, v128, v192
    v_mfma_f32_16x16x32_bf16 v[144:147], a[196:199], v[72:75], v[144:147]
    ds_read_b128 a[240:243], v8 offset:59392
    v_mfma_f32_16x16x32_bf16 v[144:147], a[200:203], v[80:83], v[144:147]
    v_exp_f32 v160, v128
    v_mfma_f32_16x16x32_bf16 v[144:147], a[204:207], v[88:91], v[144:147]
    ds_read_b128 a[244:247], v8 offset:59456
    v_add_f32 v129, v129, v192
    v_mfma_f32_16x16x32_bf16 v[144:147], a[208:211], v[96:99], v[144:147]
    v_exp_f32 v161, v129
    v_mfma_f32_16x16x32_bf16 v[144:147], a[212:215], v[104:107], v[144:147]
    ds_read_b128 a[248:251], v8 offset:59520
    v_add_f32 v130, v130, v192
    v_mfma_f32_16x16x32_bf16 v[144:147], a[216:219], v[112:115], v[144:147]
    v_exp_f32 v162, v130
    v_mfma_f32_16x16x32_bf16 v[144:147], a[220:223], v[120:123], v[144:147]
    ds_read_b128 a[252:255], v8 offset:59584
    v_add_f32 v131, v131, v192
    v_mfma_f32_16x16x32_bf16 v[148:151], a[192:195], v[68:71], v[196:199]
    ds_read_b64_tr_b16 a[128:129], v3 offset:0
    v_add_f32 v32, v160, v161
    v_mfma_f32_16x16x32_bf16 v[148:151], a[196:199], v[76:79], v[148:151]
    ds_read_b64_tr_b16 a[130:131], v3 offset:512
    v_cvt_pk_bf16_f32 v176, v160, v161
    v_mfma_f32_16x16x32_bf16 v[148:151], a[200:203], v[84:87], v[148:151]
    ds_read_b64_tr_b16 a[132:133], v3 offset:32
    v_add_f32 v32, v32, v162
    v_mfma_f32_16x16x32_bf16 v[148:151], a[204:207], v[92:95], v[148:151]
    ds_read_b64_tr_b16 a[134:135], v3 offset:544
    buffer_load_dwordx4 v15, s[4:7], s58 offen offset:1056 lds
    v_mfma_f32_16x16x32_bf16 v[148:151], a[208:211], v[100:103], v[148:151]
    ds_read_b64_tr_b16 a[136:137], v3 offset:64
    v_mfma_f32_16x16x32_bf16 v[148:151], a[212:215], v[108:111], v[148:151]
    ds_read_b64_tr_b16 a[138:139], v3 offset:576
    v_mfma_f32_16x16x32_bf16 v[148:151], a[216:219], v[116:119], v[148:151]
    ds_read_b64_tr_b16 a[140:141], v3 offset:96
    v_mfma_f32_16x16x32_bf16 v[148:151], a[220:223], v[124:127], v[148:151]
    ds_read_b64_tr_b16 a[142:143], v3 offset:608
    v_exp_f32 v163, v131
    s_waitcnt lgkmcnt(8)
    v_mfma_f32_16x16x32_bf16 v[152:155], a[224:227], v[64:67], v[192:195]
    ds_read_b64_tr_b16 a[144:145], v3 offset:128
    v_add_f32 v132, v132, v196
    v_exp_f32 v164, v132
    v_mfma_f32_16x16x32_bf16 v[152:155], a[228:231], v[72:75], v[152:155]
    ds_read_b64_tr_b16 a[146:147], v3 offset:640
    v_add_f32 v133, v133, v196
    v_exp_f32 v165, v133
    v_add_f32 v32, v32, v163
    v_cvt_pk_bf16_f32 v177, v162, v163
    v_mfma_f32_16x16x32_bf16 v[152:155], a[232:235], v[80:83], v[152:155]
    ds_read_b64_tr_b16 a[148:149], v3 offset:160
    v_add_f32 v134, v134, v196
    v_exp_f32 v166, v134
    v_mfma_f32_16x16x32_bf16 v[152:155], a[236:239], v[88:91], v[152:155]
    ds_read_b64_tr_b16 a[150:151], v3 offset:672
    v_add_f32 v135, v135, v196
    v_exp_f32 v167, v135
    v_add_f32 v33, v164, v165
    v_cvt_pk_bf16_f32 v180, v164, v165
    v_mfma_f32_16x16x32_bf16 v[152:155], a[240:243], v[96:99], v[152:155]
    ds_read_b64_tr_b16 a[152:153], v3 offset:192
    v_add_f32 v136, v136, v192
    v_exp_f32 v168, v136
    v_add_f32 v33, v33, v166
    v_mfma_f32_16x16x32_bf16 v[152:155], a[244:247], v[104:107], v[152:155]
    ds_read_b64_tr_b16 a[154:155], v3 offset:704
    v_add_f32 v137, v137, v192
    v_exp_f32 v169, v137
    v_add_f32 v33, v33, v167
    v_cvt_pk_bf16_f32 v181, v166, v167
    v_mfma_f32_16x16x32_bf16 v[152:155], a[248:251], v[112:115], v[152:155]
    ds_read_b64_tr_b16 a[156:157], v3 offset:224
    v_add_f32 v138, v138, v192
    v_exp_f32 v170, v138
    v_add_f32 v32, v32, v168
    v_mfma_f32_16x16x32_bf16 v[152:155], a[252:255], v[120:123], v[152:155]
    ds_read_b64_tr_b16 a[158:159], v3 offset:736
    v_add_f32 v139, v139, v192
    v_exp_f32 v171, v139
    v_add_f32 v32, v32, v169
    v_cvt_pk_bf16_f32 v178, v168, v169
    v_mfma_f32_16x16x32_bf16 v[156:159], a[224:227], v[68:71], v[196:199]
    ds_read_b64_tr_b16 a[160:161], v3 offset:256
    v_add_f32 v140, v140, v196
    v_exp_f32 v172, v140
    v_add_f32 v32, v32, v170
    v_mfma_f32_16x16x32_bf16 v[156:159], a[228:231], v[76:79], v[156:159]
    ds_read_b64_tr_b16 a[162:163], v3 offset:768
    v_add_f32 v141, v141, v196
    v_exp_f32 v173, v141
    v_add_f32 v32, v32, v171
    v_cvt_pk_bf16_f32 v179, v170, v171
    v_mfma_f32_16x16x32_bf16 v[156:159], a[232:235], v[84:87], v[156:159]
    ds_read_b64_tr_b16 a[164:165], v3 offset:288
    v_add_f32 v142, v142, v196
    v_exp_f32 v174, v142
    v_add_f32 v33, v33, v172
    v_mfma_f32_16x16x32_bf16 v[156:159], a[236:239], v[92:95], v[156:159]
    ds_read_b64_tr_b16 a[166:167], v3 offset:800
    v_add_f32 v143, v143, v196
    v_exp_f32 v175, v143
    v_add_f32 v33, v33, v173
    v_cvt_pk_bf16_f32 v182, v172, v173
    v_mfma_f32_16x16x32_bf16 v[156:159], a[240:243], v[100:103], v[156:159]
    ds_read_b64_tr_b16 a[168:169], v3 offset:320
    v_add_f32 v33, v33, v174
    v_mfma_f32_16x16x32_bf16 v[156:159], a[244:247], v[108:111], v[156:159]
    ds_read_b64_tr_b16 a[170:171], v3 offset:832
    v_add_f32 v33, v33, v175
    v_cvt_pk_bf16_f32 v183, v174, v175
    v_mfma_f32_16x16x32_bf16 v[156:159], a[248:251], v[116:119], v[156:159]
    ds_read_b64_tr_b16 a[172:173], v3 offset:352
    buffer_load_dwordx4 v16, s[4:7], s58 offen offset:2112 lds
    v_mfma_f32_16x16x32_bf16 v[156:159], a[252:255], v[124:127], v[156:159]
    ds_read_b64_tr_b16 a[174:175], v3 offset:864
    s_waitcnt lgkmcnt(8)
    v_mfma_f32_16x16x32_bf16 a[0:3], a[128:131], v[176:179], 0
    ds_read_b64_tr_b16 a[176:177], v3 offset:384
    v_add_f32 v30, v30, v32
    v_mfma_f32_16x16x32_bf16 a[4:7], a[128:131], v[180:183], 0
    ds_read_b64_tr_b16 a[178:179], v3 offset:896
    v_add_f32 v31, v31, v33
    v_mfma_f32_16x16x32_bf16 a[8:11], a[132:135], v[176:179], 0
    ds_read_b64_tr_b16 a[180:181], v3 offset:416
    buffer_load_dwordx4 v17, s[4:7], s58 offen offset:3168 lds
    v_mfma_f32_16x16x32_bf16 a[12:15], a[132:135], v[180:183], 0
    ds_read_b64_tr_b16 a[182:183], v3 offset:928
    v_mfma_f32_16x16x32_bf16 a[16:19], a[136:139], v[176:179], 0
    ds_read_b64_tr_b16 a[184:185], v3 offset:448
    v_mfma_f32_16x16x32_bf16 a[20:23], a[136:139], v[180:183], 0
    ds_read_b64_tr_b16 a[186:187], v3 offset:960
    v_mfma_f32_16x16x32_bf16 a[24:27], a[140:143], v[176:179], 0
    ds_read_b64_tr_b16 a[188:189], v3 offset:480
    v_mfma_f32_16x16x32_bf16 a[28:31], a[140:143], v[180:183], 0
    ds_read_b64_tr_b16 a[190:191], v3 offset:992
    v_mfma_f32_16x16x32_bf16 a[32:35], a[144:147], v[176:179], 0
    v_exp_f32 v160, v144
    v_mfma_f32_16x16x32_bf16 a[36:39], a[144:147], v[180:183], 0
    s_waitcnt vmcnt(12)
    s_barrier
    ds_read_b128 a[192:195], v2 offset:16896
    v_mfma_f32_16x16x32_bf16 a[40:43], a[148:151], v[176:179], 0
    v_exp_f32 v161, v145
    v_mfma_f32_16x16x32_bf16 a[44:47], a[148:151], v[180:183], 0
    ds_read_b128 a[196:199], v2 offset:16960
    s_add_u32 m0, s57, 101376
    v_mfma_f32_16x16x32_bf16 a[48:51], a[152:155], v[176:179], 0
    v_exp_f32 v162, v146
    v_mfma_f32_16x16x32_bf16 a[52:55], a[152:155], v[180:183], 0
    ds_read_b128 a[200:203], v2 offset:17024
    v_add_f32 v32, v160, v161
    v_mfma_f32_16x16x32_bf16 a[56:59], a[156:159], v[176:179], 0
    v_exp_f32 v163, v147
    v_mfma_f32_16x16x32_bf16 a[60:63], a[156:159], v[180:183], 0
    ds_read_b128 a[204:207], v2 offset:17088
    s_waitcnt lgkmcnt(4)
    v_mfma_f32_16x16x32_bf16 a[64:67], a[160:163], v[176:179], 0
    v_exp_f32 v164, v148
    v_mfma_f32_16x16x32_bf16 a[68:71], a[160:163], v[180:183], 0
    ds_read_b128 a[208:211], v2 offset:17152
    s_add_u32 s59, s59, 16384
    v_mfma_f32_16x16x32_bf16 a[72:75], a[164:167], v[176:179], 0
    v_exp_f32 v165, v149
    v_mfma_f32_16x16x32_bf16 a[76:79], a[164:167], v[180:183], 0
    ds_read_b128 a[212:215], v2 offset:17216
    v_cvt_pk_bf16_f32 v184, v160, v161
    v_mfma_f32_16x16x32_bf16 a[80:83], a[168:171], v[176:179], 0
    v_exp_f32 v166, v150
    v_mfma_f32_16x16x32_bf16 a[84:87], a[168:171], v[180:183], 0
    ds_read_b128 a[216:219], v2 offset:17280
    buffer_load_dwordx4 v18, s[8:11], s59 offen offset:0 lds
    v_mfma_f32_16x16x32_bf16 a[88:91], a[172:175], v[176:179], 0
    v_exp_f32 v167, v151
    v_mfma_f32_16x16x32_bf16 a[92:95], a[172:175], v[180:183], 0
    ds_read_b128 a[220:223], v2 offset:17344
    v_add_f32 v32, v32, v162
    v_mfma_f32_16x16x32_bf16 a[96:99], a[176:179], v[176:179], 0
    v_exp_f32 v168, v152
    v_mfma_f32_16x16x32_bf16 a[100:103], a[176:179], v[180:183], 0
    ds_read_b128 a[224:227], v2 offset:25344
    buffer_load_dwordx4 v19, s[8:11], s59 offen offset:1056 lds
    v_mfma_f32_16x16x32_bf16 a[104:107], a[180:183], v[176:179], 0
    v_exp_f32 v169, v153
    v_mfma_f32_16x16x32_bf16 a[108:111], a[180:183], v[180:183], 0
    ds_read_b128 a[228:231], v2 offset:25408
    v_add_f32 v32, v32, v163
    v_mfma_f32_16x16x32_bf16 a[112:115], a[184:187], v[176:179], 0
    v_exp_f32 v170, v154
    v_mfma_f32_16x16x32_bf16 a[116:119], a[184:187], v[180:183], 0
    ds_read_b128 a[232:235], v2 offset:25472
    v_cvt_pk_bf16_f32 v185, v162, v163
    v_mfma_f32_16x16x32_bf16 a[120:123], a[188:191], v[176:179], 0
    v_exp_f32 v171, v155
    v_mfma_f32_16x16x32_bf16 a[124:127], a[188:191], v[180:183], 0
    ds_read_b128 a[236:239], v2 offset:25536
    s_waitcnt lgkmcnt(4)
    v_mfma_f32_16x16x32_bf16 v[128:131], a[192:195], v[64:67], v[192:195]
    v_exp_f32 v172, v156
    v_mfma_f32_16x16x32_bf16 v[128:131], a[196:199], v[72:75], v[128:131]
    ds_read_b128 a[240:243], v2 offset:25600
    buffer_load_dwordx4 v20, s[8:11], s59 offen offset:2112 lds
    v_mfma_f32_16x16x32_bf16 v[128:131], a[200:203], v[80:83], v[128:131]
    v_exp_f32 v173, v157
    v_mfma_f32_16x16x32_bf16 v[128:131], a[204:207], v[88:91], v[128:131]
    ds_read_b128 a[244:247], v2 offset:25664
    v_add_f32 v33, v164, v165
    v_mfma_f32_16x16x32_bf16 v[128:131], a[208:211], v[96:99], v[128:131]
    v_exp_f32 v174, v158
    v_mfma_f32_16x16x32_bf16 v[128:131], a[212:215], v[104:107], v[128:131]
    ds_read_b128 a[248:251], v2 offset:25728
    v_cvt_pk_bf16_f32 v188, v164, v165
    v_mfma_f32_16x16x32_bf16 v[128:131], a[216:219], v[112:115], v[128:131]
    v_exp_f32 v175, v159
    v_mfma_f32_16x16x32_bf16 v[128:131], a[220:223], v[120:123], v[128:131]
    ds_read_b128 a[252:255], v2 offset:25792
    buffer_load_dwordx4 v21, s[8:11], s59 offen offset:3168 lds
    v_mfma_f32_16x16x32_bf16 v[132:135], a[192:195], v[68:71], v[196:199]
    ds_read_b64_tr_b16 a[128:129], v3 offset:33792
    v_add_f32 v33, v33, v166
    v_mfma_f32_16x16x32_bf16 v[132:135], a[196:199], v[76:79], v[132:135]
    ds_read_b64_tr_b16 a[130:131], v3 offset:34304
    v_add_f32 v33, v33, v167
    v_mfma_f32_16x16x32_bf16 v[132:135], a[200:203], v[84:87], v[132:135]
    ds_read_b64_tr_b16 a[132:133], v3 offset:33824
    v_cvt_pk_bf16_f32 v189, v166, v167
    v_mfma_f32_16x16x32_bf16 v[132:135], a[204:207], v[92:95], v[132:135]
    ds_read_b64_tr_b16 a[134:135], v3 offset:34336
    v_add_f32 v32, v32, v168
    v_mfma_f32_16x16x32_bf16 v[132:135], a[208:211], v[100:103], v[132:135]
    ds_read_b64_tr_b16 a[136:137], v3 offset:33856
    v_add_f32 v32, v32, v169
    v_mfma_f32_16x16x32_bf16 v[132:135], a[212:215], v[108:111], v[132:135]
    ds_read_b64_tr_b16 a[138:139], v3 offset:34368
    s_add_u32 m0, s57, 118272
    v_mfma_f32_16x16x32_bf16 v[132:135], a[216:219], v[116:119], v[132:135]
    ds_read_b64_tr_b16 a[140:141], v3 offset:33888
    v_cvt_pk_bf16_f32 v186, v168, v169
    v_mfma_f32_16x16x32_bf16 v[132:135], a[220:223], v[124:127], v[132:135]
    ds_read_b64_tr_b16 a[142:143], v3 offset:34400
    s_waitcnt lgkmcnt(8)
    v_mfma_f32_16x16x32_bf16 v[136:139], a[224:227], v[64:67], v[192:195]
    ds_read_b64_tr_b16 a[144:145], v3 offset:33920
    v_add_f32 v32, v32, v170
    v_mfma_f32_16x16x32_bf16 v[136:139], a[228:231], v[72:75], v[136:139]
    ds_read_b64_tr_b16 a[146:147], v3 offset:34432
    v_add_f32 v32, v32, v171
    v_mfma_f32_16x16x32_bf16 v[136:139], a[232:235], v[80:83], v[136:139]
    ds_read_b64_tr_b16 a[148:149], v3 offset:33952
    v_cvt_pk_bf16_f32 v187, v170, v171
    v_mfma_f32_16x16x32_bf16 v[136:139], a[236:239], v[88:91], v[136:139]
    ds_read_b64_tr_b16 a[150:151], v3 offset:34464
    v_add_f32 v33, v33, v172
    v_mfma_f32_16x16x32_bf16 v[136:139], a[240:243], v[96:99], v[136:139]
    ds_read_b64_tr_b16 a[152:153], v3 offset:33984
    s_add_u32 s58, s58, 16384
    v_mfma_f32_16x16x32_bf16 v[136:139], a[244:247], v[104:107], v[136:139]
    ds_read_b64_tr_b16 a[154:155], v3 offset:34496
    v_add_f32 v33, v33, v173
    v_mfma_f32_16x16x32_bf16 v[136:139], a[248:251], v[112:115], v[136:139]
    ds_read_b64_tr_b16 a[156:157], v3 offset:34016
    v_cvt_pk_bf16_f32 v190, v172, v173
    v_mfma_f32_16x16x32_bf16 v[136:139], a[252:255], v[120:123], v[136:139]
    ds_read_b64_tr_b16 a[158:159], v3 offset:34528
    v_add_f32 v33, v33, v174
    v_mfma_f32_16x16x32_bf16 v[140:143], a[224:227], v[68:71], v[196:199]
    ds_read_b64_tr_b16 a[160:161], v3 offset:34048
    v_add_f32 v33, v33, v175
    v_mfma_f32_16x16x32_bf16 v[140:143], a[228:231], v[76:79], v[140:143]
    ds_read_b64_tr_b16 a[162:163], v3 offset:34560
    v_cvt_pk_bf16_f32 v191, v174, v175
    v_mfma_f32_16x16x32_bf16 v[140:143], a[232:235], v[84:87], v[140:143]
    ds_read_b64_tr_b16 a[164:165], v3 offset:34080
    buffer_load_dwordx4 v14, s[4:7], s58 offen offset:0 lds
    v_mfma_f32_16x16x32_bf16 v[140:143], a[236:239], v[92:95], v[140:143]
    ds_read_b64_tr_b16 a[166:167], v3 offset:34592
    v_max_f32 v52, v32, v33
    v_mfma_f32_16x16x32_bf16 v[140:143], a[240:243], v[100:103], v[140:143]
    ds_read_b64_tr_b16 a[168:169], v3 offset:34112
    v_cmp_lt_f32 vcc, s90, v52
    v_mfma_f32_16x16x32_bf16 v[140:143], a[244:247], v[108:111], v[140:143]
    ds_read_b64_tr_b16 a[170:171], v3 offset:34624
    buffer_load_dwordx4 v15, s[4:7], s58 offen offset:1056 lds
    v_mfma_f32_16x16x32_bf16 v[140:143], a[248:251], v[116:119], v[140:143]
    ds_read_b64_tr_b16 a[172:173], v3 offset:34144
    buffer_load_dwordx4 v16, s[4:7], s58 offen offset:2112 lds
    v_mfma_f32_16x16x32_bf16 v[140:143], a[252:255], v[124:127], v[140:143]
    ds_read_b64_tr_b16 a[174:175], v3 offset:34656
    s_cbranch_vccnz L_tr_p1
L_bk_p1:
    s_waitcnt lgkmcnt(8)
    v_mfma_f32_16x16x32_bf16 a[0:3], a[128:131], v[184:187], a[0:3]
    ds_read_b64_tr_b16 a[176:177], v3 offset:34176
    v_add_f32 v30, v30, v32
    v_mfma_f32_16x16x32_bf16 a[4:7], a[128:131], v[188:191], a[4:7]
    ds_read_b64_tr_b16 a[178:179], v3 offset:34688
    v_add_f32 v31, v31, v33
    v_mfma_f32_16x16x32_bf16 a[8:11], a[132:135], v[184:187], a[8:11]
    ds_read_b64_tr_b16 a[180:181], v3 offset:34208
    buffer_load_dwordx4 v17, s[4:7], s58 offen offset:3168 lds
    v_mfma_f32_16x16x32_bf16 a[12:15], a[132:135], v[188:191], a[12:15]
    ds_read_b64_tr_b16 a[182:183], v3 offset:34720
    v_mfma_f32_16x16x32_bf16 a[16:19], a[136:139], v[184:187], a[16:19]
    ds_read_b64_tr_b16 a[184:185], v3 offset:34240
    v_mfma_f32_16x16x32_bf16 a[20:23], a[136:139], v[188:191], a[20:23]
    ds_read_b64_tr_b16 a[186:187], v3 offset:34752
    v_mfma_f32_16x16x32_bf16 a[24:27], a[140:143], v[184:187], a[24:27]
    ds_read_b64_tr_b16 a[188:189], v3 offset:34272
    v_mfma_f32_16x16x32_bf16 a[28:31], a[140:143], v[188:191], a[28:31]
    ds_read_b64_tr_b16 a[190:191], v3 offset:34784
    v_mfma_f32_16x16x32_bf16 a[32:35], a[144:147], v[184:187], a[32:35]
    v_exp_f32 v160, v128
    v_mfma_f32_16x16x32_bf16 a[36:39], a[144:147], v[188:191], a[36:39]
    s_waitcnt vmcnt(12)
    s_barrier
    ds_read_b128 a[192:195], v2 offset:50688
    v_mfma_f32_16x16x32_bf16 a[40:43], a[148:151], v[184:187], a[40:43]
    v_exp_f32 v161, v129
    v_mfma_f32_16x16x32_bf16 a[44:47], a[148:151], v[188:191], a[44:47]
    ds_read_b128 a[196:199], v2 offset:50752
    s_add_u32 m0, s57, 0
    v_mfma_f32_16x16x32_bf16 a[48:51], a[152:155], v[184:187], a[48:51]
    v_exp_f32 v162, v130
    v_mfma_f32_16x16x32_bf16 a[52:55], a[152:155], v[188:191], a[52:55]
    ds_read_b128 a[200:203], v2 offset:50816
    v_add_f32 v32, v160, v161
    v_mfma_f32_16x16x32_bf16 a[56:59], a[156:159], v[184:187], a[56:59]
    v_exp_f32 v163, v131
    v_mfma_f32_16x16x32_bf16 a[60:63], a[156:159], v[188:191], a[60:63]
    ds_read_b128 a[204:207], v2 offset:50880
    s_waitcnt lgkmcnt(4)
    v_mfma_f32_16x16x32_bf16 a[64:67], a[160:163], v[184:187], a[64:67]
    v_exp_f32 v164, v132
    v_mfma_f32_16x16x32_bf16 a[68:71], a[160:163], v[188:191], a[68:71]
    ds_read_b128 a[208:211], v2 offset:50944
    s_add_u32 s59, s59, 16384
    v_mfma_f32_16x16x32_bf16 a[72:75], a[164:167], v[184:187], a[72:75]
    v_exp_f32 v165, v133
    v_mfma_f32_16x16x32_bf16 a[76:79], a[164:167], v[188:191], a[76:79]
    ds_read_b128 a[212:215], v2 offset:51008
    v_cvt_pk_bf16_f32 v176, v160, v161
    v_mfma_f32_16x16x32_bf16 a[80:83], a[168:171], v[184:187], a[80:83]
    v_exp_f32 v166, v134
    v_mfma_f32_16x16x32_bf16 a[84:87], a[168:171], v[188:191], a[84:87]
    ds_read_b128 a[216:219], v2 offset:51072
    buffer_load_dwordx4 v18, s[8:11], s59 offen offset:0 lds
    v_mfma_f32_16x16x32_bf16 a[88:91], a[172:175], v[184:187], a[88:91]
    v_exp_f32 v167, v135
    v_mfma_f32_16x16x32_bf16 a[92:95], a[172:175], v[188:191], a[92:95]
    ds_read_b128 a[220:223], v2 offset:51136
    v_add_f32 v32, v32, v162
    v_mfma_f32_16x16x32_bf16 a[96:99], a[176:179], v[184:187], a[96:99]
    v_exp_f32 v168, v136
    v_mfma_f32_16x16x32_bf16 a[100:103], a[176:179], v[188:191], a[100:103]
    ds_read_b128 a[224:227], v2 offset:59136
    buffer_load_dwordx4 v19, s[8:11], s59 offen offset:1056 lds
    v_mfma_f32_16x16x32_bf16 a[104:107], a[180:183], v[184:187], a[104:107]
    v_exp_f32 v169, v137
    v_mfma_f32_16x16x32_bf16 a[108:111], a[180:183], v[188:191], a[108:111]
    ds_read_b128 a[228:231], v2 offset:59200
    v_add_f32 v32, v32, v163
    v_mfma_f32_16x16x32_bf16 a[112:115], a[184:187], v[184:187], a[112:115]
    v_exp_f32 v170, v138
    v_mfma_f32_16x16x32_bf16 a[116:119], a[184:187], v[188:191], a[116:119]
    ds_read_b128 a[232:235], v2 offset:59264
    v_cvt_pk_bf16_f32 v177, v162, v163
    v_mfma_f32_16x16x32_bf16 a[120:123], a[188:191], v[184:187], a[120:123]
    v_exp_f32 v171, v139
    v_mfma_f32_16x16x32_bf16 a[124:127], a[188:191], v[188:191], a[124:127]
    ds_read_b128 a[236:239], v2 offset:59328
L_loop:
    s_waitcnt lgkmcnt(4)
    v_mfma_f32_16x16x32_bf16 v[144:147], a[192:195], v[64:67], v[192:195]
    v_exp_f32 v172, v140
    v_mfma_f32_16x16x32_bf16 v[144:147], a[196:199], v[72:75], v[144:147]
    ds_read_b128 a[240:243], v2 offset:59392
    buffer_load_dwordx4 v20, s[8:11], s59 offen offset:2112 lds
    v_mfma_f32_16x16x32_bf16 v[144:147], a[200:203], v[80:83], v[144:147]
    v_exp_f32 v173, v141
    v_mfma_f32_16x16x32_bf16 v[144:147], a[204:207], v[88:91], v[144:147]
    ds_read_b128 a[244:247], v2 offset:59456
    v_add_f32 v33, v164, v165
    v_mfma_f32_16x16x32_bf16 v[144:147], a[208:211], v[96:99], v[144:147]
    v_exp_f32 v174, v142
    v_mfma_f32_16x16x32_bf16 v[144:147], a[212:215], v[104:107], v[144:147]
    ds_read_b128 a[248:251], v2 offset:59520
    v_cvt_pk_bf16_f32 v180, v164, v165
    v_mfma_f32_16x16x32_bf16 v[144:147], a[216:219], v[112:115], v[144:147]
    v_exp_f32 v175, v143
    v_mfma_f32_16x16x32_bf16 v[144:147], a[220:223], v[120:123], v[144:147]
    ds_read_b128 a[252:255], v2 offset:59584
    buffer_load_dwordx4 v21, s[8:11], s59 offen offset:3168 lds
    v_mfma_f32_16x16x32_bf16 v[148:151], a[192:195], v[68:71], v[196:199]
    ds_read_b64_tr_b16 a[128:129], v9 offset:0
    v_add_f32 v33, v33, v166
    v_mfma_f32_16x16x32_bf16 v[148:151], a[196:199], v[76:79], v[148:151]
    ds_read_b64_tr_b16 a[130:131], v9 offset:512
    v_add_f32 v33, v33, v167
    v_mfma_f32_16x16x32_bf16 v[148:151], a[200:203], v[84:87], v[148:151]
    ds_read_b64_tr_b16 a[132:133], v9 offset:32
    v_cvt_pk_bf16_f32 v181, v166, v167
    v_mfma_f32_16x16x32_bf16 v[148:151], a[204:207], v[92:95], v[148:151]
    ds_read_b64_tr_b16 a[134:135], v9 offset:544
    v_add_f32 v32, v32, v168
    v_mfma_f32_16x16x32_bf16 v[148:151], a[208:211], v[100:103], v[148:151]
    ds_read_b64_tr_b16 a[136:137], v9 offset:64
    v_add_f32 v32, v32, v169
    v_mfma_f32_16x16x32_bf16 v[148:151], a[212:215], v[108:111], v[148:151]
    ds_read_b64_tr_b16 a[138:139], v9 offset:576
    s_add_u32 m0, s57, 16896
    v_mfma_f32_16x16x32_bf16 v[148:151], a[216:219], v[116:119], v[148:151]
    ds_read_b64_tr_b16 a[140:141], v9 offset:96
    v_cvt_pk_bf16_f32 v178, v168, v169
    v_mfma_f32_16x16x32_bf16 v[148:151], a[220:223], v[124:127], v[148:151]
    ds_read_b64_tr_b16 a[142:143], v9 offset:608
    s_waitcnt lgkmcnt(8)
    v_mfma_f32_16x16x32_bf16 v[152:155], a[224:227], v[64:67], v[192:195]
    ds_read_b64_tr_b16 a[144:145], v9 offset:128
    v_add_f32 v32, v32, v170
    v_mfma_f32_16x16x32_bf16 v[152:155], a[228:231], v[72:75], v[152:155]
    ds_read_b64_tr_b16 a[146:147], v9 offset:640
    v_add_f32 v32, v32, v171
    v_mfma_f32_16x16x32_bf16 v[152:155], a[232:235], v[80:83], v[152:155]
    ds_read_b64_tr_b16 a[148:149], v9 offset:160
    v_cvt_pk_bf16_f32 v179, v170, v171
    v_mfma_f32_16x16x32_bf16 v[152:155], a[236:239], v[88:91], v[152:155]
    ds_read_b64_tr_b16 a[150:151], v9 offset:672
    v_add_f32 v33, v33, v172
    v_mfma_f32_16x16x32_bf16 v[152:155], a[240:243], v[96:99], v[152:155]
    ds_read_b64_tr_b16 a[152:153], v9 offset:192
    s_add_u32 s58, s58, 16384
    v_mfma_f32_16x16x32_bf16 v[152:155], a[244:247], v[104:107], v[152:155]
    ds_read_b64_tr_b16 a[154:155], v9 offset:704
    v_add_f32 v33, v33, v173
    v_mfma_f32_16x16x32_bf16 v[152:155], a[248:251], v[112:115], v[152:155]
    ds_read_b64_tr_b16 a[156:157], v9 offset:224
    v_cvt_pk_bf16_f32 v182, v172, v173
    v_mfma_f32_16x16x32_bf16 v[152:155], a[252:255], v[120:123], v[152:155]
    ds_read_b64_tr_b16 a[158:159], v9 offset:736
    v_add_f32 v33, v33, v174
    v_mfma_f32_16x16x32_bf16 v[156:159], a[224:227], v[68:71], v[196:199]
    ds_read_b64_tr_b16 a[160:161], v9 offset:256
    v_add_f32 v33, v33, v175
    v_mfma_f32_16x16x32_bf16 v[156:159], a[228:231], v[76:79], v[156:159]
    ds_read_b64_tr_b16 a[162:163], v9 offset:768
    v_cvt_pk_bf16_f32 v183, v174, v175
    v_mfma_f32_16x16x32_bf16 v[156:159], a[232:235], v[84:87], v[156:159]
    ds_read_b64_tr_b16 a[164:165], v9 offset:288
    buffer_load_dwordx4 v14, s[4:7], s58 offen offset:0 lds
    v_mfma_f32_16x16x32_bf16 v[156:159], a[236:239], v[92:95], v[156:159]
    ds_read_b64_tr_b16 a[166:167], v9 offset:800
    v_max_f32 v52, v32, v33
    v_mfma_f32_16x16x32_bf16 v[156:159], a[240:243], v[100:103], v[156:159]
    ds_read_b64_tr_b16 a[168:169], v9 offset:320
    v_cmp_lt_f32 vcc, s90, v52
    v_mfma_f32_16x16x32_bf16 v[156:159], a[244:247], v[108:111], v[156:159]
    ds_read_b64_tr_b16 a[170:171], v9 offset:832
    buffer_load_dwordx4 v15, s[4:7], s58 offen offset:1056 lds
    v_mfma_f32_16x16x32_bf16 v[156:159], a[248:251], v[116:119], v[156:159]
    ds_read_b64_tr_b16 a[172:173], v9 offset:352
    buffer_load_dwordx4 v16, s[4:7], s58 offen offset:2112 lds
    v_mfma_f32_16x16x32_bf16 v[156:159], a[252:255], v[124:127], v[156:159]
    ds_read_b64_tr_b16 a[174:175], v9 offset:864
    s_cbranch_vccnz L_tr_lp0
L_bk_lp0:
    s_waitcnt lgkmcnt(8)
    v_mfma_f32_16x16x32_bf16 a[0:3], a[128:131], v[176:179], a[0:3]
    ds_read_b64_tr_b16 a[176:177], v9 offset:384
    v_add_f32 v30, v30, v32
    v_mfma_f32_16x16x32_bf16 a[4:7], a[128:131], v[180:183], a[4:7]
    ds_read_b64_tr_b16 a[178:179], v9 offset:896
    v_add_f32 v31, v31, v33
    v_mfma_f32_16x16x32_bf16 a[8:11], a[132:135], v[176:179], a[8:11]
    ds_read_b64_tr_b16 a[180:181], v9 offset:416
    buffer_load_dwordx4 v17, s[4:7], s58 offen offset:3168 lds
    v_mfma_f32_16x16x32_bf16 a[12:15], a[132:135], v[180:183], a[12:15]
    ds_read_b64_tr_b16 a[182:183], v9 offset:928
    buffer_load_dword v56, v53, s[4:7], s58 offen
    v_mfma_f32_16x16x32_bf16 a[16:19], a[136:139], v[176:179], a[16:19]
    ds_read_b64_tr_b16 a[184:185], v9 offset:448
    v_mfma_f32_16x16x32_bf16 a[20:23], a[136:139], v[180:183], a[20:23]
    ds_read_b64_tr_b16 a[186:187], v9 offset:960
    v_mfma_f32_16x16x32_bf16 a[24:27], a[140:143], v[176:179], a[24:27]
    ds_read_b64_tr_b16 a[188:189], v9 offset:480
    v_mfma_f32_16x16x32_bf16 a[28:31], a[140:143], v[180:183], a[28:31]
    ds_read_b64_tr_b16 a[190:191], v9 offset:992
    v_mfma_f32_16x16x32_bf16 a[32:35], a[144:147], v[176:179], a[32:35]
    v_exp_f32 v160, v144
    v_mfma_f32_16x16x32_bf16 a[36:39], a[144:147], v[180:183], a[36:39]
    s_waitcnt vmcnt(13)
    s_barrier
    ds_read_b128 a[192:195], v8 offset:16896
    v_mfma_f32_16x16x32_bf16 a[40:43], a[148:151], v[176:179], a[40:43]
    v_exp_f32 v161, v145
    v_mfma_f32_16x16x32_bf16 a[44:47], a[148:151], v[180:183], a[44:47]
    ds_read_b128 a[196:199], v8 offset:16960
    s_add_u32 m0, s57, 33792
    v_mfma_f32_16x16x32_bf16 a[48:51], a[152:155], v[176:179], a[48:51]
    v_exp_f32 v162, v146
    v_mfma_f32_16x16x32_bf16 a[52:55], a[152:155], v[180:183], a[52:55]
    ds_read_b128 a[200:203], v8 offset:17024
    v_add_f32 v32, v160, v161
    v_mfma_f32_16x16x32_bf16 a[56:59], a[156:159], v[176:179], a[56:59]
    v_exp_f32 v163, v147
    v_mfma_f32_16x16x32_bf16 a[60:63], a[156:159], v[180:183], a[60:63]
    ds_read_b128 a[204:207], v8 offset:17088
    s_waitcnt lgkmcnt(4)
    v_mfma_f32_16x16x32_bf16 a[64:67], a[160:163], v[176:179], a[64:67]
    v_exp_f32 v164, v148
    v_mfma_f32_16x16x32_bf16 a[68:71], a[160:163], v[180:183], a[68:71]
    ds_read_b128 a[208:211], v8 offset:17152
    s_add_u32 s59, s59, 16384
    v_mfma_f32_16x16x32_bf16 a[72:75], a[164:167], v[176:179], a[72:75]
    v_exp_f32 v165, v149
    v_mfma_f32_16x16x32_bf16 a[76:79], a[164:167], v[180:183], a[76:79]
    ds_read_b128 a[212:215], v8 offset:17216
    v_cvt_pk_bf16_f32 v184, v160, v161
    v_mfma_f32_16x16x32_bf16 a[80:83], a[168:171], v[176:179], a[80:83]
    v_exp_f32 v166, v150
    v_mfma_f32_16x16x32_bf16 a[84:87], a[168:171], v[180:183], a[84:87]
    ds_read_b128 a[216:219], v8 offset:17280
    buffer_load_dwordx4 v18, s[8:11], s59 offen offset:0 lds
    v_mfma_f32_16x16x32_bf16 a[88:91], a[172:175], v[176:179], a[88:91]
    v_exp_f32 v167, v151
    v_mfma_f32_16x16x32_bf16 a[92:95], a[172:175], v[180:183], a[92:95]
    ds_read_b128 a[220:223], v8 offset:17344
    v_add_f32 v32, v32, v162
    v_mfma_f32_16x16x32_bf16 a[96:99], a[176:179], v[176:179], a[96:99]
    v_exp_f32 v168, v152
    v_mfma_f32_16x16x32_bf16 a[100:103], a[176:179], v[180:183], a[100:103]
    ds_read_b128 a[224:227], v8 offset:25344
    buffer_load_dwordx4 v19, s[8:11], s59 offen offset:1056 lds
    v_mfma_f32_16x16x32_bf16 a[104:107], a[180:183], v[176:179], a[104:107]
    v_exp_f32 v169, v153
    v_mfma_f32_16x16x32_bf16 a[108:111], a[180:183], v[180:183], a[108:111]
    ds_read_b128 a[228:231], v8 offset:25408
    v_add_f32 v32, v32, v163
    v_mfma_f32_16x16x32_bf16 a[112:115], a[184:187], v[176:179], a[112:115]
    v_exp_f32 v170, v154
    v_mfma_f32_16x16x32_bf16 a[116:119], a[184:187], v[180:183], a[116:119]
    ds_read_b128 a[232:235], v8 offset:25472
    v_cvt_pk_bf16_f32 v185, v162, v163
    v_mfma_f32_16x16x32_bf16 a[120:123], a[188:191], v[176:179], a[120:123]
    v_exp_f32 v171, v155
    v_mfma_f32_16x16x32_bf16 a[124:127], a[188:191], v[180:183], a[124:127]
    ds_read_b128 a[236:239], v8 offset:25536
    s_waitcnt lgkmcnt(4)
    v_mfma_f32_16x16x32_bf16 v[128:131], a[192:195], v[64:67], v[192:195]
    v_exp_f32 v172, v156
    v_mfma_f32_16x16x32_bf16 v[128:131], a[196:199], v[72:75], v[128:131]
    ds_read_b128 a[240:243], v8 offset:25600
    buffer_load_dwordx4 v20, s[8:11], s59 offen offset:2112 lds
    v_mfma_f32_16x16x32_bf16 v[128:131], a[200:203], v[80:83], v[128:131]
    v_exp_f32 v173, v157
    v_mfma_f32_16x16x32_bf16 v[128:131], a[204:207], v[88:91], v[128:131]
    ds_read_b128 a[244:247], v8 offset:25664
    v_add_f32 v33, v164, v165
    v_mfma_f32_16x16x32_bf16 v[128:131], a[208:211], v[96:99], v[128:131]
    v_exp_f32 v174, v158
    v_mfma_f32_16x16x32_bf16 v[128:131], a[212:215], v[104:107], v[128:131]
    ds_read_b128 a[248:251], v8 offset:25728
    v_cvt_pk_bf16_f32 v188, v164, v165
    v_mfma_f32_16x16x32_bf16 v[128:131], a[216:219], v[112:115], v[128:131]
    v_exp_f32 v175, v159
    v_mfma_f32_16x16x32_bf16 v[128:131], a[220:223], v[120:123], v[128:131]
    ds_read_b128 a[252:255], v8 offset:25792
    buffer_load_dwordx4 v21, s[8:11], s59 offen offset:3168 lds
    v_mfma_f32_16x16x32_bf16 v[132:135], a[192:195], v[68:71], v[196:199]
    ds_read_b64_tr_b16 a[128:129], v9 offset:33792
    v_add_f32 v33, v33, v166
    v_mfma_f32_16x16x32_bf16 v[132:135], a[196:199], v[76:79], v[132:135]
    ds_read_b64_tr_b16 a[130:131], v9 offset:34304
    v_add_f32 v33, v33, v167
    v_mfma_f32_16x16x32_bf16 v[132:135], a[200:203], v[84:87], v[132:135]
    ds_read_b64_tr_b16 a[132:133], v9 offset:33824
    v_cvt_pk_bf16_f32 v189, v166, v167
    v_mfma_f32_16x16x32_bf16 v[132:135], a[204:207], v[92:95], v[132:135]
    ds_read_b64_tr_b16 a[134:135], v9 offset:34336
    v_add_f32 v32, v32, v168
    v_mfma_f32_16x16x32_bf16 v[132:135], a[208:211], v[100:103], v[132:135]
    ds_read_b64_tr_b16 a[136:137], v9 offset:33856
    v_add_f32 v32, v32, v169
    v_mfma_f32_16x16x32_bf16 v[132:135], a[212:215], v[108:111], v[132:135]
    ds_read_b64_tr_b16 a[138:139], v9 offset:34368
    s_add_u32 m0, s57, 50688
    v_mfma_f32_16x16x32_bf16 v[132:135], a[216:219], v[116:119], v[132:135]
    ds_read_b64_tr_b16 a[140:141], v9 offset:33888
    v_cvt_pk_bf16_f32 v186, v168, v169
    v_mfma_f32_16x16x32_bf16 v[132:135], a[220:223], v[124:127], v[132:135]
    ds_read_b64_tr_b16 a[142:143], v9 offset:34400
    s_waitcnt lgkmcnt(8)
    v_mfma_f32_16x16x32_bf16 v[136:139], a[224:227], v[64:67], v[192:195]
    ds_read_b64_tr_b16 a[144:145], v9 offset:33920
    v_add_f32 v32, v32, v170
    v_mfma_f32_16x16x32_bf16 v[136:139], a[228:231], v[72:75], v[136:139]
    ds_read_b64_tr_b16 a[146:147], v9 offset:34432
    v_add_f32 v32, v32, v171
    v_mfma_f32_16x16x32_bf16 v[136:139], a[232:235], v[80:83], v[136:139]
    ds_read_b64_tr_b16 a[148:149], v9 offset:33952
    v_cvt_pk_bf16_f32 v187, v170, v171
    v_mfma_f32_16x16x32_bf16 v[136:139], a[236:239], v[88:91], v[136:139]
    ds_read_b64_tr_b16 a[150:151], v9 offset:34464
    v_add_f32 v33, v33, v172
    v_mfma_f32_16x16x32_bf16 v[136:139], a[240:243], v[96:99], v[136:139]
    ds_read_b64_tr_b16 a[152:153], v9 offset:33984
    s_add_u32 s58, s58, 16384
    v_mfma_f32_16x16x32_bf16 v[136:139], a[244:247], v[104:107], v[136:139]
    ds_read_b64_tr_b16 a[154:155], v9 offset:34496
    v_add_f32 v33, v33, v173
    v_mfma_f32_16x16x32_bf16 v[136:139], a[248:251], v[112:115], v[136:139]
    ds_read_b64_tr_b16 a[156:157], v9 offset:34016
    v_cvt_pk_bf16_f32 v190, v172, v173
    v_mfma_f32_16x16x32_bf16 v[136:139], a[252:255], v[120:123], v[136:139]
    ds_read_b64_tr_b16 a[158:159], v9 offset:34528
    v_add_f32 v33, v33, v174
    v_mfma_f32_16x16x32_bf16 v[140:143], a[224:227], v[68:71], v[196:199]
    ds_read_b64_tr_b16 a[160:161], v9 offset:34048
    v_add_f32 v33, v33, v175
    v_mfma_f32_16x16x32_bf16 v[140:143], a[228:231], v[76:79], v[140:143]
    ds_read_b64_tr_b16 a[162:163], v9 offset:34560
    v_cvt_pk_bf16_f32 v191, v174, v175
    v_mfma_f32_16x16x32_bf16 v[140:143], a[232:235], v[84:87], v[140:143]
    ds_read_b64_tr_b16 a[164:165], v9 offset:34080
    buffer_load_dwordx4 v14, s[4:7], s58 offen offset:0 lds
    v_mfma_f32_16x16x32_bf16 v[140:143], a[236:239], v[92:95], v[140:143]
    ds_read_b64_tr_b16 a[166:167], v9 offset:34592
    v_max_f32 v52, v32, v33
    v_mfma_f32_16x16x32_bf16 v[140:143], a[240:243], v[100:103], v[140:143]
    ds_read_b64_tr_b16 a[168:169], v9 offset:34112
    v_cmp_lt_f32 vcc, s90, v52
    v_mfma_f32_16x16x32_bf16 v[140:143], a[244:247], v[108:111], v[140:143]
    ds_read_b64_tr_b16 a[170:171], v9 offset:34624
    buffer_load_dwordx4 v15, s[4:7], s58 offen offset:1056 lds
    v_mfma_f32_16x16x32_bf16 v[140:143], a[248:251], v[116:119], v[140:143]
    ds_read_b64_tr_b16 a[172:173], v9 offset:34144
    buffer_load_dwordx4 v16, s[4:7], s58 offen offset:2112 lds
    v_mfma_f32_16x16x32_bf16 v[140:143], a[252:255], v[124:127], v[140:143]
    ds_read_b64_tr_b16 a[174:175], v9 offset:34656
    s_cbranch_vccnz L_tr_lp1
L_bk_lp1:
    s_waitcnt lgkmcnt(8)
    v_mfma_f32_16x16x32_bf16 a[0:3], a[128:131], v[184:187], a[0:3]
    ds_read_b64_tr_b16 a[176:177], v9 offset:34176
    v_add_f32 v30, v30, v32
    v_mfma_f32_16x16x32_bf16 a[4:7], a[128:131], v[188:191], a[4:7]
    ds_read_b64_tr_b16 a[178:179], v9 offset:34688
    v_add_f32 v31, v31, v33
    v_mfma_f32_16x16x32_bf16 a[8:11], a[132:135], v[184:187], a[8:11]
    ds_read_b64_tr_b16 a[180:181], v9 offset:34208
    buffer_load_dwordx4 v17, s[4:7], s58 offen offset:3168 lds
    v_mfma_f32_16x16x32_bf16 a[12:15], a[132:135], v[188:191], a[12:15]
    ds_read_b64_tr_b16 a[182:183], v9 offset:34720
    v_mfma_f32_16x16x32_bf16 a[16:19], a[136:139], v[184:187], a[16:19]
    ds_read_b64_tr_b16 a[184:185], v9 offset:34240
    v_mfma_f32_16x16x32_bf16 a[20:23], a[136:139], v[188:191], a[20:23]
    ds_read_b64_tr_b16 a[186:187], v9 offset:34752
    v_mfma_f32_16x16x32_bf16 a[24:27], a[140:143], v[184:187], a[24:27]
    ds_read_b64_tr_b16 a[188:189], v9 offset:34272
    v_mfma_f32_16x16x32_bf16 a[28:31], a[140:143], v[188:191], a[28:31]
    ds_read_b64_tr_b16 a[190:191], v9 offset:34784
    v_mfma_f32_16x16x32_bf16 a[32:35], a[144:147], v[184:187], a[32:35]
    v_exp_f32 v160, v128
    v_mfma_f32_16x16x32_bf16 a[36:39], a[144:147], v[188:191], a[36:39]
    s_waitcnt vmcnt(13)
    s_barrier
    ds_read_b128 a[192:195], v8 offset:50688
    v_mfma_f32_16x16x32_bf16 a[40:43], a[148:151], v[184:187], a[40:43]
    v_exp_f32 v161, v129
    v_mfma_f32_16x16x32_bf16 a[44:47], a[148:151], v[188:191], a[44:47]
    ds_read_b128 a[196:199], v8 offset:50752
    s_add_u32 m0, s57, 67584
    v_mfma_f32_16x16x32_bf16 a[48:51], a[152:155], v[184:187], a[48:51]
    v_exp_f32 v162, v130
    v_mfma_f32_16x16x32_bf16 a[52:55], a[152:155], v[188:191], a[52:55]
    ds_read_b128 a[200:203], v8 offset:50816
    v_add_f32 v32, v160, v161
    v_mfma_f32_16x16x32_bf16 a[56:59], a[156:159], v[184:187], a[56:59]
    v_exp_f32 v163, v131
    v_mfma_f32_16x16x32_bf16 a[60:63], a[156:159], v[188:191], a[60:63]
    ds_read_b128 a[204:207], v8 offset:50880
    s_waitcnt lgkmcnt(4)
    v_mfma_f32_16x16x32_bf16 a[64:67], a[160:163], v[184:187], a[64:67]
    v_exp_f32 v164, v132
    v_mfma_f32_16x16x32_bf16 a[68:71], a[160:163], v[188:191], a[68:71]
    ds_read_b128 a[208:211], v8 offset:50944
    s_add_u32 s59, s59, 16384
    v_mfma_f32_16x16x32_bf16 a[72:75], a[164:167], v[184:187], a[72:75]
    v_exp_f32 v165, v133
    v_mfma_f32_16x16x32_bf16 a[76:79], a[164:167], v[188:191], a[76:79]
    ds_read_b128 a[212:215], v8 offset:51008
    v_cvt_pk_bf16_f32 v176, v160, v161
    v_mfma_f32_16x16x32_bf16 a[80:83], a[168:171], v[184:187], a[80:83]
    v_exp_f32 v166, v134
    v_mfma_f32_16x16x32_bf16 a[84:87], a[168:171], v[188:191], a[84:87]
    ds_read_b128 a[216:219], v8 offset:51072
    buffer_load_dwordx4 v18, s[8:11], s59 offen offset:0 lds
    v_mfma_f32_16x16x32_bf16 a[88:91], a[172:175], v[184:187], a[88:91]
    v_exp_f32 v167, v135
    v_mfma_f32_16x16x32_bf16 a[92:95], a[172:175], v[188:191], a[92:95]
    ds_read_b128 a[220:223], v8 offset:51136
    v_add_f32 v32, v32, v162
    v_mfma_f32_16x16x32_bf16 a[96:99], a[176:179], v[184:187], a[96:99]
    v_exp_f32 v168, v136
    v_mfma_f32_16x16x32_bf16 a[100:103], a[176:179], v[188:191], a[100:103]
    ds_read_b128 a[224:227], v8 offset:59136
    buffer_load_dwordx4 v19, s[8:11], s59 offen offset:1056 lds
    v_mfma_f32_16x16x32_bf16 a[104:107], a[180:183], v[184:187], a[104:107]
    v_exp_f32 v169, v137
    v_mfma_f32_16x16x32_bf16 a[108:111], a[180:183], v[188:191], a[108:111]
    ds_read_b128 a[228:231], v8 offset:59200
    v_add_f32 v32, v32, v163
    v_mfma_f32_16x16x32_bf16 a[112:115], a[184:187], v[184:187], a[112:115]
    v_exp_f32 v170, v138
    v_mfma_f32_16x16x32_bf16 a[116:119], a[184:187], v[188:191], a[116:119]
    ds_read_b128 a[232:235], v8 offset:59264
    v_cvt_pk_bf16_f32 v177, v162, v163
    v_mfma_f32_16x16x32_bf16 a[120:123], a[188:191], v[184:187], a[120:123]
    v_exp_f32 v171, v139
    v_mfma_f32_16x16x32_bf16 a[124:127], a[188:191], v[188:191], a[124:127]
    ds_read_b128 a[236:239], v8 offset:59328
    s_waitcnt lgkmcnt(4)
    v_mfma_f32_16x16x32_bf16 v[144:147], a[192:195], v[64:67], v[192:195]
    v_exp_f32 v172, v140
    v_mfma_f32_16x16x32_bf16 v[144:147], a[196:199], v[72:75], v[144:147]
    ds_read_b128 a[240:243], v8 offset:59392
    buffer_load_dwordx4 v20, s[8:11], s59 offen offset:2112 lds
    v_mfma_f32_16x16x32_bf16 v[144:147], a[200:203], v[80:83], v[144:147]
    v_exp_f32 v173, v141
    v_mfma_f32_16x16x32_bf16 v[144:147], a[204:207], v[88:91], v[144:147]
    ds_read_b128 a[244:247], v8 offset:59456
    v_add_f32 v33, v164, v165
    v_mfma_f32_16x16x32_bf16 v[144:147], a[208:211], v[96:99], v[144:147]
    v_exp_f32 v174, v142
    v_mfma_f32_16x16x32_bf16 v[144:147], a[212:215], v[104:107], v[144:147]
    ds_read_b128 a[248:251], v8 offset:59520
    v_cvt_pk_bf16_f32 v180, v164, v165
    v_mfma_f32_16x16x32_bf16 v[144:147], a[216:219], v[112:115], v[144:147]
    v_exp_f32 v175, v143
    v_mfma_f32_16x16x32_bf16 v[144:147], a[220:223], v[120:123], v[144:147]
    ds_read_b128 a[252:255], v8 offset:59584
    buffer_load_dwordx4 v21, s[8:11], s59 offen offset:3168 lds
    v_mfma_f32_16x16x32_bf16 v[148:151], a[192:195], v[68:71], v[196:199]
    ds_read_b64_tr_b16 a[128:129], v3 offset:0
    v_add_f32 v33, v33, v166
    v_mfma_f32_16x16x32_bf16 v[148:151], a[196:199], v[76:79], v[148:151]
    ds_read_b64_tr_b16 a[130:131], v3 offset:512
    v_add_f32 v33, v33, v167
    v_mfma_f32_16x16x32_bf16 v[148:151], a[200:203], v[84:87], v[148:151]
    ds_read_b64_tr_b16 a[132:133], v3 offset:32
    v_cvt_pk_bf16_f32 v181, v166, v167
    v_mfma_f32_16x16x32_bf16 v[148:151], a[204:207], v[92:95], v[148:151]
    ds_read_b64_tr_b16 a[134:135], v3 offset:544
    v_add_f32 v32, v32, v168
    v_mfma_f32_16x16x32_bf16 v[148:151], a[208:211], v[100:103], v[148:151]
    ds_read_b64_tr_b16 a[136:137], v3 offset:64
    v_add_f32 v32, v32, v169
    v_mfma_f32_16x16x32_bf16 v[148:151], a[212:215], v[108:111], v[148:151]
    ds_read_b64_tr_b16 a[138:139], v3 offset:576
    s_add_u32 m0, s57, 84480
    v_mfma_f32_16x16x32_bf16 v[148:151], a[216:219], v[116:119], v[148:151]
    ds_read_b64_tr_b16 a[140:141], v3 offset:96
    v_cvt_pk_bf16_f32 v178, v168, v169
    v_mfma_f32_16x16x32_bf16 v[148:151], a[220:223], v[124:127], v[148:151]
    ds_read_b64_tr_b16 a[142:143], v3 offset:608
    s_waitcnt lgkmcnt(8)
    v_mfma_f32_16x16x32_bf16 v[152:155], a[224:227], v[64:67], v[192:195]
    ds_read_b64_tr_b16 a[144:145], v3 offset:128
    v_add_f32 v32, v32, v170
    v_mfma_f32_16x16x32_bf16 v[152:155], a[228:231], v[72:75], v[152:155]
    ds_read_b64_tr_b16 a[146:147], v3 offset:640
    v_add_f32 v32, v32, v171
    v_mfma_f32_16x16x32_bf16 v[152:155], a[232:235], v[80:83], v[152:155]
    ds_read_b64_tr_b16 a[148:149], v3 offset:160
    v_cvt_pk_bf16_f32 v179, v170, v171
    v_mfma_f32_16x16x32_bf16 v[152:155], a[236:239], v[88:91], v[152:155]
    ds_read_b64_tr_b16 a[150:151], v3 offset:672
    v_add_f32 v33, v33, v172
    v_mfma_f32_16x16x32_bf16 v[152:155], a[240:243], v[96:99], v[152:155]
    ds_read_b64_tr_b16 a[152:153], v3 offset:192
    s_add_u32 s58, s58, 16384
    v_mfma_f32_16x16x32_bf16 v[152:155], a[244:247], v[104:107], v[152:155]
    ds_read_b64_tr_b16 a[154:155], v3 offset:704
    v_add_f32 v33, v33, v173
    v_mfma_f32_16x16x32_bf16 v[152:155], a[248:251], v[112:115], v[152:155]
    ds_read_b64_tr_b16 a[156:157], v3 offset:224
    v_cvt_pk_bf16_f32 v182, v172, v173
    v_mfma_f32_16x16x32_bf16 v[152:155], a[252:255], v[120:123], v[152:155]
    ds_read_b64_tr_b16 a[158:159], v3 offset:736
    v_add_f32 v33, v33, v174
    v_mfma_f32_16x16x32_bf16 v[156:159], a[224:227], v[68:71], v[196:199]
    ds_read_b64_tr_b16 a[160:161], v3 offset:256
    v_add_f32 v33, v33, v175
    v_mfma_f32_16x16x32_bf16 v[156:159], a[228:231], v[76:79], v[156:159]
    ds_read_b64_tr_b16 a[162:163], v3 offset:768
    v_cvt_pk_bf16_f32 v183, v174, v175
    v_mfma_f32_16x16x32_bf16 v[156:159], a[232:235], v[84:87], v[156:159]
    ds_read_b64_tr_b16 a[164:165], v3 offset:288
    buffer_load_dwordx4 v14, s[4:7], s58 offen offset:0 lds
    v_mfma_f32_16x16x32_bf16 v[156:159], a[236:239], v[92:95], v[156:159]
    ds_read_b64_tr_b16 a[166:167], v3 offset:800
    v_max_f32 v52, v32, v33
    v_mfma_f32_16x16x32_bf16 v[156:159], a[240:243], v[100:103], v[156:159]
    ds_read_b64_tr_b16 a[168:169], v3 offset:320
    v_cmp_lt_f32 vcc, s90, v52
    v_mfma_f32_16x16x32_bf16 v[156:159], a[244:247], v[108:111], v[156:159]
    ds_read_b64_tr_b16 a[170:171], v3 offset:832
    buffer_load_dwordx4 v15, s[4:7], s58 offen offset:1056 lds
    v_mfma_f32_16x16x32_bf16 v[156:159], a[248:251], v[116:119], v[156:159]
    ds_read_b64_tr_b16 a[172:173], v3 offset:352
    buffer_load_dwordx4 v16, s[4:7], s58 offen offset:2112 lds
    v_mfma_f32_16x16x32_bf16 v[156:159], a[252:255], v[124:127], v[156:159]
    ds_read_b64_tr_b16 a[174:175], v3 offset:864
    s_cbranch_vccnz L_tr_lp2
L_bk_lp2:
    s_waitcnt lgkmcnt(8)
    v_mfma_f32_16x16x32_bf16 a[0:3], a[128:131], v[176:179], a[0:3]
    ds_read_b64_tr_b16 a[176:177], v3 offset:384
    v_add_f32 v30, v30, v32
    v_mfma_f32_16x16x32_bf16 a[4:7], a[128:131], v[180:183], a[4:7]
    ds_read_b64_tr_b16 a[178:179], v3 offset:896
    v_add_f32 v31, v31, v33
    v_mfma_f32_16x16x32_bf16 a[8:11], a[132:135], v[176:179], a[8:11]
    ds_read_b64_tr_b16 a[180:181], v3 offset:416
    buffer_load_dwordx4 v17, s[4:7], s58 offen offset:3168 lds
    v_mfma_f32_16x16x32_bf16 a[12:15], a[132:135], v[180:183], a[12:15]
    ds_read_b64_tr_b16 a[182:183], v3 offset:928
    buffer_load_dword v56, v53, s[8:11], s59 offen
    v_mfma_f32_16x16x32_bf16 a[16:19], a[136:139], v[176:179], a[16:19]
    ds_read_b64_tr_b16 a[184:185], v3 offset:448
    v_mfma_f32_16x16x32_bf16 a[20:23], a[136:139], v[180:183], a[20:23]
    ds_read_b64_tr_b16 a[186:187], v3 offset:960
    v_mfma_f32_16x16x32_bf16 a[24:27], a[140:143], v[176:179], a[24:27]
    ds_read_b64_tr_b16 a[188:189], v3 offset:480
    v_mfma_f32_16x16x32_bf16 a[28:31], a[140:143], v[180:183], a[28:31]
    ds_read_b64_tr_b16 a[190:191], v3 offset:992
    v_mfma_f32_16x16x32_bf16 a[32:35], a[144:147], v[176:179], a[32:35]
    v_exp_f32 v160, v144
    v_mfma_f32_16x16x32_bf16 a[36:39], a[144:147], v[180:183], a[36:39]
    s_waitcnt vmcnt(13)
    s_barrier
    ds_read_b128 a[192:195], v2 offset:16896
    v_mfma_f32_16x16x32_bf16 a[40:43], a[148:151], v[176:179], a[40:43]
    v_exp_f32 v161, v145
    v_mfma_f32_16x16x32_bf16 a[44:47], a[148:151], v[180:183], a[44:47]
    ds_read_b128 a[196:199], v2 offset:16960
    s_add_u32 m0, s57, 101376
    v_mfma_f32_16x16x32_bf16 a[48:51], a[152:155], v[176:179], a[48:51]
    v_exp_f32 v162, v146
    v_mfma_f32_16x16x32_bf16 a[52:55], a[152:155], v[180:183], a[52:55]
    ds_read_b128 a[200:203], v2 offset:17024
    v_add_f32 v32, v160, v161
    v_mfma_f32_16x16x32_bf16 a[56:59], a[156:159], v[176:179], a[56:59]
    v_exp_f32 v163, v147
    v_mfma_f32_16x16x32_bf16 a[60:63], a[156:159], v[180:183], a[60:63]
    ds_read_b128 a[204:207], v2 offset:17088
    s_waitcnt lgkmcnt(4)
    v_mfma_f32_16x16x32_bf16 a[64:67], a[160:163], v[176:179], a[64:67]
    v_exp_f32 v164, v148
    v_mfma_f32_16x16x32_bf16 a[68:71], a[160:163], v[180:183], a[68:71]
    ds_read_b128 a[208:211], v2 offset:17152
    s_add_u32 s59, s59, 16384
    v_mfma_f32_16x16x32_bf16 a[72:75], a[164:167], v[176:179], a[72:75]
    v_exp_f32 v165, v149
    v_mfma_f32_16x16x32_bf16 a[76:79], a[164:167], v[180:183], a[76:79]
    ds_read_b128 a[212:215], v2 offset:17216
    v_cvt_pk_bf16_f32 v184, v160, v161
    v_mfma_f32_16x16x32_bf16 a[80:83], a[168:171], v[176:179], a[80:83]
    v_exp_f32 v166, v150
    v_mfma_f32_16x16x32_bf16 a[84:87], a[168:171], v[180:183], a[84:87]
    ds_read_b128 a[216:219], v2 offset:17280
    buffer_load_dwordx4 v18, s[8:11], s59 offen offset:0 lds
    v_mfma_f32_16x16x32_bf16 a[88:91], a[172:175], v[176:179], a[88:91]
    v_exp_f32 v167, v151
    v_mfma_f32_16x16x32_bf16 a[92:95], a[172:175], v[180:183], a[92:95]
    ds_read_b128 a[220:223], v2 offset:17344
    v_add_f32 v32, v32, v162
    v_mfma_f32_16x16x32_bf16 a[96:99], a[176:179], v[176:179], a[96:99]
    v_exp_f32 v168, v152
    v_mfma_f32_16x16x32_bf16 a[100:103], a[176:179], v[180:183], a[100:103]
    ds_read_b128 a[224:227], v2 offset:25344
    buffer_load_dwordx4 v19, s[8:11], s59 offen offset:1056 lds
    v_mfma_f32_16x16x32_bf16 a[104:107], a[180:183], v[176:179], a[104:107]
    v_exp_f32 v169, v153
    v_mfma_f32_16x16x32_bf16 a[108:111], a[180:183], v[180:183], a[108:111]
    ds_read_b128 a[228:231], v2 offset:25408
    v_add_f32 v32, v32, v163
    v_mfma_f32_16x16x32_bf16 a[112:115], a[184:187], v[176:179], a[112:115]
    v_exp_f32 v170, v154
    v_mfma_f32_16x16x32_bf16 a[116:119], a[184:187], v[180:183], a[116:119]
    ds_read_b128 a[232:235], v2 offset:25472
    v_cvt_pk_bf16_f32 v185, v162, v163
    v_mfma_f32_16x16x32_bf16 a[120:123], a[188:191], v[176:179], a[120:123]
    v_exp_f32 v171, v155
    v_mfma_f32_16x16x32_bf16 a[124:127], a[188:191], v[180:183], a[124:127]
    ds_read_b128 a[236:239], v2 offset:25536
    s_waitcnt lgkmcnt(4)
    v_mfma_f32_16x16x32_bf16 v[128:131], a[192:195], v[64:67], v[192:195]
    v_exp_f32 v172, v156
    v_mfma_f32_16x16x32_bf16 v[128:131], a[196:199], v[72:75], v[128:131]
    ds_read_b128 a[240:243], v2 offset:25600
    buffer_load_dwordx4 v20, s[8:11], s59 offen offset:2112 lds
    v_mfma_f32_16x16x32_bf16 v[128:131], a[200:203], v[80:83], v[128:131]
    v_exp_f32 v173, v157
    v_mfma_f32_16x16x32_bf16 v[128:131], a[204:207], v[88:91], v[128:131]
    ds_read_b128 a[244:247], v2 offset:25664
    v_add_f32 v33, v164, v165
    v_mfma_f32_16x16x32_bf16 v[128:131], a[208:211], v[96:99], v[128:131]
    v_exp_f32 v174, v158
    v_mfma_f32_16x16x32_bf16 v[128:131], a[212:215], v[104:107], v[128:131]
    ds_read_b128 a[248:251], v2 offset:25728
    v_cvt_pk_bf16_f32 v188, v164, v165
    v_mfma_f32_16x16x32_bf16 v[128:131], a[216:219], v[112:115], v[128:131]
    v_exp_f32 v175, v159
    v_mfma_f32_16x16x32_bf16 v[128:131], a[220:223], v[120:123], v[128:131]
    ds_read_b128 a[252:255], v2 offset:25792
    buffer_load_dwordx4 v21, s[8:11], s59 offen offset:3168 lds
    v_mfma_f32_16x16x32_bf16 v[132:135], a[192:195], v[68:71], v[196:199]
    ds_read_b64_tr_b16 a[128:129], v3 offset:33792
    v_add_f32 v33, v33, v166
    v_mfma_f32_16x16x32_bf16 v[132:135], a[196:199], v[76:79], v[132:135]
    ds_read_b64_tr_b16 a[130:131], v3 offset:34304
    v_add_f32 v33, v33, v167
    v_mfma_f32_16x16x32_bf16 v[132:135], a[200:203], v[84:87], v[132:135]
    ds_read_b64_tr_b16 a[132:133], v3 offset:33824
    v_cvt_pk_bf16_f32 v189, v166, v167
    v_mfma_f32_16x16x32_bf16 v[132:135], a[204:207], v[92:95], v[132:135]
    ds_read_b64_tr_b16 a[134:135], v3 offset:34336
    v_add_f32 v32, v32, v168
    v_mfma_f32_16x16x32_bf16 v[132:135], a[208:211], v[100:103], v[132:135]
    ds_read_b64_tr_b16 a[136:137], v3 offset:33856
    v_add_f32 v32, v32, v169
    v_mfma_f32_16x16x32_bf16 v[132:135], a[212:215], v[108:111], v[132:135]
    ds_read_b64_tr_b16 a[138:139], v3 offset:34368
    s_add_u32 m0, s57, 118272
    v_mfma_f32_16x16x32_bf16 v[132:135], a[216:219], v[116:119], v[132:135]
    ds_read_b64_tr_b16 a[140:141], v3 offset:33888
    v_cvt_pk_bf16_f32 v186, v168, v169
    v_mfma_f32_16x16x32_bf16 v[132:135], a[220:223], v[124:127], v[132:135]
    ds_read_b64_tr_b16 a[142:143], v3 offset:34400
    s_waitcnt lgkmcnt(8)
    v_mfma_f32_16x16x32_bf16 v[136:139], a[224:227], v[64:67], v[192:195]
    ds_read_b64_tr_b16 a[144:145], v3 offset:33920
    v_add_f32 v32, v32, v170
    v_mfma_f32_16x16x32_bf16 v[136:139], a[228:231], v[72:75], v[136:139]
    ds_read_b64_tr_b16 a[146:147], v3 offset:34432
    v_add_f32 v32, v32, v171
    v_mfma_f32_16x16x32_bf16 v[136:139], a[232:235], v[80:83], v[136:139]
    ds_read_b64_tr_b16 a[148:149], v3 offset:33952
    v_cvt_pk_bf16_f32 v187, v170, v171
    v_mfma_f32_16x16x32_bf16 v[136:139], a[236:239], v[88:91], v[136:139]
    ds_read_b64_tr_b16 a[150:151], v3 offset:34464
    v_add_f32 v33, v33, v172
    v_mfma_f32_16x16x32_bf16 v[136:139], a[240:243], v[96:99], v[136:139]
    ds_read_b64_tr_b16 a[152:153], v3 offset:33984
    s_add_u32 s58, s58, 16384
    v_mfma_f32_16x16x32_bf16 v[136:139], a[244:247], v[104:107], v[136:139]
    ds_read_b64_tr_b16 a[154:155], v3 offset:34496
    v_add_f32 v33, v33, v173
    v_mfma_f32_16x16x32_bf16 v[136:139], a[248:251], v[112:115], v[136:139]
    ds_read_b64_tr_b16 a[156:157], v3 offset:34016
    v_cvt_pk_bf16_f32 v190, v172, v173
    v_mfma_f32_16x16x32_bf16 v[136:139], a[252:255], v[120:123], v[136:139]
    ds_read_b64_tr_b16 a[158:159], v3 offset:34528
    v_add_f32 v33, v33, v174
    v_mfma_f32_16x16x32_bf16 v[140:143], a[224:227], v[68:71], v[196:199]
    ds_read_b64_tr_b16 a[160:161], v3 offset:34048
    v_add_f32 v33, v33, v175
    v_mfma_f32_16x16x32_bf16 v[140:143], a[228:231], v[76:79], v[140:143]
    ds_read_b64_tr_b16 a[162:163], v3 offset:34560
    v_cvt_pk_bf16_f32 v191, v174, v175
    v_mfma_f32_16x16x32_bf16 v[140:143], a[232:235], v[84:87], v[140:143]
    ds_read_b64_tr_b16 a[164:165], v3 offset:34080
    buffer_load_dwordx4 v14, s[4:7], s58 offen offset:0 lds
    v_mfma_f32_16x16x32_bf16 v[140:143], a[236:239], v[92:95], v[140:143]
    ds_read_b64_tr_b16 a[166:167], v3 offset:34592
    v_max_f32 v52, v32, v33
    v_mfma_f32_16x16x32_bf16 v[140:143], a[240:243], v[100:103], v[140:143]
    ds_read_b64_tr_b16 a[168:169], v3 offset:34112
    v_cmp_lt_f32 vcc, s90, v52
    v_mfma_f32_16x16x32_bf16 v[140:143], a[244:247], v[108:111], v[140:143]
    ds_read_b64_tr_b16 a[170:171], v3 offset:34624
    buffer_load_dwordx4 v15, s[4:7], s58 offen offset:1056 lds
    v_mfma_f32_16x16x32_bf16 v[140:143], a[248:251], v[116:119], v[140:143]
    ds_read_b64_tr_b16 a[172:173], v3 offset:34144
    buffer_load_dwordx4 v16, s[4:7], s58 offen offset:2112 lds
    v_mfma_f32_16x16x32_bf16 v[140:143], a[252:255], v[124:127], v[140:143]
    ds_read_b64_tr_b16 a[174:175], v3 offset:34656
    s_cbranch_vccnz L_tr_lp3
L_bk_lp3:
    s_waitcnt lgkmcnt(8)
    v_mfma_f32_16x16x32_bf16 a[0:3], a[128:131], v[184:187], a[0:3]
    ds_read_b64_tr_b16 a[176:177], v3 offset:34176
    v_add_f32 v30, v30, v32
    v_mfma_f32_16x16x32_bf16 a[4:7], a[128:131], v[188:191], a[4:7]
    ds_read_b64_tr_b16 a[178:179], v3 offset:34688
    v_add_f32 v31, v31, v33
    v_mfma_f32_16x16x32_bf16 a[8:11], a[132:135], v[184:187], a[8:11]
    ds_read_b64_tr_b16 a[180:181], v3 offset:34208
    buffer_load_dwordx4 v17, s[4:7], s58 offen offset:3168 lds
    v_mfma_f32_16x16x32_bf16 a[12:15], a[132:135], v[188:191], a[12:15]
    ds_read_b64_tr_b16 a[182:183], v3 offset:34720
    s_sub_u32 s62, s62, 1
    v_mfma_f32_16x16x32_bf16 a[16:19], a[136:139], v[184:187], a[16:19]
    ds_read_b64_tr_b16 a[184:185], v3 offset:34240
    v_mfma_f32_16x16x32_bf16 a[20:23], a[136:139], v[188:191], a[20:23]
    ds_read_b64_tr_b16 a[186:187], v3 offset:34752
    v_mfma_f32_16x16x32_bf16 a[24:27], a[140:143], v[184:187], a[24:27]
    ds_read_b64_tr_b16 a[188:189], v3 offset:34272
    v_mfma_f32_16x16x32_bf16 a[28:31], a[140:143], v[188:191], a[28:31]
    ds_read_b64_tr_b16 a[190:191], v3 offset:34784
    v_mfma_f32_16x16x32_bf16 a[32:35], a[144:147], v[184:187], a[32:35]
    v_exp_f32 v160, v128
    v_mfma_f32_16x16x32_bf16 a[36:39], a[144:147], v[188:191], a[36:39]
    s_waitcnt vmcnt(13)
    s_barrier
    ds_read_b128 a[192:195], v2 offset:50688
    v_mfma_f32_16x16x32_bf16 a[40:43], a[148:151], v[184:187], a[40:43]
    v_exp_f32 v161, v129
    v_mfma_f32_16x16x32_bf16 a[44:47], a[148:151], v[188:191], a[44:47]
    ds_read_b128 a[196:199], v2 offset:50752
    s_add_u32 m0, s57, 0
    v_mfma_f32_16x16x32_bf16 a[48:51], a[152:155], v[184:187], a[48:51]
    v_exp_f32 v162, v130
    v_mfma_f32_16x16x32_bf16 a[52:55], a[152:155], v[188:191], a[52:55]
    ds_read_b128 a[200:203], v2 offset:50816
    v_add_f32 v32, v160, v161
    v_mfma_f32_16x16x32_bf16 a[56:59], a[156:159], v[184:187], a[56:59]
    v_exp_f32 v163, v131
    v_mfma_f32_16x16x32_bf16 a[60:63], a[156:159], v[188:191], a[60:63]
    ds_read_b128 a[204:207], v2 offset:50880
    s_waitcnt lgkmcnt(4)
    v_mfma_f32_16x16x32_bf16 a[64:67], a[160:163], v[184:187], a[64:67]
    v_exp_f32 v164, v132
    v_mfma_f32_16x16x32_bf16 a[68:71], a[160:163], v[188:191], a[68:71]
    ds_read_b128 a[208:211], v2 offset:50944
    s_add_u32 s59, s59, 16384
    v_mfma_f32_16x16x32_bf16 a[72:75], a[164:167], v[184:187], a[72:75]
    v_exp_f32 v165, v133
    v_mfma_f32_16x16x32_bf16 a[76:79], a[164:167], v[188:191], a[76:79]
    ds_read_b128 a[212:215], v2 offset:51008
    v_cvt_pk_bf16_f32 v176, v160, v161
    v_mfma_f32_16x16x32_bf16 a[80:83], a[168:171], v[184:187], a[80:83]
    v_exp_f32 v166, v134
    v_mfma_f32_16x16x32_bf16 a[84:87], a[168:171], v[188:191], a[84:87]
    ds_read_b128 a[216:219], v2 offset:51072
    buffer_load_dwordx4 v18, s[8:11], s59 offen offset:0 lds
    v_mfma_f32_16x16x32_bf16 a[88:91], a[172:175], v[184:187], a[88:91]
    v_exp_f32 v167, v135
    v_mfma_f32_16x16x32_bf16 a[92:95], a[172:175], v[188:191], a[92:95]
    ds_read_b128 a[220:223], v2 offset:51136
    v_add_f32 v32, v32, v162
    v_mfma_f32_16x16x32_bf16 a[96:99], a[176:179], v[184:187], a[96:99]
    v_exp_f32 v168, v136
    v_mfma_f32_16x16x32_bf16 a[100:103], a[176:179], v[188:191], a[100:103]
    ds_read_b128 a[224:227], v2 offset:59136
    buffer_load_dwordx4 v19, s[8:11], s59 offen offset:1056 lds
    v_mfma_f32_16x16x32_bf16 a[104:107], a[180:183], v[184:187], a[104:107]
    v_exp_f32 v169, v137
    v_mfma_f32_16x16x32_bf16 a[108:111], a[180:183], v[188:191], a[108:111]
    ds_read_b128 a[228:231], v2 offset:59200
    v_add_f32 v32, v32, v163
    v_mfma_f32_16x16x32_bf16 a[112:115], a[184:187], v[184:187], a[112:115]
    v_exp_f32 v170, v138
    v_mfma_f32_16x16x32_bf16 a[116:119], a[184:187], v[188:191], a[116:119]
    ds_read_b128 a[232:235], v2 offset:59264
    v_cvt_pk_bf16_f32 v177, v162, v163
    v_mfma_f32_16x16x32_bf16 a[120:123], a[188:191], v[184:187], a[120:123]
    v_exp_f32 v171, v139
    v_mfma_f32_16x16x32_bf16 a[124:127], a[188:191], v[188:191], a[124:127]
    ds_read_b128 a[236:239], v2 offset:59328
    s_cmp_lg_u32 s62, 0
    s_cbranch_scc1 L_loop
    s_waitcnt lgkmcnt(4)
    v_mfma_f32_16x16x32_bf16 v[144:147], a[192:195], v[64:67], v[192:195]
    v_exp_f32 v172, v140
    v_mfma_f32_16x16x32_bf16 v[144:147], a[196:199], v[72:75], v[144:147]
    ds_read_b128 a[240:243], v2 offset:59392
    buffer_load_dwordx4 v20, s[8:11], s59 offen offset:2112 lds
    v_mfma_f32_16x16x32_bf16 v[144:147], a[200:203], v[80:83], v[144:147]
    v_exp_f32 v173, v141
    v_mfma_f32_16x16x32_bf16 v[144:147], a[204:207], v[88:91], v[144:147]
    ds_read_b128 a[244:247], v2 offset:59456
    v_add_f32 v33, v164, v165
    v_mfma_f32_16x16x32_bf16 v[144:147], a[208:211], v[96:99], v[144:147]
    v_exp_f32 v174, v142
    v_mfma_f32_16x16x32_bf16 v[144:147], a[212:215], v[104:107], v[144:147]
    ds_read_b128 a[248:251], v2 offset:59520
    v_cvt_pk_bf16_f32 v180, v164, v165
    v_mfma_f32_16x16x32_bf16 v[144:147], a[216:219], v[112:115], v[144:147]
    v_exp_f32 v175, v143
    v_mfma_f32_16x16x32_bf16 v[144:147], a[220:223], v[120:123], v[144:147]
    ds_read_b128 a[252:255], v2 offset:59584
    buffer_load_dwordx4 v21, s[8:11], s59 offen offset:3168 lds
    v_mfma_f32_16x16x32_bf16 v[148:151], a[192:195], v[68:71], v[196:199]
    ds_read_b64_tr_b16 a[128:129], v9 offset:0
    v_add_f32 v33, v33, v166
    v_mfma_f32_16x16x32_bf16 v[148:151], a[196:199], v[76:79], v[148:151]
    ds_read_b64_tr_b16 a[130:131], v9 offset:512
    v_add_f32 v33, v33, v167
    v_mfma_f32_16x16x32_bf16 v[148:151], a[200:203], v[84:87], v[148:151]
    ds_read_b64_tr_b16 a[132:133], v9 offset:32
    v_cvt_pk_bf16_f32 v181, v166, v167
    v_mfma_f32_16x16x32_bf16 v[148:151], a[204:207], v[92:95], v[148:151]
    ds_read_b64_tr_b16 a[134:135], v9 offset:544
    v_add_f32 v32, v32, v168
    v_mfma_f32_16x16x32_bf16 v[148:151], a[208:211], v[100:103], v[148:151]
    ds_read_b64_tr_b16 a[136:137], v9 offset:64
    v_add_f32 v32, v32, v169
    v_mfma_f32_16x16x32_bf16 v[148:151], a[212:215], v[108:111], v[148:151]
    ds_read_b64_tr_b16 a[138:139], v9 offset:576
    s_add_u32 m0, s57, 16896
    v_mfma_f32_16x16x32_bf16 v[148:151], a[216:219], v[116:119], v[148:151]
    ds_read_b64_tr_b16 a[140:141], v9 offset:96
    s_mul_i32 s60, s54, 14336
    v_lshlrev_b32 v55, 6, v0
    v_add_u32 v54, s60, v55
    v_mfma_f32_16x16x32_bf16 v[148:151], a[220:223], v[124:127], v[148:151]
    ds_read_b64_tr_b16 a[142:143], v9 offset:608
    s_waitcnt lgkmcnt(8)
    v_mfma_f32_16x16x32_bf16 v[152:155], a[224:227], v[64:67], v[192:195]
    ds_read_b64_tr_b16 a[144:145], v9 offset:128
    buffer_load_dword v56, v54, s[16:19], 0 offen
    v_mfma_f32_16x16x32_bf16 v[152:155], a[228:231], v[72:75], v[152:155]
    ds_read_b64_tr_b16 a[146:147], v9 offset:640
    v_cvt_pk_bf16_f32 v178, v168, v169
    v_mfma_f32_16x16x32_bf16 v[152:155], a[232:235], v[80:83], v[152:155]
    ds_read_b64_tr_b16 a[148:149], v9 offset:160
    v_add_f32 v32, v32, v170
    v_mfma_f32_16x16x32_bf16 v[152:155], a[236:239], v[88:91], v[152:155]
    ds_read_b64_tr_b16 a[150:151], v9 offset:672
    v_add_f32 v32, v32, v171
    v_mfma_f32_16x16x32_bf16 v[152:155], a[240:243], v[96:99], v[152:155]
    ds_read_b64_tr_b16 a[152:153], v9 offset:192
    v_lshlrev_b32 v55, 6, v0
    v_add_u32 v55, L_tail-L_pc+0, v55
    v_min_u32 v55, (L_end-L_pc)&0xfffffffc, v55
    v_mfma_f32_16x16x32_bf16 v[152:155], a[244:247], v[104:107], v[152:155]
    ds_read_b64_tr_b16 a[154:155], v9 offset:704
    global_load_dword v56, v55, s[50:51]
    v_mfma_f32_16x16x32_bf16 v[152:155], a[248:251], v[112:115], v[152:155]
    ds_read_b64_tr_b16 a[156:157], v9 offset:224
    v_cvt_pk_bf16_f32 v179, v170, v171
    v_mfma_f32_16x16x32_bf16 v[152:155], a[252:255], v[120:123], v[152:155]
    ds_read_b64_tr_b16 a[158:159], v9 offset:736
    v_add_f32 v33, v33, v172
    v_mfma_f32_16x16x32_bf16 v[156:159], a[224:227], v[68:71], v[196:199]
    ds_read_b64_tr_b16 a[160:161], v9 offset:256
    s_add_u32 s58, s58, 16384
    v_mfma_f32_16x16x32_bf16 v[156:159], a[228:231], v[76:79], v[156:159]
    ds_read_b64_tr_b16 a[162:163], v9 offset:768
    v_add_f32 v33, v33, v173
    v_mfma_f32_16x16x32_bf16 v[156:159], a[232:235], v[84:87], v[156:159]
    ds_read_b64_tr_b16 a[164:165], v9 offset:288
    v_cvt_pk_bf16_f32 v182, v172, v173
    v_mfma_f32_16x16x32_bf16 v[156:159], a[236:239], v[92:95], v[156:159]
    ds_read_b64_tr_b16 a[166:167], v9 offset:800
    v_lshlrev_b32 v55, 6, v0
    v_add_u32 v55, L_tail-L_pc+16384, v55
    v_min_u32 v55, (L_end-L_pc)&0xfffffffc, v55
    v_mfma_f32_16x16x32_bf16 v[156:159], a[240:243], v[100:103], v[156:159]
    ds_read_b64_tr_b16 a[168:169], v9 offset:320
    v_add_f32 v33, v33, v174
    global_load_dword v56, v55, s[50:51]
    v_mfma_f32_16x16x32_bf16 v[156:159], a[244:247], v[108:111], v[156:159]
    ds_read_b64_tr_b16 a[170:171], v9 offset:832
    v_add_f32 v33, v33, v175
    v_cvt_pk_bf16_f32 v183, v174, v175
    buffer_load_dwordx4 v14, s[4:7], s58 offen offset:0 lds
    v_mfma_f32_16x16x32_bf16 v[156:159], a[248:251], v[116:119], v[156:159]
    ds_read_b64_tr_b16 a[172:173], v9 offset:352
    v_max_f32 v52, v32, v33
    v_mfma_f32_16x16x32_bf16 v[156:159], a[252:255], v[124:127], v[156:159]
    ds_read_b64_tr_b16 a[174:175], v9 offset:864
    v_cmp_lt_f32 vcc, s90, v52
    s_cbranch_vccnz L_tr_p14
L_bk_p14:
    s_waitcnt lgkmcnt(8)
    v_mfma_f32_16x16x32_bf16 a[0:3], a[128:131], v[176:179], a[0:3]
    ds_read_b64_tr_b16 a[176:177], v9 offset:384
    buffer_load_dwordx4 v15, s[4:7], s58 offen offset:1056 lds
    v_mfma_f32_16x16x32_bf16 a[4:7], a[128:131], v[180:183], a[4:7]
    ds_read_b64_tr_b16 a[178:179], v9 offset:896
    v_lshlrev_b32 v55, 6, v0
    v_add_u32 v55, L_tail-L_pc+32768, v55
    v_min_u32 v55, (L_end-L_pc)&0xfffffffc, v55
    v_mfma_f32_16x16x32_bf16 a[8:11], a[132:135], v[176:179], a[8:11]
    ds_read_b64_tr_b16 a[180:181], v9 offset:416
    global_load_dword v56, v55, s[50:51]
    v_mfma_f32_16x16x32_bf16 a[12:15], a[132:135], v[180:183], a[12:15]
    ds_read_b64_tr_b16 a[182:183], v9 offset:928
    v_add_f32 v30, v30, v32
    v_mfma_f32_16x16x32_bf16 a[16:19], a[136:139], v[176:179], a[16:19]
    ds_read_b64_tr_b16 a[184:185], v9 offset:448
    v_add_f32 v31, v31, v33
    v_mfma_f32_16x16x32_bf16 a[20:23], a[136:139], v[180:183], a[20:23]
    ds_read_b64_tr_b16 a[186:187], v9 offset:960
    buffer_load_dwordx4 v16, s[4:7], s58 offen offset:2112 lds
    v_mfma_f32_16x16x32_bf16 a[24:27], a[140:143], v[176:179], a[24:27]
    ds_read_b64_tr_b16 a[188:189], v9 offset:480
    buffer_load_dwordx4 v17, s[4:7], s58 offen offset:3168 lds
    v_mfma_f32_16x16x32_bf16 a[28:31], a[140:143], v[180:183], a[28:31]
    ds_read_b64_tr_b16 a[190:191], v9 offset:992
    v_mfma_f32_16x16x32_bf16 a[32:35], a[144:147], v[176:179], a[32:35]
    v_exp_f32 v160, v144
    v_mfma_f32_16x16x32_bf16 a[36:39], a[144:147], v[180:183], a[36:39]
    s_waitcnt vmcnt(16)
    s_barrier
    ds_read_b128 a[192:195], v8 offset:16896
    v_mfma_f32_16x16x32_bf16 a[40:43], a[148:151], v[176:179], a[40:43]
    v_exp_f32 v161, v145
    v_mfma_f32_16x16x32_bf16 a[44:47], a[148:151], v[180:183], a[44:47]
    ds_read_b128 a[196:199], v8 offset:16960
    s_add_u32 m0, s57, 33792
    v_mfma_f32_16x16x32_bf16 a[48:51], a[152:155], v[176:179], a[48:51]
    v_exp_f32 v162, v146
    v_mfma_f32_16x16x32_bf16 a[52:55], a[152:155], v[180:183], a[52:55]
    ds_read_b128 a[200:203], v8 offset:17024
    v_add_f32 v32, v160, v161
    v_mfma_f32_16x16x32_bf16 a[56:59], a[156:159], v[176:179], a[56:59]
    v_exp_f32 v163, v147
    v_mfma_f32_16x16x32_bf16 a[60:63], a[156:159], v[180:183], a[60:63]
    ds_read_b128 a[204:207], v8 offset:17088
    s_waitcnt lgkmcnt(4)
    v_mfma_f32_16x16x32_bf16 a[64:67], a[160:163], v[176:179], a[64:67]
    s_mul_i32 s60, s54, 100352
    s_lshl_b32 s61, s53, 8
    s_add_u32 s60, s60, s61
    v_lshrrev_b32 v55, 2, v0
    v_min_u32 v55, 27, v55
    v_mul_u32_u24 v55, 3584, v55
    v_and_b32 v54, 3, v0
    v_lshl_add_u32 v55, v54, 6, v55
    v_add_u32 v55, s60, v55
    v_mfma_f32_16x16x32_bf16 a[68:71], a[160:163], v[180:183], a[68:71]
    ds_read_b128 a[208:211], v8 offset:17152
    buffer_load_dword v56, v55, s[32:35], 0 offen
    v_mfma_f32_16x16x32_bf16 a[72:75], a[164:167], v[176:179], a[72:75]
    v_exp_f32 v164, v148
    v_mfma_f32_16x16x32_bf16 a[76:79], a[164:167], v[180:183], a[76:79]
    ds_read_b128 a[212:215], v8 offset:17216
    s_add_u32 s59, s59, 16384
    v_mfma_f32_16x16x32_bf16 a[80:83], a[168:171], v[176:179], a[80:83]
    s_lshl_b32 s60, s54, 1
    s_and_b32 s61, s53, 1
    s_add_u32 s60, s60, s61
    s_mul_i32 s60, s60, 7168
    v_min_u32 v54, 111, v0
    v_lshlrev_b32 v54, 6, v54
    v_add_u32 v54, s60, v54
    buffer_load_dword v56, v54, s[36:39], 0 offen
    v_mfma_f32_16x16x32_bf16 a[84:87], a[168:171], v[180:183], a[84:87]
    ds_read_b128 a[216:219], v8 offset:17280
    buffer_load_dwordx4 v18, s[8:11], s59 offen offset:0 lds
    v_mfma_f32_16x16x32_bf16 a[88:91], a[172:175], v[176:179], a[88:91]
    v_exp_f32 v165, v149
    v_mfma_f32_16x16x32_bf16 a[92:95], a[172:175], v[180:183], a[92:95]
    ds_read_b128 a[220:223], v8 offset:17344
    v_cvt_pk_bf16_f32 v184, v160, v161
    v_mfma_f32_16x16x32_bf16 a[96:99], a[176:179], v[176:179], a[96:99]
    v_exp_f32 v166, v150
    v_mfma_f32_16x16x32_bf16 a[100:103], a[176:179], v[180:183], a[100:103]
    ds_read_b128 a[224:227], v8 offset:25344
    buffer_load_dwordx4 v19, s[8:11], s59 offen offset:1056 lds
    v_mfma_f32_16x16x32_bf16 a[104:107], a[180:183], v[176:179], a[104:107]
    v_exp_f32 v167, v151
    v_mfma_f32_16x16x32_bf16 a[108:111], a[180:183], v[180:183], a[108:111]
    ds_read_b128 a[228:231], v8 offset:25408
    v_add_f32 v32, v32, v162
    v_mfma_f32_16x16x32_bf16 a[112:115], a[184:187], v[176:179], a[112:115]
    v_exp_f32 v168, v152
    v_mfma_f32_16x16x32_bf16 a[116:119], a[184:187], v[180:183], a[116:119]
    ds_read_b128 a[232:235], v8 offset:25472
    v_add_f32 v32, v32, v163
    v_mfma_f32_16x16x32_bf16 a[120:123], a[188:191], v[176:179], a[120:123]
    v_exp_f32 v169, v153
    v_mfma_f32_16x16x32_bf16 a[124:127], a[188:191], v[180:183], a[124:127]
    ds_read_b128 a[236:239], v8 offset:25536
L_tail:
    s_waitcnt lgkmcnt(4)
    v_mfma_f32_16x16x32_bf16 v[128:131], a[192:195], v[64:67], v[192:195]
    v_exp_f32 v170, v154
    v_mfma_f32_16x16x32_bf16 v[128:131], a[196:199], v[72:75], v[128:131]
    ds_read_b128 a[240:243], v8 offset:25600
    buffer_load_dwordx4 v20, s[8:11], s59 offen offset:2112 lds
    v_mfma_f32_16x16x32_bf16 v[128:131], a[200:203], v[80:83], v[128:131]
    v_exp_f32 v171, v155
    v_mfma_f32_16x16x32_bf16 v[128:131], a[204:207], v[88:91], v[128:131]
    ds_read_b128 a[244:247], v8 offset:25664
    v_cvt_pk_bf16_f32 v185, v162, v163
    v_mfma_f32_16x16x32_bf16 v[128:131], a[208:211], v[96:99], v[128:131]
    v_exp_f32 v172, v156
    v_mfma_f32_16x16x32_bf16 v[128:131], a[212:215], v[104:107], v[128:131]
    ds_read_b128 a[248:251], v8 offset:25728
    v_add_f32 v33, v164, v165
    v_mfma_f32_16x16x32_bf16 v[128:131], a[216:219], v[112:115], v[128:131]
    v_exp_f32 v173, v157
    v_mfma_f32_16x16x32_bf16 v[128:131], a[220:223], v[120:123], v[128:131]
    ds_read_b128 a[252:255], v8 offset:25792
    v_cvt_pk_bf16_f32 v188, v164, v165
    v_mfma_f32_16x16x32_bf16 v[132:135], a[192:195], v[68:71], v[196:199]
    ds_read_b64_tr_b16 a[128:129], v9 offset:33792
    buffer_load_dwordx4 v21, s[8:11], s59 offen offset:3168 lds
    v_mfma_f32_16x16x32_bf16 v[132:135], a[196:199], v[76:79], v[132:135]
    ds_read_b64_tr_b16 a[130:131], v9 offset:34304
    v_add_f32 v33, v33, v166
    v_mfma_f32_16x16x32_bf16 v[132:135], a[200:203], v[84:87], v[132:135]
    ds_read_b64_tr_b16 a[132:133], v9 offset:33824
    v_add_f32 v33, v33, v167
    v_mfma_f32_16x16x32_bf16 v[132:135], a[204:207], v[92:95], v[132:135]
    ds_read_b64_tr_b16 a[134:135], v9 offset:34336
    v_cvt_pk_bf16_f32 v189, v166, v167
    v_mfma_f32_16x16x32_bf16 v[132:135], a[208:211], v[100:103], v[132:135]
    ds_read_b64_tr_b16 a[136:137], v9 offset:33856
    v_add_f32 v32, v32, v168
    v_mfma_f32_16x16x32_bf16 v[132:135], a[212:215], v[108:111], v[132:135]
    ds_read_b64_tr_b16 a[138:139], v9 offset:34368
    v_add_f32 v32, v32, v169
    v_mfma_f32_16x16x32_bf16 v[132:135], a[216:219], v[116:119], v[132:135]
    ds_read_b64_tr_b16 a[140:141], v9 offset:33888
    s_add_u32 m0, s57, 50688
    v_mfma_f32_16x16x32_bf16 v[132:135], a[220:223], v[124:127], v[132:135]
    ds_read_b64_tr_b16 a[142:143], v9 offset:34400
    s_waitcnt lgkmcnt(8)
    v_mfma_f32_16x16x32_bf16 v[136:139], a[224:227], v[64:67], v[192:195]
    ds_read_b64_tr_b16 a[144:145], v9 offset:33920
    v_cvt_pk_bf16_f32 v186, v168, v169
    v_mfma_f32_16x16x32_bf16 v[136:139], a[228:231], v[72:75], v[136:139]
    ds_read_b64_tr_b16 a[146:147], v9 offset:34432
    v_add_f32 v32, v32, v170
    v_mfma_f32_16x16x32_bf16 v[136:139], a[232:235], v[80:83], v[136:139]
    ds_read_b64_tr_b16 a[148:149], v9 offset:33952
    v_add_f32 v32, v32, v171
    v_mfma_f32_16x16x32_bf16 v[136:139], a[236:239], v[88:91], v[136:139]
    ds_read_b64_tr_b16 a[150:151], v9 offset:34464
    v_cvt_pk_bf16_f32 v187, v170, v171
    v_mfma_f32_16x16x32_bf16 v[136:139], a[240:243], v[96:99], v[136:139]
    ds_read_b64_tr_b16 a[152:153], v9 offset:33984
    v_add_f32 v33, v33, v172
    v_mfma_f32_16x16x32_bf16 v[136:139], a[244:247], v[104:107], v[136:139]
    ds_read_b64_tr_b16 a[154:155], v9 offset:34496
    s_add_u32 s58, s58, 16384
    v_mfma_f32_16x16x32_bf16 v[136:139], a[248:251], v[112:115], v[136:139]
    ds_read_b64_tr_b16 a[156:157], v9 offset:34016
    v_add_f32 v33, v33, v173
    v_mfma_f32_16x16x32_bf16 v[136:139], a[252:255], v[120:123], v[136:139]
    ds_read_b64_tr_b16 a[158:159], v9 offset:34528
    v_cvt_pk_bf16_f32 v190, v172, v173
    v_mfma_f32_16x16x32_bf16 v[140:143], a[224:227], v[68:71], v[196:199]
    ds_read_b64_tr_b16 a[160:161], v9 offset:34048
    buffer_load_dwordx4 v14, s[4:7], s58 offen offset:0 lds
    v_mfma_f32_16x16x32_bf16 v[140:143], a[228:231], v[76:79], v[140:143]
    ds_read_b64_tr_b16 a[162:163], v9 offset:34560
    buffer_load_dwordx4 v15, s[4:7], s58 offen offset:1056 lds
    v_mfma_f32_16x16x32_bf16 v[140:143], a[232:235], v[84:87], v[140:143]
    ds_read_b64_tr_b16 a[164:165], v9 offset:34080
    v_exp_f32 v174, v158
    v_mfma_f32_16x16x32_bf16 v[140:143], a[236:239], v[92:95], v[140:143]
    ds_read_b64_tr_b16 a[166:167], v9 offset:34592
    v_exp_f32 v175, v159
    v_mfma_f32_16x16x32_bf16 v[140:143], a[240:243], v[100:103], v[140:143]
    ds_read_b64_tr_b16 a[168:169], v9 offset:34112
    v_add_f32 v33, v33, v174
    v_mfma_f32_16x16x32_bf16 v[140:143], a[244:247], v[108:111], v[140:143]
    ds_read_b64_tr_b16 a[170:171], v9 offset:34624
    v_add_f32 v33, v33, v175
    v_cvt_pk_bf16_f32 v191, v174, v175
    v_mfma_f32_16x16x32_bf16 v[140:143], a[248:251], v[116:119], v[140:143]
    ds_read_b64_tr_b16 a[172:173], v9 offset:34144
    v_max_f32 v52, v32, v33
    v_mfma_f32_16x16x32_bf16 v[140:143], a[252:255], v[124:127], v[140:143]
    ds_read_b64_tr_b16 a[174:175], v9 offset:34656
    v_cmp_lt_f32 vcc, s90, v52
    s_cbranch_vccnz L_tr_p15
L_bk_p15:
    s_waitcnt lgkmcnt(8)
    v_mfma_f32_16x16x32_bf16 a[0:3], a[128:131], v[184:187], a[0:3]
    ds_read_b64_tr_b16 a[176:177], v9 offset:34176
    v_add_f32 v30, v30, v32
    v_mfma_f32_16x16x32_bf16 a[4:7], a[128:131], v[188:191], a[4:7]
    ds_read_b64_tr_b16 a[178:179], v9 offset:34688
    v_add_f32 v31, v31, v33
    v_mfma_f32_16x16x32_bf16 a[8:11], a[132:135], v[184:187], a[8:11]
    ds_read_b64_tr_b16 a[180:181], v9 offset:34208
    buffer_load_dwordx4 v16, s[4:7], s58 offen offset:2112 lds
    v_mfma_f32_16x16x32_bf16 a[12:15], a[132:135], v[188:191], a[12:15]
    ds_read_b64_tr_b16 a[182:183], v9 offset:34720
    buffer_load_dwordx4 v17, s[4:7], s58 offen offset:3168 lds
    v_mfma_f32_16x16x32_bf16 a[16:19], a[136:139], v[184:187], a[16:19]
    ds_read_b64_tr_b16 a[184:185], v9 offset:34240
    v_mfma_f32_16x16x32_bf16 a[20:23], a[136:139], v[188:191], a[20:23]
    ds_read_b64_tr_b16 a[186:187], v9 offset:34752
    v_mfma_f32_16x16x32_bf16 a[24:27], a[140:143], v[184:187], a[24:27]
    ds_read_b64_tr_b16 a[188:189], v9 offset:34272
    v_mfma_f32_16x16x32_bf16 a[28:31], a[140:143], v[188:191], a[28:31]
    ds_read_b64_tr_b16 a[190:191], v9 offset:34784
    v_mfma_f32_16x16x32_bf16 a[32:35], a[144:147], v[184:187], a[32:35]
    v_exp_f32 v160, v128
    v_mfma_f32_16x16x32_bf16 a[36:39], a[144:147], v[188:191], a[36:39]
    s_waitcnt vmcnt(18)
    s_barrier
    ds_read_b128 a[192:195], v8 offset:50688
    v_mfma_f32_16x16x32_bf16 a[40:43], a[148:151], v[184:187], a[40:43]
    v_exp_f32 v161, v129
    v_mfma_f32_16x16x32_bf16 a[44:47], a[148:151], v[188:191], a[44:47]
    ds_read_b128 a[196:199], v8 offset:50752
    s_add_u32 m0, s57, 67584
    v_mfma_f32_16x16x32_bf16 a[48:51], a[152:155], v[184:187], a[48:51]
    v_exp_f32 v162, v130
    v_mfma_f32_16x16x32_bf16 a[52:55], a[152:155], v[188:191], a[52:55]
    ds_read_b128 a[200:203], v8 offset:50816
    v_add_f32 v32, v160, v161
    v_mfma_f32_16x16x32_bf16 a[56:59], a[156:159], v[184:187], a[56:59]
    v_exp_f32 v163, v131
    v_mfma_f32_16x16x32_bf16 a[60:63], a[156:159], v[188:191], a[60:63]
    ds_read_b128 a[204:207], v8 offset:50880
    s_waitcnt lgkmcnt(4)
    v_mfma_f32_16x16x32_bf16 a[64:67], a[160:163], v[184:187], a[64:67]
    v_exp_f32 v164, v132
    v_mfma_f32_16x16x32_bf16 a[68:71], a[160:163], v[188:191], a[68:71]
    ds_read_b128 a[208:211], v8 offset:50944
    s_add_u32 s59, s59, 16384
    v_mfma_f32_16x16x32_bf16 a[72:75], a[164:167], v[184:187], a[72:75]
    v_exp_f32 v165, v133
    v_mfma_f32_16x16x32_bf16 a[76:79], a[164:167], v[188:191], a[76:79]
    ds_read_b128 a[212:215], v8 offset:51008
    v_cvt_pk_bf16_f32 v176, v160, v161
    v_mfma_f32_16x16x32_bf16 a[80:83], a[168:171], v[184:187], a[80:83]
    v_exp_f32 v166, v134
    v_mfma_f32_16x16x32_bf16 a[84:87], a[168:171], v[188:191], a[84:87]
    ds_read_b128 a[216:219], v8 offset:51072
    buffer_load_dwordx4 v18, s[8:11], s59 offen offset:0 lds
    v_mfma_f32_16x16x32_bf16 a[88:91], a[172:175], v[184:187], a[88:91]
    v_exp_f32 v167, v135
    v_mfma_f32_16x16x32_bf16 a[92:95], a[172:175], v[188:191], a[92:95]
    ds_read_b128 a[220:223], v8 offset:51136
    v_add_f32 v32, v32, v162
    v_mfma_f32_16x16x32_bf16 a[96:99], a[176:179], v[184:187], a[96:99]
    v_exp_f32 v168, v136
    v_mfma_f32_16x16x32_bf16 a[100:103], a[176:179], v[188:191], a[100:103]
    ds_read_b128 a[224:227], v8 offset:59136
    buffer_load_dwordx4 v19, s[8:11], s59 offen offset:1056 lds
    v_mfma_f32_16x16x32_bf16 a[104:107], a[180:183], v[184:187], a[104:107]
    v_exp_f32 v169, v137
    v_mfma_f32_16x16x32_bf16 a[108:111], a[180:183], v[188:191], a[108:111]
    ds_read_b128 a[228:231], v8 offset:59200
    v_add_f32 v32, v32, v163
    v_mfma_f32_16x16x32_bf16 a[112:115], a[184:187], v[184:187], a[112:115]
    v_exp_f32 v170, v138
    v_mfma_f32_16x16x32_bf16 a[116:119], a[184:187], v[188:191], a[116:119]
    ds_read_b128 a[232:235], v8 offset:59264
    v_cvt_pk_bf16_f32 v177, v162, v163
    v_mfma_f32_16x16x32_bf16 a[120:123], a[188:191], v[184:187], a[120:123]
    v_exp_f32 v171, v139
    v_mfma_f32_16x16x32_bf16 a[124:127], a[188:191], v[188:191], a[124:127]
    ds_read_b128 a[236:239], v8 offset:59328
    s_waitcnt lgkmcnt(4)
    v_mfma_f32_16x16x32_bf16 v[144:147], a[192:195], v[64:67], v[192:195]
    v_exp_f32 v172, v140
    v_mfma_f32_16x16x32_bf16 v[144:147], a[196:199], v[72:75], v[144:147]
    ds_read_b128 a[240:243], v8 offset:59392
    buffer_load_dwordx4 v20, s[8:11], s59 offen offset:2112 lds
    v_mfma_f32_16x16x32_bf16 v[144:147], a[200:203], v[80:83], v[144:147]
    v_exp_f32 v173, v141
    v_mfma_f32_16x16x32_bf16 v[144:147], a[204:207], v[88:91], v[144:147]
    ds_read_b128 a[244:247], v8 offset:59456
    v_add_f32 v33, v164, v165
    v_mfma_f32_16x16x32_bf16 v[144:147], a[208:211], v[96:99], v[144:147]
    v_exp_f32 v174, v142
    v_mfma_f32_16x16x32_bf16 v[144:147], a[212:215], v[104:107], v[144:147]
    ds_read_b128 a[248:251], v8 offset:59520
    v_cvt_pk_bf16_f32 v180, v164, v165
    v_mfma_f32_16x16x32_bf16 v[144:147], a[216:219], v[112:115], v[144:147]
    v_exp_f32 v175, v143
    v_mfma_f32_16x16x32_bf16 v[144:147], a[220:223], v[120:123], v[144:147]
    ds_read_b128 a[252:255], v8 offset:59584
    buffer_load_dwordx4 v21, s[8:11], s59 offen offset:3168 lds
    v_mfma_f32_16x16x32_bf16 v[148:151], a[192:195], v[68:71], v[196:199]
    ds_read_b64_tr_b16 a[128:129], v3 offset:0
    v_add_f32 v33, v33, v166
    v_mfma_f32_16x16x32_bf16 v[148:151], a[196:199], v[76:79], v[148:151]
    ds_read_b64_tr_b16 a[130:131], v3 offset:512
    v_add_f32 v33, v33, v167
    v_mfma_f32_16x16x32_bf16 v[148:151], a[200:203], v[84:87], v[148:151]
    ds_read_b64_tr_b16 a[132:133], v3 offset:32
    v_cvt_pk_bf16_f32 v181, v166, v167
    v_mfma_f32_16x16x32_bf16 v[148:151], a[204:207], v[92:95], v[148:151]
    ds_read_b64_tr_b16 a[134:135], v3 offset:544
    v_add_f32 v32, v32, v168
    v_mfma_f32_16x16x32_bf16 v[148:151], a[208:211], v[100:103], v[148:151]
    ds_read_b64_tr_b16 a[136:137], v3 offset:64
    v_add_f32 v32, v32, v169
    v_mfma_f32_16x16x32_bf16 v[148:151], a[212:215], v[108:111], v[148:151]
    ds_read_b64_tr_b16 a[138:139], v3 offset:576
    s_add_u32 m0, s57, 84480
    v_mfma_f32_16x16x32_bf16 v[148:151], a[216:219], v[116:119], v[148:151]
    ds_read_b64_tr_b16 a[140:141], v3 offset:96
    v_cvt_pk_bf16_f32 v178, v168, v169
    v_mfma_f32_16x16x32_bf16 v[148:151], a[220:223], v[124:127], v[148:151]
    ds_read_b64_tr_b16 a[142:143], v3 offset:608
    s_waitcnt lgkmcnt(8)
    v_mfma_f32_16x16x32_bf16 v[152:155], a[224:227], v[64:67], v[192:195]
    ds_read_b64_tr_b16 a[144:145], v3 offset:128
    v_add_f32 v32, v32, v170
    v_mfma_f32_16x16x32_bf16 v[152:155], a[228:231], v[72:75], v[152:155]
    ds_read_b64_tr_b16 a[146:147], v3 offset:640
    v_add_f32 v32, v32, v171
    v_mfma_f32_16x16x32_bf16 v[152:155], a[232:235], v[80:83], v[152:155]
    ds_read_b64_tr_b16 a[148:149], v3 offset:160
    v_cvt_pk_bf16_f32 v179, v170, v171
    v_mfma_f32_16x16x32_bf16 v[152:155], a[236:239], v[88:91], v[152:155]
    ds_read_b64_tr_b16 a[150:151], v3 offset:672
    v_add_f32 v33, v33, v172
    v_mfma_f32_16x16x32_bf16 v[152:155], a[240:243], v[96:99], v[152:155]
    ds_read_b64_tr_b16 a[152:153], v3 offset:192
    s_add_u32 s59, s59, 16384
    v_mfma_f32_16x16x32_bf16 v[152:155], a[244:247], v[104:107], v[152:155]
    ds_read_b64_tr_b16 a[154:155], v3 offset:704
    v_add_f32 v33, v33, v173
    v_mfma_f32_16x16x32_bf16 v[152:155], a[248:251], v[112:115], v[152:155]
    ds_read_b64_tr_b16 a[156:157], v3 offset:224
    v_cvt_pk_bf16_f32 v182, v172, v173
    v_mfma_f32_16x16x32_bf16 v[152:155], a[252:255], v[120:123], v[152:155]
    ds_read_b64_tr_b16 a[158:159], v3 offset:736
    v_add_f32 v33, v33, v174
    v_mfma_f32_16x16x32_bf16 v[156:159], a[224:227], v[68:71], v[196:199]
    ds_read_b64_tr_b16 a[160:161], v3 offset:256
    v_add_f32 v33, v33, v175
    v_mfma_f32_16x16x32_bf16 v[156:159], a[228:231], v[76:79], v[156:159]
    ds_read_b64_tr_b16 a[162:163], v3 offset:768
    v_cvt_pk_bf16_f32 v183, v174, v175
    v_mfma_f32_16x16x32_bf16 v[156:159], a[232:235], v[84:87], v[156:159]
    ds_read_b64_tr_b16 a[164:165], v3 offset:288
    buffer_load_dwordx4 v18, s[8:11], s59 offen offset:0 lds
    v_mfma_f32_16x16x32_bf16 v[156:159], a[236:239], v[92:95], v[156:159]
    ds_read_b64_tr_b16 a[166:167], v3 offset:800
    v_max_f32 v52, v32, v33
    v_mfma_f32_16x16x32_bf16 v[156:159], a[240:243], v[100:103], v[156:159]
    ds_read_b64_tr_b16 a[168:169], v3 offset:320
    v_cmp_lt_f32 vcc, s90, v52
    v_mfma_f32_16x16x32_bf16 v[156:159], a[244:247], v[108:111], v[156:159]
    ds_read_b64_tr_b16 a[170:171], v3 offset:832
    buffer_load_dwordx4 v19, s[8:11], s59 offen offset:1056 lds
    v_mfma_f32_16x16x32_bf16 v[156:159], a[248:251], v[116:119], v[156:159]
    ds_read_b64_tr_b16 a[172:173], v3 offset:352
    buffer_load_dwordx4 v20, s[8:11], s59 offen offset:2112 lds
    v_mfma_f32_16x16x32_bf16 v[156:159], a[252:255], v[124:127], v[156:159]
    ds_read_b64_tr_b16 a[174:175], v3 offset:864
    s_cbranch_vccnz L_tr_p16
L_bk_p16:
    s_waitcnt lgkmcnt(8)
    v_mfma_f32_16x16x32_bf16 a[0:3], a[128:131], v[176:179], a[0:3]
    ds_read_b64_tr_b16 a[176:177], v3 offset:384
    v_add_f32 v30, v30, v32
    v_mfma_f32_16x16x32_bf16 a[4:7], a[128:131], v[180:183], a[4:7]
    ds_read_b64_tr_b16 a[178:179], v3 offset:896
    v_add_f32 v31, v31, v33
    v_mfma_f32_16x16x32_bf16 a[8:11], a[132:135], v[176:179], a[8:11]
    ds_read_b64_tr_b16 a[180:181], v3 offset:416
    buffer_load_dwordx4 v21, s[8:11], s59 offen offset:3168 lds
    v_mfma_f32_16x16x32_bf16 a[12:15], a[132:135], v[180:183], a[12:15]
    ds_read_b64_tr_b16 a[182:183], v3 offset:928
    v_mfma_f32_16x16x32_bf16 a[16:19], a[136:139], v[176:179], a[16:19]
    ds_read_b64_tr_b16 a[184:185], v3 offset:448
    v_mfma_f32_16x16x32_bf16 a[20:23], a[136:139], v[180:183], a[20:23]
    ds_read_b64_tr_b16 a[186:187], v3 offset:960
    v_mfma_f32_16x16x32_bf16 a[24:27], a[140:143], v[176:179], a[24:27]
    ds_read_b64_tr_b16 a[188:189], v3 offset:480
    v_mfma_f32_16x16x32_bf16 a[28:31], a[140:143], v[180:183], a[28:31]
    ds_read_b64_tr_b16 a[190:191], v3 offset:992
    v_mfma_f32_16x16x32_bf16 a[32:35], a[144:147], v[176:179], a[32:35]
    v_exp_f32 v160, v144
    v_mfma_f32_16x16x32_bf16 a[36:39], a[144:147], v[180:183], a[36:39]
    s_waitcnt vmcnt(12)
    s_barrier
    ds_read_b128 a[192:195], v2 offset:16896
    v_mfma_f32_16x16x32_bf16 a[40:43], a[148:151], v[176:179], a[40:43]
    v_exp_f32 v161, v145
    v_mfma_f32_16x16x32_bf16 a[44:47], a[148:151], v[180:183], a[44:47]
    ds_read_b128 a[196:199], v2 offset:16960
    s_add_u32 m0, s57, 101376
    v_mfma_f32_16x16x32_bf16 a[48:51], a[152:155], v[176:179], a[48:51]
    v_exp_f32 v162, v146
    v_mfma_f32_16x16x32_bf16 a[52:55], a[152:155], v[180:183], a[52:55]
    ds_read_b128 a[200:203], v2 offset:17024
    v_add_f32 v32, v160, v161
    v_mfma_f32_16x16x32_bf16 a[56:59], a[156:159], v[176:179], a[56:59]
    v_exp_f32 v163, v147
    v_mfma_f32_16x16x32_bf16 a[60:63], a[156:159], v[180:183], a[60:63]
    ds_read_b128 a[204:207], v2 offset:17088
    s_waitcnt lgkmcnt(4)
    v_mfma_f32_16x16x32_bf16 a[64:67], a[160:163], v[176:179], a[64:67]
    v_exp_f32 v164, v148
    v_mfma_f32_16x16x32_bf16 a[68:71], a[160:163], v[180:183], a[68:71]
    ds_read_b128 a[208:211], v2 offset:17152
    s_mov_b32 s91, 0
    v_mfma_f32_16x16x32_bf16 a[72:75], a[164:167], v[176:179], a[72:75]
    v_exp_f32 v165, v149
    v_mfma_f32_16x16x32_bf16 a[76:79], a[164:167], v[180:183], a[76:79]
    ds_read_b128 a[212:215], v2 offset:17216
    v_cvt_pk_bf16_f32 v184, v160, v161
    v_mfma_f32_16x16x32_bf16 a[80:83], a[168:171], v[176:179], a[80:83]
    v_exp_f32 v166, v150
    v_mfma_f32_16x16x32_bf16 a[84:87], a[168:171], v[180:183], a[84:87]
    ds_read_b128 a[216:219], v2 offset:17280
    buffer_load_dwordx4 v26, s[16:19], s91 offen offset:0 lds
    v_mfma_f32_16x16x32_bf16 a[88:91], a[172:175], v[176:179], a[88:91]
    v_exp_f32 v167, v151
    v_mfma_f32_16x16x32_bf16 a[92:95], a[172:175], v[180:183], a[92:95]
    ds_read_b128 a[220:223], v2 offset:17344
    v_add_f32 v32, v32, v162
    v_mfma_f32_16x16x32_bf16 a[96:99], a[176:179], v[176:179], a[96:99]
    v_exp_f32 v168, v152
    v_mfma_f32_16x16x32_bf16 a[100:103], a[176:179], v[180:183], a[100:103]
    ds_read_b128 a[224:227], v2 offset:25344
    buffer_load_dwordx4 v27, s[16:19], s91 offen offset:1024 lds
    v_mfma_f32_16x16x32_bf16 a[104:107], a[180:183], v[176:179], a[104:107]
    v_exp_f32 v169, v153
    v_mfma_f32_16x16x32_bf16 a[108:111], a[180:183], v[180:183], a[108:111]
    ds_read_b128 a[228:231], v2 offset:25408
    v_add_f32 v32, v32, v163
    v_mfma_f32_16x16x32_bf16 a[112:115], a[184:187], v[176:179], a[112:115]
    v_exp_f32 v170, v154
    v_mfma_f32_16x16x32_bf16 a[116:119], a[184:187], v[180:183], a[116:119]
    ds_read_b128 a[232:235], v2 offset:25472
    v_cvt_pk_bf16_f32 v185, v162, v163
    v_mfma_f32_16x16x32_bf16 a[120:123], a[188:191], v[176:179], a[120:123]
    v_exp_f32 v171, v155
    v_mfma_f32_16x16x32_bf16 a[124:127], a[188:191], v[180:183], a[124:127]
    ds_read_b128 a[236:239], v2 offset:25536
    s_waitcnt lgkmcnt(4)
    v_mfma_f32_16x16x32_bf16 v[128:131], a[192:195], v[64:67], v[192:195]
    v_exp_f32 v172, v156
    v_mfma_f32_16x16x32_bf16 v[128:131], a[196:199], v[72:75], v[128:131]
    ds_read_b128 a[240:243], v2 offset:25600
    buffer_load_dwordx4 v28, s[16:19], s91 offen offset:2048 lds
    v_mfma_f32_16x16x32_bf16 v[128:131], a[200:203], v[80:83], v[128:131]
    v_exp_f32 v173, v157
    v_mfma_f32_16x16x32_bf16 v[128:131], a[204:207], v[88:91], v[128:131]
    ds_read_b128 a[244:247], v2 offset:25664
    v_add_f32 v33, v164, v165
    v_mfma_f32_16x16x32_bf16 v[128:131], a[208:211], v[96:99], v[128:131]
    v_exp_f32 v174, v158
    v_mfma_f32_16x16x32_bf16 v[128:131], a[212:215], v[104:107], v[128:131]
    ds_read_b128 a[248:251], v2 offset:25728
    v_cvt_pk_bf16_f32 v188, v164, v165
    v_mfma_f32_16x16x32_bf16 v[128:131], a[216:219], v[112:115], v[128:131]
    v_exp_f32 v175, v159
    v_mfma_f32_16x16x32_bf16 v[128:131], a[220:223], v[120:123], v[128:131]
    ds_read_b128 a[252:255], v2 offset:25792
    buffer_load_dwordx4 v29, s[16:19], s91 offen offset:3072 lds
    v_mfma_f32_16x16x32_bf16 v[132:135], a[192:195], v[68:71], v[196:199]
    ds_read_b64_tr_b16 a[128:129], v3 offset:33792
    v_add_f32 v33, v33, v166
    v_mfma_f32_16x16x32_bf16 v[132:135], a[196:199], v[76:79], v[132:135]
    ds_read_b64_tr_b16 a[130:131], v3 offset:34304
    v_add_f32 v33, v33, v167
    v_mfma_f32_16x16x32_bf16 v[132:135], a[200:203], v[84:87], v[132:135]
    ds_read_b64_tr_b16 a[132:133], v3 offset:33824
    v_cvt_pk_bf16_f32 v189, v166, v167
    v_mfma_f32_16x16x32_bf16 v[132:135], a[204:207], v[92:95], v[132:135]
    ds_read_b64_tr_b16 a[134:135], v3 offset:34336
    v_add_f32 v32, v32, v168
    v_mfma_f32_16x16x32_bf16 v[132:135], a[208:211], v[100:103], v[132:135]
    ds_read_b64_tr_b16 a[136:137], v3 offset:33856
    v_add_f32 v32, v32, v169
    v_mfma_f32_16x16x32_bf16 v[132:135], a[212:215], v[108:111], v[132:135]
    ds_read_b64_tr_b16 a[138:139], v3 offset:34368
    s_add_u32 m0, s57, 118272
    v_mfma_f32_16x16x32_bf16 v[132:135], a[216:219], v[116:119], v[132:135]
    ds_read_b64_tr_b16 a[140:141], v3 offset:33888
    v_cvt_pk_bf16_f32 v186, v168, v169
    v_mfma_f32_16x16x32_bf16 v[132:135], a[220:223], v[124:127], v[132:135]
    ds_read_b64_tr_b16 a[142:143], v3 offset:34400
    s_waitcnt lgkmcnt(8)
    v_mfma_f32_16x16x32_bf16 v[136:139], a[224:227], v[64:67], v[192:195]
    ds_read_b64_tr_b16 a[144:145], v3 offset:33920
    v_add_f32 v32, v32, v170
    v_mfma_f32_16x16x32_bf16 v[136:139], a[228:231], v[72:75], v[136:139]
    ds_read_b64_tr_b16 a[146:147], v3 offset:34432
    v_add_f32 v32, v32, v171
    v_mfma_f32_16x16x32_bf16 v[136:139], a[232:235], v[80:83], v[136:139]
    ds_read_b64_tr_b16 a[148:149], v3 offset:33952
    v_cvt_pk_bf16_f32 v187, v170, v171
    v_mfma_f32_16x16x32_bf16 v[136:139], a[236:239], v[88:91], v[136:139]
    ds_read_b64_tr_b16 a[150:151], v3 offset:34464
    v_add_f32 v33, v33, v172
    v_mfma_f32_16x16x32_bf16 v[136:139], a[240:243], v[96:99], v[136:139]
    ds_read_b64_tr_b16 a[152:153], v3 offset:33984
    s_mov_b32 s91, 114688
    v_mfma_f32_16x16x32_bf16 v[136:139], a[244:247], v[104:107], v[136:139]
    ds_read_b64_tr_b16 a[154:155], v3 offset:34496
    v_add_f32 v33, v33, v173
    v_mfma_f32_16x16x32_bf16 v[136:139], a[248:251], v[112:115], v[136:139]
    ds_read_b64_tr_b16 a[156:157], v3 offset:34016
    v_cvt_pk_bf16_f32 v190, v172, v173
    v_mfma_f32_16x16x32_bf16 v[136:139], a[252:255], v[120:123], v[136:139]
    ds_read_b64_tr_b16 a[158:159], v3 offset:34528
    v_add_f32 v33, v33, v174
    v_mfma_f32_16x16x32_bf16 v[140:143], a[224:227], v[68:71], v[196:199]
    ds_read_b64_tr_b16 a[160:161], v3 offset:34048
    v_add_f32 v33, v33, v175
    v_mfma_f32_16x16x32_bf16 v[140:143], a[228:231], v[76:79], v[140:143]
    ds_read_b64_tr_b16 a[162:163], v3 offset:34560
    v_cvt_pk_bf16_f32 v191, v174, v175
    v_mfma_f32_16x16x32_bf16 v[140:143], a[232:235], v[84:87], v[140:143]
    ds_read_b64_tr_b16 a[164:165], v3 offset:34080
    buffer_load_dwordx4 v26, s[16:19], s91 offen offset:0 lds
    v_mfma_f32_16x16x32_bf16 v[140:143], a[236:239], v[92:95], v[140:143]
    ds_read_b64_tr_b16 a[166:167], v3 offset:34592
    v_max_f32 v52, v32, v33
    v_mfma_f32_16x16x32_bf16 v[140:143], a[240:243], v[100:103], v[140:143]
    ds_read_b64_tr_b16 a[168:169], v3 offset:34112
    v_cmp_lt_f32 vcc, s90, v52
    v_mfma_f32_16x16x32_bf16 v[140:143], a[244:247], v[108:111], v[140:143]
    ds_read_b64_tr_b16 a[170:171], v3 offset:34624
    buffer_load_dwordx4 v27, s[16:19], s91 offen offset:1024 lds
    v_mfma_f32_16x16x32_bf16 v[140:143], a[248:251], v[116:119], v[140:143]
    ds_read_b64_tr_b16 a[172:173], v3 offset:34144
    buffer_load_dwordx4 v28, s[16:19], s91 offen offset:2048 lds
    v_mfma_f32_16x16x32_bf16 v[140:143], a[252:255], v[124:127], v[140:143]
    ds_read_b64_tr_b16 a[174:175], v3 offset:34656
    s_cbranch_vccnz L_tr_p17
L_bk_p17:
    s_waitcnt lgkmcnt(8)
    v_mfma_f32_16x16x32_bf16 a[0:3], a[128:131], v[184:187], a[0:3]
    ds_read_b64_tr_b16 a[176:177], v3 offset:34176
    v_add_f32 v30, v30, v32
    v_mfma_f32_16x16x32_bf16 a[4:7], a[128:131], v[188:191], a[4:7]
    ds_read_b64_tr_b16 a[178:179], v3 offset:34688
    v_add_f32 v31, v31, v33
    v_mfma_f32_16x16x32_bf16 a[8:11], a[132:135], v[184:187], a[8:11]
    ds_read_b64_tr_b16 a[180:181], v3 offset:34208
    buffer_load_dwordx4 v29, s[16:19], s91 offen offset:3072 lds
    v_mfma_f32_16x16x32_bf16 a[12:15], a[132:135], v[188:191], a[12:15]
    ds_read_b64_tr_b16 a[182:183], v3 offset:34720
    v_mfma_f32_16x16x32_bf16 a[16:19], a[136:139], v[184:187], a[16:19]
    ds_read_b64_tr_b16 a[184:185], v3 offset:34240
    v_mfma_f32_16x16x32_bf16 a[20:23], a[136:139], v[188:191], a[20:23]
    ds_read_b64_tr_b16 a[186:187], v3 offset:34752
    v_mfma_f32_16x16x32_bf16 a[24:27], a[140:143], v[184:187], a[24:27]
    ds_read_b64_tr_b16 a[188:189], v3 offset:34272
    v_mfma_f32_16x16x32_bf16 a[28:31], a[140:143], v[188:191], a[28:31]
    ds_read_b64_tr_b16 a[190:191], v3 offset:34784
    v_mfma_f32_16x16x32_bf16 a[32:35], a[144:147], v[184:187], a[32:35]
    v_exp_f32 v160, v128
    v_mfma_f32_16x16x32_bf16 a[36:39], a[144:147], v[188:191], a[36:39]
    s_waitcnt vmcnt(12)
    s_barrier
    ds_read_b128 a[192:195], v2 offset:50688
    v_mfma_f32_16x16x32_bf16 a[40:43], a[148:151], v[184:187], a[40:43]
    v_exp_f32 v161, v129
    v_mfma_f32_16x16x32_bf16 a[44:47], a[148:151], v[188:191], a[44:47]
    ds_read_b128 a[196:199], v2 offset:50752
    s_add_u32 m0, s57, 0
    v_mfma_f32_16x16x32_bf16 a[48:51], a[152:155], v[184:187], a[48:51]
    v_exp_f32 v162, v130
    v_mfma_f32_16x16x32_bf16 a[52:55], a[152:155], v[188:191], a[52:55]
    ds_read_b128 a[200:203], v2 offset:50816
    v_add_f32 v32, v160, v161
    v_mfma_f32_16x16x32_bf16 a[56:59], a[156:159], v[184:187], a[56:59]
    v_exp_f32 v163, v131
    v_mfma_f32_16x16x32_bf16 a[60:63], a[156:159], v[188:191], a[60:63]
    ds_read_b128 a[204:207], v2 offset:50880
    s_waitcnt lgkmcnt(4)
    v_mfma_f32_16x16x32_bf16 a[64:67], a[160:163], v[184:187], a[64:67]
    v_exp_f32 v164, v132
    v_mfma_f32_16x16x32_bf16 a[68:71], a[160:163], v[188:191], a[68:71]
    ds_read_b128 a[208:211], v2 offset:50944
    s_mov_b32 s91, 128
    v_mfma_f32_16x16x32_bf16 a[72:75], a[164:167], v[184:187], a[72:75]
    v_exp_f32 v165, v133
    v_mfma_f32_16x16x32_bf16 a[76:79], a[164:167], v[188:191], a[76:79]
    ds_read_b128 a[212:215], v2 offset:51008
    v_cvt_pk_bf16_f32 v176, v160, v161
    v_mfma_f32_16x16x32_bf16 a[80:83], a[168:171], v[184:187], a[80:83]
    v_exp_f32 v166, v134
    v_mfma_f32_16x16x32_bf16 a[84:87], a[168:171], v[188:191], a[84:87]
    ds_read_b128 a[216:219], v2 offset:51072
    buffer_load_dwordx4 v26, s[16:19], s91 offen offset:0 lds
    v_mfma_f32_16x16x32_bf16 a[88:91], a[172:175], v[184:187], a[88:91]
    v_exp_f32 v167, v135
    v_mfma_f32_16x16x32_bf16 a[92:95], a[172:175], v[188:191], a[92:95]
    ds_read_b128 a[220:223], v2 offset:51136
    v_add_f32 v32, v32, v162
    v_mfma_f32_16x16x32_bf16 a[96:99], a[176:179], v[184:187], a[96:99]
    v_exp_f32 v168, v136
    v_mfma_f32_16x16x32_bf16 a[100:103], a[176:179], v[188:191], a[100:103]
    ds_read_b128 a[224:227], v2 offset:59136
    buffer_load_dwordx4 v27, s[16:19], s91 offen offset:1024 lds
    v_mfma_f32_16x16x32_bf16 a[104:107], a[180:183], v[184:187], a[104:107]
    v_exp_f32 v169, v137
    v_mfma_f32_16x16x32_bf16 a[108:111], a[180:183], v[188:191], a[108:111]
    ds_read_b128 a[228:231], v2 offset:59200
    v_add_f32 v32, v32, v163
    v_mfma_f32_16x16x32_bf16 a[112:115], a[184:187], v[184:187], a[112:115]
    v_exp_f32 v170, v138
    v_mfma_f32_16x16x32_bf16 a[116:119], a[184:187], v[188:191], a[116:119]
    ds_read_b128 a[232:235], v2 offset:59264
    v_cvt_pk_bf16_f32 v177, v162, v163
    v_mfma_f32_16x16x32_bf16 a[120:123], a[188:191], v[184:187], a[120:123]
    v_exp_f32 v171, v139
    v_mfma_f32_16x16x32_bf16 a[124:127], a[188:191], v[188:191], a[124:127]
    ds_read_b128 a[236:239], v2 offset:59328
    s_waitcnt lgkmcnt(4)
    v_mfma_f32_16x16x32_bf16 v[144:147], a[192:195], v[64:67], v[192:195]
    v_exp_f32 v172, v140
    v_mfma_f32_16x16x32_bf16 v[144:147], a[196:199], v[72:75], v[144:147]
    ds_read_b128 a[240:243], v2 offset:59392
    buffer_load_dwordx4 v28, s[16:19], s91 offen offset:2048 lds
    v_mfma_f32_16x16x32_bf16 v[144:147], a[200:203], v[80:83], v[144:147]
    v_exp_f32 v173, v141
    v_mfma_f32_16x16x32_bf16 v[144:147], a[204:207], v[88:91], v[144:147]
    ds_read_b128 a[244:247], v2 offset:59456
    v_add_f32 v33, v164, v165
    v_mfma_f32_16x16x32_bf16 v[144:147], a[208:211], v[96:99], v[144:147]
    v_exp_f32 v174, v142
    v_mfma_f32_16x16x32_bf16 v[144:147], a[212:215], v[104:107], v[144:147]
    ds_read_b128 a[248:251], v2 offset:59520
    v_cvt_pk_bf16_f32 v180, v164, v165
    v_mfma_f32_16x16x32_bf16 v[144:147], a[216:219], v[112:115], v[144:147]
    v_exp_f32 v175, v143
    v_mfma_f32_16x16x32_bf16 v[144:147], a[220:223], v[120:123], v[144:147]
    ds_read_b128 a[252:255], v2 offset:59584
    buffer_load_dwordx4 v29, s[16:19], s91 offen offset:3072 lds
    v_mfma_f32_16x16x32_bf16 v[148:151], a[192:195], v[68:71], v[196:199]
    ds_read_b64_tr_b16 a[128:129], v9 offset:0
    v_add_f32 v33, v33, v166
    v_mfma_f32_16x16x32_bf16 v[148:151], a[196:199], v[76:79], v[148:151]
    ds_read_b64_tr_b16 a[130:131], v9 offset:512
    v_add_f32 v33, v33, v167
    v_mfma_f32_16x16x32_bf16 v[148:151], a[200:203], v[84:87], v[148:151]
    ds_read_b64_tr_b16 a[132:133], v9 offset:32
    v_cvt_pk_bf16_f32 v181, v166, v167
    v_mfma_f32_16x16x32_bf16 v[148:151], a[204:207], v[92:95], v[148:151]
    ds_read_b64_tr_b16 a[134:135], v9 offset:544
    v_add_f32 v32, v32, v168
    v_mfma_f32_16x16x32_bf16 v[148:151], a[208:211], v[100:103], v[148:151]
    ds_read_b64_tr_b16 a[136:137], v9 offset:64
    v_add_f32 v32, v32, v169
    v_mfma_f32_16x16x32_bf16 v[148:151], a[212:215], v[108:111], v[148:151]
    ds_read_b64_tr_b16 a[138:139], v9 offset:576
    s_add_u32 m0, s57, 16896
    v_mfma_f32_16x16x32_bf16 v[148:151], a[216:219], v[116:119], v[148:151]
    ds_read_b64_tr_b16 a[140:141], v9 offset:96
    v_cvt_pk_bf16_f32 v178, v168, v169
    v_mfma_f32_16x16x32_bf16 v[148:151], a[220:223], v[124:127], v[148:151]
    ds_read_b64_tr_b16 a[142:143], v9 offset:608
    s_waitcnt lgkmcnt(8)
    v_mfma_f32_16x16x32_bf16 v[152:155], a[224:227], v[64:67], v[192:195]
    ds_read_b64_tr_b16 a[144:145], v9 offset:128
    v_add_f32 v32, v32, v170
    v_mfma_f32_16x16x32_bf16 v[152:155], a[228:231], v[72:75], v[152:155]
    ds_read_b64_tr_b16 a[146:147], v9 offset:640
    v_add_f32 v32, v32, v171
    v_mfma_f32_16x16x32_bf16 v[152:155], a[232:235], v[80:83], v[152:155]
    ds_read_b64_tr_b16 a[148:149], v9 offset:160
    v_cvt_pk_bf16_f32 v179, v170, v171
    v_mfma_f32_16x16x32_bf16 v[152:155], a[236:239], v[88:91], v[152:155]
    ds_read_b64_tr_b16 a[150:151], v9 offset:672
    v_add_f32 v33, v33, v172
    v_mfma_f32_16x16x32_bf16 v[152:155], a[240:243], v[96:99], v[152:155]
    ds_read_b64_tr_b16 a[152:153], v9 offset:192
    s_mov_b32 s91, 114816
    v_mfma_f32_16x16x32_bf16 v[152:155], a[244:247], v[104:107], v[152:155]
    ds_read_b64_tr_b16 a[154:155], v9 offset:704
    v_add_f32 v33, v33, v173
    v_mfma_f32_16x16x32_bf16 v[152:155], a[248:251], v[112:115], v[152:155]
    ds_read_b64_tr_b16 a[156:157], v9 offset:224
    v_cvt_pk_bf16_f32 v182, v172, v173
    v_mfma_f32_16x16x32_bf16 v[152:155], a[252:255], v[120:123], v[152:155]
    ds_read_b64_tr_b16 a[158:159], v9 offset:736
    v_add_f32 v33, v33, v174
    v_mfma_f32_16x16x32_bf16 v[156:159], a[224:227], v[68:71], v[196:199]
    ds_read_b64_tr_b16 a[160:161], v9 offset:256
    v_add_f32 v33, v33, v175
    v_mfma_f32_16x16x32_bf16 v[156:159], a[228:231], v[76:79], v[156:159]
    ds_read_b64_tr_b16 a[162:163], v9 offset:768
    v_cvt_pk_bf16_f32 v183, v174, v175
    v_mfma_f32_16x16x32_bf16 v[156:159], a[232:235], v[84:87], v[156:159]
    ds_read_b64_tr_b16 a[164:165], v9 offset:288
    buffer_load_dwordx4 v26, s[16:19], s91 offen offset:0 lds
    v_mfma_f32_16x16x32_bf16 v[156:159], a[236:239], v[92:95], v[156:159]
    ds_read_b64_tr_b16 a[166:167], v9 offset:800
    v_max_f32 v52, v32, v33
    v_mfma_f32_16x16x32_bf16 v[156:159], a[240:243], v[100:103], v[156:159]
    ds_read_b64_tr_b16 a[168:169], v9 offset:320
    v_cmp_lt_f32 vcc, s90, v52
    v_mfma_f32_16x16x32_bf16 v[156:159], a[244:247], v[108:111], v[156:159]
    ds_read_b64_tr_b16 a[170:171], v9 offset:832
    buffer_load_dwordx4 v27, s[16:19], s91 offen offset:1024 lds
    v_mfma_f32_16x16x32_bf16 v[156:159], a[248:251], v[116:119], v[156:159]
    ds_read_b64_tr_b16 a[172:173], v9 offset:352
    buffer_load_dwordx4 v28, s[16:19], s91 offen offset:2048 lds
    v_mfma_f32_16x16x32_bf16 v[156:159], a[252:255], v[124:127], v[156:159]
    ds_read_b64_tr_b16 a[174:175], v9 offset:864
    s_cbranch_vccnz L_tr_p18
L_bk_p18:
    s_waitcnt lgkmcnt(8)
    v_mfma_f32_16x16x32_bf16 a[0:3], a[128:131], v[176:179], a[0:3]
    ds_read_b64_tr_b16 a[176:177], v9 offset:384
    v_add_f32 v30, v30, v32
    v_mfma_f32_16x16x32_bf16 a[4:7], a[128:131], v[180:183], a[4:7]
    ds_read_b64_tr_b16 a[178:179], v9 offset:896
    v_add_f32 v31, v31, v33
    v_mfma_f32_16x16x32_bf16 a[8:11], a[132:135], v[176:179], a[8:11]
    ds_read_b64_tr_b16 a[180:181], v9 offset:416
    buffer_load_dwordx4 v29, s[16:19], s91 offen offset:3072 lds
    v_mfma_f32_16x16x32_bf16 a[12:15], a[132:135], v[180:183], a[12:15]
    ds_read_b64_tr_b16 a[182:183], v9 offset:928
    v_mfma_f32_16x16x32_bf16 a[16:19], a[136:139], v[176:179], a[16:19]
    ds_read_b64_tr_b16 a[184:185], v9 offset:448
    v_mfma_f32_16x16x32_bf16 a[20:23], a[136:139], v[180:183], a[20:23]
    ds_read_b64_tr_b16 a[186:187], v9 offset:960
    v_mfma_f32_16x16x32_bf16 a[24:27], a[140:143], v[176:179], a[24:27]
    ds_read_b64_tr_b16 a[188:189], v9 offset:480
    v_mfma_f32_16x16x32_bf16 a[28:31], a[140:143], v[180:183], a[28:31]
    ds_read_b64_tr_b16 a[190:191], v9 offset:992
    v_mfma_f32_16x16x32_bf16 a[32:35], a[144:147], v[176:179], a[32:35]
    s_waitcnt vmcnt(12)
    s_barrier
    ds_read_b64_tr_b16 a[192:193], v9 offset:16896
    v_mfma_f32_16x16x32_bf16 a[36:39], a[144:147], v[180:183], a[36:39]
    ds_read_b64_tr_b16 a[194:195], v9 offset:17408
    s_add_u32 m0, s57, 33792
    v_mfma_f32_16x16x32_bf16 a[40:43], a[148:151], v[176:179], a[40:43]
    ds_read_b64_tr_b16 a[196:197], v9 offset:16928
    v_mfma_f32_16x16x32_bf16 a[44:47], a[148:151], v[180:183], a[44:47]
    ds_read_b64_tr_b16 a[198:199], v9 offset:17440
    v_mfma_f32_16x16x32_bf16 a[48:51], a[152:155], v[176:179], a[48:51]
    ds_read_b64_tr_b16 a[200:201], v9 offset:16960
    v_exp_f32 v160, v144
    v_mfma_f32_16x16x32_bf16 a[52:55], a[152:155], v[180:183], a[52:55]
    ds_read_b64_tr_b16 a[202:203], v9 offset:17472
    v_exp_f32 v161, v145
    v_mfma_f32_16x16x32_bf16 a[56:59], a[156:159], v[176:179], a[56:59]
    ds_read_b64_tr_b16 a[204:205], v9 offset:16992
    v_exp_f32 v162, v146
    v_mfma_f32_16x16x32_bf16 a[60:63], a[156:159], v[180:183], a[60:63]
    ds_read_b64_tr_b16 a[206:207], v9 offset:17504
    v_exp_f32 v163, v147
    v_add_f32 v32, v160, v161
    v_cvt_pk_bf16_f32 v184, v160, v161
    s_waitcnt lgkmcnt(8)
    v_mfma_f32_16x16x32_bf16 a[64:67], a[160:163], v[176:179], a[64:67]
    ds_read_b64_tr_b16 a[208:209], v9 offset:17024
    v_exp_f32 v164, v148
    v_add_f32 v32, v32, v162
    v_mfma_f32_16x16x32_bf16 a[68:71], a[160:163], v[180:183], a[68:71]
    ds_read_b64_tr_b16 a[210:211], v9 offset:17536
    v_exp_f32 v165, v149
    v_add_f32 v32, v32, v163
    v_cvt_pk_bf16_f32 v185, v162, v163
    v_mfma_f32_16x16x32_bf16 a[72:75], a[164:167], v[176:179], a[72:75]
    ds_read_b64_tr_b16 a[212:213], v9 offset:17056
    v_exp_f32 v166, v150
    v_mfma_f32_16x16x32_bf16 a[76:79], a[164:167], v[180:183], a[76:79]
    ds_read_b64_tr_b16 a[214:215], v9 offset:17568
    v_exp_f32 v167, v151
    v_add_f32 v33, v164, v165
    v_cvt_pk_bf16_f32 v188, v164, v165
    v_mfma_f32_16x16x32_bf16 a[80:83], a[168:171], v[176:179], a[80:83]
    ds_read_b64_tr_b16 a[216:217], v9 offset:17088
    v_exp_f32 v168, v152
    v_add_f32 v33, v33, v166
    v_mfma_f32_16x16x32_bf16 a[84:87], a[168:171], v[180:183], a[84:87]
    ds_read_b64_tr_b16 a[218:219], v9 offset:17600
    v_exp_f32 v169, v153
    v_add_f32 v33, v33, v167
    v_cvt_pk_bf16_f32 v189, v166, v167
    v_mfma_f32_16x16x32_bf16 a[88:91], a[172:175], v[176:179], a[88:91]
    ds_read_b64_tr_b16 a[220:221], v9 offset:17120
    v_exp_f32 v170, v154
    v_add_f32 v32, v32, v168
    v_mfma_f32_16x16x32_bf16 a[92:95], a[172:175], v[180:183], a[92:95]
    ds_read_b64_tr_b16 a[222:223], v9 offset:17632
    v_exp_f32 v171, v155
    v_add_f32 v32, v32, v169
    v_cvt_pk_bf16_f32 v186, v168, v169
    v_mfma_f32_16x16x32_bf16 a[96:99], a[176:179], v[176:179], a[96:99]
    ds_read_b64_tr_b16 a[224:225], v9 offset:17152
    v_exp_f32 v172, v156
    v_add_f32 v32, v32, v170
    v_mfma_f32_16x16x32_bf16 a[100:103], a[176:179], v[180:183], a[100:103]
    ds_read_b64_tr_b16 a[226:227], v9 offset:17664
    v_exp_f32 v173, v157
    v_add_f32 v32, v32, v171
    v_cvt_pk_bf16_f32 v187, v170, v171
    s_mov_b32 s91, 256
    v_mfma_f32_16x16x32_bf16 a[104:107], a[180:183], v[176:179], a[104:107]
    ds_read_b64_tr_b16 a[228:229], v9 offset:17184
    v_exp_f32 v174, v158
    v_add_f32 v33, v33, v172
    v_mfma_f32_16x16x32_bf16 a[108:111], a[180:183], v[180:183], a[108:111]
    ds_read_b64_tr_b16 a[230:231], v9 offset:17696
    v_exp_f32 v175, v159
    v_add_f32 v33, v33, v173
    v_cvt_pk_bf16_f32 v190, v172, v173
    v_mfma_f32_16x16x32_bf16 a[112:115], a[184:187], v[176:179], a[112:115]
    ds_read_b64_tr_b16 a[232:233], v9 offset:17216
    v_add_f32 v33, v33, v174
    v_mfma_f32_16x16x32_bf16 a[116:119], a[184:187], v[180:183], a[116:119]
    ds_read_b64_tr_b16 a[234:235], v9 offset:17728
    v_add_f32 v33, v33, v175
    v_cvt_pk_bf16_f32 v191, v174, v175
    v_mfma_f32_16x16x32_bf16 a[120:123], a[188:191], v[176:179], a[120:123]
    ds_read_b64_tr_b16 a[236:237], v9 offset:17248
    v_max_f32 v52, v32, v33
    buffer_load_dwordx4 v26, s[16:19], s91 offen offset:0 lds
    v_mfma_f32_16x16x32_bf16 a[124:127], a[188:191], v[180:183], a[124:127]
    ds_read_b64_tr_b16 a[238:239], v9 offset:17760
    v_cmp_lt_f32 vcc, s90, v52
    s_cbranch_vccnz L_tr_p19
L_bk_p19:
    s_waitcnt lgkmcnt(8)
    v_mfma_f32_16x16x32_bf16 a[0:3], a[192:195], v[184:187], a[0:3]
    ds_read_b64_tr_b16 a[240:241], v9 offset:17280
    v_add_f32 v30, v30, v32
    v_mfma_f32_16x16x32_bf16 a[4:7], a[192:195], v[188:191], a[4:7]
    ds_read_b64_tr_b16 a[242:243], v9 offset:17792
    v_add_f32 v31, v31, v33
    v_mfma_f32_16x16x32_bf16 a[8:11], a[196:199], v[184:187], a[8:11]
    ds_read_b64_tr_b16 a[244:245], v9 offset:17312
    buffer_load_dwordx4 v27, s[16:19], s91 offen offset:1024 lds
    v_mfma_f32_16x16x32_bf16 a[12:15], a[196:199], v[188:191], a[12:15]
    ds_read_b64_tr_b16 a[246:247], v9 offset:17824
    v_mov_b32 v38, v30
    v_mov_b32 v39, v31
    s_nop 1
    v_permlane16_swap_b32 v30, v38
    v_permlane16_swap_b32 v31, v39
    s_nop 1
    v_add_f32 v30, v30, v38
    v_add_f32 v31, v31, v39
    v_mov_b32 v38, v30
    v_mov_b32 v39, v31
    s_nop 1
    v_permlane32_swap_b32 v30, v38
    v_permlane32_swap_b32 v31, v39
    s_nop 1
    v_add_f32 v30, v30, v38
    v_add_f32 v31, v31, v39
    v_rcp_f32 v34, v30
    v_rcp_f32 v35, v31
    s_nop 0
    v_mfma_f32_16x16x32_bf16 a[16:19], a[200:203], v[184:187], a[16:19]
    ds_read_b64_tr_b16 a[248:249], v9 offset:17344
    buffer_load_dwordx4 v28, s[16:19], s91 offen offset:2048 lds
    v_mfma_f32_16x16x32_bf16 a[20:23], a[200:203], v[188:191], a[20:23]
    ds_read_b64_tr_b16 a[250:251], v9 offset:17856
    buffer_load_dwordx4 v29, s[16:19], s91 offen offset:3072 lds
    v_mfma_f32_16x16x32_bf16 a[24:27], a[204:207], v[184:187], a[24:27]
    ds_read_b64_tr_b16 a[252:253], v9 offset:17376
    v_accvgpr_read_b32 v208, a0
    v_mfma_f32_16x16x32_bf16 a[28:31], a[204:207], v[188:191], a[28:31]
    ds_read_b64_tr_b16 a[254:255], v9 offset:17888
    v_accvgpr_read_b32 v209, a1
    v_mfma_f32_16x16x32_bf16 a[32:35], a[208:211], v[184:187], a[32:35]
    ds_read_b64_tr_b16 a[128:129], v10 offset:33792
    v_accvgpr_read_b32 v210, a2
    v_mfma_f32_16x16x32_bf16 a[36:39], a[208:211], v[188:191], a[36:39]
    ds_read_b64_tr_b16 a[130:131], v10 offset:35840
    v_accvgpr_read_b32 v211, a3
    v_mfma_f32_16x16x32_bf16 a[40:43], a[212:215], v[184:187], a[40:43]
    ds_read_b64_tr_b16 a[132:133], v10 offset:38016
    v_accvgpr_read_b32 v212, a8
    v_mfma_f32_16x16x32_bf16 a[44:47], a[212:215], v[188:191], a[44:47]
    ds_read_b64_tr_b16 a[134:135], v10 offset:40064
    v_accvgpr_read_b32 v213, a9
    v_mfma_f32_16x16x32_bf16 a[48:51], a[216:219], v[184:187], a[48:51]
    ds_read_b64_tr_b16 a[136:137], v10 offset:42240
    v_accvgpr_read_b32 v214, a10
    v_mfma_f32_16x16x32_bf16 a[52:55], a[216:219], v[188:191], a[52:55]
    ds_read_b64_tr_b16 a[138:139], v10 offset:44288
    v_accvgpr_read_b32 v215, a11
    v_mfma_f32_16x16x32_bf16 a[56:59], a[220:223], v[184:187], a[56:59]
    ds_read_b64_tr_b16 a[140:141], v10 offset:46464
    v_mul_f32 v208, v208, v34
    v_mfma_f32_16x16x32_bf16 a[60:63], a[220:223], v[188:191], a[60:63]
    ds_read_b64_tr_b16 a[142:143], v10 offset:48512
    s_waitcnt lgkmcnt(8)
    v_mfma_f32_16x16x32_bf16 a[64:67], a[224:227], v[184:187], a[64:67]
    ds_read_b64_tr_b16 a[144:145], v11 offset:33792
    v_mul_f32 v209, v209, v34
    v_mfma_f32_16x16x32_bf16 a[68:71], a[224:227], v[188:191], a[68:71]
    ds_read_b64_tr_b16 a[146:147], v11 offset:35840
    v_mul_f32 v210, v210, v34
    v_mfma_f32_16x16x32_bf16 a[72:75], a[228:231], v[184:187], a[72:75]
    ds_read_b64_tr_b16 a[148:149], v11 offset:38016
    s_add_u32 m0, s57, 50688
    v_mfma_f32_16x16x32_bf16 a[76:79], a[228:231], v[188:191], a[76:79]
    ds_read_b64_tr_b16 a[150:151], v11 offset:40064
    v_mul_f32 v211, v211, v34
    v_mfma_f32_16x16x32_bf16 a[80:83], a[232:235], v[184:187], a[80:83]
    ds_read_b64_tr_b16 a[152:153], v11 offset:42240
    v_mul_f32 v212, v212, v34
    v_mfma_f32_16x16x32_bf16 a[84:87], a[232:235], v[188:191], a[84:87]
    ds_read_b64_tr_b16 a[154:155], v11 offset:44288
    v_mul_f32 v213, v213, v34
    v_mfma_f32_16x16x32_bf16 a[88:91], a[236:239], v[184:187], a[88:91]
    ds_read_b64_tr_b16 a[156:157], v11 offset:46464
    v_mul_f32 v214, v214, v34
    v_mfma_f32_16x16x32_bf16 a[92:95], a[236:239], v[188:191], a[92:95]
    ds_read_b64_tr_b16 a[158:159], v11 offset:48512
    s_mov_b32 s91, 114944
    v_mfma_f32_16x16x32_bf16 a[96:99], a[240:243], v[184:187], a[96:99]
    ds_read_b64_tr_b16 a[160:161], v12 offset:33792
    v_mul_f32 v215, v215, v34
    v_mfma_f32_16x16x32_bf16 a[100:103], a[240:243], v[188:191], a[100:103]
    ds_read_b64_tr_b16 a[162:163], v12 offset:35840
    v_cvt_pk_bf16_f32 v64, v208, v209
    v_mfma_f32_16x16x32_bf16 a[104:107], a[244:247], v[184:187], a[104:107]
    ds_read_b64_tr_b16 a[164:165], v12 offset:38016
    v_cvt_pk_bf16_f32 v65, v210, v211
    v_mfma_f32_16x16x32_bf16 a[108:111], a[244:247], v[188:191], a[108:111]
    ds_read_b64_tr_b16 a[166:167], v12 offset:40064
    v_cvt_pk_bf16_f32 v66, v212, v213
    v_mfma_f32_16x16x32_bf16 a[112:115], a[248:251], v[184:187], a[112:115]
    ds_read_b64_tr_b16 a[168:169], v12 offset:42240
    buffer_load_dwordx4 v26, s[16:19], s91 offen offset:0 lds
    v_mfma_f32_16x16x32_bf16 a[116:119], a[248:251], v[188:191], a[116:119]
    ds_read_b64_tr_b16 a[170:171], v12 offset:44288
    v_cvt_pk_bf16_f32 v67, v214, v215
    v_mfma_f32_16x16x32_bf16 a[120:123], a[252:255], v[184:187], a[120:123]
    ds_read_b64_tr_b16 a[172:173], v12 offset:46464
    v_accvgpr_read_b32 v208, a16
    v_accvgpr_read_b32 v209, a17
    v_accvgpr_read_b32 v210, a18
    v_accvgpr_read_b32 v211, a19
    v_accvgpr_read_b32 v212, a24
    v_accvgpr_read_b32 v213, a25
    v_accvgpr_read_b32 v214, a26
    v_accvgpr_read_b32 v215, a27
    v_mul_f32 v208, v208, v34
    v_mul_f32 v209, v209, v34
    v_mul_f32 v210, v210, v34
    v_mul_f32 v211, v211, v34
    v_mul_f32 v212, v212, v34
    v_mul_f32 v213, v213, v34
    v_mul_f32 v214, v214, v34
    v_mul_f32 v215, v215, v34
    v_cvt_pk_bf16_f32 v72, v208, v209
    v_cvt_pk_bf16_f32 v73, v210, v211
    v_cvt_pk_bf16_f32 v74, v212, v213
    v_cvt_pk_bf16_f32 v75, v214, v215
    v_mfma_f32_16x16x32_bf16 a[124:127], a[252:255], v[188:191], a[124:127]
    ds_read_b64_tr_b16 a[174:175], v12 offset:48512
    v_accvgpr_read_b32 v208, a32
    v_accvgpr_read_b32 v209, a33
    v_accvgpr_read_b32 v210, a34
    v_accvgpr_read_b32 v211, a35
    v_accvgpr_read_b32 v212, a40
    v_accvgpr_read_b32 v213, a41
    v_accvgpr_read_b32 v214, a42
    v_accvgpr_read_b32 v215, a43
    v_mul_f32 v208, v208, v34
    v_mul_f32 v209, v209, v34
    v_mul_f32 v210, v210, v34
    v_mul_f32 v211, v211, v34
    v_mul_f32 v212, v212, v34
    v_mul_f32 v213, v213, v34
    v_mul_f32 v214, v214, v34
    v_mul_f32 v215, v215, v34
    v_cvt_pk_bf16_f32 v80, v208, v209
    v_cvt_pk_bf16_f32 v81, v210, v211
    v_cvt_pk_bf16_f32 v82, v212, v213
    v_cvt_pk_bf16_f32 v83, v214, v215
    s_waitcnt lgkmcnt(8)
    v_mfma_f32_16x16x32_bf16 v[128:131], a[128:131], v[64:67], 0
    ds_read_b64_tr_b16 a[176:177], v13 offset:33792
    v_accvgpr_read_b32 v208, a48
    v_accvgpr_read_b32 v209, a49
    v_accvgpr_read_b32 v210, a50
    v_accvgpr_read_b32 v211, a51
    v_accvgpr_read_b32 v212, a56
    v_accvgpr_read_b32 v213, a57
    v_accvgpr_read_b32 v214, a58
    v_accvgpr_read_b32 v215, a59
    v_mul_f32 v208, v208, v34
    v_mul_f32 v209, v209, v34
    v_mul_f32 v210, v210, v34
    v_mul_f32 v211, v211, v34
    v_mul_f32 v212, v212, v34
    v_mul_f32 v213, v213, v34
    v_mul_f32 v214, v214, v34
    v_mul_f32 v215, v215, v34
    v_cvt_pk_bf16_f32 v88, v208, v209
    v_cvt_pk_bf16_f32 v89, v210, v211
    v_cvt_pk_bf16_f32 v90, v212, v213
    v_cvt_pk_bf16_f32 v91, v214, v215
    v_mfma_f32_16x16x32_bf16 v[128:131], a[132:135], v[72:75], v[128:131]
    ds_read_b64_tr_b16 a[178:179], v13 offset:35840
    v_accvgpr_read_b32 v216, a4
    v_accvgpr_read_b32 v217, a5
    v_accvgpr_read_b32 v218, a6
    v_accvgpr_read_b32 v219, a7
    v_accvgpr_read_b32 v220, a12
    v_accvgpr_read_b32 v221, a13
    v_accvgpr_read_b32 v222, a14
    v_accvgpr_read_b32 v223, a15
    v_mul_f32 v216, v216, v35
    v_mul_f32 v217, v217, v35
    v_mul_f32 v218, v218, v35
    v_mul_f32 v219, v219, v35
    v_mul_f32 v220, v220, v35
    v_mul_f32 v221, v221, v35
    v_mul_f32 v222, v222, v35
    v_mul_f32 v223, v223, v35
    v_cvt_pk_bf16_f32 v68, v216, v217
    v_cvt_pk_bf16_f32 v69, v218, v219
    v_cvt_pk_bf16_f32 v70, v220, v221
    v_cvt_pk_bf16_f32 v71, v222, v223
    buffer_load_dwordx4 v27, s[16:19], s91 offen offset:1024 lds
    v_mfma_f32_16x16x32_bf16 v[128:131], a[136:139], v[80:83], v[128:131]
    ds_read_b64_tr_b16 a[180:181], v13 offset:38016
    v_accvgpr_read_b32 v216, a20
    v_accvgpr_read_b32 v217, a21
    v_accvgpr_read_b32 v218, a22
    v_accvgpr_read_b32 v219, a23
    v_accvgpr_read_b32 v220, a28
    v_accvgpr_read_b32 v221, a29
    v_accvgpr_read_b32 v222, a30
    v_accvgpr_read_b32 v223, a31
    v_mul_f32 v216, v216, v35
    v_mul_f32 v217, v217, v35
    v_mul_f32 v218, v218, v35
    v_mul_f32 v219, v219, v35
    v_mul_f32 v220, v220, v35
    v_mul_f32 v221, v221, v35
    v_mul_f32 v222, v222, v35
    v_mul_f32 v223, v223, v35
    v_cvt_pk_bf16_f32 v76, v216, v217
    v_cvt_pk_bf16_f32 v77, v218, v219
    v_cvt_pk_bf16_f32 v78, v220, v221
    v_cvt_pk_bf16_f32 v79, v222, v223
    v_mfma_f32_16x16x32_bf16 v[128:131], a[140:143], v[88:91], v[128:131]
    ds_read_b64_tr_b16 a[182:183], v13 offset:40064
    v_accvgpr_read_b32 v216, a36
    v_accvgpr_read_b32 v217, a37
    v_accvgpr_read_b32 v218, a38
    v_accvgpr_read_b32 v219, a39
    v_accvgpr_read_b32 v220, a44
    v_accvgpr_read_b32 v221, a45
    v_accvgpr_read_b32 v222, a46
    v_accvgpr_read_b32 v223, a47
    v_mul_f32 v216, v216, v35
    v_mul_f32 v217, v217, v35
    v_mul_f32 v218, v218, v35
    v_mul_f32 v219, v219, v35
    v_mul_f32 v220, v220, v35
    v_mul_f32 v221, v221, v35
    v_mul_f32 v222, v222, v35
    v_mul_f32 v223, v223, v35
    v_cvt_pk_bf16_f32 v84, v216, v217
    v_cvt_pk_bf16_f32 v85, v218, v219
    v_cvt_pk_bf16_f32 v86, v220, v221
    v_cvt_pk_bf16_f32 v87, v222, v223
    v_mfma_f32_16x16x32_bf16 v[132:135], a[128:131], v[68:71], 0
    ds_read_b64_tr_b16 a[184:185], v13 offset:42240
    v_accvgpr_read_b32 v216, a52
    v_accvgpr_read_b32 v217, a53
    v_accvgpr_read_b32 v218, a54
    v_accvgpr_read_b32 v219, a55
    v_accvgpr_read_b32 v220, a60
    v_accvgpr_read_b32 v221, a61
    v_accvgpr_read_b32 v222, a62
    v_accvgpr_read_b32 v223, a63
    v_mul_f32 v216, v216, v35
    v_mul_f32 v217, v217, v35
    v_mul_f32 v218, v218, v35
    v_mul_f32 v219, v219, v35
    v_mul_f32 v220, v220, v35
    v_mul_f32 v221, v221, v35
    v_mul_f32 v222, v222, v35
    v_mul_f32 v223, v223, v35
    v_cvt_pk_bf16_f32 v92, v216, v217
    v_cvt_pk_bf16_f32 v93, v218, v219
    v_cvt_pk_bf16_f32 v94, v220, v221
    v_cvt_pk_bf16_f32 v95, v222, v223
    v_mfma_f32_16x16x32_bf16 v[132:135], a[132:135], v[76:79], v[132:135]
    ds_read_b64_tr_b16 a[186:187], v13 offset:44288
    v_accvgpr_read_b32 v208, a64
    v_mfma_f32_16x16x32_bf16 v[132:135], a[136:139], v[84:87], v[132:135]
    ds_read_b64_tr_b16 a[188:189], v13 offset:46464
    buffer_load_dwordx4 v28, s[16:19], s91 offen offset:2048 lds
    buffer_load_dwordx4 v29, s[16:19], s91 offen offset:3072 lds
    v_mfma_f32_16x16x32_bf16 v[132:135], a[140:143], v[92:95], v[132:135]
    ds_read_b64_tr_b16 a[190:191], v13 offset:48512
    v_accvgpr_read_b32 v209, a65
    v_mfma_f32_16x16x32_bf16 v[136:139], a[144:147], v[64:67], 0
    s_waitcnt vmcnt(12)
    s_barrier
    ds_read_b64_tr_b16 a[192:193], v10 offset:50688
    v_mfma_f32_16x16x32_bf16 v[136:139], a[148:151], v[72:75], v[136:139]
    ds_read_b64_tr_b16 a[194:195], v10 offset:52736
    v_accvgpr_read_b32 v210, a66
    v_mfma_f32_16x16x32_bf16 v[136:139], a[152:155], v[80:83], v[136:139]
    ds_read_b64_tr_b16 a[196:197], v10 offset:54912
    v_accvgpr_read_b32 v211, a67
    v_mfma_f32_16x16x32_bf16 v[136:139], a[156:159], v[88:91], v[136:139]
    ds_read_b64_tr_b16 a[198:199], v10 offset:56960
    v_accvgpr_read_b32 v212, a72
    v_mfma_f32_16x16x32_bf16 v[140:143], a[144:147], v[68:71], 0
    ds_read_b64_tr_b16 a[200:201], v10 offset:59136
    v_accvgpr_read_b32 v213, a73
    v_mfma_f32_16x16x32_bf16 v[140:143], a[148:151], v[76:79], v[140:143]
    ds_read_b64_tr_b16 a[202:203], v10 offset:61184
    v_accvgpr_read_b32 v214, a74
    v_mfma_f32_16x16x32_bf16 v[140:143], a[152:155], v[84:87], v[140:143]
    ds_read_b64_tr_b16 a[204:205], v10 offset:63360
    v_accvgpr_read_b32 v215, a75
    v_mfma_f32_16x16x32_bf16 v[140:143], a[156:159], v[92:95], v[140:143]
    ds_read_b64_tr_b16 a[206:207], v10 offset:65408
    s_waitcnt lgkmcnt(8)
    v_mfma_f32_16x16x32_bf16 v[144:147], a[160:163], v[64:67], 0
    ds_read_b64_tr_b16 a[208:209], v11 offset:50688
    v_mul_f32 v208, v208, v34
    v_mfma_f32_16x16x32_bf16 v[144:147], a[164:167], v[72:75], v[144:147]
    ds_read_b64_tr_b16 a[210:211], v11 offset:52736
    v_mul_f32 v209, v209, v34
    v_mfma_f32_16x16x32_bf16 v[144:147], a[168:171], v[80:83], v[144:147]
    ds_read_b64_tr_b16 a[212:213], v11 offset:54912
    v_mul_f32 v210, v210, v34
    v_mfma_f32_16x16x32_bf16 v[144:147], a[172:175], v[88:91], v[144:147]
    ds_read_b64_tr_b16 a[214:215], v11 offset:56960
    v_mul_f32 v211, v211, v34
    v_mfma_f32_16x16x32_bf16 v[148:151], a[160:163], v[68:71], 0
    ds_read_b64_tr_b16 a[216:217], v11 offset:59136
    s_add_u32 m0, s57, 67584
    v_mfma_f32_16x16x32_bf16 v[148:151], a[164:167], v[76:79], v[148:151]
    ds_read_b64_tr_b16 a[218:219], v11 offset:61184
    v_mul_f32 v212, v212, v34
    v_mfma_f32_16x16x32_bf16 v[148:151], a[168:171], v[84:87], v[148:151]
    ds_read_b64_tr_b16 a[220:221], v11 offset:63360
    v_mul_f32 v213, v213, v34
    v_mfma_f32_16x16x32_bf16 v[148:151], a[172:175], v[92:95], v[148:151]
    ds_read_b64_tr_b16 a[222:223], v11 offset:65408
    v_mul_f32 v214, v214, v34
    v_mfma_f32_16x16x32_bf16 v[152:155], a[176:179], v[64:67], 0
    ds_read_b64_tr_b16 a[224:225], v12 offset:50688
    v_mul_f32 v215, v215, v34
    v_mfma_f32_16x16x32_bf16 v[152:155], a[180:183], v[72:75], v[152:155]
    ds_read_b64_tr_b16 a[226:227], v12 offset:52736
    s_mov_b32 s91, 384
    v_mfma_f32_16x16x32_bf16 v[152:155], a[184:187], v[80:83], v[152:155]
    ds_read_b64_tr_b16 a[228:229], v12 offset:54912
    v_cvt_pk_bf16_f32 v96, v208, v209
    v_mfma_f32_16x16x32_bf16 v[152:155], a[188:191], v[88:91], v[152:155]
    ds_read_b64_tr_b16 a[230:231], v12 offset:56960
    v_cvt_pk_bf16_f32 v97, v210, v211
    v_mfma_f32_16x16x32_bf16 v[156:159], a[176:179], v[68:71], 0
    ds_read_b64_tr_b16 a[232:233], v12 offset:59136
    v_cvt_pk_bf16_f32 v98, v212, v213
    v_mfma_f32_16x16x32_bf16 v[156:159], a[180:183], v[76:79], v[156:159]
    ds_read_b64_tr_b16 a[234:235], v12 offset:61184
    v_cvt_pk_bf16_f32 v99, v214, v215
    v_mfma_f32_16x16x32_bf16 v[156:159], a[184:187], v[84:87], v[156:159]
    ds_read_b64_tr_b16 a[236:237], v12 offset:63360
    v_accvgpr_read_b32 v208, a80
    v_accvgpr_read_b32 v209, a81
    v_accvgpr_read_b32 v210, a82
    v_accvgpr_read_b32 v211, a83
    v_accvgpr_read_b32 v212, a88
    v_accvgpr_read_b32 v213, a89
    v_accvgpr_read_b32 v214, a90
    v_accvgpr_read_b32 v215, a91
    v_mul_f32 v208, v208, v34
    v_mul_f32 v209, v209, v34
    v_mul_f32 v210, v210, v34
    v_mul_f32 v211, v211, v34
    v_mul_f32 v212, v212, v34
    v_mul_f32 v213, v213, v34
    v_mul_f32 v214, v214, v34
    v_mul_f32 v215, v215, v34
    v_cvt_pk_bf16_f32 v104, v208, v209
    v_cvt_pk_bf16_f32 v105, v210, v211
    v_cvt_pk_bf16_f32 v106, v212, v213
    v_cvt_pk_bf16_f32 v107, v214, v215
    buffer_load_dwordx4 v26, s[16:19], s91 offen offset:0 lds
    v_mfma_f32_16x16x32_bf16 v[156:159], a[188:191], v[92:95], v[156:159]
    ds_read_b64_tr_b16 a[238:239], v12 offset:65408
    v_accvgpr_read_b32 v208, a96
    v_accvgpr_read_b32 v209, a97
    v_accvgpr_read_b32 v210, a98
    v_accvgpr_read_b32 v211, a99
    v_accvgpr_read_b32 v212, a104
    v_accvgpr_read_b32 v213, a105
    v_accvgpr_read_b32 v214, a106
    v_accvgpr_read_b32 v215, a107
    v_mul_f32 v208, v208, v34
    v_mul_f32 v209, v209, v34
    v_mul_f32 v210, v210, v34
    v_mul_f32 v211, v211, v34
    v_mul_f32 v212, v212, v34
    v_mul_f32 v213, v213, v34
    v_mul_f32 v214, v214, v34
    v_mul_f32 v215, v215, v34
    v_cvt_pk_bf16_f32 v112, v208, v209
    v_cvt_pk_bf16_f32 v113, v210, v211
    v_cvt_pk_bf16_f32 v114, v212, v213
    v_cvt_pk_bf16_f32 v115, v214, v215
    s_waitcnt lgkmcnt(8)
    v_mfma_f32_16x16x32_bf16 v[128:131], a[192:195], v[96:99], v[128:131]
    ds_read_b64_tr_b16 a[240:241], v13 offset:50688
    v_accvgpr_read_b32 v208, a112
    v_accvgpr_read_b32 v209, a113
    v_accvgpr_read_b32 v210, a114
    v_accvgpr_read_b32 v211, a115
    v_accvgpr_read_b32 v212, a120
    v_accvgpr_read_b32 v213, a121
    v_accvgpr_read_b32 v214, a122
    v_accvgpr_read_b32 v215, a123
    v_mul_f32 v208, v208, v34
    v_mul_f32 v209, v209, v34
    v_mul_f32 v210, v210, v34
    v_mul_f32 v211, v211, v34
    v_mul_f32 v212, v212, v34
    v_mul_f32 v213, v213, v34
    v_mul_f32 v214, v214, v34
    v_mul_f32 v215, v215, v34
    v_cvt_pk_bf16_f32 v120, v208, v209
    v_cvt_pk_bf16_f32 v121, v210, v211
    v_cvt_pk_bf16_f32 v122, v212, v213
    v_cvt_pk_bf16_f32 v123, v214, v215
    v_mfma_f32_16x16x32_bf16 v[128:131], a[196:199], v[104:107], v[128:131]
    ds_read_b64_tr_b16 a[242:243], v13 offset:52736
    v_accvgpr_read_b32 v216, a68
    v_accvgpr_read_b32 v217, a69
    v_accvgpr_read_b32 v218, a70
    v_accvgpr_read_b32 v219, a71
    v_accvgpr_read_b32 v220, a76
    v_accvgpr_read_b32 v221, a77
    v_accvgpr_read_b32 v222, a78
    v_accvgpr_read_b32 v223, a79
    v_mul_f32 v216, v216, v35
    v_mul_f32 v217, v217, v35
    v_mul_f32 v218, v218, v35
    v_mul_f32 v219, v219, v35
    v_mul_f32 v220, v220, v35
    v_mul_f32 v221, v221, v35
    v_mul_f32 v222, v222, v35
    v_mul_f32 v223, v223, v35
    v_cvt_pk_bf16_f32 v100, v216, v217
    v_cvt_pk_bf16_f32 v101, v218, v219
    v_cvt_pk_bf16_f32 v102, v220, v221
    v_cvt_pk_bf16_f32 v103, v222, v223
    v_mfma_f32_16x16x32_bf16 v[128:131], a[200:203], v[112:115], v[128:131]
    ds_read_b64_tr_b16 a[244:245], v13 offset:54912
    v_accvgpr_read_b32 v216, a84
    v_accvgpr_read_b32 v217, a85
    v_accvgpr_read_b32 v218, a86
    v_accvgpr_read_b32 v219, a87
    v_accvgpr_read_b32 v220, a92
    v_accvgpr_read_b32 v221, a93
    v_accvgpr_read_b32 v222, a94
    v_accvgpr_read_b32 v223, a95
    v_mul_f32 v216, v216, v35
    v_mul_f32 v217, v217, v35
    v_mul_f32 v218, v218, v35
    v_mul_f32 v219, v219, v35
    v_mul_f32 v220, v220, v35
    v_mul_f32 v221, v221, v35
    v_mul_f32 v222, v222, v35
    v_mul_f32 v223, v223, v35
    v_cvt_pk_bf16_f32 v108, v216, v217
    v_cvt_pk_bf16_f32 v109, v218, v219
    v_cvt_pk_bf16_f32 v110, v220, v221
    v_cvt_pk_bf16_f32 v111, v222, v223
    v_mfma_f32_16x16x32_bf16 v[128:131], a[204:207], v[120:123], v[128:131]
    ds_read_b64_tr_b16 a[246:247], v13 offset:56960
    v_accvgpr_read_b32 v216, a100
    v_accvgpr_read_b32 v217, a101
    v_accvgpr_read_b32 v218, a102
    v_accvgpr_read_b32 v219, a103
    v_accvgpr_read_b32 v220, a108
    v_accvgpr_read_b32 v221, a109
    v_accvgpr_read_b32 v222, a110
    v_accvgpr_read_b32 v223, a111
    v_mul_f32 v216, v216, v35
    v_mul_f32 v217, v217, v35
    v_mul_f32 v218, v218, v35
    v_mul_f32 v219, v219, v35
    v_mul_f32 v220, v220, v35
    v_mul_f32 v221, v221, v35
    v_mul_f32 v222, v222, v35
    v_mul_f32 v223, v223, v35
    v_cvt_pk_bf16_f32 v116, v216, v217
    v_cvt_pk_bf16_f32 v117, v218, v219
    v_cvt_pk_bf16_f32 v118, v220, v221
    v_cvt_pk_bf16_f32 v119, v222, v223
    buffer_load_dwordx4 v27, s[16:19], s91 offen offset:1024 lds
    v_mfma_f32_16x16x32_bf16 v[132:135], a[192:195], v[100:103], v[132:135]
    ds_read_b64_tr_b16 a[248:249], v13 offset:59136
    v_accvgpr_read_b32 v216, a116
    v_accvgpr_read_b32 v217, a117
    v_accvgpr_read_b32 v218, a118
    v_accvgpr_read_b32 v219, a119
    v_accvgpr_read_b32 v220, a124
    v_accvgpr_read_b32 v221, a125
    v_accvgpr_read_b32 v222, a126
    v_accvgpr_read_b32 v223, a127
    v_mul_f32 v216, v216, v35
    v_mul_f32 v217, v217, v35
    v_mul_f32 v218, v218, v35
    v_mul_f32 v219, v219, v35
    v_mul_f32 v220, v220, v35
    v_mul_f32 v221, v221, v35
    v_mul_f32 v222, v222, v35
    v_mul_f32 v223, v223, v35
    v_cvt_pk_bf16_f32 v124, v216, v217
    v_cvt_pk_bf16_f32 v125, v218, v219
    v_cvt_pk_bf16_f32 v126, v220, v221
    v_cvt_pk_bf16_f32 v127, v222, v223
    v_mfma_f32_16x16x32_bf16 v[132:135], a[196:199], v[108:111], v[132:135]
    ds_read_b64_tr_b16 a[250:251], v13 offset:61184
    buffer_load_dwordx4 v28, s[16:19], s91 offen offset:2048 lds
    v_mfma_f32_16x16x32_bf16 v[132:135], a[200:203], v[116:119], v[132:135]
    ds_read_b64_tr_b16 a[252:253], v13 offset:63360
    buffer_load_dwordx4 v29, s[16:19], s91 offen offset:3072 lds
    v_mfma_f32_16x16x32_bf16 v[132:135], a[204:207], v[124:127], v[132:135]
    ds_read_b64_tr_b16 a[254:255], v13 offset:65408
    s_add_u32 m0, s57, 84480
    v_mfma_f32_16x16x32_bf16 v[136:139], a[208:211], v[96:99], v[136:139]
    ds_read_b64_tr_b16 a[128:129], v4 offset:0
    v_mfma_f32_16x16x32_bf16 v[136:139], a[212:215], v[104:107], v[136:139]
    ds_read_b64_tr_b16 a[130:131], v4 offset:2048
    v_mfma_f32_16x16x32_bf16 v[136:139], a[216:219], v[112:115], v[136:139]
    ds_read_b64_tr_b16 a[132:133], v4 offset:4224
    v_mfma_f32_16x16x32_bf16 v[136:139], a[220:223], v[120:123], v[136:139]
    ds_read_b64_tr_b16 a[134:135], v4 offset:6272
    v_mfma_f32_16x16x32_bf16 v[140:143], a[208:211], v[100:103], v[140:143]
    ds_read_b64_tr_b16 a[136:137], v4 offset:8448
    s_mov_b32 s91, 115072
    v_mfma_f32_16x16x32_bf16 v[140:143], a[212:215], v[108:111], v[140:143]
    ds_read_b64_tr_b16 a[138:139], v4 offset:10496
    v_mfma_f32_16x16x32_bf16 v[140:143], a[216:219], v[116:119], v[140:143]
    ds_read_b64_tr_b16 a[140:141], v4 offset:12672
    v_mfma_f32_16x16x32_bf16 v[140:143], a[220:223], v[124:127], v[140:143]
    ds_read_b64_tr_b16 a[142:143], v4 offset:14720
    s_waitcnt lgkmcnt(8)
    v_mfma_f32_16x16x32_bf16 v[144:147], a[224:227], v[96:99], v[144:147]
    ds_read_b64_tr_b16 a[144:145], v5 offset:0
    v_mfma_f32_16x16x32_bf16 v[144:147], a[228:231], v[104:107], v[144:147]
    ds_read_b64_tr_b16 a[146:147], v5 offset:2048
    buffer_load_dwordx4 v26, s[16:19], s91 offen offset:0 lds
    v_mfma_f32_16x16x32_bf16 v[144:147], a[232:235], v[112:115], v[144:147]
    ds_read_b64_tr_b16 a[148:149], v5 offset:4224
    v_mfma_f32_16x16x32_bf16 v[144:147], a[236:239], v[120:123], v[144:147]
    ds_read_b64_tr_b16 a[150:151], v5 offset:6272
    v_mfma_f32_16x16x32_bf16 v[148:151], a[224:227], v[100:103], v[148:151]
    ds_read_b64_tr_b16 a[152:153], v5 offset:8448
    v_mfma_f32_16x16x32_bf16 v[148:151], a[228:231], v[108:111], v[148:151]
    ds_read_b64_tr_b16 a[154:155], v5 offset:10496
    v_mfma_f32_16x16x32_bf16 v[148:151], a[232:235], v[116:119], v[148:151]
    ds_read_b64_tr_b16 a[156:157], v5 offset:12672
    buffer_load_dwordx4 v27, s[16:19], s91 offen offset:1024 lds
    v_mfma_f32_16x16x32_bf16 v[148:151], a[236:239], v[124:127], v[148:151]
    ds_read_b64_tr_b16 a[158:159], v5 offset:14720
    v_mfma_f32_16x16x32_bf16 v[152:155], a[240:243], v[96:99], v[152:155]
    ds_read_b64_tr_b16 a[160:161], v6 offset:0
    v_mfma_f32_16x16x32_bf16 v[152:155], a[244:247], v[104:107], v[152:155]
    ds_read_b64_tr_b16 a[162:163], v6 offset:2048
    v_mfma_f32_16x16x32_bf16 v[152:155], a[248:251], v[112:115], v[152:155]
    ds_read_b64_tr_b16 a[164:165], v6 offset:4224
    v_mfma_f32_16x16x32_bf16 v[152:155], a[252:255], v[120:123], v[152:155]
    ds_read_b64_tr_b16 a[166:167], v6 offset:6272
    buffer_load_dwordx4 v28, s[16:19], s91 offen offset:2048 lds
    v_mfma_f32_16x16x32_bf16 v[156:159], a[240:243], v[100:103], v[156:159]
    ds_read_b64_tr_b16 a[168:169], v6 offset:8448
    v_mfma_f32_16x16x32_bf16 v[156:159], a[244:247], v[108:111], v[156:159]
    ds_read_b64_tr_b16 a[170:171], v6 offset:10496
    v_mfma_f32_16x16x32_bf16 v[156:159], a[248:251], v[116:119], v[156:159]
    ds_read_b64_tr_b16 a[172:173], v6 offset:12672
    v_mfma_f32_16x16x32_bf16 v[156:159], a[252:255], v[124:127], v[156:159]
    ds_read_b64_tr_b16 a[174:175], v6 offset:14720
    s_waitcnt lgkmcnt(8)
    v_mfma_f32_16x16x32_bf16 v[160:163], a[128:131], v[64:67], 0
    ds_read_b64_tr_b16 a[176:177], v7 offset:0
    buffer_load_dwordx4 v29, s[16:19], s91 offen offset:3072 lds
    v_mfma_f32_16x16x32_bf16 v[160:163], a[132:135], v[72:75], v[160:163]
    ds_read_b64_tr_b16 a[178:179], v7 offset:2048
    v_mfma_f32_16x16x32_bf16 v[160:163], a[136:139], v[80:83], v[160:163]
    ds_read_b64_tr_b16 a[180:181], v7 offset:4224
    v_cvt_pk_bf16_f32 v192, v128, v129
    v_mfma_f32_16x16x32_bf16 v[160:163], a[140:143], v[88:91], v[160:163]
    ds_read_b64_tr_b16 a[182:183], v7 offset:6272
    v_cvt_pk_bf16_f32 v193, v130, v131
    v_mfma_f32_16x16x32_bf16 v[164:167], a[128:131], v[68:71], 0
    ds_read_b64_tr_b16 a[184:185], v7 offset:8448
    v_cvt_pk_bf16_f32 v194, v136, v137
    v_mfma_f32_16x16x32_bf16 v[164:167], a[132:135], v[76:79], v[164:167]
    ds_read_b64_tr_b16 a[186:187], v7 offset:10496
    v_cvt_pk_bf16_f32 v195, v138, v139
    v_mfma_f32_16x16x32_bf16 v[164:167], a[136:139], v[84:87], v[164:167]
    ds_read_b64_tr_b16 a[188:189], v7 offset:12672
    v_mfma_f32_16x16x32_bf16 v[164:167], a[140:143], v[92:95], v[164:167]
    ds_read_b64_tr_b16 a[190:191], v7 offset:14720
    v_cvt_pk_bf16_f32 v196, v144, v145
    v_mfma_f32_16x16x32_bf16 v[168:171], a[144:147], v[64:67], 0
    s_waitcnt vmcnt(12)
    s_barrier
    ds_read_b64_tr_b16 a[192:193], v4 offset:16896
    v_mfma_f32_16x16x32_bf16 v[168:171], a[148:151], v[72:75], v[168:171]
    ds_read_b64_tr_b16 a[194:195], v4 offset:18944
    v_cvt_pk_bf16_f32 v197, v146, v147
    v_mfma_f32_16x16x32_bf16 v[168:171], a[152:155], v[80:83], v[168:171]
    ds_read_b64_tr_b16 a[196:197], v4 offset:21120
    v_cvt_pk_bf16_f32 v198, v152, v153
    v_mfma_f32_16x16x32_bf16 v[168:171], a[156:159], v[88:91], v[168:171]
    ds_read_b64_tr_b16 a[198:199], v4 offset:23168
    v_cvt_pk_bf16_f32 v199, v154, v155
    v_mfma_f32_16x16x32_bf16 v[172:175], a[144:147], v[68:71], 0
    ds_read_b64_tr_b16 a[200:201], v4 offset:25344
    v_cvt_pk_bf16_f32 v200, v132, v133
    v_mfma_f32_16x16x32_bf16 v[172:175], a[148:151], v[76:79], v[172:175]
    ds_read_b64_tr_b16 a[202:203], v4 offset:27392
    v_cvt_pk_bf16_f32 v201, v134, v135
    v_mfma_f32_16x16x32_bf16 v[172:175], a[152:155], v[84:87], v[172:175]
    ds_read_b64_tr_b16 a[204:205], v4 offset:29568
    s_add_u32 m0, s57, 101376
    v_mfma_f32_16x16x32_bf16 v[172:175], a[156:159], v[92:95], v[172:175]
    ds_read_b64_tr_b16 a[206:207], v4 offset:31616
    s_waitcnt lgkmcnt(8)
    v_mfma_f32_16x16x32_bf16 v[176:179], a[160:163], v[64:67], 0
    ds_read_b64_tr_b16 a[208:209], v5 offset:16896
    v_cvt_pk_bf16_f32 v202, v140, v141
    v_mfma_f32_16x16x32_bf16 v[176:179], a[164:167], v[72:75], v[176:179]
    ds_read_b64_tr_b16 a[210:211], v5 offset:18944
    v_cvt_pk_bf16_f32 v203, v142, v143
    v_mfma_f32_16x16x32_bf16 v[176:179], a[168:171], v[80:83], v[176:179]
    ds_read_b64_tr_b16 a[212:213], v5 offset:21120
    v_cvt_pk_bf16_f32 v204, v148, v149
    v_mfma_f32_16x16x32_bf16 v[176:179], a[172:175], v[88:91], v[176:179]
    ds_read_b64_tr_b16 a[214:215], v5 offset:23168
    v_cvt_pk_bf16_f32 v205, v150, v151
    v_mfma_f32_16x16x32_bf16 v[180:183], a[160:163], v[68:71], 0
    ds_read_b64_tr_b16 a[216:217], v5 offset:25344
    v_cvt_pk_bf16_f32 v206, v156, v157
    v_mfma_f32_16x16x32_bf16 v[180:183], a[164:167], v[76:79], v[180:183]
    ds_read_b64_tr_b16 a[218:219], v5 offset:27392
    v_cvt_pk_bf16_f32 v207, v158, v159
    v_mfma_f32_16x16x32_bf16 v[180:183], a[168:171], v[84:87], v[180:183]
    ds_read_b64_tr_b16 a[220:221], v5 offset:29568
    s_mov_b32 s91, 512
    v_mfma_f32_16x16x32_bf16 v[180:183], a[172:175], v[92:95], v[180:183]
    ds_read_b64_tr_b16 a[222:223], v5 offset:31616
    buffer_load_dwordx4 v26, s[16:19], s91 offen offset:0 lds
    v_mfma_f32_16x16x32_bf16 v[184:187], a[176:179], v[64:67], 0
    ds_read_b64_tr_b16 a[224:225], v6 offset:16896
    buffer_store_dwordx4 v[192:195], v49, s[20:23], s63 offen offset:0 sc1
    v_mfma_f32_16x16x32_bf16 v[184:187], a[180:183], v[72:75], v[184:187]
    ds_read_b64_tr_b16 a[226:227], v6 offset:18944
    buffer_load_dwordx4 v27, s[16:19], s91 offen offset:1024 lds
    v_mfma_f32_16x16x32_bf16 v[184:187], a[184:187], v[80:83], v[184:187]
    ds_read_b64_tr_b16 a[228:229], v6 offset:21120
    v_mfma_f32_16x16x32_bf16 v[184:187], a[188:191], v[88:91], v[184:187]
    ds_read_b64_tr_b16 a[230:231], v6 offset:23168
    v_mfma_f32_16x16x32_bf16 v[188:191], a[176:179], v[68:71], 0
    ds_read_b64_tr_b16 a[232:233], v6 offset:25344
    v_mfma_f32_16x16x32_bf16 v[188:191], a[180:183], v[76:79], v[188:191]
    ds_read_b64_tr_b16 a[234:235], v6 offset:27392
    buffer_load_dwordx4 v28, s[16:19], s91 offen offset:2048 lds
    v_mfma_f32_16x16x32_bf16 v[188:191], a[184:187], v[84:87], v[188:191]
    ds_read_b64_tr_b16 a[236:237], v6 offset:29568
    v_mfma_f32_16x16x32_bf16 v[188:191], a[188:191], v[92:95], v[188:191]
    ds_read_b64_tr_b16 a[238:239], v6 offset:31616
    s_waitcnt lgkmcnt(8)
    v_mfma_f32_16x16x32_bf16 v[160:163], a[192:195], v[96:99], v[160:163]
    ds_read_b64_tr_b16 a[240:241], v7 offset:16896
    buffer_store_dwordx4 v[196:199], v49, s[20:23], s63 offen offset:512 sc1
    v_mfma_f32_16x16x32_bf16 v[160:163], a[196:199], v[104:107], v[160:163]
    ds_read_b64_tr_b16 a[242:243], v7 offset:18944
    v_mfma_f32_16x16x32_bf16 v[160:163], a[200:203], v[112:115], v[160:163]
    ds_read_b64_tr_b16 a[244:245], v7 offset:21120
    buffer_load_dwordx4 v29, s[16:19], s91 offen offset:3072 lds
    v_mfma_f32_16x16x32_bf16 v[160:163], a[204:207], v[120:123], v[160:163]
    ds_read_b64_tr_b16 a[246:247], v7 offset:23168
    v_mfma_f32_16x16x32_bf16 v[164:167], a[192:195], v[100:103], v[164:167]
    ds_read_b64_tr_b16 a[248:249], v7 offset:25344
    v_mfma_f32_16x16x32_bf16 v[164:167], a[196:199], v[108:111], v[164:167]
    ds_read_b64_tr_b16 a[250:251], v7 offset:27392
    v_mfma_f32_16x16x32_bf16 v[164:167], a[200:203], v[116:119], v[164:167]
    ds_read_b64_tr_b16 a[252:253], v7 offset:29568
    v_mfma_f32_16x16x32_bf16 v[164:167], a[204:207], v[124:127], v[164:167]
    ds_read_b64_tr_b16 a[254:255], v7 offset:31616
    s_add_u32 m0, s57, 118272
    v_mfma_f32_16x16x32_bf16 v[168:171], a[208:211], v[96:99], v[168:171]
    ds_read_b64_tr_b16 a[128:129], v4 offset:33792
    buffer_store_dwordx4 v[200:203], v50, s[20:23], s63 offen offset:0 sc1
    v_mfma_f32_16x16x32_bf16 v[168:171], a[212:215], v[104:107], v[168:171]
    ds_read_b64_tr_b16 a[130:131], v4 offset:35840
    v_mfma_f32_16x16x32_bf16 v[168:171], a[216:219], v[112:115], v[168:171]
    ds_read_b64_tr_b16 a[132:133], v4 offset:38016
    v_mfma_f32_16x16x32_bf16 v[168:171], a[220:223], v[120:123], v[168:171]
    ds_read_b64_tr_b16 a[134:135], v4 offset:40064
    v_mfma_f32_16x16x32_bf16 v[172:175], a[208:211], v[100:103], v[172:175]
    ds_read_b64_tr_b16 a[136:137], v4 offset:42240
    s_mov_b32 s91, 115200
    v_mfma_f32_16x16x32_bf16 v[172:175], a[212:215], v[108:111], v[172:175]
    ds_read_b64_tr_b16 a[138:139], v4 offset:44288
    v_mfma_f32_16x16x32_bf16 v[172:175], a[216:219], v[116:119], v[172:175]
    ds_read_b64_tr_b16 a[140:141], v4 offset:46464
    v_mfma_f32_16x16x32_bf16 v[172:175], a[220:223], v[124:127], v[172:175]
    ds_read_b64_tr_b16 a[142:143], v4 offset:48512
    s_waitcnt lgkmcnt(8)
    v_mfma_f32_16x16x32_bf16 v[176:179], a[224:227], v[96:99], v[176:179]
    ds_read_b64_tr_b16 a[144:145], v5 offset:33792
    buffer_store_dwordx4 v[204:207], v50, s[20:23], s63 offen offset:512 sc1
    v_mfma_f32_16x16x32_bf16 v[176:179], a[228:231], v[104:107], v[176:179]
    ds_read_b64_tr_b16 a[146:147], v5 offset:35840
    s_add_u32 s63, s63, 1024
    v_mfma_f32_16x16x32_bf16 v[176:179], a[232:235], v[112:115], v[176:179]
    ds_read_b64_tr_b16 a[148:149], v5 offset:38016
    buffer_load_dwordx4 v26, s[16:19], s91 offen offset:0 lds
    v_mfma_f32_16x16x32_bf16 v[176:179], a[236:239], v[120:123], v[176:179]
    ds_read_b64_tr_b16 a[150:151], v5 offset:40064
    v_mfma_f32_16x16x32_bf16 v[180:183], a[224:227], v[100:103], v[180:183]
    ds_read_b64_tr_b16 a[152:153], v5 offset:42240
    v_mfma_f32_16x16x32_bf16 v[180:183], a[228:231], v[108:111], v[180:183]
    ds_read_b64_tr_b16 a[154:155], v5 offset:44288
    v_mfma_f32_16x16x32_bf16 v[180:183], a[232:235], v[116:119], v[180:183]
    ds_read_b64_tr_b16 a[156:157], v5 offset:46464
    buffer_load_dwordx4 v27, s[16:19], s91 offen offset:1024 lds
    v_mfma_f32_16x16x32_bf16 v[180:183], a[236:239], v[124:127], v[180:183]
    ds_read_b64_tr_b16 a[158:159], v5 offset:48512
    v_mfma_f32_16x16x32_bf16 v[184:187], a[240:243], v[96:99], v[184:187]
    ds_read_b64_tr_b16 a[160:161], v6 offset:33792
    v_mfma_f32_16x16x32_bf16 v[184:187], a[244:247], v[104:107], v[184:187]
    ds_read_b64_tr_b16 a[162:163], v6 offset:35840
    v_mfma_f32_16x16x32_bf16 v[184:187], a[248:251], v[112:115], v[184:187]
    ds_read_b64_tr_b16 a[164:165], v6 offset:38016
    v_mfma_f32_16x16x32_bf16 v[184:187], a[252:255], v[120:123], v[184:187]
    ds_read_b64_tr_b16 a[166:167], v6 offset:40064
    buffer_load_dwordx4 v28, s[16:19], s91 offen offset:2048 lds
    v_mfma_f32_16x16x32_bf16 v[188:191], a[240:243], v[100:103], v[188:191]
    ds_read_b64_tr_b16 a[168:169], v6 offset:42240
    v_mfma_f32_16x16x32_bf16 v[188:191], a[244:247], v[108:111], v[188:191]
    ds_read_b64_tr_b16 a[170:171], v6 offset:44288
    v_mfma_f32_16x16x32_bf16 v[188:191], a[248:251], v[116:119], v[188:191]
    ds_read_b64_tr_b16 a[172:173], v6 offset:46464
    v_mfma_f32_16x16x32_bf16 v[188:191], a[252:255], v[124:127], v[188:191]
    ds_read_b64_tr_b16 a[174:175], v6 offset:48512
    s_waitcnt lgkmcnt(8)
    v_mfma_f32_16x16x32_bf16 v[128:131], a[128:131], v[64:67], 0
    ds_read_b64_tr_b16 a[176:177], v7 offset:33792
    buffer_load_dwordx4 v29, s[16:19], s91 offen offset:3072 lds
    v_mfma_f32_16x16x32_bf16 v[128:131], a[132:135], v[72:75], v[128:131]
    ds_read_b64_tr_b16 a[178:179], v7 offset:35840
    v_mfma_f32_16x16x32_bf16 v[128:131], a[136:139], v[80:83], v[128:131]
    ds_read_b64_tr_b16 a[180:181], v7 offset:38016
    v_cvt_pk_bf16_f32 v208, v160, v161
    v_mfma_f32_16x16x32_bf16 v[128:131], a[140:143], v[88:91], v[128:131]
    ds_read_b64_tr_b16 a[182:183], v7 offset:40064
    v_cvt_pk_bf16_f32 v209, v162, v163
    v_mfma_f32_16x16x32_bf16 v[132:135], a[128:131], v[68:71], 0
    ds_read_b64_tr_b16 a[184:185], v7 offset:42240
    v_cvt_pk_bf16_f32 v210, v168, v169
    v_mfma_f32_16x16x32_bf16 v[132:135], a[132:135], v[76:79], v[132:135]
    ds_read_b64_tr_b16 a[186:187], v7 offset:44288
    v_cvt_pk_bf16_f32 v211, v170, v171
    v_mfma_f32_16x16x32_bf16 v[132:135], a[136:139], v[84:87], v[132:135]
    ds_read_b64_tr_b16 a[188:189], v7 offset:46464
    v_mfma_f32_16x16x32_bf16 v[132:135], a[140:143], v[92:95], v[132:135]
    ds_read_b64_tr_b16 a[190:191], v7 offset:48512
    v_cvt_pk_bf16_f32 v212, v176, v177
    v_mfma_f32_16x16x32_bf16 v[136:139], a[144:147], v[64:67], 0
    s_waitcnt vmcnt(16)
    s_barrier
    ds_read_b64_tr_b16 a[192:193], v4 offset:50688
    v_mfma_f32_16x16x32_bf16 v[136:139], a[148:151], v[72:75], v[136:139]
    ds_read_b64_tr_b16 a[194:195], v4 offset:52736
    v_cvt_pk_bf16_f32 v213, v178, v179
    v_mfma_f32_16x16x32_bf16 v[136:139], a[152:155], v[80:83], v[136:139]
    ds_read_b64_tr_b16 a[196:197], v4 offset:54912
    v_cvt_pk_bf16_f32 v214, v184, v185
    v_mfma_f32_16x16x32_bf16 v[136:139], a[156:159], v[88:91], v[136:139]
    ds_read_b64_tr_b16 a[198:199], v4 offset:56960
    v_cvt_pk_bf16_f32 v215, v186, v187
    v_mfma_f32_16x16x32_bf16 v[140:143], a[144:147], v[68:71], 0
    ds_read_b64_tr_b16 a[200:201], v4 offset:59136
    v_cvt_pk_bf16_f32 v216, v164, v165
    v_mfma_f32_16x16x32_bf16 v[140:143], a[148:151], v[76:79], v[140:143]
    ds_read_b64_tr_b16 a[202:203], v4 offset:61184
    v_cvt_pk_bf16_f32 v217, v166, v167
    v_mfma_f32_16x16x32_bf16 v[140:143], a[152:155], v[84:87], v[140:143]
    ds_read_b64_tr_b16 a[204:205], v4 offset:63360
    s_add_u32 m0, s57, 0
    v_mfma_f32_16x16x32_bf16 v[140:143], a[156:159], v[92:95], v[140:143]
    ds_read_b64_tr_b16 a[206:207], v4 offset:65408
    s_waitcnt lgkmcnt(8)
    v_mfma_f32_16x16x32_bf16 v[144:147], a[160:163], v[64:67], 0
    ds_read_b64_tr_b16 a[208:209], v5 offset:50688
    v_cvt_pk_bf16_f32 v218, v172, v173
    v_mfma_f32_16x16x32_bf16 v[144:147], a[164:167], v[72:75], v[144:147]
    ds_read_b64_tr_b16 a[210:211], v5 offset:52736
    v_cvt_pk_bf16_f32 v219, v174, v175
    v_mfma_f32_16x16x32_bf16 v[144:147], a[168:171], v[80:83], v[144:147]
    ds_read_b64_tr_b16 a[212:213], v5 offset:54912
    v_cvt_pk_bf16_f32 v220, v180, v181
    v_mfma_f32_16x16x32_bf16 v[144:147], a[172:175], v[88:91], v[144:147]
    ds_read_b64_tr_b16 a[214:215], v5 offset:56960
    v_cvt_pk_bf16_f32 v221, v182, v183
    v_mfma_f32_16x16x32_bf16 v[148:151], a[160:163], v[68:71], 0
    ds_read_b64_tr_b16 a[216:217], v5 offset:59136
    v_cvt_pk_bf16_f32 v222, v188, v189
    v_mfma_f32_16x16x32_bf16 v[148:151], a[164:167], v[76:79], v[148:151]
    ds_read_b64_tr_b16 a[218:219], v5 offset:61184
    v_cvt_pk_bf16_f32 v223, v190, v191
    v_mfma_f32_16x16x32_bf16 v[148:151], a[168:171], v[84:87], v[148:151]
    ds_read_b64_tr_b16 a[220:221], v5 offset:63360
    s_mov_b32 s91, 640
    v_mfma_f32_16x16x32_bf16 v[148:151], a[172:175], v[92:95], v[148:151]
    ds_read_b64_tr_b16 a[222:223], v5 offset:65408
    buffer_load_dwordx4 v26, s[16:19], s91 offen offset:0 lds
    v_mfma_f32_16x16x32_bf16 v[152:155], a[176:179], v[64:67], 0
    ds_read_b64_tr_b16 a[224:225], v6 offset:50688
    buffer_store_dwordx4 v[208:211], v49, s[20:23], s63 offen offset:0 sc1
    v_mfma_f32_16x16x32_bf16 v[152:155], a[180:183], v[72:75], v[152:155]
    ds_read_b64_tr_b16 a[226:227], v6 offset:52736
    v_lshrrev_b32 v36, 5, v0
    v_mfma_f32_16x16x32_bf16 v[152:155], a[184:187], v[80:83], v[152:155]
    ds_read_b64_tr_b16 a[228:229], v6 offset:54912
    buffer_load_dwordx4 v27, s[16:19], s91 offen offset:1024 lds
    v_mfma_f32_16x16x32_bf16 v[152:155], a[188:191], v[88:91], v[152:155]
    ds_read_b64_tr_b16 a[230:231], v6 offset:56960
    v_and_b32 v37, 3, v0
    v_mfma_f32_16x16x32_bf16 v[156:159], a[176:179], v[68:71], 0
    ds_read_b64_tr_b16 a[232:233], v6 offset:59136
    v_mfma_f32_16x16x32_bf16 v[156:159], a[180:183], v[76:79], v[156:159]
    ds_read_b64_tr_b16 a[234:235], v6 offset:61184
    buffer_load_dwordx4 v28, s[16:19], s91 offen offset:2048 lds
    v_mfma_f32_16x16x32_bf16 v[156:159], a[184:187], v[84:87], v[156:159]
    ds_read_b64_tr_b16 a[236:237], v6 offset:63360
    v_bfe_u32 v38, v0, 2, 3
    v_mfma_f32_16x16x32_bf16 v[156:159], a[188:191], v[92:95], v[156:159]
    ds_read_b64_tr_b16 a[238:239], v6 offset:65408
    s_waitcnt lgkmcnt(8)
    v_mfma_f32_16x16x32_bf16 v[128:131], a[192:195], v[96:99], v[128:131]
    ds_read_b64_tr_b16 a[240:241], v7 offset:50688
    buffer_store_dwordx4 v[212:215], v49, s[20:23], s63 offen offset:512 sc1
    v_mfma_f32_16x16x32_bf16 v[128:131], a[196:199], v[104:107], v[128:131]
    ds_read_b64_tr_b16 a[242:243], v7 offset:52736
    v_mfma_f32_16x16x32_bf16 v[128:131], a[200:203], v[112:115], v[128:131]
    ds_read_b64_tr_b16 a[244:245], v7 offset:54912
    v_lshlrev_b32 v53, 10, v38
    v_mfma_f32_16x16x32_bf16 v[128:131], a[204:207], v[120:123], v[128:131]
    ds_read_b64_tr_b16 a[246:247], v7 offset:56960
    buffer_load_dwordx4 v29, s[16:19], s91 offen offset:3072 lds
    v_mfma_f32_16x16x32_bf16 v[132:135], a[192:195], v[100:103], v[132:135]
    ds_read_b64_tr_b16 a[248:249], v7 offset:59136
    v_mfma_f32_16x16x32_bf16 v[132:135], a[196:199], v[108:111], v[132:135]
    ds_read_b64_tr_b16 a[250:251], v7 offset:61184
    v_mfma_f32_16x16x32_bf16 v[132:135], a[200:203], v[116:119], v[132:135]
    ds_read_b64_tr_b16 a[252:253], v7 offset:63360
    v_lshl_add_u32 v53, v36, 6, v53
    v_mfma_f32_16x16x32_bf16 v[132:135], a[204:207], v[124:127], v[132:135]
    ds_read_b64_tr_b16 a[254:255], v7 offset:65408
    s_add_u32 m0, s57, 16896
    v_mfma_f32_16x16x32_bf16 v[136:139], a[208:211], v[96:99], v[136:139]
    ds_read_b64_tr_b16 a[128:129], v10 offset:0
    buffer_store_dwordx4 v[216:219], v50, s[20:23], s63 offen offset:0 sc1
    v_mfma_f32_16x16x32_bf16 v[136:139], a[212:215], v[104:107], v[136:139]
    ds_read_b64_tr_b16 a[130:131], v10 offset:2048
    v_mfma_f32_16x16x32_bf16 v[136:139], a[216:219], v[112:115], v[136:139]
    ds_read_b64_tr_b16 a[132:133], v10 offset:4224
    v_lshl_add_u32 v53, v37, 4, v53
    v_mfma_f32_16x16x32_bf16 v[136:139], a[220:223], v[120:123], v[136:139]
    ds_read_b64_tr_b16 a[134:135], v10 offset:6272
    v_mfma_f32_16x16x32_bf16 v[140:143], a[208:211], v[100:103], v[140:143]
    ds_read_b64_tr_b16 a[136:137], v10 offset:8448
    s_mov_b32 s91, 115328
    v_mfma_f32_16x16x32_bf16 v[140:143], a[212:215], v[108:111], v[140:143]
    ds_read_b64_tr_b16 a[138:139], v10 offset:10496
    v_mfma_f32_16x16x32_bf16 v[140:143], a[216:219], v[116:119], v[140:143]
    ds_read_b64_tr_b16 a[140:141], v10 offset:12672
    v_mul_u32_u24 v54, 896, v36
    v_mfma_f32_16x16x32_bf16 v[140:143], a[220:223], v[124:127], v[140:143]
    ds_read_b64_tr_b16 a[142:143], v10 offset:14720
    s_waitcnt lgkmcnt(8)
    v_mfma_f32_16x16x32_bf16 v[144:147], a[224:227], v[96:99], v[144:147]
    ds_read_b64_tr_b16 a[144:145], v11 offset:0
    buffer_store_dwordx4 v[220:223], v50, s[20:23], s63 offen offset:512 sc1
    v_mfma_f32_16x16x32_bf16 v[144:147], a[228:231], v[104:107], v[144:147]
    ds_read_b64_tr_b16 a[146:147], v11 offset:2048
    s_add_u32 s63, s63, 1024
    v_mfma_f32_16x16x32_bf16 v[144:147], a[232:235], v[112:115], v[144:147]
    ds_read_b64_tr_b16 a[148:149], v11 offset:4224
    v_lshl_add_u32 v54, v38, 7, v54
    v_mfma_f32_16x16x32_bf16 v[144:147], a[236:239], v[120:123], v[144:147]
    ds_read_b64_tr_b16 a[150:151], v11 offset:6272
    buffer_load_dwordx4 v26, s[16:19], s91 offen offset:0 lds
    v_mfma_f32_16x16x32_bf16 v[148:151], a[224:227], v[100:103], v[148:151]
    ds_read_b64_tr_b16 a[152:153], v11 offset:8448
    v_mfma_f32_16x16x32_bf16 v[148:151], a[228:231], v[108:111], v[148:151]
    ds_read_b64_tr_b16 a[154:155], v11 offset:10496
    v_mfma_f32_16x16x32_bf16 v[148:151], a[232:235], v[116:119], v[148:151]
    ds_read_b64_tr_b16 a[156:157], v11 offset:12672
    v_lshl_add_u32 v54, v37, 3, v54
    v_mfma_f32_16x16x32_bf16 v[148:151], a[236:239], v[124:127], v[148:151]
    ds_read_b64_tr_b16 a[158:159], v11 offset:14720
    buffer_load_dwordx4 v27, s[16:19], s91 offen offset:1024 lds
    v_mfma_f32_16x16x32_bf16 v[152:155], a[240:243], v[96:99], v[152:155]
    ds_read_b64_tr_b16 a[160:161], v12 offset:0
    v_mfma_f32_16x16x32_bf16 v[152:155], a[244:247], v[104:107], v[152:155]
    ds_read_b64_tr_b16 a[162:163], v12 offset:2048
    v_mfma_f32_16x16x32_bf16 v[152:155], a[248:251], v[112:115], v[152:155]
    ds_read_b64_tr_b16 a[164:165], v12 offset:4224
    v_lshlrev_b32 v55, 8, v38
    v_mfma_f32_16x16x32_bf16 v[152:155], a[252:255], v[120:123], v[152:155]
    ds_read_b64_tr_b16 a[166:167], v12 offset:6272
    buffer_load_dwordx4 v28, s[16:19], s91 offen offset:2048 lds
    v_mfma_f32_16x16x32_bf16 v[156:159], a[240:243], v[100:103], v[156:159]
    ds_read_b64_tr_b16 a[168:169], v12 offset:8448
    v_mfma_f32_16x16x32_bf16 v[156:159], a[244:247], v[108:111], v[156:159]
    ds_read_b64_tr_b16 a[170:171], v12 offset:10496
    v_mfma_f32_16x16x32_bf16 v[156:159], a[248:251], v[116:119], v[156:159]
    ds_read_b64_tr_b16 a[172:173], v12 offset:12672
    v_lshl_add_u32 v55, v37, 4, v55
    v_mfma_f32_16x16x32_bf16 v[156:159], a[252:255], v[124:127], v[156:159]
    ds_read_b64_tr_b16 a[174:175], v12 offset:14720
    s_waitcnt lgkmcnt(8)
    v_mfma_f32_16x16x32_bf16 v[160:163], a[128:131], v[64:67], 0
    ds_read_b64_tr_b16 a[176:177], v13 offset:0
    buffer_load_dwordx4 v29, s[16:19], s91 offen offset:3072 lds
    v_mfma_f32_16x16x32_bf16 v[160:163], a[132:135], v[72:75], v[160:163]
    ds_read_b64_tr_b16 a[178:179], v13 offset:2048
    v_mfma_f32_16x16x32_bf16 v[160:163], a[136:139], v[80:83], v[160:163]
    ds_read_b64_tr_b16 a[180:181], v13 offset:4224
    v_cvt_pk_bf16_f32 v224, v128, v129
    v_mfma_f32_16x16x32_bf16 v[160:163], a[140:143], v[88:91], v[160:163]
    ds_read_b64_tr_b16 a[182:183], v13 offset:6272
    v_cvt_pk_bf16_f32 v225, v130, v131
    v_mfma_f32_16x16x32_bf16 v[164:167], a[128:131], v[68:71], 0
    ds_read_b64_tr_b16 a[184:185], v13 offset:8448
    v_cvt_pk_bf16_f32 v226, v136, v137
    v_mfma_f32_16x16x32_bf16 v[164:167], a[132:135], v[76:79], v[164:167]
    ds_read_b64_tr_b16 a[186:187], v13 offset:10496
    v_cvt_pk_bf16_f32 v227, v138, v139
    v_mfma_f32_16x16x32_bf16 v[164:167], a[136:139], v[84:87], v[164:167]
    ds_read_b64_tr_b16 a[188:189], v13 offset:12672
    v_lshlrev_b32 v56, 12, v38
    v_mfma_f32_16x16x32_bf16 v[164:167], a[140:143], v[92:95], v[164:167]
    ds_read_b64_tr_b16 a[190:191], v13 offset:14720
    v_cvt_pk_bf16_f32 v228, v144, v145
    v_mfma_f32_16x16x32_bf16 v[168:171], a[144:147], v[64:67], 0
    s_waitcnt vmcnt(18)
    s_barrier
    ds_read_b64_tr_b16 a[192:193], v10 offset:16896
    v_mfma_f32_16x16x32_bf16 v[168:171], a[148:151], v[72:75], v[168:171]
    ds_read_b64_tr_b16 a[194:195], v10 offset:18944
    v_cvt_pk_bf16_f32 v229, v146, v147
    v_mfma_f32_16x16x32_bf16 v[168:171], a[152:155], v[80:83], v[168:171]
    ds_read_b64_tr_b16 a[196:197], v10 offset:21120
    v_cvt_pk_bf16_f32 v230, v152, v153
    v_mfma_f32_16x16x32_bf16 v[168:171], a[156:159], v[88:91], v[168:171]
    ds_read_b64_tr_b16 a[198:199], v10 offset:23168
    v_cvt_pk_bf16_f32 v231, v154, v155
    v_mfma_f32_16x16x32_bf16 v[172:175], a[144:147], v[68:71], 0
    ds_read_b64_tr_b16 a[200:201], v10 offset:25344
    v_lshl_add_u32 v56, v37, 8, v56
    v_mfma_f32_16x16x32_bf16 v[172:175], a[148:151], v[76:79], v[172:175]
    ds_read_b64_tr_b16 a[202:203], v10 offset:27392
    v_cvt_pk_bf16_f32 v232, v132, v133
    v_mfma_f32_16x16x32_bf16 v[172:175], a[152:155], v[84:87], v[172:175]
    ds_read_b64_tr_b16 a[204:205], v10 offset:29568
    v_cvt_pk_bf16_f32 v233, v134, v135
    v_mfma_f32_16x16x32_bf16 v[172:175], a[156:159], v[92:95], v[172:175]
    ds_read_b64_tr_b16 a[206:207], v10 offset:31616
    s_waitcnt lgkmcnt(8)
    v_mfma_f32_16x16x32_bf16 v[176:179], a[160:163], v[64:67], 0
    ds_read_b64_tr_b16 a[208:209], v11 offset:16896
    v_cvt_pk_bf16_f32 v234, v140, v141
    v_mfma_f32_16x16x32_bf16 v[176:179], a[164:167], v[72:75], v[176:179]
    ds_read_b64_tr_b16 a[210:211], v11 offset:18944
    v_cvt_pk_bf16_f32 v235, v142, v143
    v_mfma_f32_16x16x32_bf16 v[176:179], a[168:171], v[80:83], v[176:179]
    ds_read_b64_tr_b16 a[212:213], v11 offset:21120
    v_lshl_add_u32 v56, v36, 4, v56
    v_mfma_f32_16x16x32_bf16 v[176:179], a[172:175], v[88:91], v[176:179]
    ds_read_b64_tr_b16 a[214:215], v11 offset:23168
    s_add_u32 m0, s57, 33792
    v_mfma_f32_16x16x32_bf16 v[180:183], a[160:163], v[68:71], 0
    ds_read_b64_tr_b16 a[216:217], v11 offset:25344
    v_cvt_pk_bf16_f32 v236, v148, v149
    v_mfma_f32_16x16x32_bf16 v[180:183], a[164:167], v[76:79], v[180:183]
    ds_read_b64_tr_b16 a[218:219], v11 offset:27392
    v_cvt_pk_bf16_f32 v237, v150, v151
    v_mfma_f32_16x16x32_bf16 v[180:183], a[168:171], v[84:87], v[180:183]
    ds_read_b64_tr_b16 a[220:221], v11 offset:29568
    v_cvt_pk_bf16_f32 v238, v156, v157
    v_mfma_f32_16x16x32_bf16 v[180:183], a[172:175], v[92:95], v[180:183]
    ds_read_b64_tr_b16 a[222:223], v11 offset:31616
    v_cvt_pk_bf16_f32 v239, v158, v159
    v_mfma_f32_16x16x32_bf16 v[184:187], a[176:179], v[64:67], 0
    ds_read_b64_tr_b16 a[224:225], v12 offset:16896
    v_cmp_eq_u32 vcc, 7, v38
    v_mov_b32 v39, 0x7ffffff0
    s_nop 0
    v_cndmask_b32 v53, v53, v39, vcc
    v_cndmask_b32 v54, v54, v39, vcc
    v_cndmask_b32 v55, v55, v39, vcc
    v_cndmask_b32 v56, v56, v39, vcc
    v_mfma_f32_16x16x32_bf16 v[184:187], a[180:183], v[72:75], v[184:187]
    ds_read_b64_tr_b16 a[226:227], v12 offset:18944
    s_mov_b32 s91, 768
    v_mfma_f32_16x16x32_bf16 v[184:187], a[184:187], v[80:83], v[184:187]
    ds_read_b64_tr_b16 a[228:229], v12 offset:21120
    buffer_store_dwordx4 v[224:227], v49, s[20:23], s63 offen offset:0 sc1
    v_mfma_f32_16x16x32_bf16 v[184:187], a[188:191], v[88:91], v[184:187]
    ds_read_b64_tr_b16 a[230:231], v12 offset:23168
    s_lshl_b32 s58, s54, 4
    s_add_u32 s58, s58, s53
    s_mul_i32 s58, s58, 7168
    v_mfma_f32_16x16x32_bf16 v[188:191], a[176:179], v[68:71], 0
    ds_read_b64_tr_b16 a[232:233], v12 offset:25344
    buffer_load_dwordx4 v26, s[16:19], s91 offen offset:0 lds
    v_mfma_f32_16x16x32_bf16 v[188:191], a[180:183], v[76:79], v[188:191]
    ds_read_b64_tr_b16 a[234:235], v12 offset:27392
    s_mov_b32 s97, 0x3f80
    v_mfma_f32_16x16x32_bf16 v[188:191], a[184:187], v[84:87], v[188:191]
    ds_read_b64_tr_b16 a[236:237], v12 offset:29568
    buffer_load_dwordx4 v27, s[16:19], s91 offen offset:1024 lds
    v_mfma_f32_16x16x32_bf16 v[188:191], a[188:191], v[92:95], v[188:191]
    ds_read_b64_tr_b16 a[238:239], v12 offset:31616
    s_waitcnt lgkmcnt(8)
    v_mfma_f32_16x16x32_bf16 v[160:163], a[192:195], v[96:99], v[160:163]
    ds_read_b64_tr_b16 a[240:241], v13 offset:16896
    buffer_store_dwordx4 v[228:231], v49, s[20:23], s63 offen offset:512 sc1
    v_mfma_f32_16x16x32_bf16 v[160:163], a[196:199], v[104:107], v[160:163]
    ds_read_b64_tr_b16 a[242:243], v13 offset:18944
    s_mov_b32 s3, 0x3f800000
    v_mfma_f32_16x16x32_bf16 v[160:163], a[200:203], v[112:115], v[160:163]
    ds_read_b64_tr_b16 a[244:245], v13 offset:21120
    v_and_b32 v19, 15, v1
    v_mfma_f32_16x16x32_bf16 v[160:163], a[204:207], v[120:123], v[160:163]
    ds_read_b64_tr_b16 a[246:247], v13 offset:23168
    buffer_load_dwordx4 v28, s[16:19], s91 offen offset:2048 lds
    v_mfma_f32_16x16x32_bf16 v[164:167], a[192:195], v[100:103], v[164:167]
    ds_read_b64_tr_b16 a[248:249], v13 offset:25344
    v_lshlrev_b32 v19, 2, v19
    v_mfma_f32_16x16x32_bf16 v[164:167], a[196:199], v[108:111], v[164:167]
    ds_read_b64_tr_b16 a[250:251], v13 offset:27392
    buffer_load_dwordx4 v29, s[16:19], s91 offen offset:3072 lds
    v_mfma_f32_16x16x32_bf16 v[164:167], a[200:203], v[116:119], v[164:167]
    ds_read_b64_tr_b16 a[252:253], v13 offset:29568
    v_lshrrev_b32 v38, 2, v1
    v_mfma_f32_16x16x32_bf16 v[164:167], a[204:207], v[124:127], v[164:167]
    ds_read_b64_tr_b16 a[254:255], v13 offset:31616
    s_add_u32 m0, s57, 50688
    v_mfma_f32_16x16x32_bf16 v[168:171], a[208:211], v[96:99], v[168:171]
    ds_read_b64_tr_b16 a[128:129], v10 offset:33792
    buffer_store_dwordx4 v[232:235], v50, s[20:23], s63 offen offset:0 sc1
    v_mfma_f32_16x16x32_bf16 v[168:171], a[212:215], v[104:107], v[168:171]
    ds_read_b64_tr_b16 a[130:131], v10 offset:35840
    v_mfma_f32_16x16x32_bf16 v[168:171], a[216:219], v[112:115], v[168:171]
    ds_read_b64_tr_b16 a[132:133], v10 offset:38016
    v_lshlrev_b32 v38, 7, v38
    v_mfma_f32_16x16x32_bf16 v[168:171], a[220:223], v[120:123], v[168:171]
    ds_read_b64_tr_b16 a[134:135], v10 offset:40064
    v_mfma_f32_16x16x32_bf16 v[172:175], a[208:211], v[100:103], v[172:175]
    ds_read_b64_tr_b16 a[136:137], v10 offset:42240
    s_mov_b32 s91, 115456
    v_mfma_f32_16x16x32_bf16 v[172:175], a[212:215], v[108:111], v[172:175]
    ds_read_b64_tr_b16 a[138:139], v10 offset:44288
    v_mfma_f32_16x16x32_bf16 v[172:175], a[216:219], v[116:119], v[172:175]
    ds_read_b64_tr_b16 a[140:141], v10 offset:46464
    v_and_b32 v39, 3, v1
    v_mfma_f32_16x16x32_bf16 v[172:175], a[220:223], v[124:127], v[172:175]
    ds_read_b64_tr_b16 a[142:143], v10 offset:48512
    s_waitcnt lgkmcnt(8)
    v_mfma_f32_16x16x32_bf16 v[176:179], a[224:227], v[96:99], v[176:179]
    ds_read_b64_tr_b16 a[144:145], v11 offset:33792
    buffer_store_dwordx4 v[236:239], v50, s[20:23], s63 offen offset:512 sc1
    v_mfma_f32_16x16x32_bf16 v[176:179], a[228:231], v[104:107], v[176:179]
    ds_read_b64_tr_b16 a[146:147], v11 offset:35840
    s_add_u32 s63, s63, 1024
    v_mfma_f32_16x16x32_bf16 v[176:179], a[232:235], v[112:115], v[176:179]
    ds_read_b64_tr_b16 a[148:149], v11 offset:38016
    v_lshl_add_u32 v20, v39, 4, v38
    v_mfma_f32_16x16x32_bf16 v[176:179], a[236:239], v[120:123], v[176:179]
    ds_read_b64_tr_b16 a[150:151], v11 offset:40064
    buffer_load_dwordx4 v26, s[16:19], s91 offen offset:0 lds
    v_mfma_f32_16x16x32_bf16 v[180:183], a[224:227], v[100:103], v[180:183]
    ds_read_b64_tr_b16 a[152:153], v11 offset:42240
    v_mfma_f32_16x16x32_bf16 v[180:183], a[228:231], v[108:111], v[180:183]
    ds_read_b64_tr_b16 a[154:155], v11 offset:44288
    v_mfma_f32_16x16x32_bf16 v[180:183], a[232:235], v[116:119], v[180:183]
    ds_read_b64_tr_b16 a[156:157], v11 offset:46464
    s_mov_b32 s96, 400000
    v_mfma_f32_16x16x32_bf16 v[180:183], a[236:239], v[124:127], v[180:183]
    ds_read_b64_tr_b16 a[158:159], v11 offset:48512
    buffer_load_dwordx4 v27, s[16:19], s91 offen offset:1024 lds
    v_mfma_f32_16x16x32_bf16 v[184:187], a[240:243], v[96:99], v[184:187]
    ds_read_b64_tr_b16 a[160:161], v12 offset:33792
    v_mfma_f32_16x16x32_bf16 v[184:187], a[244:247], v[104:107], v[184:187]
    ds_read_b64_tr_b16 a[162:163], v12 offset:35840
    v_mfma_f32_16x16x32_bf16 v[184:187], a[248:251], v[112:115], v[184:187]
    ds_read_b64_tr_b16 a[164:165], v12 offset:38016
    v_mfma_f32_16x16x32_bf16 v[184:187], a[252:255], v[120:123], v[184:187]
    ds_read_b64_tr_b16 a[166:167], v12 offset:40064
    buffer_load_dwordx4 v28, s[16:19], s91 offen offset:2048 lds
    v_mfma_f32_16x16x32_bf16 v[188:191], a[240:243], v[100:103], v[188:191]
    ds_read_b64_tr_b16 a[168:169], v12 offset:42240
    v_mfma_f32_16x16x32_bf16 v[188:191], a[244:247], v[108:111], v[188:191]
    ds_read_b64_tr_b16 a[170:171], v12 offset:44288
    v_mfma_f32_16x16x32_bf16 v[188:191], a[248:251], v[116:119], v[188:191]
    ds_read_b64_tr_b16 a[172:173], v12 offset:46464
    v_mfma_f32_16x16x32_bf16 v[188:191], a[252:255], v[124:127], v[188:191]
    ds_read_b64_tr_b16 a[174:175], v12 offset:48512
    s_waitcnt lgkmcnt(8)
    v_mfma_f32_16x16x32_bf16 v[128:131], a[128:131], v[64:67], 0
    ds_read_b64_tr_b16 a[176:177], v13 offset:33792
    buffer_load_dwordx4 v29, s[16:19], s91 offen offset:3072 lds
    v_mfma_f32_16x16x32_bf16 v[128:131], a[132:135], v[72:75], v[128:131]
    ds_read_b64_tr_b16 a[178:179], v13 offset:35840
    v_mfma_f32_16x16x32_bf16 v[128:131], a[136:139], v[80:83], v[128:131]
    ds_read_b64_tr_b16 a[180:181], v13 offset:38016
    v_cvt_pk_bf16_f32 v240, v160, v161
    v_mfma_f32_16x16x32_bf16 v[128:131], a[140:143], v[88:91], v[128:131]
    ds_read_b64_tr_b16 a[182:183], v13 offset:40064
    v_cvt_pk_bf16_f32 v241, v162, v163
    v_mfma_f32_16x16x32_bf16 v[132:135], a[128:131], v[68:71], 0
    ds_read_b64_tr_b16 a[184:185], v13 offset:42240
    v_cvt_pk_bf16_f32 v242, v168, v169
    v_mfma_f32_16x16x32_bf16 v[132:135], a[132:135], v[76:79], v[132:135]
    ds_read_b64_tr_b16 a[186:187], v13 offset:44288
    v_cvt_pk_bf16_f32 v243, v170, v171
    v_mfma_f32_16x16x32_bf16 v[132:135], a[136:139], v[84:87], v[132:135]
    ds_read_b64_tr_b16 a[188:189], v13 offset:46464
    v_mfma_f32_16x16x32_bf16 v[132:135], a[140:143], v[92:95], v[132:135]
    ds_read_b64_tr_b16 a[190:191], v13 offset:48512
    v_cvt_pk_bf16_f32 v244, v176, v177
    v_mfma_f32_16x16x32_bf16 v[136:139], a[144:147], v[64:67], 0
    s_waitcnt vmcnt(18)
    s_barrier
    ds_read_b64_tr_b16 a[192:193], v10 offset:50688
    v_mfma_f32_16x16x32_bf16 v[136:139], a[148:151], v[72:75], v[136:139]
    ds_read_b64_tr_b16 a[194:195], v10 offset:52736
    v_cvt_pk_bf16_f32 v245, v178, v179
    v_mfma_f32_16x16x32_bf16 v[136:139], a[152:155], v[80:83], v[136:139]
    ds_read_b64_tr_b16 a[196:197], v10 offset:54912
    v_cvt_pk_bf16_f32 v246, v184, v185
    v_mfma_f32_16x16x32_bf16 v[136:139], a[156:159], v[88:91], v[136:139]
    ds_read_b64_tr_b16 a[198:199], v10 offset:56960
    v_cvt_pk_bf16_f32 v247, v186, v187
    v_mfma_f32_16x16x32_bf16 v[140:143], a[144:147], v[68:71], 0
    ds_read_b64_tr_b16 a[200:201], v10 offset:59136
    v_cvt_pk_bf16_f32 v248, v164, v165
    v_mfma_f32_16x16x32_bf16 v[140:143], a[148:151], v[76:79], v[140:143]
    ds_read_b64_tr_b16 a[202:203], v10 offset:61184
    v_cvt_pk_bf16_f32 v249, v166, v167
    v_mfma_f32_16x16x32_bf16 v[140:143], a[152:155], v[84:87], v[140:143]
    ds_read_b64_tr_b16 a[204:205], v10 offset:63360
    s_add_u32 m0, s57, 67584
    v_mfma_f32_16x16x32_bf16 v[140:143], a[156:159], v[92:95], v[140:143]
    ds_read_b64_tr_b16 a[206:207], v10 offset:65408
    s_waitcnt lgkmcnt(8)
    v_mfma_f32_16x16x32_bf16 v[144:147], a[160:163], v[64:67], 0
    ds_read_b64_tr_b16 a[208:209], v11 offset:50688
    v_cvt_pk_bf16_f32 v250, v172, v173
    v_mfma_f32_16x16x32_bf16 v[144:147], a[164:167], v[72:75], v[144:147]
    ds_read_b64_tr_b16 a[210:211], v11 offset:52736
    v_cvt_pk_bf16_f32 v251, v174, v175
    v_mfma_f32_16x16x32_bf16 v[144:147], a[168:171], v[80:83], v[144:147]
    ds_read_b64_tr_b16 a[212:213], v11 offset:54912
    v_cvt_pk_bf16_f32 v252, v180, v181
    v_mfma_f32_16x16x32_bf16 v[144:147], a[172:175], v[88:91], v[144:147]
    ds_read_b64_tr_b16 a[214:215], v11 offset:56960
    v_cvt_pk_bf16_f32 v253, v182, v183
    v_mfma_f32_16x16x32_bf16 v[148:151], a[160:163], v[68:71], 0
    ds_read_b64_tr_b16 a[216:217], v11 offset:59136
    v_cvt_pk_bf16_f32 v254, v188, v189
    v_mfma_f32_16x16x32_bf16 v[148:151], a[164:167], v[76:79], v[148:151]
    ds_read_b64_tr_b16 a[218:219], v11 offset:61184
    s_nop 0
    v_mfma_f32_16x16x32_bf16 v[148:151], a[168:171], v[84:87], v[148:151]
    ds_read_b64_tr_b16 a[220:221], v11 offset:63360
    v_cvt_pk_bf16_f32 v255, v190, v191
    v_mfma_f32_16x16x32_bf16 v[148:151], a[172:175], v[92:95], v[148:151]
    ds_read_b64_tr_b16 a[222:223], v11 offset:65408
    buffer_load_dwordx4 v22, s[32:35], s48 offen offset:0 lds
    v_mfma_f32_16x16x32_bf16 v[152:155], a[176:179], v[64:67], 0
    ds_read_b64_tr_b16 a[224:225], v12 offset:50688
    buffer_store_dwordx4 v[240:243], v49, s[20:23], s63 offen offset:0 sc1
    v_mfma_f32_16x16x32_bf16 v[152:155], a[180:183], v[72:75], v[152:155]
    ds_read_b64_tr_b16 a[226:227], v12 offset:52736
    buffer_load_dwordx4 v23, s[32:35], s48 offen offset:1024 lds
    v_mfma_f32_16x16x32_bf16 v[152:155], a[184:187], v[80:83], v[152:155]
    ds_read_b64_tr_b16 a[228:229], v12 offset:54912
    buffer_load_dwordx4 v24, s[32:35], s48 offen offset:2048 lds
    v_mfma_f32_16x16x32_bf16 v[152:155], a[188:191], v[88:91], v[152:155]
    ds_read_b64_tr_b16 a[230:231], v12 offset:56960
    v_mfma_f32_16x16x32_bf16 v[156:159], a[176:179], v[68:71], 0
    ds_read_b64_tr_b16 a[232:233], v12 offset:59136
    v_mfma_f32_16x16x32_bf16 v[156:159], a[180:183], v[76:79], v[156:159]
    ds_read_b64_tr_b16 a[234:235], v12 offset:61184
    buffer_load_dwordx4 v25, s[32:35], s48 offen offset:3072 lds
    v_mfma_f32_16x16x32_bf16 v[156:159], a[184:187], v[84:87], v[156:159]
    ds_read_b64_tr_b16 a[236:237], v12 offset:63360
    v_mfma_f32_16x16x32_bf16 v[156:159], a[188:191], v[92:95], v[156:159]
    ds_read_b64_tr_b16 a[238:239], v12 offset:65408
    s_waitcnt lgkmcnt(8)
    v_mfma_f32_16x16x32_bf16 v[128:131], a[192:195], v[96:99], v[128:131]
    ds_read_b64_tr_b16 a[240:241], v13 offset:50688
    buffer_store_dwordx4 v[244:247], v49, s[20:23], s63 offen offset:512 sc1
    v_mfma_f32_16x16x32_bf16 v[128:131], a[196:199], v[104:107], v[128:131]
    ds_read_b64_tr_b16 a[242:243], v13 offset:52736
    s_add_u32 m0, s57, 84480
    v_mfma_f32_16x16x32_bf16 v[128:131], a[200:203], v[112:115], v[128:131]
    ds_read_b64_tr_b16 a[244:245], v13 offset:54912
    v_mfma_f32_16x16x32_bf16 v[128:131], a[204:207], v[120:123], v[128:131]
    ds_read_b64_tr_b16 a[246:247], v13 offset:56960
    v_mfma_f32_16x16x32_bf16 v[132:135], a[192:195], v[100:103], v[132:135]
    ds_read_b64_tr_b16 a[248:249], v13 offset:59136
    v_mfma_f32_16x16x32_bf16 v[132:135], a[196:199], v[108:111], v[132:135]
    ds_read_b64_tr_b16 a[250:251], v13 offset:61184
    v_mfma_f32_16x16x32_bf16 v[132:135], a[200:203], v[116:119], v[132:135]
    ds_read_b64_tr_b16 a[252:253], v13 offset:63360
    v_mfma_f32_16x16x32_bf16 v[132:135], a[204:207], v[124:127], v[132:135]
    ds_read_b64_tr_b16 a[254:255], v13 offset:65408
    v_mfma_f32_16x16x32_bf16 v[136:139], a[208:211], v[96:99], v[136:139]
    ds_read_b64_tr_b16 a[128:129], v4 offset:0
    buffer_store_dwordx4 v[248:251], v50, s[20:23], s63 offen offset:0 sc1
    v_mfma_f32_16x16x32_bf16 v[136:139], a[212:215], v[104:107], v[136:139]
    ds_read_b64_tr_b16 a[130:131], v4 offset:2048
    v_mfma_f32_16x16x32_bf16 v[136:139], a[216:219], v[112:115], v[136:139]
    ds_read_b64_tr_b16 a[132:133], v4 offset:4224
    v_mfma_f32_16x16x32_bf16 v[136:139], a[220:223], v[120:123], v[136:139]
    ds_read_b64_tr_b16 a[134:135], v4 offset:6272
    v_mfma_f32_16x16x32_bf16 v[140:143], a[208:211], v[100:103], v[140:143]
    ds_read_b64_tr_b16 a[136:137], v4 offset:8448
    v_mfma_f32_16x16x32_bf16 v[140:143], a[212:215], v[108:111], v[140:143]
    ds_read_b64_tr_b16 a[138:139], v4 offset:10496
    v_mfma_f32_16x16x32_bf16 v[140:143], a[216:219], v[116:119], v[140:143]
    ds_read_b64_tr_b16 a[140:141], v4 offset:12672
    v_mfma_f32_16x16x32_bf16 v[140:143], a[220:223], v[124:127], v[140:143]
    ds_read_b64_tr_b16 a[142:143], v4 offset:14720
    s_waitcnt lgkmcnt(8)
    v_mfma_f32_16x16x32_bf16 v[144:147], a[224:227], v[96:99], v[144:147]
    ds_read_b64_tr_b16 a[144:145], v5 offset:0
    buffer_store_dwordx4 v[252:255], v50, s[20:23], s63 offen offset:512 sc1
    v_mfma_f32_16x16x32_bf16 v[144:147], a[228:231], v[104:107], v[144:147]
    ds_read_b64_tr_b16 a[146:147], v5 offset:2048
    s_add_u32 s63, s63, 1024
    v_mfma_f32_16x16x32_bf16 v[144:147], a[232:235], v[112:115], v[144:147]
    ds_read_b64_tr_b16 a[148:149], v5 offset:4224
    v_mfma_f32_16x16x32_bf16 v[144:147], a[236:239], v[120:123], v[144:147]
    ds_read_b64_tr_b16 a[150:151], v5 offset:6272
    v_mfma_f32_16x16x32_bf16 v[148:151], a[224:227], v[100:103], v[148:151]
    ds_read_b64_tr_b16 a[152:153], v5 offset:8448
    v_mfma_f32_16x16x32_bf16 v[148:151], a[228:231], v[108:111], v[148:151]
    ds_read_b64_tr_b16 a[154:155], v5 offset:10496
    v_mfma_f32_16x16x32_bf16 v[148:151], a[232:235], v[116:119], v[148:151]
    ds_read_b64_tr_b16 a[156:157], v5 offset:12672
    v_mfma_f32_16x16x32_bf16 v[148:151], a[236:239], v[124:127], v[148:151]
    ds_read_b64_tr_b16 a[158:159], v5 offset:14720
    v_mfma_f32_16x16x32_bf16 v[152:155], a[240:243], v[96:99], v[152:155]
    ds_read_b64_tr_b16 a[160:161], v6 offset:0
    v_mfma_f32_16x16x32_bf16 v[152:155], a[244:247], v[104:107], v[152:155]
    ds_read_b64_tr_b16 a[162:163], v6 offset:2048
    v_mfma_f32_16x16x32_bf16 v[152:155], a[248:251], v[112:115], v[152:155]
    ds_read_b64_tr_b16 a[164:165], v6 offset:4224
    v_mfma_f32_16x16x32_bf16 v[152:155], a[252:255], v[120:123], v[152:155]
    ds_read_b64_tr_b16 a[166:167], v6 offset:6272
    s_add_u32 s48, s48, 458752
    s_cmp_ge_u32 s48, 1605632
    s_cselect_b32 s60, 1605504, 0
    s_sub_u32 s48, s48, s60
    v_mfma_f32_16x16x32_bf16 v[156:159], a[240:243], v[100:103], v[156:159]
    ds_read_b64_tr_b16 a[168:169], v6 offset:8448
    buffer_load_dwordx4 v22, s[32:35], s48 offen offset:0 lds
    v_mfma_f32_16x16x32_bf16 v[156:159], a[244:247], v[108:111], v[156:159]
    ds_read_b64_tr_b16 a[170:171], v6 offset:10496
    buffer_load_dwordx4 v23, s[32:35], s48 offen offset:1024 lds
    v_mfma_f32_16x16x32_bf16 v[156:159], a[248:251], v[116:119], v[156:159]
    ds_read_b64_tr_b16 a[172:173], v6 offset:12672
    buffer_load_dwordx4 v24, s[32:35], s48 offen offset:2048 lds
    v_mfma_f32_16x16x32_bf16 v[156:159], a[252:255], v[124:127], v[156:159]
    ds_read_b64_tr_b16 a[174:175], v6 offset:14720
    s_waitcnt lgkmcnt(8)
    v_mfma_f32_16x16x32_bf16 v[160:163], a[128:131], v[64:67], 0
    ds_read_b64_tr_b16 a[176:177], v7 offset:0
    v_mfma_f32_16x16x32_bf16 v[160:163], a[132:135], v[72:75], v[160:163]
    ds_read_b64_tr_b16 a[178:179], v7 offset:2048
    buffer_load_dwordx4 v25, s[32:35], s48 offen offset:3072 lds
    v_mfma_f32_16x16x32_bf16 v[160:163], a[136:139], v[80:83], v[160:163]
    ds_read_b64_tr_b16 a[180:181], v7 offset:4224
    v_cvt_pk_bf16_f32 v192, v128, v129
    v_mfma_f32_16x16x32_bf16 v[160:163], a[140:143], v[88:91], v[160:163]
    ds_read_b64_tr_b16 a[182:183], v7 offset:6272
    v_cvt_pk_bf16_f32 v193, v130, v131
    v_mfma_f32_16x16x32_bf16 v[164:167], a[128:131], v[68:71], 0
    ds_read_b64_tr_b16 a[184:185], v7 offset:8448
    v_cvt_pk_bf16_f32 v194, v136, v137
    v_mfma_f32_16x16x32_bf16 v[164:167], a[132:135], v[76:79], v[164:167]
    ds_read_b64_tr_b16 a[186:187], v7 offset:10496
    v_cvt_pk_bf16_f32 v195, v138, v139
    v_mfma_f32_16x16x32_bf16 v[164:167], a[136:139], v[84:87], v[164:167]
    ds_read_b64_tr_b16 a[188:189], v7 offset:12672
    v_mfma_f32_16x16x32_bf16 v[164:167], a[140:143], v[92:95], v[164:167]
    ds_read_b64_tr_b16 a[190:191], v7 offset:14720
    v_cvt_pk_bf16_f32 v196, v144, v145
    v_mfma_f32_16x16x32_bf16 v[168:171], a[144:147], v[64:67], 0
    s_waitcnt vmcnt(18)
    s_barrier
    ds_read_b64_tr_b16 a[192:193], v4 offset:16896
    v_mfma_f32_16x16x32_bf16 v[168:171], a[148:151], v[72:75], v[168:171]
    ds_read_b64_tr_b16 a[194:195], v4 offset:18944
    v_cvt_pk_bf16_f32 v197, v146, v147
    v_mfma_f32_16x16x32_bf16 v[168:171], a[152:155], v[80:83], v[168:171]
    ds_read_b64_tr_b16 a[196:197], v4 offset:21120
    v_cvt_pk_bf16_f32 v198, v152, v153
    v_mfma_f32_16x16x32_bf16 v[168:171], a[156:159], v[88:91], v[168:171]
    ds_read_b64_tr_b16 a[198:199], v4 offset:23168
    v_cvt_pk_bf16_f32 v199, v154, v155
    v_mfma_f32_16x16x32_bf16 v[172:175], a[144:147], v[68:71], 0
    ds_read_b64_tr_b16 a[200:201], v4 offset:25344
    v_cvt_pk_bf16_f32 v200, v132, v133
    v_mfma_f32_16x16x32_bf16 v[172:175], a[148:151], v[76:79], v[172:175]
    ds_read_b64_tr_b16 a[202:203], v4 offset:27392
    v_cvt_pk_bf16_f32 v201, v134, v135
    v_mfma_f32_16x16x32_bf16 v[172:175], a[152:155], v[84:87], v[172:175]
    ds_read_b64_tr_b16 a[204:205], v4 offset:29568
    s_add_u32 m0, s57, 101376
    v_mfma_f32_16x16x32_bf16 v[172:175], a[156:159], v[92:95], v[172:175]
    ds_read_b64_tr_b16 a[206:207], v4 offset:31616
    s_waitcnt lgkmcnt(8)
    v_mfma_f32_16x16x32_bf16 v[176:179], a[160:163], v[64:67], 0
    ds_read_b64_tr_b16 a[208:209], v5 offset:16896
    v_cvt_pk_bf16_f32 v202, v140, v141
    v_mfma_f32_16x16x32_bf16 v[176:179], a[164:167], v[72:75], v[176:179]
    ds_read_b64_tr_b16 a[210:211], v5 offset:18944
    v_cvt_pk_bf16_f32 v203, v142, v143
    v_mfma_f32_16x16x32_bf16 v[176:179], a[168:171], v[80:83], v[176:179]
    ds_read_b64_tr_b16 a[212:213], v5 offset:21120
    v_cvt_pk_bf16_f32 v204, v148, v149
    v_mfma_f32_16x16x32_bf16 v[176:179], a[172:175], v[88:91], v[176:179]
    ds_read_b64_tr_b16 a[214:215], v5 offset:23168
    v_cvt_pk_bf16_f32 v205, v150, v151
    v_mfma_f32_16x16x32_bf16 v[180:183], a[160:163], v[68:71], 0
    ds_read_b64_tr_b16 a[216:217], v5 offset:25344
    v_cvt_pk_bf16_f32 v206, v156, v157
    v_mfma_f32_16x16x32_bf16 v[180:183], a[164:167], v[76:79], v[180:183]
    ds_read_b64_tr_b16 a[218:219], v5 offset:27392
    v_cvt_pk_bf16_f32 v207, v158, v159
    v_mfma_f32_16x16x32_bf16 v[180:183], a[168:171], v[84:87], v[180:183]
    ds_read_b64_tr_b16 a[220:221], v5 offset:29568
    v_mfma_f32_16x16x32_bf16 v[180:183], a[172:175], v[92:95], v[180:183]
    ds_read_b64_tr_b16 a[222:223], v5 offset:31616
    v_mfma_f32_16x16x32_bf16 v[184:187], a[176:179], v[64:67], 0
    ds_read_b64_tr_b16 a[224:225], v6 offset:16896
    buffer_store_dwordx4 v[192:195], v49, s[20:23], s63 offen offset:0 sc1
    v_mfma_f32_16x16x32_bf16 v[184:187], a[180:183], v[72:75], v[184:187]
    ds_read_b64_tr_b16 a[226:227], v6 offset:18944
    v_mfma_f32_16x16x32_bf16 v[184:187], a[184:187], v[80:83], v[184:187]
    ds_read_b64_tr_b16 a[228:229], v6 offset:21120
    v_mfma_f32_16x16x32_bf16 v[184:187], a[188:191], v[88:91], v[184:187]
    ds_read_b64_tr_b16 a[230:231], v6 offset:23168
    v_mfma_f32_16x16x32_bf16 v[188:191], a[176:179], v[68:71], 0
    ds_read_b64_tr_b16 a[232:233], v6 offset:25344
    v_mfma_f32_16x16x32_bf16 v[188:191], a[180:183], v[76:79], v[188:191]
    ds_read_b64_tr_b16 a[234:235], v6 offset:27392
    v_mfma_f32_16x16x32_bf16 v[188:191], a[184:187], v[84:87], v[188:191]
    ds_read_b64_tr_b16 a[236:237], v6 offset:29568
    v_mfma_f32_16x16x32_bf16 v[188:191], a[188:191], v[92:95], v[188:191]
    ds_read_b64_tr_b16 a[238:239], v6 offset:31616
    s_add_u32 s48, s48, 458752
    s_cmp_ge_u32 s48, 1605632
    s_cselect_b32 s60, 1605504, 0
    s_sub_u32 s48, s48, s60
    s_waitcnt lgkmcnt(8)
    v_mfma_f32_16x16x32_bf16 v[160:163], a[192:195], v[96:99], v[160:163]
    ds_read_b64_tr_b16 a[240:241], v7 offset:16896
    buffer_load_dwordx4 v22, s[32:35], s48 offen offset:0 lds
    v_mfma_f32_16x16x32_bf16 v[160:163], a[196:199], v[104:107], v[160:163]
    ds_read_b64_tr_b16 a[242:243], v7 offset:18944
    buffer_store_dwordx4 v[196:199], v49, s[20:23], s63 offen offset:512 sc1
    v_mfma_f32_16x16x32_bf16 v[160:163], a[200:203], v[112:115], v[160:163]
    ds_read_b64_tr_b16 a[244:245], v7 offset:21120
    buffer_load_dwordx4 v23, s[32:35], s48 offen offset:1024 lds
    v_mfma_f32_16x16x32_bf16 v[160:163], a[204:207], v[120:123], v[160:163]
    ds_read_b64_tr_b16 a[246:247], v7 offset:23168
    buffer_load_dwordx4 v24, s[32:35], s48 offen offset:2048 lds
    v_mfma_f32_16x16x32_bf16 v[164:167], a[192:195], v[100:103], v[164:167]
    ds_read_b64_tr_b16 a[248:249], v7 offset:25344
    buffer_load_dwordx4 v25, s[32:35], s48 offen offset:3072 lds
    v_mfma_f32_16x16x32_bf16 v[164:167], a[196:199], v[108:111], v[164:167]
    ds_read_b64_tr_b16 a[250:251], v7 offset:27392
    v_mfma_f32_16x16x32_bf16 v[164:167], a[200:203], v[116:119], v[164:167]
    ds_read_b64_tr_b16 a[252:253], v7 offset:29568
    v_mfma_f32_16x16x32_bf16 v[164:167], a[204:207], v[124:127], v[164:167]
    ds_read_b64_tr_b16 a[254:255], v7 offset:31616
    s_add_u32 m0, s57, 118272
    v_mfma_f32_16x16x32_bf16 v[168:171], a[208:211], v[96:99], v[168:171]
    ds_read_b64_tr_b16 a[128:129], v4 offset:33792
    buffer_store_dwordx4 v[200:203], v50, s[20:23], s63 offen offset:0 sc1
    v_mfma_f32_16x16x32_bf16 v[168:171], a[212:215], v[104:107], v[168:171]
    ds_read_b64_tr_b16 a[130:131], v4 offset:35840
    v_mfma_f32_16x16x32_bf16 v[168:171], a[216:219], v[112:115], v[168:171]
    ds_read_b64_tr_b16 a[132:133], v4 offset:38016
    v_mfma_f32_16x16x32_bf16 v[168:171], a[220:223], v[120:123], v[168:171]
    ds_read_b64_tr_b16 a[134:135], v4 offset:40064
    v_mfma_f32_16x16x32_bf16 v[172:175], a[208:211], v[100:103], v[172:175]
    ds_read_b64_tr_b16 a[136:137], v4 offset:42240
    v_mfma_f32_16x16x32_bf16 v[172:175], a[212:215], v[108:111], v[172:175]
    ds_read_b64_tr_b16 a[138:139], v4 offset:44288
    v_mfma_f32_16x16x32_bf16 v[172:175], a[216:219], v[116:119], v[172:175]
    ds_read_b64_tr_b16 a[140:141], v4 offset:46464
    v_mfma_f32_16x16x32_bf16 v[172:175], a[220:223], v[124:127], v[172:175]
    ds_read_b64_tr_b16 a[142:143], v4 offset:48512
    s_waitcnt lgkmcnt(8)
    v_mfma_f32_16x16x32_bf16 v[176:179], a[224:227], v[96:99], v[176:179]
    ds_read_b64_tr_b16 a[144:145], v5 offset:33792
    buffer_store_dwordx4 v[204:207], v50, s[20:23], s63 offen offset:512 sc1
    v_mfma_f32_16x16x32_bf16 v[176:179], a[228:231], v[104:107], v[176:179]
    ds_read_b64_tr_b16 a[146:147], v5 offset:35840
    s_add_u32 s63, s63, 1024
    v_mfma_f32_16x16x32_bf16 v[176:179], a[232:235], v[112:115], v[176:179]
    ds_read_b64_tr_b16 a[148:149], v5 offset:38016
    v_mfma_f32_16x16x32_bf16 v[176:179], a[236:239], v[120:123], v[176:179]
    ds_read_b64_tr_b16 a[150:151], v5 offset:40064
    v_mfma_f32_16x16x32_bf16 v[180:183], a[224:227], v[100:103], v[180:183]
    ds_read_b64_tr_b16 a[152:153], v5 offset:42240
    v_mfma_f32_16x16x32_bf16 v[180:183], a[228:231], v[108:111], v[180:183]
    ds_read_b64_tr_b16 a[154:155], v5 offset:44288
    v_mfma_f32_16x16x32_bf16 v[180:183], a[232:235], v[116:119], v[180:183]
    ds_read_b64_tr_b16 a[156:157], v5 offset:46464
    v_mfma_f32_16x16x32_bf16 v[180:183], a[236:239], v[124:127], v[180:183]
    ds_read_b64_tr_b16 a[158:159], v5 offset:48512
    v_mfma_f32_16x16x32_bf16 v[184:187], a[240:243], v[96:99], v[184:187]
    ds_read_b64_tr_b16 a[160:161], v6 offset:33792
    v_mfma_f32_16x16x32_bf16 v[184:187], a[244:247], v[104:107], v[184:187]
    ds_read_b64_tr_b16 a[162:163], v6 offset:35840
    v_mfma_f32_16x16x32_bf16 v[184:187], a[248:251], v[112:115], v[184:187]
    ds_read_b64_tr_b16 a[164:165], v6 offset:38016
    v_mfma_f32_16x16x32_bf16 v[184:187], a[252:255], v[120:123], v[184:187]
    ds_read_b64_tr_b16 a[166:167], v6 offset:40064
    v_mfma_f32_16x16x32_bf16 v[188:191], a[240:243], v[100:103], v[188:191]
    ds_read_b64_tr_b16 a[168:169], v6 offset:42240
    v_mfma_f32_16x16x32_bf16 v[188:191], a[244:247], v[108:111], v[188:191]
    ds_read_b64_tr_b16 a[170:171], v6 offset:44288
    v_mfma_f32_16x16x32_bf16 v[188:191], a[248:251], v[116:119], v[188:191]
    ds_read_b64_tr_b16 a[172:173], v6 offset:46464
    s_add_u32 s48, s48, 458752
    s_cmp_ge_u32 s48, 1605632
    s_cselect_b32 s60, 1605504, 0
    s_sub_u32 s48, s48, s60
    v_mfma_f32_16x16x32_bf16 v[188:191], a[252:255], v[124:127], v[188:191]
    ds_read_b64_tr_b16 a[174:175], v6 offset:48512
    s_waitcnt lgkmcnt(8)
    v_mfma_f32_16x16x32_bf16 v[128:131], a[128:131], v[64:67], 0
    ds_read_b64_tr_b16 a[176:177], v7 offset:33792
    buffer_load_dwordx4 v22, s[32:35], s48 offen offset:0 lds
    v_mfma_f32_16x16x32_bf16 v[128:131], a[132:135], v[72:75], v[128:131]
    ds_read_b64_tr_b16 a[178:179], v7 offset:35840
    buffer_load_dwordx4 v23, s[32:35], s48 offen offset:1024 lds
    v_mfma_f32_16x16x32_bf16 v[128:131], a[136:139], v[80:83], v[128:131]
    ds_read_b64_tr_b16 a[180:181], v7 offset:38016
    buffer_load_dwordx4 v24, s[32:35], s48 offen offset:2048 lds
    v_mfma_f32_16x16x32_bf16 v[128:131], a[140:143], v[88:91], v[128:131]
    ds_read_b64_tr_b16 a[182:183], v7 offset:40064
    buffer_load_dwordx4 v25, s[32:35], s48 offen offset:3072 lds
    v_mfma_f32_16x16x32_bf16 v[132:135], a[128:131], v[68:71], 0
    ds_read_b64_tr_b16 a[184:185], v7 offset:42240
    v_cvt_pk_bf16_f32 v208, v160, v161
    v_mfma_f32_16x16x32_bf16 v[132:135], a[132:135], v[76:79], v[132:135]
    ds_read_b64_tr_b16 a[186:187], v7 offset:44288
    v_cvt_pk_bf16_f32 v209, v162, v163
    v_mfma_f32_16x16x32_bf16 v[132:135], a[136:139], v[84:87], v[132:135]
    ds_read_b64_tr_b16 a[188:189], v7 offset:46464
    v_cvt_pk_bf16_f32 v210, v168, v169
    v_mfma_f32_16x16x32_bf16 v[132:135], a[140:143], v[92:95], v[132:135]
    ds_read_b64_tr_b16 a[190:191], v7 offset:48512
    v_cvt_pk_bf16_f32 v211, v170, v171
    v_mfma_f32_16x16x32_bf16 v[136:139], a[144:147], v[64:67], 0
    s_waitcnt vmcnt(24)
    s_barrier
    ds_read_b64_tr_b16 a[192:193], v4 offset:50688
    v_mfma_f32_16x16x32_bf16 v[136:139], a[148:151], v[72:75], v[136:139]
    ds_read_b64_tr_b16 a[194:195], v4 offset:52736
    v_cvt_pk_bf16_f32 v212, v176, v177
    v_mfma_f32_16x16x32_bf16 v[136:139], a[152:155], v[80:83], v[136:139]
    ds_read_b64_tr_b16 a[196:197], v4 offset:54912
    v_cvt_pk_bf16_f32 v213, v178, v179
    v_mfma_f32_16x16x32_bf16 v[136:139], a[156:159], v[88:91], v[136:139]
    ds_read_b64_tr_b16 a[198:199], v4 offset:56960
    v_cvt_pk_bf16_f32 v214, v184, v185
    v_mfma_f32_16x16x32_bf16 v[140:143], a[144:147], v[68:71], 0
    ds_read_b64_tr_b16 a[200:201], v4 offset:59136
    v_cvt_pk_bf16_f32 v215, v186, v187
    v_mfma_f32_16x16x32_bf16 v[140:143], a[148:151], v[76:79], v[140:143]
    ds_read_b64_tr_b16 a[202:203], v4 offset:61184
    v_cvt_pk_bf16_f32 v216, v164, v165
    v_mfma_f32_16x16x32_bf16 v[140:143], a[152:155], v[84:87], v[140:143]
    ds_read_b64_tr_b16 a[204:205], v4 offset:63360
    v_cvt_pk_bf16_f32 v217, v166, v167
    v_mfma_f32_16x16x32_bf16 v[140:143], a[156:159], v[92:95], v[140:143]
    ds_read_b64_tr_b16 a[206:207], v4 offset:65408
    s_waitcnt lgkmcnt(8)
    v_mfma_f32_16x16x32_bf16 v[144:147], a[160:163], v[64:67], 0
    ds_read_b64_tr_b16 a[208:209], v5 offset:50688
    v_cvt_pk_bf16_f32 v218, v172, v173
    v_mfma_f32_16x16x32_bf16 v[144:147], a[164:167], v[72:75], v[144:147]
    ds_read_b64_tr_b16 a[210:211], v5 offset:52736
    v_cvt_pk_bf16_f32 v219, v174, v175
    v_mfma_f32_16x16x32_bf16 v[144:147], a[168:171], v[80:83], v[144:147]
    ds_read_b64_tr_b16 a[212:213], v5 offset:54912
    v_cvt_pk_bf16_f32 v220, v180, v181
    v_mfma_f32_16x16x32_bf16 v[144:147], a[172:175], v[88:91], v[144:147]
    ds_read_b64_tr_b16 a[214:215], v5 offset:56960
    v_cvt_pk_bf16_f32 v221, v182, v183
    v_mfma_f32_16x16x32_bf16 v[148:151], a[160:163], v[68:71], 0
    ds_read_b64_tr_b16 a[216:217], v5 offset:59136
    v_cvt_pk_bf16_f32 v222, v188, v189
    v_mfma_f32_16x16x32_bf16 v[148:151], a[164:167], v[76:79], v[148:151]
    ds_read_b64_tr_b16 a[218:219], v5 offset:61184
    v_cvt_pk_bf16_f32 v223, v190, v191
    v_mfma_f32_16x16x32_bf16 v[148:151], a[168:171], v[84:87], v[148:151]
    ds_read_b64_tr_b16 a[220:221], v5 offset:63360
    v_mfma_f32_16x16x32_bf16 v[148:151], a[172:175], v[92:95], v[148:151]
    ds_read_b64_tr_b16 a[222:223], v5 offset:65408
    v_mfma_f32_16x16x32_bf16 v[152:155], a[176:179], v[64:67], 0
    ds_read_b64_tr_b16 a[224:225], v6 offset:50688
    buffer_store_dwordx4 v[208:211], v49, s[20:23], s63 offen offset:0 sc1
    v_mfma_f32_16x16x32_bf16 v[152:155], a[180:183], v[72:75], v[152:155]
    ds_read_b64_tr_b16 a[226:227], v6 offset:52736
    v_mfma_f32_16x16x32_bf16 v[152:155], a[184:187], v[80:83], v[152:155]
    ds_read_b64_tr_b16 a[228:229], v6 offset:54912
    v_mfma_f32_16x16x32_bf16 v[152:155], a[188:191], v[88:91], v[152:155]
    ds_read_b64_tr_b16 a[230:231], v6 offset:56960
    v_mfma_f32_16x16x32_bf16 v[156:159], a[176:179], v[68:71], 0
    ds_read_b64_tr_b16 a[232:233], v6 offset:59136
    v_mfma_f32_16x16x32_bf16 v[156:159], a[180:183], v[76:79], v[156:159]
    ds_read_b64_tr_b16 a[234:235], v6 offset:61184
    v_mfma_f32_16x16x32_bf16 v[156:159], a[184:187], v[84:87], v[156:159]
    ds_read_b64_tr_b16 a[236:237], v6 offset:63360
    v_mfma_f32_16x16x32_bf16 v[156:159], a[188:191], v[92:95], v[156:159]
    ds_read_b64_tr_b16 a[238:239], v6 offset:65408
    s_waitcnt lgkmcnt(8)
    v_mfma_f32_16x16x32_bf16 v[128:131], a[192:195], v[96:99], v[128:131]
    ds_read_b64_tr_b16 a[240:241], v7 offset:50688
    buffer_store_dwordx4 v[212:215], v49, s[20:23], s63 offen offset:512 sc1
    v_mfma_f32_16x16x32_bf16 v[128:131], a[196:199], v[104:107], v[128:131]
    ds_read_b64_tr_b16 a[242:243], v7 offset:52736
    v_mfma_f32_16x16x32_bf16 v[128:131], a[200:203], v[112:115], v[128:131]
    ds_read_b64_tr_b16 a[244:245], v7 offset:54912
    v_mfma_f32_16x16x32_bf16 v[128:131], a[204:207], v[120:123], v[128:131]
    ds_read_b64_tr_b16 a[246:247], v7 offset:56960
    v_mfma_f32_16x16x32_bf16 v[132:135], a[192:195], v[100:103], v[132:135]
    ds_read_b64_tr_b16 a[248:249], v7 offset:59136
    v_mfma_f32_16x16x32_bf16 v[132:135], a[196:199], v[108:111], v[132:135]
    ds_read_b64_tr_b16 a[250:251], v7 offset:61184
    v_mfma_f32_16x16x32_bf16 v[132:135], a[200:203], v[116:119], v[132:135]
    ds_read_b64_tr_b16 a[252:253], v7 offset:63360
    v_mfma_f32_16x16x32_bf16 v[132:135], a[204:207], v[124:127], v[132:135]
    ds_read_b64_tr_b16 a[254:255], v7 offset:65408
    v_mfma_f32_16x16x32_bf16 v[136:139], a[208:211], v[96:99], v[136:139]
    buffer_store_dwordx4 v[216:219], v50, s[20:23], s63 offen offset:0 sc1
    v_mfma_f32_16x16x32_bf16 v[136:139], a[212:215], v[104:107], v[136:139]
    v_mfma_f32_16x16x32_bf16 v[136:139], a[216:219], v[112:115], v[136:139]
    v_mfma_f32_16x16x32_bf16 v[136:139], a[220:223], v[120:123], v[136:139]
    v_mfma_f32_16x16x32_bf16 v[140:143], a[208:211], v[100:103], v[140:143]
    v_mfma_f32_16x16x32_bf16 v[140:143], a[212:215], v[108:111], v[140:143]
    v_mfma_f32_16x16x32_bf16 v[140:143], a[216:219], v[116:119], v[140:143]
    v_mfma_f32_16x16x32_bf16 v[140:143], a[220:223], v[124:127], v[140:143]
    s_waitcnt lgkmcnt(0)
    v_mfma_f32_16x16x32_bf16 v[144:147], a[224:227], v[96:99], v[144:147]
    buffer_store_dwordx4 v[220:223], v50, s[20:23], s63 offen offset:512 sc1
    s_add_u32 s63, s63, 1024
    v_mfma_f32_16x16x32_bf16 v[144:147], a[228:231], v[104:107], v[144:147]
    v_mfma_f32_16x16x32_bf16 v[144:147], a[232:235], v[112:115], v[144:147]
    v_mfma_f32_16x16x32_bf16 v[144:147], a[236:239], v[120:123], v[144:147]
    v_mfma_f32_16x16x32_bf16 v[148:151], a[224:227], v[100:103], v[148:151]
    v_mfma_f32_16x16x32_bf16 v[148:151], a[228:231], v[108:111], v[148:151]
    v_mfma_f32_16x16x32_bf16 v[148:151], a[232:235], v[116:119], v[148:151]
    v_mfma_f32_16x16x32_bf16 v[148:151], a[236:239], v[124:127], v[148:151]
    v_mfma_f32_16x16x32_bf16 v[152:155], a[240:243], v[96:99], v[152:155]
    v_mfma_f32_16x16x32_bf16 v[152:155], a[244:247], v[104:107], v[152:155]
    v_mfma_f32_16x16x32_bf16 v[152:155], a[248:251], v[112:115], v[152:155]
    v_mfma_f32_16x16x32_bf16 v[152:155], a[252:255], v[120:123], v[152:155]
    v_mfma_f32_16x16x32_bf16 v[156:159], a[240:243], v[100:103], v[156:159]
    v_mfma_f32_16x16x32_bf16 v[156:159], a[244:247], v[108:111], v[156:159]
    v_mfma_f32_16x16x32_bf16 v[156:159], a[248:251], v[116:119], v[156:159]
    v_mfma_f32_16x16x32_bf16 v[156:159], a[252:255], v[124:127], v[156:159]
    s_nop 7
    v_cvt_pk_bf16_f32 v224, v128, v129
    v_cvt_pk_bf16_f32 v225, v130, v131
    v_cvt_pk_bf16_f32 v226, v136, v137
    v_cvt_pk_bf16_f32 v227, v138, v139
    v_cvt_pk_bf16_f32 v228, v144, v145
    v_cvt_pk_bf16_f32 v229, v146, v147
    v_cvt_pk_bf16_f32 v230, v152, v153
    v_cvt_pk_bf16_f32 v231, v154, v155
    v_cvt_pk_bf16_f32 v232, v132, v133
    v_cvt_pk_bf16_f32 v233, v134, v135
    v_cvt_pk_bf16_f32 v234, v140, v141
    v_cvt_pk_bf16_f32 v235, v142, v143
    v_cvt_pk_bf16_f32 v236, v148, v149
    v_cvt_pk_bf16_f32 v237, v150, v151
    v_cvt_pk_bf16_f32 v238, v156, v157
    v_cvt_pk_bf16_f32 v239, v158, v159
    buffer_store_dwordx4 v[224:227], v49, s[20:23], s63 offen offset:0 sc1
    buffer_store_dwordx4 v[228:231], v49, s[20:23], s63 offen offset:512 sc1
    buffer_store_dwordx4 v[232:235], v50, s[20:23], s63 offen offset:0 sc1
    buffer_store_dwordx4 v[236:239], v50, s[20:23], s63 offen offset:512 sc1
    s_add_u32 s63, s63, 1024
    s_mov_b32 s60, 24576
L_pl_z:
    buffer_load_dwordx4 v[248:251], v20, s[20:23], s60 offen sc1
    s_waitcnt vmcnt(0)
    v_xor_b32 v248, s49, v248
    v_xor_b32 v249, s49, v249
    v_xor_b32 v250, s49, v250
    v_xor_b32 v251, s49, v251
    v_or3_b32 v248, v248, v249, v250
    v_or_b32 v248, v248, v251
    v_cmp_eq_u32 vcc, 0, v248
    s_cmp_eq_u64 vcc, exec
    s_cbranch_scc1 L_px_z
    s_sleep 1
    s_sub_u32 s96, s96, 1
    s_cmp_lg_u32 s96, 0
    s_cbranch_scc1 L_pl_z
L_px_z:
    s_barrier
    s_cmp_lg_u32 s52, 0
    s_cbranch_scc1 L_nf0
    s_mov_b64 exec, 1
    v_mov_b32 v36, s49
    v_mov_b32 v37, 2048
    buffer_store_dword v36, v37, s[20:23], s92 offen sc1
    s_mov_b64 exec, -1
L_nf0:
    s_or_b32 s60, s2, s52
    s_cmp_lg_u32 s60, 0
    s_cbranch_scc1 L_noep
    s_mov_b64 exec, 1
    v_mov_b32 v36, s49
    v_mov_b32 v37, 12288
    buffer_store_dword v36, v37, s[20:23], 0 offen sc1
    s_mov_b64 exec, -1
L_noep:
    buffer_load_dwordx2 v[192:193], v54, s[24:27], s58 offen offset:0
    buffer_load_dwordx2 v[194:195], v54, s[24:27], s58 offen offset:32
    buffer_load_dwordx2 v[196:197], v54, s[24:27], s58 offen offset:64
    buffer_load_dwordx2 v[198:199], v54, s[24:27], s58 offen offset:96
    s_mov_b32 s61, 4096
    buffer_load_dwordx4 v[200:203], v55, s[20:23], s61 offen offset:0 sc1
    buffer_load_dwordx4 v[204:207], v55, s[20:23], s61 offen offset:64 sc1
    buffer_load_dwordx4 v[208:211], v55, s[20:23], s61 offen offset:128 sc1
    buffer_load_dwordx4 v[212:215], v55, s[20:23], s61 offen offset:192 sc1
    s_mov_b32 s61, 8192
    buffer_load_dwordx4 v[216:219], v55, s[20:23], s61 offen offset:0 sc1
    buffer_load_dwordx4 v[220:223], v55, s[20:23], s61 offen offset:64 sc1
    buffer_load_dwordx4 v[224:227], v55, s[20:23], s61 offen offset:128 sc1
    buffer_load_dwordx4 v[228:231], v55, s[20:23], s61 offen offset:192 sc1
    s_mov_b32 s61, 6144
    buffer_load_dwordx4 v[232:235], v55, s[20:23], s61 offen offset:0 sc1
    buffer_load_dwordx4 v[236:239], v55, s[20:23], s61 offen offset:64 sc1
    buffer_load_dwordx4 v[240:243], v55, s[20:23], s61 offen offset:128 sc1
    buffer_load_dwordx4 v[244:247], v55, s[20:23], s61 offen offset:192 sc1
    s_add_u32 m0, s57, 0
    s_add_u32 s48, s48, 458752
    s_cmp_ge_u32 s48, 1605632
    s_cselect_b32 s60, 1605504, 0
    s_sub_u32 s48, s48, s60
    buffer_load_dwordx4 v22, s[32:35], s48 offen offset:0 lds
    buffer_load_dwordx4 v23, s[32:35], s48 offen offset:1024 lds
    buffer_load_dwordx4 v24, s[32:35], s48 offen offset:2048 lds
    buffer_load_dwordx4 v25, s[32:35], s48 offen offset:3072 lds
    s_add_u32 m0, s57, 16896
    s_add_u32 s48, s48, 458752
    s_cmp_ge_u32 s48, 1605632
    s_cselect_b32 s60, 1605504, 0
    s_sub_u32 s48, s48, s60
    buffer_load_dwordx4 v22, s[32:35], s48 offen offset:0 lds
    buffer_load_dwordx4 v23, s[32:35], s48 offen offset:1024 lds
    buffer_load_dwordx4 v24, s[32:35], s48 offen offset:2048 lds
    buffer_load_dwordx4 v25, s[32:35], s48 offen offset:3072 lds
    s_add_u32 m0, s57, 33792
    s_add_u32 s48, s48, 458752
    s_cmp_ge_u32 s48, 1605632
    s_cselect_b32 s60, 1605504, 0
    s_sub_u32 s48, s48, s60
    buffer_load_dwordx4 v22, s[32:35], s48 offen offset:0 lds
    buffer_load_dwordx4 v23, s[32:35], s48 offen offset:1024 lds
    buffer_load_dwordx4 v24, s[32:35], s48 offen offset:2048 lds
    buffer_load_dwordx4 v25, s[32:35], s48 offen offset:3072 lds
    s_add_u32 m0, s57, 50688
    s_add_u32 s48, s48, 458752
    s_cmp_ge_u32 s48, 1605632
    s_cselect_b32 s60, 1605504, 0
    s_sub_u32 s48, s48, s60
    buffer_load_dwordx4 v22, s[32:35], s48 offen offset:0 lds
    buffer_load_dwordx4 v23, s[32:35], s48 offen offset:1024 lds
    buffer_load_dwordx4 v24, s[32:35], s48 offen offset:2048 lds
    buffer_load_dwordx4 v25, s[32:35], s48 offen offset:3072 lds
    v_mov_b32 v57, 0
    v_mov_b32 v58, 0
    v_mov_b32 v59, 0
    v_mov_b32 v60, 0
    v_mov_b32 v61, 0
    v_mov_b32 v62, 0
    v_mov_b32 v63, 0
    v_mov_b32 v248, 0
    v_mov_b32 v249, 0
    v_mov_b32 v250, 0
    v_mov_b32 v251, 0
    v_mov_b32 v252, 0
    v_mov_b32 v253, 0
    v_mov_b32 v254, 0
    v_mov_b32 v255, 0
    v_mov_b32 v52, 0
    s_and_b32 s93, s92, 0xffffff80
    s_add_u32 s93, s93, 2048
    s_add_u32 s91, s58, 0x800000
    s_mov_b32 s59, 0
    s_mov_b32 s62, 0xffff
    s_cmp_lg_u32 s59, 0
    s_cbranch_scc1 L_hv0_0
    s_call_b64 s[94:95], L_gpoll
L_hv0_0:
    s_ff1_i32_b32 s90, s59
    s_bitset0_b32 s59, s90
    s_bitset0_b32 s62, s90
    s_mul_i32 s60, s90, 1835008
    s_add_u32 s60, s60, s91
    buffer_load_dwordx4 v[64:67], v53, s[20:23], s60 offen offset:0 sc1
    buffer_load_dwordx4 v[68:71], v53, s[20:23], s60 offen offset:512 sc1
    s_cmp_lg_u32 s59, 0
    s_cbranch_scc1 L_hv0_1
    s_call_b64 s[94:95], L_gpoll
L_hv0_1:
    s_ff1_i32_b32 s90, s59
    s_bitset0_b32 s59, s90
    s_bitset0_b32 s62, s90
    s_mul_i32 s60, s90, 1835008
    s_add_u32 s60, s60, s91
    buffer_load_dwordx4 v[72:75], v53, s[20:23], s60 offen offset:0 sc1
    buffer_load_dwordx4 v[76:79], v53, s[20:23], s60 offen offset:512 sc1
    s_cmp_lg_u32 s59, 0
    s_cbranch_scc1 L_hv0_2
    s_call_b64 s[94:95], L_gpoll
L_hv0_2:
    s_ff1_i32_b32 s90, s59
    s_bitset0_b32 s59, s90
    s_bitset0_b32 s62, s90
    s_mul_i32 s60, s90, 1835008
    s_add_u32 s60, s60, s91
    buffer_load_dwordx4 v[80:83], v53, s[20:23], s60 offen offset:0 sc1
    buffer_load_dwordx4 v[84:87], v53, s[20:23], s60 offen offset:512 sc1
    s_cmp_lg_u32 s59, 0
    s_cbranch_scc1 L_hv0_3
    s_call_b64 s[94:95], L_gpoll
L_hv0_3:
    s_ff1_i32_b32 s90, s59
    s_bitset0_b32 s59, s90
    s_bitset0_b32 s62, s90
    s_mul_i32 s60, s90, 1835008
    s_add_u32 s60, s60, s91
    buffer_load_dwordx4 v[88:91], v53, s[20:23], s60 offen offset:0 sc1
    buffer_load_dwordx4 v[92:95], v53, s[20:23], s60 offen offset:512 sc1
    s_cmp_lg_u32 s59, 0
    s_cbranch_scc1 L_hv0_4
    s_call_b64 s[94:95], L_gpoll
L_hv0_4:
    s_ff1_i32_b32 s90, s59
    s_bitset0_b32 s59, s90
    s_bitset0_b32 s62, s90
    s_mul_i32 s60, s90, 1835008
    s_add_u32 s60, s60, s91
    buffer_load_dwordx4 v[96:99], v53, s[20:23], s60 offen offset:0 sc1
    buffer_load_dwordx4 v[100:103], v53, s[20:23], s60 offen offset:512 sc1
    s_cmp_lg_u32 s59, 0
    s_cbranch_scc1 L_hv0_5
    s_call_b64 s[94:95], L_gpoll
L_hv0_5:
    s_ff1_i32_b32 s90, s59
    s_bitset0_b32 s59, s90
    s_bitset0_b32 s62, s90
    s_mul_i32 s60, s90, 1835008
    s_add_u32 s60, s60, s91
    buffer_load_dwordx4 v[104:107], v53, s[20:23], s60 offen offset:0 sc1
    buffer_load_dwordx4 v[108:111], v53, s[20:23], s60 offen offset:512 sc1
    s_cmp_lg_u32 s59, 0
    s_cbranch_scc1 L_hv0_6
    s_call_b64 s[94:95], L_gpoll
L_hv0_6:
    s_ff1_i32_b32 s90, s59
    s_bitset0_b32 s59, s90
    s_bitset0_b32 s62, s90
    s_mul_i32 s60, s90, 1835008
    s_add_u32 s60, s60, s91
    buffer_load_dwordx4 v[112:115], v53, s[20:23], s60 offen offset:0 sc1
    buffer_load_dwordx4 v[116:119], v53, s[20:23], s60 offen offset:512 sc1
    s_cmp_lg_u32 s59, 0
    s_cbranch_scc1 L_hv0_7
    s_call_b64 s[94:95], L_gpoll
L_hv0_7:
    s_ff1_i32_b32 s90, s59
    s_bitset0_b32 s59, s90
    s_bitset0_b32 s62, s90
    s_mul_i32 s60, s90, 1835008
    s_add_u32 s60, s60, s91
    buffer_load_dwordx4 v[120:123], v53, s[20:23], s60 offen offset:0 sc1
    buffer_load_dwordx4 v[124:127], v53, s[20:23], s60 offen offset:512 sc1
    s_cmp_lg_u32 s59, 0
    s_cbranch_scc1 L_hv0_8
    s_call_b64 s[94:95], L_gpoll
L_hv0_8:
    s_ff1_i32_b32 s90, s59
    s_bitset0_b32 s59, s90
    s_bitset0_b32 s62, s90
    s_mul_i32 s60, s90, 1835008
    s_add_u32 s60, s60, s91
    buffer_load_dwordx4 v[128:131], v53, s[20:23], s60 offen offset:0 sc1
    buffer_load_dwordx4 v[132:135], v53, s[20:23], s60 offen offset:512 sc1
    s_cmp_lg_u32 s59, 0
    s_cbranch_scc1 L_hv0_9
    s_call_b64 s[94:95], L_gpoll
L_hv0_9:
    s_ff1_i32_b32 s90, s59
    s_bitset0_b32 s59, s90
    s_bitset0_b32 s62, s90
    s_mul_i32 s60, s90, 1835008
    s_add_u32 s60, s60, s91
    buffer_load_dwordx4 v[136:139], v53, s[20:23], s60 offen offset:0 sc1
    buffer_load_dwordx4 v[140:143], v53, s[20:23], s60 offen offset:512 sc1
    s_cmp_lg_u32 s59, 0
    s_cbranch_scc1 L_hv0_10
    s_call_b64 s[94:95], L_gpoll
L_hv0_10:
    s_ff1_i32_b32 s90, s59
    s_bitset0_b32 s59, s90
    s_bitset0_b32 s62, s90
    s_mul_i32 s60, s90, 1835008
    s_add_u32 s60, s60, s91
    buffer_load_dwordx4 v[144:147], v53, s[20:23], s60 offen offset:0 sc1
    buffer_load_dwordx4 v[148:151], v53, s[20:23], s60 offen offset:512 sc1
    s_cmp_lg_u32 s59, 0
    s_cbranch_scc1 L_hv0_11
    s_call_b64 s[94:95], L_gpoll
L_hv0_11:
    s_ff1_i32_b32 s90, s59
    s_bitset0_b32 s59, s90
    s_bitset0_b32 s62, s90
    s_mul_i32 s60, s90, 1835008
    s_add_u32 s60, s60, s91
    buffer_load_dwordx4 v[152:155], v53, s[20:23], s60 offen offset:0 sc1
    buffer_load_dwordx4 v[156:159], v53, s[20:23], s60 offen offset:512 sc1
    s_cmp_lg_u32 s59, 0
    s_cbranch_scc1 L_hv0_12
    s_call_b64 s[94:95], L_gpoll
L_hv0_12:
    s_ff1_i32_b32 s90, s59
    s_bitset0_b32 s59, s90
    s_bitset0_b32 s62, s90
    s_mul_i32 s60, s90, 1835008
    s_add_u32 s60, s60, s91
    buffer_load_dwordx4 v[160:163], v53, s[20:23], s60 offen offset:0 sc1
    buffer_load_dwordx4 v[164:167], v53, s[20:23], s60 offen offset:512 sc1
    s_cmp_lg_u32 s59, 0
    s_cbranch_scc1 L_hv0_13
    s_call_b64 s[94:95], L_gpoll
L_hv0_13:
    s_ff1_i32_b32 s90, s59
    s_bitset0_b32 s59, s90
    s_bitset0_b32 s62, s90
    s_mul_i32 s60, s90, 1835008
    s_add_u32 s60, s60, s91
    buffer_load_dwordx4 v[168:171], v53, s[20:23], s60 offen offset:0 sc1
    buffer_load_dwordx4 v[172:175], v53, s[20:23], s60 offen offset:512 sc1
    s_waitcnt vmcnt(27)
    v_dot2_f32_bf16 v57, v64, s97, v57
    v_dot2_f32_bf16 v58, v64, s3, v58
    v_dot2_f32_bf16 v59, v65, s97, v59
    v_dot2_f32_bf16 v60, v65, s3, v60
    v_dot2_f32_bf16 v61, v66, s97, v61
    v_dot2_f32_bf16 v62, v66, s3, v62
    v_dot2_f32_bf16 v63, v67, s97, v63
    v_dot2_f32_bf16 v248, v67, s3, v248
    s_waitcnt vmcnt(26)
    v_dot2_f32_bf16 v249, v68, s97, v249
    v_dot2_f32_bf16 v250, v68, s3, v250
    v_dot2_f32_bf16 v251, v69, s97, v251
    v_dot2_f32_bf16 v252, v69, s3, v252
    v_dot2_f32_bf16 v253, v70, s97, v253
    v_dot2_f32_bf16 v254, v70, s3, v254
    v_dot2_f32_bf16 v255, v71, s97, v255
    v_dot2_f32_bf16 v52, v71, s3, v52
    s_cmp_lg_u32 s59, 0
    s_cbranch_scc1 L_hv0_14
    s_call_b64 s[94:95], L_gpoll
L_hv0_14:
    s_ff1_i32_b32 s90, s59
    s_bitset0_b32 s59, s90
    s_bitset0_b32 s62, s90
    s_mul_i32 s60, s90, 1835008
    s_add_u32 s60, s60, s91
    buffer_load_dwordx4 v[176:179], v53, s[20:23], s60 offen offset:0 sc1
    buffer_load_dwordx4 v[180:183], v53, s[20:23], s60 offen offset:512 sc1
    s_waitcnt vmcnt(27)
    v_dot2_f32_bf16 v57, v72, s97, v57
    v_dot2_f32_bf16 v58, v72, s3, v58
    v_dot2_f32_bf16 v59, v73, s97, v59
    v_dot2_f32_bf16 v60, v73, s3, v60
    v_dot2_f32_bf16 v61, v74, s97, v61
    v_dot2_f32_bf16 v62, v74, s3, v62
    v_dot2_f32_bf16 v63, v75, s97, v63
    v_dot2_f32_bf16 v248, v75, s3, v248
    s_waitcnt vmcnt(26)
    v_dot2_f32_bf16 v249, v76, s97, v249
    v_dot2_f32_bf16 v250, v76, s3, v250
    v_dot2_f32_bf16 v251, v77, s97, v251
    v_dot2_f32_bf16 v252, v77, s3, v252
    v_dot2_f32_bf16 v253, v78, s97, v253
    v_dot2_f32_bf16 v254, v78, s3, v254
    v_dot2_f32_bf16 v255, v79, s97, v255
    v_dot2_f32_bf16 v52, v79, s3, v52
    s_cmp_lg_u32 s59, 0
    s_cbranch_scc1 L_hv0_15
    s_call_b64 s[94:95], L_gpoll
L_hv0_15:
    s_ff1_i32_b32 s90, s59
    s_bitset0_b32 s59, s90
    s_bitset0_b32 s62, s90
    s_mul_i32 s60, s90, 1835008
    s_add_u32 s60, s60, s91
    buffer_load_dwordx4 v[184:187], v53, s[20:23], s60 offen offset:0 sc1
    buffer_load_dwordx4 v[188:191], v53, s[20:23], s60 offen offset:512 sc1
    s_waitcnt vmcnt(27)
    v_dot2_f32_bf16 v57, v80, s97, v57
    v_dot2_f32_bf16 v58, v80, s3, v58
    v_dot2_f32_bf16 v59, v81, s97, v59
    v_dot2_f32_bf16 v60, v81, s3, v60
    v_dot2_f32_bf16 v61, v82, s97, v61
    v_dot2_f32_bf16 v62, v82, s3, v62
    v_dot2_f32_bf16 v63, v83, s97, v63
    v_dot2_f32_bf16 v248, v83, s3, v248
    s_waitcnt vmcnt(26)
    v_dot2_f32_bf16 v249, v84, s97, v249
    v_dot2_f32_bf16 v250, v84, s3, v250
    v_dot2_f32_bf16 v251, v85, s97, v251
    v_dot2_f32_bf16 v252, v85, s3, v252
    v_dot2_f32_bf16 v253, v86, s97, v253
    v_dot2_f32_bf16 v254, v86, s3, v254
    v_dot2_f32_bf16 v255, v87, s97, v255
    v_dot2_f32_bf16 v52, v87, s3, v52
    s_lshr_b32 s61, s52, 1
    s_lshl_b32 s60, s61, 6
    v_xor_b32 v2, s60, v4
    v_xor_b32 v3, 32, v2
    s_mul_i32 s60, s61, 4224
    s_sub_u32 s61, 4224, s60
    v_add_u32 v4, s60, v2
    v_add_u32 v6, s61, v2
    v_add_u32 v5, s60, v3
    v_add_u32 v7, s61, v3
    v_add_u32 v8, 67584, v2
    v_add_u32 v9, 67584, v3
    v_add_u32 v10, 67584, v4
    v_add_u32 v11, 67584, v5
    v_add_u32 v12, 67584, v6
    v_add_u32 v13, 67584, v7
    ds_read_b64_tr_b16 a[128:129], v8 offset:0
    ds_read_b64_tr_b16 a[130:131], v8 offset:2048
    ds_read_b64_tr_b16 a[132:133], v8 offset:4224
    ds_read_b64_tr_b16 a[134:135], v8 offset:6272
    ds_read_b64_tr_b16 a[136:137], v8 offset:8448
    ds_read_b64_tr_b16 a[138:139], v8 offset:10496
    ds_read_b64_tr_b16 a[140:141], v8 offset:12672
    ds_read_b64_tr_b16 a[142:143], v8 offset:14720
    ds_read_b64_tr_b16 a[144:145], v9 offset:0
    ds_read_b64_tr_b16 a[146:147], v9 offset:2048
    ds_read_b64_tr_b16 a[148:149], v9 offset:4224
    ds_read_b64_tr_b16 a[150:151], v9 offset:6272
    ds_read_b64_tr_b16 a[152:153], v9 offset:8448
    ds_read_b64_tr_b16 a[154:155], v9 offset:10496
    ds_read_b64_tr_b16 a[156:157], v9 offset:12672
    s_waitcnt lgkmcnt(14)
    ds_read_b64_tr_b16 a[158:159], v9 offset:14720
    s_waitcnt lgkmcnt(14)
    ds_read_b64_tr_b16 a[160:161], v8 offset:16896
    s_waitcnt lgkmcnt(14)
    ds_read_b64_tr_b16 a[162:163], v8 offset:18944
    s_waitcnt lgkmcnt(14)
    ds_read_b64_tr_b16 a[164:165], v8 offset:21120
    s_waitcnt lgkmcnt(14)
    ds_read_b64_tr_b16 a[166:167], v8 offset:23168
    s_waitcnt lgkmcnt(14)
    ds_read_b64_tr_b16 a[168:169], v8 offset:25344
    s_waitcnt lgkmcnt(14)
    ds_read_b64_tr_b16 a[170:171], v8 offset:27392
    s_waitcnt lgkmcnt(14)
    ds_read_b64_tr_b16 a[172:173], v8 offset:29568
    s_waitcnt lgkmcnt(14)
    ds_read_b64_tr_b16 a[174:175], v8 offset:31616
    s_waitcnt lgkmcnt(14)
    ds_read_b64_tr_b16 a[176:177], v9 offset:16896
    s_waitcnt lgkmcnt(14)
    ds_read_b64_tr_b16 a[178:179], v9 offset:18944
    s_waitcnt lgkmcnt(14)
    ds_read_b64_tr_b16 a[180:181], v9 offset:21120
    s_waitcnt lgkmcnt(14)
    ds_read_b64_tr_b16 a[182:183], v9 offset:23168
    s_waitcnt lgkmcnt(14)
    ds_read_b64_tr_b16 a[184:185], v9 offset:25344
    s_waitcnt lgkmcnt(14)
    ds_read_b64_tr_b16 a[186:187], v9 offset:27392
    s_waitcnt lgkmcnt(14)
    ds_read_b64_tr_b16 a[188:189], v9 offset:29568
    s_waitcnt lgkmcnt(14)
    ds_read_b64_tr_b16 a[190:191], v9 offset:31616
    s_waitcnt lgkmcnt(14)
    ds_read_b64_tr_b16 a[192:193], v8 offset:33792
    s_waitcnt lgkmcnt(14)
    ds_read_b64_tr_b16 a[194:195], v8 offset:35840
    s_waitcnt lgkmcnt(14)
    ds_read_b64_tr_b16 a[196:197], v8 offset:38016
    s_waitcnt lgkmcnt(14)
    ds_read_b64_tr_b16 a[198:199], v8 offset:40064
    s_waitcnt lgkmcnt(14)
    ds_read_b64_tr_b16 a[200:201], v8 offset:42240
    s_waitcnt lgkmcnt(14)
    ds_read_b64_tr_b16 a[202:203], v8 offset:44288
    s_waitcnt lgkmcnt(14)
    ds_read_b64_tr_b16 a[204:205], v8 offset:46464
    s_waitcnt lgkmcnt(14)
    ds_read_b64_tr_b16 a[206:207], v8 offset:48512
    s_waitcnt lgkmcnt(14)
    ds_read_b64_tr_b16 a[208:209], v9 offset:33792
    s_waitcnt lgkmcnt(14)
    ds_read_b64_tr_b16 a[210:211], v9 offset:35840
    s_waitcnt lgkmcnt(14)
    ds_read_b64_tr_b16 a[212:213], v9 offset:38016
    s_waitcnt lgkmcnt(14)
    ds_read_b64_tr_b16 a[214:215], v9 offset:40064
    s_waitcnt lgkmcnt(14)
    ds_read_b64_tr_b16 a[216:217], v9 offset:42240
    s_waitcnt lgkmcnt(14)
    ds_read_b64_tr_b16 a[218:219], v9 offset:44288
    s_waitcnt lgkmcnt(14)
    ds_read_b64_tr_b16 a[220:221], v9 offset:46464
    s_waitcnt lgkmcnt(14)
    ds_read_b64_tr_b16 a[222:223], v9 offset:48512
    s_waitcnt lgkmcnt(14)
    ds_read_b64_tr_b16 a[224:225], v8 offset:50688
    s_waitcnt lgkmcnt(14)
    ds_read_b64_tr_b16 a[226:227], v8 offset:52736
    s_waitcnt lgkmcnt(14)
    ds_read_b64_tr_b16 a[228:229], v8 offset:54912
    s_waitcnt lgkmcnt(14)
    ds_read_b64_tr_b16 a[230:231], v8 offset:56960
    s_waitcnt lgkmcnt(14)
    ds_read_b64_tr_b16 a[232:233], v9 offset:50688
    s_waitcnt lgkmcnt(14)
    ds_read_b64_tr_b16 a[234:235], v9 offset:52736
    s_waitcnt lgkmcnt(14)
    ds_read_b64_tr_b16 a[236:237], v9 offset:54912
    s_waitcnt lgkmcnt(14)
    ds_read_b64_tr_b16 a[238:239], v9 offset:56960
    s_waitcnt lgkmcnt(14)
    ds_read_b64_tr_b16 a[240:241], v8 offset:59136
    s_waitcnt lgkmcnt(14)
    ds_read_b64_tr_b16 a[242:243], v8 offset:61184
    s_waitcnt lgkmcnt(14)
    ds_read_b64_tr_b16 a[244:245], v8 offset:63360
    s_waitcnt lgkmcnt(14)
    ds_read_b64_tr_b16 a[246:247], v8 offset:65408
    s_waitcnt lgkmcnt(14)
    ds_read_b64_tr_b16 a[248:249], v9 offset:59136
    s_waitcnt lgkmcnt(14)
    ds_read_b64_tr_b16 a[250:251], v9 offset:61184
    s_waitcnt lgkmcnt(14)
    ds_read_b64_tr_b16 a[252:253], v9 offset:63360
    s_waitcnt lgkmcnt(14)
    ds_read_b64_tr_b16 a[254:255], v9 offset:65408
    s_waitcnt vmcnt(25)
    v_dot2_f32_bf16 v57, v88, s97, v57
    v_dot2_f32_bf16 v58, v88, s3, v58
    v_dot2_f32_bf16 v59, v89, s97, v59
    v_dot2_f32_bf16 v60, v89, s3, v60
    v_dot2_f32_bf16 v61, v90, s97, v61
    v_dot2_f32_bf16 v62, v90, s3, v62
    v_dot2_f32_bf16 v63, v91, s97, v63
    v_dot2_f32_bf16 v248, v91, s3, v248
    s_waitcnt vmcnt(24)
    v_dot2_f32_bf16 v249, v92, s97, v249
    v_dot2_f32_bf16 v250, v92, s3, v250
    v_dot2_f32_bf16 v251, v93, s97, v251
    v_dot2_f32_bf16 v252, v93, s3, v252
    v_dot2_f32_bf16 v253, v94, s97, v253
    v_dot2_f32_bf16 v254, v94, s3, v254
    v_dot2_f32_bf16 v255, v95, s97, v255
    v_dot2_f32_bf16 v52, v95, s3, v52
    s_waitcnt vmcnt(23)
    v_dot2_f32_bf16 v57, v96, s97, v57
    v_dot2_f32_bf16 v58, v96, s3, v58
    v_dot2_f32_bf16 v59, v97, s97, v59
    v_dot2_f32_bf16 v60, v97, s3, v60
    v_dot2_f32_bf16 v61, v98, s97, v61
    v_dot2_f32_bf16 v62, v98, s3, v62
    v_dot2_f32_bf16 v63, v99, s97, v63
    v_dot2_f32_bf16 v248, v99, s3, v248
    s_waitcnt vmcnt(22)
    v_dot2_f32_bf16 v249, v100, s97, v249
    v_dot2_f32_bf16 v250, v100, s3, v250
    v_dot2_f32_bf16 v251, v101, s97, v251
    v_dot2_f32_bf16 v252, v101, s3, v252
    v_dot2_f32_bf16 v253, v102, s97, v253
    v_dot2_f32_bf16 v254, v102, s3, v254
    v_dot2_f32_bf16 v255, v103, s97, v255
    v_dot2_f32_bf16 v52, v103, s3, v52
    s_waitcnt vmcnt(21)
    v_dot2_f32_bf16 v57, v104, s97, v57
    v_dot2_f32_bf16 v58, v104, s3, v58
    v_dot2_f32_bf16 v59, v105, s97, v59
    v_dot2_f32_bf16 v60, v105, s3, v60
    v_dot2_f32_bf16 v61, v106, s97, v61
    v_dot2_f32_bf16 v62, v106, s3, v62
    v_dot2_f32_bf16 v63, v107, s97, v63
    v_dot2_f32_bf16 v248, v107, s3, v248
    s_waitcnt vmcnt(20)
    v_dot2_f32_bf16 v249, v108, s97, v249
    v_dot2_f32_bf16 v250, v108, s3, v250
    v_dot2_f32_bf16 v251, v109, s97, v251
    v_dot2_f32_bf16 v252, v109, s3, v252
    v_dot2_f32_bf16 v253, v110, s97, v253
    v_dot2_f32_bf16 v254, v110, s3, v254
    v_dot2_f32_bf16 v255, v111, s97, v255
    v_dot2_f32_bf16 v52, v111, s3, v52
    s_waitcnt vmcnt(19)
    v_dot2_f32_bf16 v57, v112, s97, v57
    v_dot2_f32_bf16 v58, v112, s3, v58
    v_dot2_f32_bf16 v59, v113, s97, v59
    v_dot2_f32_bf16 v60, v113, s3, v60
    v_dot2_f32_bf16 v61, v114, s97, v61
    v_dot2_f32_bf16 v62, v114, s3, v62
    v_dot2_f32_bf16 v63, v115, s97, v63
    v_dot2_f32_bf16 v248, v115, s3, v248
    s_waitcnt vmcnt(18)
    v_dot2_f32_bf16 v249, v116, s97, v249
    v_dot2_f32_bf16 v250, v116, s3, v250
    v_dot2_f32_bf16 v251, v117, s97, v251
    v_dot2_f32_bf16 v252, v117, s3, v252
    v_dot2_f32_bf16 v253, v118, s97, v253
    v_dot2_f32_bf16 v254, v118, s3, v254
    v_dot2_f32_bf16 v255, v119, s97, v255
    v_dot2_f32_bf16 v52, v119, s3, v52
    s_waitcnt vmcnt(17)
    v_dot2_f32_bf16 v57, v120, s97, v57
    v_dot2_f32_bf16 v58, v120, s3, v58
    v_dot2_f32_bf16 v59, v121, s97, v59
    v_dot2_f32_bf16 v60, v121, s3, v60
    v_dot2_f32_bf16 v61, v122, s97, v61
    v_dot2_f32_bf16 v62, v122, s3, v62
    v_dot2_f32_bf16 v63, v123, s97, v63
    v_dot2_f32_bf16 v248, v123, s3, v248
    s_waitcnt vmcnt(16)
    v_dot2_f32_bf16 v249, v124, s97, v249
    v_dot2_f32_bf16 v250, v124, s3, v250
    v_dot2_f32_bf16 v251, v125, s97, v251
    v_dot2_f32_bf16 v252, v125, s3, v252
    v_dot2_f32_bf16 v253, v126, s97, v253
    v_dot2_f32_bf16 v254, v126, s3, v254
    v_dot2_f32_bf16 v255, v127, s97, v255
    v_dot2_f32_bf16 v52, v127, s3, v52
    s_waitcnt vmcnt(15)
    v_dot2_f32_bf16 v57, v128, s97, v57
    v_dot2_f32_bf16 v58, v128, s3, v58
    v_dot2_f32_bf16 v59, v129, s97, v59
    v_dot2_f32_bf16 v60, v129, s3, v60
    v_dot2_f32_bf16 v61, v130, s97, v61
    v_dot2_f32_bf16 v62, v130, s3, v62
    v_dot2_f32_bf16 v63, v131, s97, v63
    v_dot2_f32_bf16 v248, v131, s3, v248
    s_waitcnt vmcnt(14)
    v_dot2_f32_bf16 v249, v132, s97, v249
    v_dot2_f32_bf16 v250, v132, s3, v250
    v_dot2_f32_bf16 v251, v133, s97, v251
    v_dot2_f32_bf16 v252, v133, s3, v252
    v_dot2_f32_bf16 v253, v134, s97, v253
    v_dot2_f32_bf16 v254, v134, s3, v254
    v_dot2_f32_bf16 v255, v135, s97, v255
    v_dot2_f32_bf16 v52, v135, s3, v52
    s_waitcnt vmcnt(13)
    v_dot2_f32_bf16 v57, v136, s97, v57
    v_dot2_f32_bf16 v58, v136, s3, v58
    v_dot2_f32_bf16 v59, v137, s97, v59
    v_dot2_f32_bf16 v60, v137, s3, v60
    v_dot2_f32_bf16 v61, v138, s97, v61
    v_dot2_f32_bf16 v62, v138, s3, v62
    v_dot2_f32_bf16 v63, v139, s97, v63
    v_dot2_f32_bf16 v248, v139, s3, v248
    s_waitcnt vmcnt(12)
    v_dot2_f32_bf16 v249, v140, s97, v249
    v_dot2_f32_bf16 v250, v140, s3, v250
    v_dot2_f32_bf16 v251, v141, s97, v251
    v_dot2_f32_bf16 v252, v141, s3, v252
    v_dot2_f32_bf16 v253, v142, s97, v253
    v_dot2_f32_bf16 v254, v142, s3, v254
    v_dot2_f32_bf16 v255, v143, s97, v255
    v_dot2_f32_bf16 v52, v143, s3, v52
    s_waitcnt vmcnt(11)
    v_dot2_f32_bf16 v57, v144, s97, v57
    v_dot2_f32_bf16 v58, v144, s3, v58
    v_dot2_f32_bf16 v59, v145, s97, v59
    v_dot2_f32_bf16 v60, v145, s3, v60
    v_dot2_f32_bf16 v61, v146, s97, v61
    v_dot2_f32_bf16 v62, v146, s3, v62
    v_dot2_f32_bf16 v63, v147, s97, v63
    v_dot2_f32_bf16 v248, v147, s3, v248
    s_waitcnt vmcnt(10)
    v_dot2_f32_bf16 v249, v148, s97, v249
    v_dot2_f32_bf16 v250, v148, s3, v250
    v_dot2_f32_bf16 v251, v149, s97, v251
    v_dot2_f32_bf16 v252, v149, s3, v252
    v_dot2_f32_bf16 v253, v150, s97, v253
    v_dot2_f32_bf16 v254, v150, s3, v254
    v_dot2_f32_bf16 v255, v151, s97, v255
    v_dot2_f32_bf16 v52, v151, s3, v52
    s_waitcnt vmcnt(9)
    v_dot2_f32_bf16 v57, v152, s97, v57
    v_dot2_f32_bf16 v58, v152, s3, v58
    v_dot2_f32_bf16 v59, v153, s97, v59
    v_dot2_f32_bf16 v60, v153, s3, v60
    v_dot2_f32_bf16 v61, v154, s97, v61
    v_dot2_f32_bf16 v62, v154, s3, v62
    v_dot2_f32_bf16 v63, v155, s97, v63
    v_dot2_f32_bf16 v248, v155, s3, v248
    s_waitcnt vmcnt(8)
    v_dot2_f32_bf16 v249, v156, s97, v249
    v_dot2_f32_bf16 v250, v156, s3, v250
    v_dot2_f32_bf16 v251, v157, s97, v251
    v_dot2_f32_bf16 v252, v157, s3, v252
    v_dot2_f32_bf16 v253, v158, s97, v253
    v_dot2_f32_bf16 v254, v158, s3, v254
    v_dot2_f32_bf16 v255, v159, s97, v255
    v_dot2_f32_bf16 v52, v159, s3, v52
    s_waitcnt vmcnt(7)
    v_dot2_f32_bf16 v57, v160, s97, v57
    v_dot2_f32_bf16 v58, v160, s3, v58
    v_dot2_f32_bf16 v59, v161, s97, v59
    v_dot2_f32_bf16 v60, v161, s3, v60
    v_dot2_f32_bf16 v61, v162, s97, v61
    v_dot2_f32_bf16 v62, v162, s3, v62
    v_dot2_f32_bf16 v63, v163, s97, v63
    v_dot2_f32_bf16 v248, v163, s3, v248
    s_waitcnt vmcnt(6)
    v_dot2_f32_bf16 v249, v164, s97, v249
    v_dot2_f32_bf16 v250, v164, s3, v250
    v_dot2_f32_bf16 v251, v165, s97, v251
    v_dot2_f32_bf16 v252, v165, s3, v252
    v_dot2_f32_bf16 v253, v166, s97, v253
    v_dot2_f32_bf16 v254, v166, s3, v254
    v_dot2_f32_bf16 v255, v167, s97, v255
    v_dot2_f32_bf16 v52, v167, s3, v52
    s_waitcnt vmcnt(5)
    v_dot2_f32_bf16 v57, v168, s97, v57
    v_dot2_f32_bf16 v58, v168, s3, v58
    v_dot2_f32_bf16 v59, v169, s97, v59
    v_dot2_f32_bf16 v60, v169, s3, v60
    v_dot2_f32_bf16 v61, v170, s97, v61
    v_dot2_f32_bf16 v62, v170, s3, v62
    v_dot2_f32_bf16 v63, v171, s97, v63
    v_dot2_f32_bf16 v248, v171, s3, v248
    s_waitcnt vmcnt(4)
    v_dot2_f32_bf16 v249, v172, s97, v249
    v_dot2_f32_bf16 v250, v172, s3, v250
    v_dot2_f32_bf16 v251, v173, s97, v251
    v_dot2_f32_bf16 v252, v173, s3, v252
    v_dot2_f32_bf16 v253, v174, s97, v253
    v_dot2_f32_bf16 v254, v174, s3, v254
    v_dot2_f32_bf16 v255, v175, s97, v255
    v_dot2_f32_bf16 v52, v175, s3, v52
    s_waitcnt vmcnt(3)
    v_dot2_f32_bf16 v57, v176, s97, v57
    v_dot2_f32_bf16 v58, v176, s3, v58
    v_dot2_f32_bf16 v59, v177, s97, v59
    v_dot2_f32_bf16 v60, v177, s3, v60
    v_dot2_f32_bf16 v61, v178, s97, v61
    v_dot2_f32_bf16 v62, v178, s3, v62
    v_dot2_f32_bf16 v63, v179, s97, v63
    v_dot2_f32_bf16 v248, v179, s3, v248
    s_waitcnt vmcnt(2)
    v_dot2_f32_bf16 v249, v180, s97, v249
    v_dot2_f32_bf16 v250, v180, s3, v250
    v_dot2_f32_bf16 v251, v181, s97, v251
    v_dot2_f32_bf16 v252, v181, s3, v252
    v_dot2_f32_bf16 v253, v182, s97, v253
    v_dot2_f32_bf16 v254, v182, s3, v254
    v_dot2_f32_bf16 v255, v183, s97, v255
    v_dot2_f32_bf16 v52, v183, s3, v52
    s_waitcnt vmcnt(1)
    v_dot2_f32_bf16 v57, v184, s97, v57
    v_dot2_f32_bf16 v58, v184, s3, v58
    v_dot2_f32_bf16 v59, v185, s97, v59
    v_dot2_f32_bf16 v60, v185, s3, v60
    v_dot2_f32_bf16 v61, v186, s97, v61
    v_dot2_f32_bf16 v62, v186, s3, v62
    v_dot2_f32_bf16 v63, v187, s97, v63
    v_dot2_f32_bf16 v248, v187, s3, v248
    s_waitcnt vmcnt(0)
    v_dot2_f32_bf16 v249, v188, s97, v249
    v_dot2_f32_bf16 v250, v188, s3, v250
    v_dot2_f32_bf16 v251, v189, s97, v251
    v_dot2_f32_bf16 v252, v189, s3, v252
    v_dot2_f32_bf16 v253, v190, s97, v253
    v_dot2_f32_bf16 v254, v190, s3, v254
    v_dot2_f32_bf16 v255, v191, s97, v255
    v_dot2_f32_bf16 v52, v191, s3, v52
    s_nop 2
    v_cvt_pk_bf16_f32 v64, v57, v58
    v_cvt_pk_bf16_f32 v65, v59, v60
    v_cvt_pk_bf16_f32 v66, v61, v62
    v_cvt_pk_bf16_f32 v67, v63, v248
    v_cvt_pk_bf16_f32 v68, v249, v250
    v_cvt_pk_bf16_f32 v69, v251, v252
    v_cvt_pk_bf16_f32 v70, v253, v254
    v_cvt_pk_bf16_f32 v71, v255, v52
    v_lshlrev_b32 v57, 16, v64
    v_and_b32 v58, 0xffff0000, v64
    v_lshlrev_b32 v59, 16, v65
    v_and_b32 v60, 0xffff0000, v65
    v_lshlrev_b32 v61, 16, v66
    v_and_b32 v62, 0xffff0000, v66
    v_lshlrev_b32 v63, 16, v67
    v_and_b32 v248, 0xffff0000, v67
    v_lshlrev_b32 v249, 16, v68
    v_and_b32 v250, 0xffff0000, v68
    v_lshlrev_b32 v251, 16, v69
    v_and_b32 v252, 0xffff0000, v69
    v_lshlrev_b32 v253, 16, v70
    v_and_b32 v254, 0xffff0000, v70
    v_lshlrev_b32 v255, 16, v71
    v_and_b32 v52, 0xffff0000, v71
    v_mul_f32 v57, v57, v200
    v_mul_f32 v58, v58, v201
    v_mul_f32 v59, v59, v202
    v_mul_f32 v60, v60, v203
    v_mul_f32 v61, v61, v204
    v_mul_f32 v62, v62, v205
    v_mul_f32 v63, v63, v206
    v_mul_f32 v248, v248, v207
    v_mul_f32 v249, v249, v208
    v_mul_f32 v250, v250, v209
    v_mul_f32 v251, v251, v210
    v_mul_f32 v252, v252, v211
    v_mul_f32 v253, v253, v212
    v_mul_f32 v254, v254, v213
    v_mul_f32 v255, v255, v214
    v_mul_f32 v52, v52, v215
    v_cvt_pk_bf16_f32 v64, v57, v58
    v_cvt_pk_bf16_f32 v65, v59, v60
    v_cvt_pk_bf16_f32 v66, v61, v62
    v_cvt_pk_bf16_f32 v67, v63, v248
    v_cvt_pk_bf16_f32 v68, v249, v250
    v_cvt_pk_bf16_f32 v69, v251, v252
    v_cvt_pk_bf16_f32 v70, v253, v254
    v_cvt_pk_bf16_f32 v71, v255, v52
    v_lshlrev_b32 v57, 16, v64
    v_and_b32 v58, 0xffff0000, v64
    v_lshlrev_b32 v59, 16, v65
    v_and_b32 v60, 0xffff0000, v65
    v_lshlrev_b32 v61, 16, v66
    v_and_b32 v62, 0xffff0000, v66
    v_lshlrev_b32 v63, 16, v67
    v_and_b32 v248, 0xffff0000, v67
    v_lshlrev_b32 v249, 16, v68
    v_and_b32 v250, 0xffff0000, v68
    v_lshlrev_b32 v251, 16, v69
    v_and_b32 v252, 0xffff0000, v69
    v_lshlrev_b32 v253, 16, v70
    v_and_b32 v254, 0xffff0000, v70
    v_lshlrev_b32 v255, 16, v71
    v_and_b32 v52, 0xffff0000, v71
    s_nop 0
    v_lshlrev_b32 v72, 16, v192
    v_and_b32 v73, 0xffff0000, v192
    v_add_f32 v57, v57, v72
    v_add_f32 v58, v58, v73
    v_lshlrev_b32 v72, 16, v193
    v_and_b32 v73, 0xffff0000, v193
    v_add_f32 v59, v59, v72
    v_add_f32 v60, v60, v73
    v_lshlrev_b32 v72, 16, v194
    v_and_b32 v73, 0xffff0000, v194
    v_add_f32 v61, v61, v72
    v_add_f32 v62, v62, v73
    v_lshlrev_b32 v72, 16, v195
    v_and_b32 v73, 0xffff0000, v195
    v_add_f32 v63, v63, v72
    v_add_f32 v248, v248, v73
    v_lshlrev_b32 v72, 16, v196
    v_and_b32 v73, 0xffff0000, v196
    v_add_f32 v249, v249, v72
    v_add_f32 v250, v250, v73
    v_lshlrev_b32 v72, 16, v197
    v_and_b32 v73, 0xffff0000, v197
    v_add_f32 v251, v251, v72
    v_add_f32 v252, v252, v73
    v_lshlrev_b32 v72, 16, v198
    v_and_b32 v73, 0xffff0000, v198
    v_add_f32 v253, v253, v72
    v_add_f32 v254, v254, v73
    v_lshlrev_b32 v72, 16, v199
    v_and_b32 v73, 0xffff0000, v199
    v_add_f32 v255, v255, v72
    v_add_f32 v52, v52, v73
    v_cvt_pk_bf16_f32 v40, v57, v58
    v_cvt_pk_bf16_f32 v41, v59, v60
    v_cvt_pk_bf16_f32 v42, v61, v62
    v_cvt_pk_bf16_f32 v43, v63, v248
    v_cvt_pk_bf16_f32 v44, v249, v250
    v_cvt_pk_bf16_f32 v45, v251, v252
    v_cvt_pk_bf16_f32 v46, v253, v254
    v_cvt_pk_bf16_f32 v47, v255, v52
    v_lshlrev_b32 v57, 16, v40
    v_and_b32 v58, 0xffff0000, v40
    v_lshlrev_b32 v59, 16, v41
    v_and_b32 v60, 0xffff0000, v41
    v_lshlrev_b32 v61, 16, v42
    v_and_b32 v62, 0xffff0000, v42
    v_lshlrev_b32 v63, 16, v43
    v_and_b32 v248, 0xffff0000, v43
    v_lshlrev_b32 v249, 16, v44
    v_and_b32 v250, 0xffff0000, v44
    v_lshlrev_b32 v251, 16, v45
    v_and_b32 v252, 0xffff0000, v45
    v_lshlrev_b32 v253, 16, v46
    v_and_b32 v254, 0xffff0000, v46
    v_lshlrev_b32 v255, 16, v47
    v_and_b32 v52, 0xffff0000, v47
    v_add_f32 v76, v57, v58
    v_add_f32 v77, v59, v60
    v_add_f32 v76, v76, v61
    v_add_f32 v77, v77, v62
    v_add_f32 v76, v76, v63
    v_add_f32 v77, v77, v248
    v_add_f32 v76, v76, v249
    v_add_f32 v77, v77, v250
    v_add_f32 v76, v76, v251
    v_add_f32 v77, v77, v252
    v_add_f32 v76, v76, v253
    v_add_f32 v77, v77, v254
    v_add_f32 v76, v76, v255
    v_add_f32 v77, v77, v52
    v_add_f32 v76, v76, v77
    s_nop 1
    v_add_f32_dpp v76, v76, v76 quad_perm:[1,0,3,2] row_mask:0xf bank_mask:0xf
    s_nop 1
    v_add_f32_dpp v76, v76, v76 quad_perm:[2,3,0,1] row_mask:0xf bank_mask:0xf
    s_nop 1
    v_add_f32_dpp v76, v76, v76 row_half_mirror row_mask:0xf bank_mask:0xf
    s_nop 1
    v_add_f32_dpp v76, v76, v76 row_mirror row_mask:0xf bank_mask:0xf
    v_mov_b32 v72, v76
    s_nop 1
    v_permlane16_swap_b32 v76, v72
    s_nop 1
    v_add_f32 v76, v76, v72
    v_mul_f32 v76, 0x3b124925, v76
    v_mov_b32 v77, 0
    v_mov_b32 v78, 0
    v_sub_f32 v72, v57, v76
    v_sub_f32 v73, v58, v76
    v_fmac_f32 v77, v72, v72
    v_fmac_f32 v78, v73, v73
    v_sub_f32 v72, v59, v76
    v_sub_f32 v73, v60, v76
    v_fmac_f32 v77, v72, v72
    v_fmac_f32 v78, v73, v73
    v_sub_f32 v72, v61, v76
    v_sub_f32 v73, v62, v76
    v_fmac_f32 v77, v72, v72
    v_fmac_f32 v78, v73, v73
    v_sub_f32 v72, v63, v76
    v_sub_f32 v73, v248, v76
    v_fmac_f32 v77, v72, v72
    v_fmac_f32 v78, v73, v73
    v_sub_f32 v72, v249, v76
    v_sub_f32 v73, v250, v76
    v_fmac_f32 v77, v72, v72
    v_fmac_f32 v78, v73, v73
    v_sub_f32 v72, v251, v76
    v_sub_f32 v73, v252, v76
    v_fmac_f32 v77, v72, v72
    v_fmac_f32 v78, v73, v73
    v_sub_f32 v72, v253, v76
    v_sub_f32 v73, v254, v76
    v_fmac_f32 v77, v72, v72
    v_fmac_f32 v78, v73, v73
    v_sub_f32 v72, v255, v76
    v_sub_f32 v73, v52, v76
    v_fmac_f32 v77, v72, v72
    v_fmac_f32 v78, v73, v73
    v_cmp_ne_u32 vcc, 0x7ffffff0, v53
    v_add_f32 v77, v77, v78
    s_nop 0
    v_cndmask_b32 v77, 0, v77, vcc
    s_nop 1
    v_add_f32_dpp v77, v77, v77 quad_perm:[1,0,3,2] row_mask:0xf bank_mask:0xf
    s_nop 1
    v_add_f32_dpp v77, v77, v77 quad_perm:[2,3,0,1] row_mask:0xf bank_mask:0xf
    s_nop 1
    v_add_f32_dpp v77, v77, v77 row_half_mirror row_mask:0xf bank_mask:0xf
    s_nop 1
    v_add_f32_dpp v77, v77, v77 row_mirror row_mask:0xf bank_mask:0xf
    v_mov_b32 v72, v77
    s_nop 1
    v_permlane16_swap_b32 v77, v72
    s_nop 1
    v_add_f32 v77, v77, v72
    v_mul_f32 v77, 0x3b124925, v77
    v_cvt_pk_bf16_f32 v76, v76, v76
    v_lshlrev_b32 v76, 16, v76
    v_cvt_pk_bf16_f32 v77, v77, v77
    v_lshlrev_b32 v77, 16, v77
    v_add_f32 v77, 0x3727c5ac, v77
    v_cvt_pk_bf16_f32 v77, v77, v77
    v_lshlrev_b32 v77, 16, v77
    v_sqrt_f32 v77, v77
    s_nop 0
    v_cvt_pk_bf16_f32 v77, v77, v77
    v_lshlrev_b32 v77, 16, v77
    v_rcp_f32 v78, v77
    s_nop 0
    v_sub_f32 v57, v57, v76
    v_sub_f32 v58, v58, v76
    v_sub_f32 v59, v59, v76
    v_sub_f32 v60, v60, v76
    v_sub_f32 v61, v61, v76
    v_sub_f32 v62, v62, v76
    v_sub_f32 v63, v63, v76
    v_sub_f32 v248, v248, v76
    v_sub_f32 v249, v249, v76
    v_sub_f32 v250, v250, v76
    v_sub_f32 v251, v251, v76
    v_sub_f32 v252, v252, v76
    v_sub_f32 v253, v253, v76
    v_sub_f32 v254, v254, v76
    v_sub_f32 v255, v255, v76
    v_sub_f32 v52, v52, v76
    v_cvt_pk_bf16_f32 v64, v57, v58
    v_cvt_pk_bf16_f32 v65, v59, v60
    v_cvt_pk_bf16_f32 v66, v61, v62
    v_cvt_pk_bf16_f32 v67, v63, v248
    v_cvt_pk_bf16_f32 v68, v249, v250
    v_cvt_pk_bf16_f32 v69, v251, v252
    v_cvt_pk_bf16_f32 v70, v253, v254
    v_cvt_pk_bf16_f32 v71, v255, v52
    v_lshlrev_b32 v57, 16, v64
    v_and_b32 v58, 0xffff0000, v64
    v_lshlrev_b32 v59, 16, v65
    v_and_b32 v60, 0xffff0000, v65
    v_lshlrev_b32 v61, 16, v66
    v_and_b32 v62, 0xffff0000, v66
    v_lshlrev_b32 v63, 16, v67
    v_and_b32 v248, 0xffff0000, v67
    v_lshlrev_b32 v249, 16, v68
    v_and_b32 v250, 0xffff0000, v68
    v_lshlrev_b32 v251, 16, v69
    v_and_b32 v252, 0xffff0000, v69
    v_lshlrev_b32 v253, 16, v70
    v_and_b32 v254, 0xffff0000, v70
    v_lshlrev_b32 v255, 16, v71
    v_and_b32 v52, 0xffff0000, v71
    v_mul_f32 v57, v57, v78
    v_mul_f32 v58, v58, v78
    v_mul_f32 v59, v59, v78
    v_mul_f32 v60, v60, v78
    v_mul_f32 v61, v61, v78
    v_mul_f32 v62, v62, v78
    v_mul_f32 v63, v63, v78
    v_mul_f32 v248, v248, v78
    v_mul_f32 v249, v249, v78
    v_mul_f32 v250, v250, v78
    v_mul_f32 v251, v251, v78
    v_mul_f32 v252, v252, v78
    v_mul_f32 v253, v253, v78
    v_mul_f32 v254, v254, v78
    v_mul_f32 v255, v255, v78
    v_mul_f32 v52, v52, v78
    v_cvt_pk_bf16_f32 v64, v57, v58
    v_cvt_pk_bf16_f32 v65, v59, v60
    v_cvt_pk_bf16_f32 v66, v61, v62
    v_cvt_pk_bf16_f32 v67, v63, v248
    v_cvt_pk_bf16_f32 v68, v249, v250
    v_cvt_pk_bf16_f32 v69, v251, v252
    v_cvt_pk_bf16_f32 v70, v253, v254
    v_cvt_pk_bf16_f32 v71, v255, v52
    v_lshlrev_b32 v57, 16, v64
    v_and_b32 v58, 0xffff0000, v64
    v_lshlrev_b32 v59, 16, v65
    v_and_b32 v60, 0xffff0000, v65
    v_lshlrev_b32 v61, 16, v66
    v_and_b32 v62, 0xffff0000, v66
    v_lshlrev_b32 v63, 16, v67
    v_and_b32 v248, 0xffff0000, v67
    v_lshlrev_b32 v249, 16, v68
    v_and_b32 v250, 0xffff0000, v68
    v_lshlrev_b32 v251, 16, v69
    v_and_b32 v252, 0xffff0000, v69
    v_lshlrev_b32 v253, 16, v70
    v_and_b32 v254, 0xffff0000, v70
    v_lshlrev_b32 v255, 16, v71
    v_and_b32 v52, 0xffff0000, v71
    v_mul_f32 v57, v57, v216
    v_mul_f32 v58, v58, v217
    v_mul_f32 v59, v59, v218
    v_mul_f32 v60, v60, v219
    v_mul_f32 v61, v61, v220
    v_mul_f32 v62, v62, v221
    v_mul_f32 v63, v63, v222
    v_mul_f32 v248, v248, v223
    v_mul_f32 v249, v249, v224
    v_mul_f32 v250, v250, v225
    v_mul_f32 v251, v251, v226
    v_mul_f32 v252, v252, v227
    v_mul_f32 v253, v253, v228
    v_mul_f32 v254, v254, v229
    v_mul_f32 v255, v255, v230
    v_mul_f32 v52, v52, v231
    v_cvt_pk_bf16_f32 v64, v57, v58
    v_cvt_pk_bf16_f32 v65, v59, v60
    v_cvt_pk_bf16_f32 v66, v61, v62
    v_cvt_pk_bf16_f32 v67, v63, v248
    v_cvt_pk_bf16_f32 v68, v249, v250
    v_cvt_pk_bf16_f32 v69, v251, v252
    v_cvt_pk_bf16_f32 v70, v253, v254
    v_cvt_pk_bf16_f32 v71, v255, v52
    v_lshlrev_b32 v57, 16, v64
    v_and_b32 v58, 0xffff0000, v64
    v_lshlrev_b32 v59, 16, v65
    v_and_b32 v60, 0xffff0000, v65
    v_lshlrev_b32 v61, 16, v66
    v_and_b32 v62, 0xffff0000, v66
    v_lshlrev_b32 v63, 16, v67
    v_and_b32 v248, 0xffff0000, v67
    v_lshlrev_b32 v249, 16, v68
    v_and_b32 v250, 0xffff0000, v68
    v_lshlrev_b32 v251, 16, v69
    v_and_b32 v252, 0xffff0000, v69
    v_lshlrev_b32 v253, 16, v70
    v_and_b32 v254, 0xffff0000, v70
    v_lshlrev_b32 v255, 16, v71
    v_and_b32 v52, 0xffff0000, v71
    v_add_f32 v57, v57, v232
    v_add_f32 v58, v58, v233
    v_add_f32 v59, v59, v234
    v_add_f32 v60, v60, v235
    v_add_f32 v61, v61, v236
    v_add_f32 v62, v62, v237
    v_add_f32 v63, v63, v238
    v_add_f32 v248, v248, v239
    v_add_f32 v249, v249, v240
    v_add_f32 v250, v250, v241
    v_add_f32 v251, v251, v242
    v_add_f32 v252, v252, v243
    v_add_f32 v253, v253, v244
    v_add_f32 v254, v254, v245
    v_add_f32 v255, v255, v246
    v_add_f32 v52, v52, v247
    v_cvt_pk_bf16_f32 v64, v57, v58
    v_cvt_pk_bf16_f32 v65, v59, v60
    v_cvt_pk_bf16_f32 v66, v61, v62
    v_cvt_pk_bf16_f32 v67, v63, v248
    v_cvt_pk_bf16_f32 v68, v249, v250
    v_cvt_pk_bf16_f32 v69, v251, v252
    v_cvt_pk_bf16_f32 v70, v253, v254
    v_cvt_pk_bf16_f32 v71, v255, v52
    s_lshl_b32 s60, s54, 2
    s_lshr_b32 s61, s53, 2
    s_add_u32 s60, s60, s61
    s_mul_i32 s60, s60, 28672
    s_bfe_u32 s61, s53, 0x10001
    s_lshl_b32 s61, s61, 10
    s_add_u32 s60, s60, s61
    s_and_b32 s61, s53, 1
    s_lshl_b32 s61, s61, 7
    s_add_u32 s60, s60, s61
    s_add_u32 s60, s60, 0x200000
    buffer_store_dwordx4 v[64:67], v56, s[20:23], s60 offen offset:0 sc1
    buffer_store_dwordx4 v[68:71], v56, s[20:23], s60 offen offset:2048 sc1
    s_and_b32 s60, s53, 1
    s_lshl_b32 s60, s60, 1
    s_and_b32 s61, s52, 1
    s_add_u32 s90, s60, s61
    s_lshl_b32 s61, s54, 2
    s_add_u32 s61, s61, s90
    s_mul_i32 s61, s61, 28672
    s_add_u32 s91, s61, 0x200000
    s_lshr_b32 s60, s53, 1
    s_mul_i32 s60, s60, 1835008
    s_add_u32 s63, s61, s60
    s_lshr_b32 s61, s52, 1
    s_lshl_b32 s60, s61, 9
    s_add_u32 s63, s63, s60
    s_add_u32 s63, s63, 0x2400000
    s_add_u32 s93, s93, 2048
    s_lshl_b32 s60, s90, 2
    s_lshl_b32 s62, 15, s60
    s_lshl_b32 s60, s52, 11
    s_add_u32 s60, s60, 135168
    v_add_u32 v14, s60, v51
    s_xor_b32 s60, s52, 2
    s_lshl_b32 s60, s60, 11
    s_add_u32 s60, s60, 135168
    v_add_u32 v15, s60, v51
    s_waitcnt vmcnt(0) lgkmcnt(0)
    s_barrier
    s_cmp_lg_u32 s52, 0
    s_cbranch_scc1 L_nf1
    s_mov_b64 exec, 1
    v_mov_b32 v36, s49
    v_mov_b32 v37, 4096
    buffer_store_dword v36, v37, s[20:23], s92 offen sc1
    s_mov_b64 exec, -1
L_nf1:
    s_cmp_ge_u32 s53, 14
    s_cbranch_scc1 L_r2
    s_add_u32 m0, s57, 67584
    s_add_u32 s48, s48, 458752
    s_cmp_ge_u32 s48, 1605632
    s_cselect_b32 s60, 1605504, 0
    s_sub_u32 s48, s48, s60
    buffer_load_dwordx4 v22, s[32:35], s48 offen offset:0 lds
    buffer_load_dwordx4 v23, s[32:35], s48 offen offset:1024 lds
    buffer_load_dwordx4 v24, s[32:35], s48 offen offset:2048 lds
    buffer_load_dwordx4 v25, s[32:35], s48 offen offset:3072 lds
    s_add_u32 m0, s57, 84480
    s_add_u32 s48, s48, 458752
    s_cmp_ge_u32 s48, 1605632
    s_cselect_b32 s60, 1605504, 0
    s_sub_u32 s48, s48, s60
    buffer_load_dwordx4 v22, s[32:35], s48 offen offset:0 lds
    buffer_load_dwordx4 v23, s[32:35], s48 offen offset:1024 lds
    buffer_load_dwordx4 v24, s[32:35], s48 offen offset:2048 lds
    buffer_load_dwordx4 v25, s[32:35], s48 offen offset:3072 lds
    s_add_u32 m0, s57, 101376
    s_add_u32 s48, s48, 458752
    s_cmp_ge_u32 s48, 1605632
    s_cselect_b32 s60, 1605504, 0
    s_sub_u32 s48, s48, s60
    buffer_load_dwordx4 v22, s[32:35], s48 offen offset:0 lds
    buffer_load_dwordx4 v23, s[32:35], s48 offen offset:1024 lds
    buffer_load_dwordx4 v24, s[32:35], s48 offen offset:2048 lds
    buffer_load_dwordx4 v25, s[32:35], s48 offen offset:3072 lds
    s_add_u32 m0, s57, 118272
    s_add_u32 s48, s48, 458752
    s_cmp_ge_u32 s48, 1605632
    s_cselect_b32 s60, 1605504, 0
    s_sub_u32 s48, s48, s60
    buffer_load_dwordx4 v22, s[32:35], s48 offen offset:0 lds
    buffer_load_dwordx4 v23, s[32:35], s48 offen offset:1024 lds
    buffer_load_dwordx4 v24, s[32:35], s48 offen offset:2048 lds
    buffer_load_dwordx4 v25, s[32:35], s48 offen offset:3072 lds
    ds_read_b64_tr_b16 v[160:161], v2 offset:0
    ds_read_b64_tr_b16 v[162:163], v2 offset:2048
    ds_read_b64_tr_b16 v[164:165], v2 offset:4224
    ds_read_b64_tr_b16 v[166:167], v2 offset:6272
    ds_read_b64_tr_b16 v[168:169], v2 offset:8448
    ds_read_b64_tr_b16 v[170:171], v2 offset:10496
    ds_read_b64_tr_b16 v[172:173], v2 offset:12672
    ds_read_b64_tr_b16 v[174:175], v2 offset:14720
    ds_read_b64_tr_b16 v[176:177], v3 offset:0
    ds_read_b64_tr_b16 v[178:179], v3 offset:2048
    ds_read_b64_tr_b16 v[180:181], v3 offset:4224
    ds_read_b64_tr_b16 v[182:183], v3 offset:6272
    ds_read_b64_tr_b16 v[184:185], v3 offset:8448
    ds_read_b64_tr_b16 v[186:187], v3 offset:10496
    ds_read_b64_tr_b16 v[188:189], v3 offset:12672
    s_waitcnt lgkmcnt(14)
    ds_read_b64_tr_b16 v[190:191], v3 offset:14720
    s_waitcnt lgkmcnt(14)
    ds_read_b64_tr_b16 v[192:193], v2 offset:16896
    s_waitcnt lgkmcnt(14)
    ds_read_b64_tr_b16 v[194:195], v2 offset:18944
    s_waitcnt lgkmcnt(14)
    ds_read_b64_tr_b16 v[196:197], v2 offset:21120
    s_waitcnt lgkmcnt(14)
    ds_read_b64_tr_b16 v[198:199], v2 offset:23168
    s_waitcnt lgkmcnt(14)
    ds_read_b64_tr_b16 v[200:201], v2 offset:25344
    s_waitcnt lgkmcnt(14)
    ds_read_b64_tr_b16 v[202:203], v2 offset:27392
    s_waitcnt lgkmcnt(14)
    ds_read_b64_tr_b16 v[204:205], v2 offset:29568
    s_waitcnt lgkmcnt(14)
    ds_read_b64_tr_b16 v[206:207], v2 offset:31616
    s_waitcnt lgkmcnt(14)
    ds_read_b64_tr_b16 v[208:209], v3 offset:16896
    s_waitcnt lgkmcnt(14)
    ds_read_b64_tr_b16 v[210:211], v3 offset:18944
    s_waitcnt lgkmcnt(14)
    ds_read_b64_tr_b16 v[212:213], v3 offset:21120
    s_waitcnt lgkmcnt(14)
    ds_read_b64_tr_b16 v[214:215], v3 offset:23168
    s_waitcnt lgkmcnt(14)
    ds_read_b64_tr_b16 v[216:217], v3 offset:25344
    s_waitcnt lgkmcnt(14)
    ds_read_b64_tr_b16 v[218:219], v3 offset:27392
    s_waitcnt lgkmcnt(14)
    ds_read_b64_tr_b16 v[220:221], v3 offset:29568
    s_waitcnt lgkmcnt(14)
    ds_read_b64_tr_b16 v[222:223], v3 offset:31616
    s_waitcnt lgkmcnt(14)
    ds_read_b64_tr_b16 v[224:225], v2 offset:33792
    s_waitcnt lgkmcnt(14)
    ds_read_b64_tr_b16 v[226:227], v2 offset:35840
    s_waitcnt lgkmcnt(14)
    ds_read_b64_tr_b16 v[228:229], v2 offset:38016
    s_waitcnt lgkmcnt(14)
    ds_read_b64_tr_b16 v[230:231], v2 offset:40064
    s_waitcnt lgkmcnt(14)
    ds_read_b64_tr_b16 v[232:233], v2 offset:42240
    s_waitcnt lgkmcnt(14)
    ds_read_b64_tr_b16 v[234:235], v2 offset:44288
    s_waitcnt lgkmcnt(14)
    ds_read_b64_tr_b16 v[236:237], v2 offset:46464
    s_waitcnt lgkmcnt(14)
    ds_read_b64_tr_b16 v[238:239], v2 offset:48512
    s_waitcnt lgkmcnt(14)
    ds_read_b64_tr_b16 v[240:241], v3 offset:33792
    s_waitcnt lgkmcnt(14)
    ds_read_b64_tr_b16 v[242:243], v3 offset:35840
    s_waitcnt lgkmcnt(14)
    ds_read_b64_tr_b16 v[244:245], v3 offset:38016
    s_waitcnt lgkmcnt(14)
    ds_read_b64_tr_b16 v[246:247], v3 offset:40064
    s_waitcnt lgkmcnt(14)
    ds_read_b64_tr_b16 v[248:249], v3 offset:42240
    s_waitcnt lgkmcnt(14)
    ds_read_b64_tr_b16 v[250:251], v3 offset:44288
    s_waitcnt lgkmcnt(14)
    ds_read_b64_tr_b16 v[252:253], v3 offset:46464
    s_waitcnt lgkmcnt(14)
    ds_read_b64_tr_b16 v[254:255], v3 offset:48512
    s_waitcnt lgkmcnt(0)
    s_barrier
    s_add_u32 m0, s57, 0
    s_add_u32 s48, s48, 458752
    s_cmp_ge_u32 s48, 1605632
    s_cselect_b32 s60, 1605504, 0
    s_sub_u32 s48, s48, s60
    buffer_load_dwordx4 v22, s[32:35], s48 offen offset:0 lds
    buffer_load_dwordx4 v23, s[32:35], s48 offen offset:1024 lds
    buffer_load_dwordx4 v24, s[32:35], s48 offen offset:2048 lds
    buffer_load_dwordx4 v25, s[32:35], s48 offen offset:3072 lds
    s_add_u32 m0, s57, 16896
    s_add_u32 s48, s48, 458752
    s_cmp_ge_u32 s48, 1605632
    s_cselect_b32 s60, 1605504, 0
    s_sub_u32 s48, s48, s60
    buffer_load_dwordx4 v22, s[32:35], s48 offen offset:0 lds
    buffer_load_dwordx4 v23, s[32:35], s48 offen offset:1024 lds
    buffer_load_dwordx4 v24, s[32:35], s48 offen offset:2048 lds
    buffer_load_dwordx4 v25, s[32:35], s48 offen offset:3072 lds
    s_add_u32 m0, s57, 33792
    s_mov_b32 s48, 0
    buffer_load_dwordx4 v26, s[36:39], s48 offen offset:0 lds
    buffer_load_dwordx4 v27, s[36:39], s48 offen offset:1024 lds
    buffer_load_dwordx4 v28, s[36:39], s48 offen offset:2048 lds
    buffer_load_dwordx4 v29, s[36:39], s48 offen offset:3072 lds
L_h2w:
    s_call_b64 s[94:95], L_gpoll
    s_andn2_b32 s62, s62, s59
    s_cbranch_scc1 L_h2w
    buffer_load_dwordx4 a[0:3], v51, s[20:23], s91 offen offset:0 sc1
    buffer_load_dwordx4 a[4:7], v51, s[20:23], s91 offen offset:1024 sc1
    buffer_load_dwordx4 a[8:11], v51, s[20:23], s91 offen offset:2048 sc1
    buffer_load_dwordx4 a[12:15], v51, s[20:23], s91 offen offset:3072 sc1
    s_add_u32 s91, s91, 4096
    buffer_load_dwordx4 a[16:19], v51, s[20:23], s91 offen offset:0 sc1
    buffer_load_dwordx4 a[20:23], v51, s[20:23], s91 offen offset:1024 sc1
    buffer_load_dwordx4 a[24:27], v51, s[20:23], s91 offen offset:2048 sc1
    buffer_load_dwordx4 a[28:31], v51, s[20:23], s91 offen offset:3072 sc1
    s_add_u32 s91, s91, 4096
    buffer_load_dwordx4 a[32:35], v51, s[20:23], s91 offen offset:0 sc1
    buffer_load_dwordx4 a[36:39], v51, s[20:23], s91 offen offset:1024 sc1
    buffer_load_dwordx4 a[40:43], v51, s[20:23], s91 offen offset:2048 sc1
    buffer_load_dwordx4 a[44:47], v51, s[20:23], s91 offen offset:3072 sc1
    s_add_u32 s91, s91, 4096
    buffer_load_dwordx4 a[48:51], v51, s[20:23], s91 offen offset:0 sc1
    buffer_load_dwordx4 a[52:55], v51, s[20:23], s91 offen offset:1024 sc1
    buffer_load_dwordx4 a[56:59], v51, s[20:23], s91 offen offset:2048 sc1
    buffer_load_dwordx4 a[60:63], v51, s[20:23], s91 offen offset:3072 sc1
    s_add_u32 s91, s91, 4096
    buffer_load_dwordx4 a[64:67], v51, s[20:23], s91 offen offset:0 sc1
    buffer_load_dwordx4 a[68:71], v51, s[20:23], s91 offen offset:1024 sc1
    buffer_load_dwordx4 a[72:75], v51, s[20:23], s91 offen offset:2048 sc1
    buffer_load_dwordx4 a[76:79], v51, s[20:23], s91 offen offset:3072 sc1
    s_add_u32 s91, s91, 4096
    buffer_load_dwordx4 a[80:83], v51, s[20:23], s91 offen offset:0 sc1
    buffer_load_dwordx4 a[84:87], v51, s[20:23], s91 offen offset:1024 sc1
    buffer_load_dwordx4 a[88:91], v51, s[20:23], s91 offen offset:2048 sc1
    buffer_load_dwordx4 a[92:95], v51, s[20:23], s91 offen offset:3072 sc1
    s_add_u32 s91, s91, 4096
    buffer_load_dwordx4 a[96:99], v51, s[20:23], s91 offen offset:0 sc1
    buffer_load_dwordx4 a[100:103], v51, s[20:23], s91 offen offset:1024 sc1
    buffer_load_dwordx4 a[104:107], v51, s[20:23], s91 offen offset:2048 sc1
    buffer_load_dwordx4 a[108:111], v51, s[20:23], s91 offen offset:3072 sc1
    s_add_u32 s91, s91, 4096
    s_waitcnt vmcnt(27)
    v_mfma_f32_16x16x32_bf16 v[64:67], a[128:131], a[0:3], 0
    s_waitcnt vmcnt(25)
    v_mfma_f32_16x16x32_bf16 v[64:67], a[132:135], a[8:11], v[64:67]
    s_waitcnt vmcnt(23)
    v_mfma_f32_16x16x32_bf16 v[64:67], a[136:139], a[16:19], v[64:67]
    s_waitcnt vmcnt(21)
    v_mfma_f32_16x16x32_bf16 v[64:67], a[140:143], a[24:27], v[64:67]
    v_mfma_f32_16x16x32_bf16 v[68:71], a[128:131], a[4:7], 0
    v_mfma_f32_16x16x32_bf16 v[68:71], a[132:135], a[12:15], v[68:71]
    v_mfma_f32_16x16x32_bf16 v[68:71], a[136:139], a[20:23], v[68:71]
    s_waitcnt vmcnt(20)
    v_mfma_f32_16x16x32_bf16 v[68:71], a[140:143], a[28:31], v[68:71]
    v_mfma_f32_16x16x32_bf16 v[72:75], a[144:147], a[0:3], 0
    v_mfma_f32_16x16x32_bf16 v[72:75], a[148:151], a[8:11], v[72:75]
    v_mfma_f32_16x16x32_bf16 v[72:75], a[152:155], a[16:19], v[72:75]
    v_mfma_f32_16x16x32_bf16 v[72:75], a[156:159], a[24:27], v[72:75]
    v_mfma_f32_16x16x32_bf16 v[76:79], a[144:147], a[4:7], 0
    v_mfma_f32_16x16x32_bf16 v[76:79], a[148:151], a[12:15], v[76:79]
    v_mfma_f32_16x16x32_bf16 v[76:79], a[152:155], a[20:23], v[76:79]
    v_mfma_f32_16x16x32_bf16 v[76:79], a[156:159], a[28:31], v[76:79]
    s_waitcnt vmcnt(19)
    v_mfma_f32_16x16x32_bf16 v[64:67], a[160:163], a[32:35], v[64:67]
    s_waitcnt vmcnt(17)
    v_mfma_f32_16x16x32_bf16 v[64:67], a[164:167], a[40:43], v[64:67]
    s_waitcnt vmcnt(15)
    v_mfma_f32_16x16x32_bf16 v[64:67], a[168:171], a[48:51], v[64:67]
    s_waitcnt vmcnt(13)
    v_mfma_f32_16x16x32_bf16 v[64:67], a[172:175], a[56:59], v[64:67]
    v_mfma_f32_16x16x32_bf16 v[68:71], a[160:163], a[36:39], v[68:71]
    v_mfma_f32_16x16x32_bf16 v[68:71], a[164:167], a[44:47], v[68:71]
    v_mfma_f32_16x16x32_bf16 v[68:71], a[168:171], a[52:55], v[68:71]
    s_waitcnt vmcnt(12)
    v_mfma_f32_16x16x32_bf16 v[68:71], a[172:175], a[60:63], v[68:71]
    v_mfma_f32_16x16x32_bf16 v[72:75], a[176:179], a[32:35], v[72:75]
    v_mfma_f32_16x16x32_bf16 v[72:75], a[180:183], a[40:43], v[72:75]
    v_mfma_f32_16x16x32_bf16 v[72:75], a[184:187], a[48:51], v[72:75]
    v_mfma_f32_16x16x32_bf16 v[72:75], a[188:191], a[56:59], v[72:75]
    v_mfma_f32_16x16x32_bf16 v[76:79], a[176:179], a[36:39], v[76:79]
    v_mfma_f32_16x16x32_bf16 v[76:79], a[180:183], a[44:47], v[76:79]
    v_mfma_f32_16x16x32_bf16 v[76:79], a[184:187], a[52:55], v[76:79]
    v_mfma_f32_16x16x32_bf16 v[76:79], a[188:191], a[60:63], v[76:79]
    s_waitcnt vmcnt(11)
    v_mfma_f32_16x16x32_bf16 v[64:67], a[192:195], a[64:67], v[64:67]
    s_waitcnt vmcnt(9)
    v_mfma_f32_16x16x32_bf16 v[64:67], a[196:199], a[72:75], v[64:67]
    s_waitcnt vmcnt(7)
    v_mfma_f32_16x16x32_bf16 v[64:67], a[200:203], a[80:83], v[64:67]
    s_waitcnt vmcnt(5)
    v_mfma_f32_16x16x32_bf16 v[64:67], a[204:207], a[88:91], v[64:67]
    v_mfma_f32_16x16x32_bf16 v[68:71], a[192:195], a[68:71], v[68:71]
    v_mfma_f32_16x16x32_bf16 v[68:71], a[196:199], a[76:79], v[68:71]
    v_mfma_f32_16x16x32_bf16 v[68:71], a[200:203], a[84:87], v[68:71]
    s_waitcnt vmcnt(4)
    v_mfma_f32_16x16x32_bf16 v[68:71], a[204:207], a[92:95], v[68:71]
    v_mfma_f32_16x16x32_bf16 v[72:75], a[208:211], a[64:67], v[72:75]
    v_mfma_f32_16x16x32_bf16 v[72:75], a[212:215], a[72:75], v[72:75]
    v_mfma_f32_16x16x32_bf16 v[72:75], a[216:219], a[80:83], v[72:75]
    v_mfma_f32_16x16x32_bf16 v[72:75], a[220:223], a[88:91], v[72:75]
    v_mfma_f32_16x16x32_bf16 v[76:79], a[208:211], a[68:71], v[76:79]
    v_mfma_f32_16x16x32_bf16 v[76:79], a[212:215], a[76:79], v[76:79]
    v_mfma_f32_16x16x32_bf16 v[76:79], a[216:219], a[84:87], v[76:79]
    v_mfma_f32_16x16x32_bf16 v[76:79], a[220:223], a[92:95], v[76:79]
    ds_read_b64_tr_b16 a[128:129], v2 offset:50688
    s_waitcnt vmcnt(3)
    v_mfma_f32_16x16x32_bf16 v[64:67], a[224:227], a[96:99], v[64:67]
    ds_read_b64_tr_b16 a[130:131], v2 offset:52736
    s_waitcnt vmcnt(1)
    v_mfma_f32_16x16x32_bf16 v[64:67], a[228:231], a[104:107], v[64:67]
    ds_read_b64_tr_b16 a[132:133], v2 offset:54912
    v_mfma_f32_16x16x32_bf16 v[68:71], a[224:227], a[100:103], v[68:71]
    ds_read_b64_tr_b16 a[134:135], v2 offset:56960
    s_waitcnt vmcnt(0)
    v_mfma_f32_16x16x32_bf16 v[68:71], a[228:231], a[108:111], v[68:71]
    ds_read_b64_tr_b16 a[136:137], v2 offset:59136
    v_mfma_f32_16x16x32_bf16 v[72:75], a[232:235], a[96:99], v[72:75]
    ds_read_b64_tr_b16 a[138:139], v2 offset:61184
    v_mfma_f32_16x16x32_bf16 v[72:75], a[236:239], a[104:107], v[72:75]
    ds_read_b64_tr_b16 a[140:141], v2 offset:63360
    v_mfma_f32_16x16x32_bf16 v[76:79], a[232:235], a[100:103], v[76:79]
    ds_read_b64_tr_b16 a[142:143], v2 offset:65408
    v_mfma_f32_16x16x32_bf16 v[76:79], a[236:239], a[108:111], v[76:79]
    ds_read_b64_tr_b16 a[144:145], v3 offset:50688
    v_mfma_f32_16x16x32_bf16 v[80:83], a[240:243], a[0:3], 0
    ds_read_b64_tr_b16 a[146:147], v3 offset:52736
    v_mfma_f32_16x16x32_bf16 v[80:83], a[244:247], a[8:11], v[80:83]
    ds_read_b64_tr_b16 a[148:149], v3 offset:54912
    v_mfma_f32_16x16x32_bf16 v[84:87], a[240:243], a[4:7], 0
    ds_read_b64_tr_b16 a[150:151], v3 offset:56960
    v_mul_f32 v96, 0xbfb8aa3b, v64
    v_mfma_f32_16x16x32_bf16 v[84:87], a[244:247], a[12:15], v[84:87]
    ds_read_b64_tr_b16 a[152:153], v3 offset:59136
    v_mul_f32 v97, 0xbfb8aa3b, v65
    v_mfma_f32_16x16x32_bf16 v[88:91], a[248:251], a[0:3], 0
    ds_read_b64_tr_b16 a[154:155], v3 offset:61184
    v_mul_f32 v98, 0xbfb8aa3b, v66
    v_mfma_f32_16x16x32_bf16 v[88:91], a[252:255], a[8:11], v[88:91]
    ds_read_b64_tr_b16 a[156:157], v3 offset:63360
    v_mul_f32 v99, 0xbfb8aa3b, v67
    v_mfma_f32_16x16x32_bf16 v[92:95], a[248:251], a[4:7], 0
    ds_read_b64_tr_b16 a[158:159], v3 offset:65408
    v_mul_f32 v100, 0xbfb8aa3b, v72
    v_mfma_f32_16x16x32_bf16 v[92:95], a[252:255], a[12:15], v[92:95]
    s_barrier
    ds_read_b64_tr_b16 a[160:161], v8 offset:0
    v_mfma_f32_16x16x32_bf16 v[80:83], v[160:163], a[16:19], v[80:83]
    ds_read_b64_tr_b16 a[162:163], v8 offset:2048
    v_mul_f32 v101, 0xbfb8aa3b, v73
    v_mfma_f32_16x16x32_bf16 v[80:83], v[164:167], a[24:27], v[80:83]
    ds_read_b64_tr_b16 a[164:165], v8 offset:4224
    v_mul_f32 v102, 0xbfb8aa3b, v74
    v_mfma_f32_16x16x32_bf16 v[80:83], v[168:171], a[32:35], v[80:83]
    ds_read_b64_tr_b16 a[166:167], v8 offset:6272
    v_mul_f32 v103, 0xbfb8aa3b, v75
    v_mfma_f32_16x16x32_bf16 v[80:83], v[172:175], a[40:43], v[80:83]
    ds_read_b64_tr_b16 a[168:169], v8 offset:8448
    v_exp_f32 v96, v96
    v_mfma_f32_16x16x32_bf16 v[84:87], v[160:163], a[20:23], v[84:87]
    ds_read_b64_tr_b16 a[170:171], v8 offset:10496
    v_exp_f32 v97, v97
    v_mfma_f32_16x16x32_bf16 v[84:87], v[164:167], a[28:31], v[84:87]
    ds_read_b64_tr_b16 a[172:173], v8 offset:12672
    v_exp_f32 v98, v98
    v_exp_f32 v99, v99
    v_mfma_f32_16x16x32_bf16 v[84:87], v[168:171], a[36:39], v[84:87]
    ds_read_b64_tr_b16 a[174:175], v8 offset:14720
    v_exp_f32 v100, v100
    v_mfma_f32_16x16x32_bf16 v[84:87], v[172:175], a[44:47], v[84:87]
    ds_read_b64_tr_b16 a[176:177], v9 offset:0
    v_exp_f32 v101, v101
    v_exp_f32 v102, v102
    v_mfma_f32_16x16x32_bf16 v[88:91], v[176:179], a[16:19], v[88:91]
    ds_read_b64_tr_b16 a[178:179], v9 offset:2048
    v_exp_f32 v103, v103
    v_mfma_f32_16x16x32_bf16 v[88:91], v[180:183], a[24:27], v[88:91]
    ds_read_b64_tr_b16 a[180:181], v9 offset:4224
    v_add_f32 v96, 1.0, v96
    v_add_f32 v97, 1.0, v97
    v_add_f32 v98, 1.0, v98
    v_mfma_f32_16x16x32_bf16 v[88:91], v[184:187], a[32:35], v[88:91]
    ds_read_b64_tr_b16 a[182:183], v9 offset:6272
    v_add_f32 v99, 1.0, v99
    v_add_f32 v100, 1.0, v100
    v_add_f32 v101, 1.0, v101
    v_mfma_f32_16x16x32_bf16 v[88:91], v[188:191], a[40:43], v[88:91]
    ds_read_b64_tr_b16 a[184:185], v9 offset:8448
    v_add_f32 v102, 1.0, v102
    v_add_f32 v103, 1.0, v103
    v_mfma_f32_16x16x32_bf16 v[92:95], v[176:179], a[20:23], v[92:95]
    ds_read_b64_tr_b16 a[186:187], v9 offset:10496
    v_rcp_f32 v96, v96
    v_rcp_f32 v97, v97
    v_mfma_f32_16x16x32_bf16 v[92:95], v[180:183], a[28:31], v[92:95]
    ds_read_b64_tr_b16 a[188:189], v9 offset:12672
    v_rcp_f32 v98, v98
    v_mfma_f32_16x16x32_bf16 v[92:95], v[184:187], a[36:39], v[92:95]
    ds_read_b64_tr_b16 a[190:191], v9 offset:14720
    v_rcp_f32 v99, v99
    v_mfma_f32_16x16x32_bf16 v[92:95], v[188:191], a[44:47], v[92:95]
    ds_read_b64_tr_b16 a[192:193], v8 offset:16896
    v_rcp_f32 v100, v100
    v_rcp_f32 v101, v101
    v_mfma_f32_16x16x32_bf16 v[80:83], v[192:195], a[48:51], v[80:83]
    ds_read_b64_tr_b16 a[194:195], v8 offset:18944
    v_rcp_f32 v102, v102
    v_mfma_f32_16x16x32_bf16 v[80:83], v[196:199], a[56:59], v[80:83]
    ds_read_b64_tr_b16 a[196:197], v8 offset:21120
    v_rcp_f32 v103, v103
    v_mul_f32 v96, v96, v64
    v_mfma_f32_16x16x32_bf16 v[80:83], v[200:203], a[64:67], v[80:83]
    ds_read_b64_tr_b16 a[198:199], v8 offset:23168
    v_mul_f32 v97, v97, v65
    v_mul_f32 v98, v98, v66
    v_mul_f32 v99, v99, v67
    v_mfma_f32_16x16x32_bf16 v[80:83], v[204:207], a[72:75], v[80:83]
    ds_read_b64_tr_b16 a[200:201], v8 offset:25344
    v_mul_f32 v100, v100, v72
    v_mul_f32 v101, v101, v73
    v_mul_f32 v102, v102, v74
    v_mfma_f32_16x16x32_bf16 v[84:87], v[192:195], a[52:55], v[84:87]
    ds_read_b64_tr_b16 a[202:203], v8 offset:27392
    v_mul_f32 v103, v103, v75
    v_cvt_pk_bf16_f32 v128, v96, v97
    v_cvt_pk_bf16_f32 v129, v98, v99
    v_mfma_f32_16x16x32_bf16 v[84:87], v[196:199], a[60:63], v[84:87]
    ds_read_b64_tr_b16 a[204:205], v8 offset:29568
    v_cvt_pk_bf16_f32 v130, v100, v101
    v_cvt_pk_bf16_f32 v131, v102, v103
    v_mfma_f32_16x16x32_bf16 v[84:87], v[200:203], a[68:71], v[84:87]
    ds_read_b64_tr_b16 a[206:207], v8 offset:31616
    s_waitcnt lgkmcnt(14)
    ds_write_b128 v14, v[128:131] offset:0
    v_mul_f32 v104, 0xbfb8aa3b, v68
    v_mul_f32 v105, 0xbfb8aa3b, v69
    v_mfma_f32_16x16x32_bf16 v[84:87], v[204:207], a[76:79], v[84:87]
    ds_read_b64_tr_b16 a[208:209], v9 offset:16896
    v_mul_f32 v106, 0xbfb8aa3b, v70
    v_mul_f32 v107, 0xbfb8aa3b, v71
    v_mul_f32 v108, 0xbfb8aa3b, v76
    v_mfma_f32_16x16x32_bf16 v[88:91], v[208:211], a[48:51], v[88:91]
    ds_read_b64_tr_b16 a[210:211], v9 offset:18944
    v_mul_f32 v109, 0xbfb8aa3b, v77
    v_mul_f32 v110, 0xbfb8aa3b, v78
    v_mul_f32 v111, 0xbfb8aa3b, v79
    v_mfma_f32_16x16x32_bf16 v[88:91], v[212:215], a[56:59], v[88:91]
    ds_read_b64_tr_b16 a[212:213], v9 offset:21120
    v_exp_f32 v104, v104
    v_mfma_f32_16x16x32_bf16 v[88:91], v[216:219], a[64:67], v[88:91]
    ds_read_b64_tr_b16 a[214:215], v9 offset:23168
    v_exp_f32 v105, v105
    v_mfma_f32_16x16x32_bf16 v[88:91], v[220:223], a[72:75], v[88:91]
    ds_read_b64_tr_b16 a[216:217], v9 offset:25344
    v_exp_f32 v106, v106
    v_exp_f32 v107, v107
    v_mfma_f32_16x16x32_bf16 v[92:95], v[208:211], a[52:55], v[92:95]
    ds_read_b64_tr_b16 a[218:219], v9 offset:27392
    v_exp_f32 v108, v108
    v_mfma_f32_16x16x32_bf16 v[92:95], v[212:215], a[60:63], v[92:95]
    ds_read_b64_tr_b16 a[220:221], v9 offset:29568
    v_exp_f32 v109, v109
    v_exp_f32 v110, v110
    v_mfma_f32_16x16x32_bf16 v[92:95], v[216:219], a[68:71], v[92:95]
    ds_read_b64_tr_b16 a[222:223], v9 offset:31616
    v_exp_f32 v111, v111
    v_mfma_f32_16x16x32_bf16 v[92:95], v[220:223], a[76:79], v[92:95]
    v_add_f32 v104, 1.0, v104
    v_add_f32 v105, 1.0, v105
    v_add_f32 v106, 1.0, v106
    v_mfma_f32_16x16x32_bf16 v[80:83], v[224:227], a[80:83], v[80:83]
    v_add_f32 v107, 1.0, v107
    v_add_f32 v108, 1.0, v108
    v_add_f32 v109, 1.0, v109
    v_mfma_f32_16x16x32_bf16 v[80:83], v[228:231], a[88:91], v[80:83]
    v_add_f32 v110, 1.0, v110
    v_add_f32 v111, 1.0, v111
    v_mfma_f32_16x16x32_bf16 v[80:83], v[232:235], a[96:99], v[80:83]
    v_rcp_f32 v104, v104
    v_rcp_f32 v105, v105
    v_mfma_f32_16x16x32_bf16 v[80:83], v[236:239], a[104:107], v[80:83]
    v_rcp_f32 v106, v106
    v_mfma_f32_16x16x32_bf16 v[84:87], v[224:227], a[84:87], v[84:87]
    v_rcp_f32 v107, v107
    v_mfma_f32_16x16x32_bf16 v[84:87], v[228:231], a[92:95], v[84:87]
    v_rcp_f32 v108, v108
    v_rcp_f32 v109, v109
    v_mfma_f32_16x16x32_bf16 v[84:87], v[232:235], a[100:103], v[84:87]
    v_rcp_f32 v110, v110
    v_rcp_f32 v111, v111
    v_mul_f32 v104, v104, v68
    v_mul_f32 v105, v105, v69
    v_mul_f32 v106, v106, v70
    v_mul_f32 v107, v107, v71
    v_mul_f32 v108, v108, v76
    v_mul_f32 v109, v109, v77
    v_mul_f32 v110, v110, v78
    v_mul_f32 v111, v111, v79
    v_cvt_pk_bf16_f32 v132, v104, v105
    v_cvt_pk_bf16_f32 v133, v106, v107
    v_cvt_pk_bf16_f32 v134, v108, v109
    v_cvt_pk_bf16_f32 v135, v110, v111
    s_waitcnt lgkmcnt(14)
    ds_write_b128 v14, v[132:135] offset:1024
    v_mfma_f32_16x16x32_bf16 v[84:87], v[236:239], a[108:111], v[84:87]
    s_waitcnt lgkmcnt(0)
    s_barrier
    ds_read_b64_tr_b16 a[224:225], v8 offset:33792
    v_mfma_f32_16x16x32_bf16 v[88:91], v[240:243], a[80:83], v[88:91]
    ds_read_b64_tr_b16 a[226:227], v8 offset:35840
    ds_read_b128 v[136:139], v15 offset:0
    v_mfma_f32_16x16x32_bf16 v[88:91], v[244:247], a[88:91], v[88:91]
    ds_read_b64_tr_b16 a[228:229], v8 offset:38016
    s_add_u32 m0, s57, 50688
    v_mfma_f32_16x16x32_bf16 v[88:91], v[248:251], a[96:99], v[88:91]
    ds_read_b64_tr_b16 a[230:231], v8 offset:40064
    ds_read_b128 v[140:143], v15 offset:1024
    v_mfma_f32_16x16x32_bf16 v[88:91], v[252:255], a[104:107], v[88:91]
    ds_read_b64_tr_b16 a[232:233], v9 offset:33792
    s_mov_b32 s48, 128
    v_mfma_f32_16x16x32_bf16 v[92:95], v[240:243], a[84:87], v[92:95]
    ds_read_b64_tr_b16 a[234:235], v9 offset:35840
    buffer_load_dwordx4 v26, s[36:39], s48 offen offset:0 lds
    v_mfma_f32_16x16x32_bf16 v[92:95], v[244:247], a[92:95], v[92:95]
    ds_read_b64_tr_b16 a[236:237], v9 offset:38016
    buffer_load_dwordx4 v27, s[36:39], s48 offen offset:1024 lds
    v_mfma_f32_16x16x32_bf16 v[92:95], v[248:251], a[100:103], v[92:95]
    ds_read_b64_tr_b16 a[238:239], v9 offset:40064
    buffer_load_dwordx4 v28, s[36:39], s48 offen offset:2048 lds
    v_mfma_f32_16x16x32_bf16 v[92:95], v[252:255], a[108:111], v[92:95]
    ds_read_b64_tr_b16 a[240:241], v8 offset:42240
    v_mfma_f32_16x16x32_bf16 v[64:67], a[128:131], a[0:3], 0
    ds_read_b64_tr_b16 a[242:243], v8 offset:44288
    buffer_load_dwordx4 v29, s[36:39], s48 offen offset:3072 lds
    v_mfma_f32_16x16x32_bf16 v[64:67], a[132:135], a[8:11], v[64:67]
    ds_read_b64_tr_b16 a[244:245], v8 offset:46464
    s_add_u32 m0, s57, 67584
    v_mfma_f32_16x16x32_bf16 v[64:67], a[136:139], a[16:19], v[64:67]
    ds_read_b64_tr_b16 a[246:247], v8 offset:48512
    v_mul_f32 v96, 0xbfb8aa3b, v80
    v_mfma_f32_16x16x32_bf16 v[64:67], a[140:143], a[24:27], v[64:67]
    ds_read_b64_tr_b16 a[248:249], v9 offset:42240
    v_mul_f32 v97, 0xbfb8aa3b, v81
    v_mfma_f32_16x16x32_bf16 v[68:71], a[128:131], a[4:7], 0
    ds_read_b64_tr_b16 a[250:251], v9 offset:44288
    v_mul_f32 v98, 0xbfb8aa3b, v82
    v_mfma_f32_16x16x32_bf16 v[68:71], a[132:135], a[12:15], v[68:71]
    ds_read_b64_tr_b16 a[252:253], v9 offset:46464
    v_mul_f32 v99, 0xbfb8aa3b, v83
    v_mfma_f32_16x16x32_bf16 v[68:71], a[136:139], a[20:23], v[68:71]
    ds_read_b64_tr_b16 a[254:255], v9 offset:48512
    v_mul_f32 v100, 0xbfb8aa3b, v88
    v_mfma_f32_16x16x32_bf16 v[68:71], a[140:143], a[28:31], v[68:71]
    ds_read_b64_tr_b16 a[128:129], v8 offset:50688
    v_mul_f32 v101, 0xbfb8aa3b, v89
    v_mfma_f32_16x16x32_bf16 v[72:75], a[144:147], a[0:3], 0
    ds_read_b64_tr_b16 a[130:131], v8 offset:52736
    v_mul_f32 v102, 0xbfb8aa3b, v90
    v_mfma_f32_16x16x32_bf16 v[72:75], a[148:151], a[8:11], v[72:75]
    ds_read_b64_tr_b16 a[132:133], v8 offset:54912
    v_mul_f32 v103, 0xbfb8aa3b, v91
    v_mfma_f32_16x16x32_bf16 v[72:75], a[152:155], a[16:19], v[72:75]
    ds_read_b64_tr_b16 a[134:135], v8 offset:56960
    s_mov_b32 s48, 256
    v_mfma_f32_16x16x32_bf16 v[72:75], a[156:159], a[24:27], v[72:75]
    ds_read_b64_tr_b16 a[136:137], v8 offset:59136
    buffer_load_dwordx4 v26, s[36:39], s48 offen offset:0 lds
    v_mfma_f32_16x16x32_bf16 v[76:79], a[144:147], a[4:7], 0
    ds_read_b64_tr_b16 a[138:139], v8 offset:61184
    v_exp_f32 v96, v96
    v_mfma_f32_16x16x32_bf16 v[76:79], a[148:151], a[12:15], v[76:79]
    ds_read_b64_tr_b16 a[140:141], v8 offset:63360
    v_exp_f32 v97, v97
    v_exp_f32 v98, v98
    v_mfma_f32_16x16x32_bf16 v[76:79], a[152:155], a[20:23], v[76:79]
    ds_read_b64_tr_b16 a[142:143], v8 offset:65408
    buffer_load_dwordx4 v27, s[36:39], s48 offen offset:1024 lds
    v_exp_f32 v99, v99
    v_mfma_f32_16x16x32_bf16 v[76:79], a[156:159], a[28:31], v[76:79]
    ds_read_b64_tr_b16 a[144:145], v9 offset:50688
    buffer_load_dwordx4 v28, s[36:39], s48 offen offset:2048 lds
    v_exp_f32 v100, v100
    v_mfma_f32_16x16x32_bf16 v[64:67], a[160:163], a[32:35], v[64:67]
    ds_read_b64_tr_b16 a[146:147], v9 offset:52736
    v_exp_f32 v101, v101
    v_mfma_f32_16x16x32_bf16 v[64:67], a[164:167], a[40:43], v[64:67]
    ds_read_b64_tr_b16 a[148:149], v9 offset:54912
    buffer_load_dwordx4 v29, s[36:39], s48 offen offset:3072 lds
    v_exp_f32 v102, v102
    v_mfma_f32_16x16x32_bf16 v[64:67], a[168:171], a[48:51], v[64:67]
    ds_read_b64_tr_b16 a[150:151], v9 offset:56960
    s_add_u32 m0, s57, 84480
    v_exp_f32 v103, v103
    v_add_f32 v96, 1.0, v96
    v_mfma_f32_16x16x32_bf16 v[64:67], a[172:175], a[56:59], v[64:67]
    ds_read_b64_tr_b16 a[152:153], v9 offset:59136
    v_add_f32 v97, 1.0, v97
    v_add_f32 v98, 1.0, v98
    v_add_f32 v99, 1.0, v99
    v_mfma_f32_16x16x32_bf16 v[68:71], a[160:163], a[36:39], v[68:71]
    ds_read_b64_tr_b16 a[154:155], v9 offset:61184
    s_mov_b32 s48, 384
    v_add_f32 v100, 1.0, v100
    v_add_f32 v101, 1.0, v101
    v_mfma_f32_16x16x32_bf16 v[68:71], a[164:167], a[44:47], v[68:71]
    ds_read_b64_tr_b16 a[156:157], v9 offset:63360
    buffer_load_dwordx4 v26, s[36:39], s48 offen offset:0 lds
    buffer_load_dwordx4 v27, s[36:39], s48 offen offset:1024 lds
    buffer_load_dwordx4 v28, s[36:39], s48 offen offset:2048 lds
    buffer_load_dwordx4 v29, s[36:39], s48 offen offset:3072 lds
    v_add_f32 v102, 1.0, v102
    v_add_f32 v103, 1.0, v103
    v_mfma_f32_16x16x32_bf16 v[68:71], a[168:171], a[52:55], v[68:71]
    ds_read_b64_tr_b16 a[158:159], v9 offset:65408
    v_rcp_f32 v96, v96
    v_mfma_f32_16x16x32_bf16 v[68:71], a[172:175], a[60:63], v[68:71]
    s_waitcnt lgkmcnt(15)
    s_barrier
    ds_read_b64_tr_b16 a[160:161], v2 offset:0
    v_rcp_f32 v97, v97
    v_mfma_f32_16x16x32_bf16 v[72:75], a[176:179], a[32:35], v[72:75]
    ds_read_b64_tr_b16 a[162:163], v2 offset:2048
    v_rcp_f32 v98, v98
    v_mfma_f32_16x16x32_bf16 v[72:75], a[180:183], a[40:43], v[72:75]
    ds_read_b64_tr_b16 a[164:165], v2 offset:4224
    v_rcp_f32 v99, v99
    v_rcp_f32 v100, v100
    v_mfma_f32_16x16x32_bf16 v[72:75], a[184:187], a[48:51], v[72:75]
    ds_read_b64_tr_b16 a[166:167], v2 offset:6272
    v_rcp_f32 v101, v101
    v_mfma_f32_16x16x32_bf16 v[72:75], a[188:191], a[56:59], v[72:75]
    ds_read_b64_tr_b16 a[168:169], v2 offset:8448
    v_rcp_f32 v102, v102
    v_mfma_f32_16x16x32_bf16 v[76:79], a[176:179], a[36:39], v[76:79]
    ds_read_b64_tr_b16 a[170:171], v2 offset:10496
    v_rcp_f32 v103, v103
    v_mul_f32 v96, v96, v80
    v_mfma_f32_16x16x32_bf16 v[76:79], a[180:183], a[44:47], v[76:79]
    ds_read_b64_tr_b16 a[172:173], v2 offset:12672
    v_mul_f32 v97, v97, v81
    v_mul_f32 v98, v98, v82
    v_mfma_f32_16x16x32_bf16 v[76:79], a[184:187], a[52:55], v[76:79]
    ds_read_b64_tr_b16 a[174:175], v2 offset:14720
    v_mul_f32 v99, v99, v83
    v_mul_f32 v100, v100, v88
    v_mfma_f32_16x16x32_bf16 v[76:79], a[188:191], a[60:63], v[76:79]
    ds_read_b64_tr_b16 a[176:177], v3 offset:0
    v_mul_f32 v101, v101, v89
    v_mul_f32 v102, v102, v90
    v_mul_f32 v103, v103, v91
    v_mfma_f32_16x16x32_bf16 v[64:67], a[192:195], a[64:67], v[64:67]
    ds_read_b64_tr_b16 a[178:179], v3 offset:2048
    v_cvt_pk_bf16_f32 v144, v96, v97
    v_cvt_pk_bf16_f32 v145, v98, v99
    v_mfma_f32_16x16x32_bf16 v[64:67], a[196:199], a[72:75], v[64:67]
    ds_read_b64_tr_b16 a[180:181], v3 offset:4224
    v_cvt_pk_bf16_f32 v146, v100, v101
    v_cvt_pk_bf16_f32 v147, v102, v103
    v_mfma_f32_16x16x32_bf16 v[64:67], a[200:203], a[80:83], v[64:67]
    ds_read_b64_tr_b16 a[182:183], v3 offset:6272
    s_add_u32 m0, s57, 101376
    s_waitcnt lgkmcnt(14)
    ds_write_b128 v14, v[144:147] offset:8192
    v_mul_f32 v104, 0xbfb8aa3b, v84
    v_mul_f32 v105, 0xbfb8aa3b, v85
    v_mfma_f32_16x16x32_bf16 v[64:67], a[204:207], a[88:91], v[64:67]
    ds_read_b64_tr_b16 a[184:185], v3 offset:8448
    v_mul_f32 v106, 0xbfb8aa3b, v86
    v_mul_f32 v107, 0xbfb8aa3b, v87
    v_mfma_f32_16x16x32_bf16 v[68:71], a[192:195], a[68:71], v[68:71]
    ds_read_b64_tr_b16 a[186:187], v3 offset:10496
    v_mul_f32 v108, 0xbfb8aa3b, v92
    v_mul_f32 v109, 0xbfb8aa3b, v93
    v_mul_f32 v110, 0xbfb8aa3b, v94
    v_mfma_f32_16x16x32_bf16 v[68:71], a[196:199], a[76:79], v[68:71]
    ds_read_b64_tr_b16 a[188:189], v3 offset:12672
    v_mul_f32 v111, 0xbfb8aa3b, v95
    v_mfma_f32_16x16x32_bf16 v[68:71], a[200:203], a[84:87], v[68:71]
    ds_read_b64_tr_b16 a[190:191], v3 offset:14720
    v_exp_f32 v104, v104
    v_mfma_f32_16x16x32_bf16 v[68:71], a[204:207], a[92:95], v[68:71]
    ds_read_b64_tr_b16 a[192:193], v2 offset:16896
    s_mov_b32 s48, 114688
    v_exp_f32 v105, v105
    v_exp_f32 v106, v106
    v_mfma_f32_16x16x32_bf16 v[72:75], a[208:211], a[64:67], v[72:75]
    ds_read_b64_tr_b16 a[194:195], v2 offset:18944
    v_exp_f32 v107, v107
    v_mfma_f32_16x16x32_bf16 v[72:75], a[212:215], a[72:75], v[72:75]
    ds_read_b64_tr_b16 a[196:197], v2 offset:21120
    v_exp_f32 v108, v108
    v_mfma_f32_16x16x32_bf16 v[72:75], a[216:219], a[80:83], v[72:75]
    ds_read_b64_tr_b16 a[198:199], v2 offset:23168
    v_exp_f32 v109, v109
    v_mfma_f32_16x16x32_bf16 v[72:75], a[220:223], a[88:91], v[72:75]
    ds_read_b64_tr_b16 a[200:201], v2 offset:25344
    v_exp_f32 v110, v110
    v_mfma_f32_16x16x32_bf16 v[76:79], a[208:211], a[68:71], v[76:79]
    ds_read_b64_tr_b16 a[202:203], v2 offset:27392
    buffer_load_dwordx4 v26, s[36:39], s48 offen offset:0 lds
    v_exp_f32 v111, v111
    v_add_f32 v104, 1.0, v104
    v_mfma_f32_16x16x32_bf16 v[76:79], a[212:215], a[76:79], v[76:79]
    ds_read_b64_tr_b16 a[204:205], v2 offset:29568
    v_add_f32 v105, 1.0, v105
    v_add_f32 v106, 1.0, v106
    v_add_f32 v107, 1.0, v107
    v_mfma_f32_16x16x32_bf16 v[76:79], a[216:219], a[84:87], v[76:79]
    ds_read_b64_tr_b16 a[206:207], v2 offset:31616
    v_add_f32 v108, 1.0, v108
    v_add_f32 v109, 1.0, v109
    v_mfma_f32_16x16x32_bf16 v[76:79], a[220:223], a[92:95], v[76:79]
    ds_read_b64_tr_b16 a[208:209], v3 offset:16896
    v_add_f32 v110, 1.0, v110
    v_add_f32 v111, 1.0, v111
    v_mfma_f32_16x16x32_bf16 v[64:67], a[224:227], a[96:99], v[64:67]
    ds_read_b64_tr_b16 a[210:211], v3 offset:18944
    v_rcp_f32 v104, v104
    v_mfma_f32_16x16x32_bf16 v[64:67], a[228:231], a[104:107], v[64:67]
    ds_read_b64_tr_b16 a[212:213], v3 offset:21120
    buffer_load_dwordx4 v27, s[36:39], s48 offen offset:1024 lds
    v_rcp_f32 v105, v105
    v_mfma_f32_16x16x32_bf16 v[68:71], a[224:227], a[100:103], v[68:71]
    ds_read_b64_tr_b16 a[214:215], v3 offset:23168
    v_rcp_f32 v106, v106
    v_mfma_f32_16x16x32_bf16 v[68:71], a[228:231], a[108:111], v[68:71]
    ds_read_b64_tr_b16 a[216:217], v3 offset:25344
    v_rcp_f32 v107, v107
    v_rcp_f32 v108, v108
    v_mfma_f32_16x16x32_bf16 v[72:75], a[232:235], a[96:99], v[72:75]
    ds_read_b64_tr_b16 a[218:219], v3 offset:27392
    v_rcp_f32 v109, v109
    v_mfma_f32_16x16x32_bf16 v[72:75], a[236:239], a[104:107], v[72:75]
    ds_read_b64_tr_b16 a[220:221], v3 offset:29568
    buffer_load_dwordx4 v28, s[36:39], s48 offen offset:2048 lds
    buffer_load_dwordx4 v29, s[36:39], s48 offen offset:3072 lds
    v_rcp_f32 v110, v110
    v_mfma_f32_16x16x32_bf16 v[76:79], a[232:235], a[100:103], v[76:79]
    ds_read_b64_tr_b16 a[222:223], v3 offset:31616
    v_rcp_f32 v111, v111
    v_mul_f32 v104, v104, v84
    v_mul_f32 v105, v105, v85
    v_mul_f32 v106, v106, v86
    v_mul_f32 v107, v107, v87
    v_mul_f32 v108, v108, v92
    v_mul_f32 v109, v109, v93
    v_mul_f32 v110, v110, v94
    v_mul_f32 v111, v111, v95
    v_cvt_pk_bf16_f32 v148, v104, v105
    v_cvt_pk_bf16_f32 v149, v106, v107
    v_cvt_pk_bf16_f32 v150, v108, v109
    v_cvt_pk_bf16_f32 v151, v110, v111
    s_waitcnt lgkmcnt(14)
    ds_write_b128 v14, v[148:151] offset:9216
    v_mfma_f32_16x16x32_bf16 v[76:79], a[236:239], a[108:111], v[76:79]
    s_waitcnt vmcnt(12) lgkmcnt(0)
    s_barrier
    ds_read_b64_tr_b16 a[224:225], v4 offset:33792
    v_mfma_f32_16x16x32_bf16 v[80:83], a[240:243], a[0:3], 0
    ds_read_b64_tr_b16 a[226:227], v4 offset:35840
    ds_read_b128 v[152:155], v15 offset:8192
    v_mfma_f32_16x16x32_bf16 v[80:83], a[244:247], a[8:11], v[80:83]
    ds_read_b64_tr_b16 a[228:229], v6 offset:33792
    ds_read_b128 v[156:159], v15 offset:9216
    v_mfma_f32_16x16x32_bf16 v[84:87], a[240:243], a[4:7], 0
    ds_read_b64_tr_b16 a[230:231], v6 offset:35840
    v_mul_f32 v96, 0xbfb8aa3b, v64
    v_mfma_f32_16x16x32_bf16 v[84:87], a[244:247], a[12:15], v[84:87]
    ds_read_b64_tr_b16 a[232:233], v4 offset:42240
    v_mul_f32 v97, 0xbfb8aa3b, v65
    v_mfma_f32_16x16x32_bf16 v[88:91], a[248:251], a[0:3], 0
    ds_read_b64_tr_b16 a[234:235], v4 offset:44288
    v_mul_f32 v98, 0xbfb8aa3b, v66
    v_mfma_f32_16x16x32_bf16 v[88:91], a[252:255], a[8:11], v[88:91]
    ds_read_b64_tr_b16 a[236:237], v6 offset:42240
    v_mul_f32 v99, 0xbfb8aa3b, v67
    v_mfma_f32_16x16x32_bf16 v[92:95], a[248:251], a[4:7], 0
    ds_read_b64_tr_b16 a[238:239], v6 offset:44288
    v_mul_f32 v100, 0xbfb8aa3b, v72
    v_mfma_f32_16x16x32_bf16 v[92:95], a[252:255], a[12:15], v[92:95]
    ds_read_b64_tr_b16 a[240:241], v5 offset:33792
    v_mfma_f32_16x16x32_bf16 v[80:83], a[128:131], a[16:19], v[80:83]
    ds_read_b64_tr_b16 a[242:243], v5 offset:35840
    s_add_u32 m0, s57, 118272
    v_mfma_f32_16x16x32_bf16 v[80:83], a[132:135], a[24:27], v[80:83]
    ds_read_b64_tr_b16 a[244:245], v7 offset:33792
    v_mul_f32 v101, 0xbfb8aa3b, v73
    v_mfma_f32_16x16x32_bf16 v[80:83], a[136:139], a[32:35], v[80:83]
    ds_read_b64_tr_b16 a[246:247], v7 offset:35840
    s_mov_b32 s48, 114816
    v_mfma_f32_16x16x32_bf16 v[80:83], a[140:143], a[40:43], v[80:83]
    ds_read_b64_tr_b16 a[248:249], v5 offset:42240
    v_mul_f32 v102, 0xbfb8aa3b, v74
    v_mul_f32 v103, 0xbfb8aa3b, v75
    v_mfma_f32_16x16x32_bf16 v[84:87], a[128:131], a[20:23], v[84:87]
    ds_read_b64_tr_b16 a[250:251], v5 offset:44288
    v_exp_f32 v96, v96
    v_mfma_f32_16x16x32_bf16 v[84:87], a[132:135], a[28:31], v[84:87]
    ds_read_b64_tr_b16 a[252:253], v7 offset:42240
    buffer_load_dwordx4 v26, s[36:39], s48 offen offset:0 lds
    v_exp_f32 v97, v97
    v_mfma_f32_16x16x32_bf16 v[84:87], a[136:139], a[36:39], v[84:87]
    ds_read_b64_tr_b16 a[254:255], v7 offset:44288
    v_exp_f32 v98, v98
    v_mfma_f32_16x16x32_bf16 v[84:87], a[140:143], a[44:47], v[84:87]
    ds_read_b64_tr_b16 a[128:129], v4 offset:50688
    buffer_load_dwordx4 v27, s[36:39], s48 offen offset:1024 lds
    v_exp_f32 v99, v99
    v_mfma_f32_16x16x32_bf16 v[88:91], a[144:147], a[16:19], v[88:91]
    ds_read_b64_tr_b16 a[130:131], v4 offset:52736
    v_exp_f32 v100, v100
    v_mfma_f32_16x16x32_bf16 v[88:91], a[148:151], a[24:27], v[88:91]
    ds_read_b64_tr_b16 a[132:133], v6 offset:50688
    v_exp_f32 v101, v101
    v_mfma_f32_16x16x32_bf16 v[88:91], a[152:155], a[32:35], v[88:91]
    ds_read_b64_tr_b16 a[134:135], v6 offset:52736
    buffer_load_dwordx4 v28, s[36:39], s48 offen offset:2048 lds
    v_exp_f32 v102, v102
    v_mfma_f32_16x16x32_bf16 v[88:91], a[156:159], a[40:43], v[88:91]
    ds_read_b64_tr_b16 a[136:137], v4 offset:59136
    v_exp_f32 v103, v103
    v_mfma_f32_16x16x32_bf16 v[92:95], a[144:147], a[20:23], v[92:95]
    ds_read_b64_tr_b16 a[138:139], v4 offset:61184
    buffer_load_dwordx4 v29, s[36:39], s48 offen offset:3072 lds
    v_add_f32 v96, 1.0, v96
    v_add_f32 v97, 1.0, v97
    v_mfma_f32_16x16x32_bf16 v[92:95], a[148:151], a[28:31], v[92:95]
    ds_read_b64_tr_b16 a[140:141], v6 offset:59136
    v_add_f32 v98, 1.0, v98
    v_add_f32 v99, 1.0, v99
    v_mfma_f32_16x16x32_bf16 v[92:95], a[152:155], a[36:39], v[92:95]
    ds_read_b64_tr_b16 a[142:143], v6 offset:61184
    s_add_u32 m0, s57, 0
    v_add_f32 v100, 1.0, v100
    v_add_f32 v101, 1.0, v101
    v_mfma_f32_16x16x32_bf16 v[92:95], a[156:159], a[44:47], v[92:95]
    ds_read_b64_tr_b16 a[144:145], v5 offset:50688
    v_add_f32 v102, 1.0, v102
    v_add_f32 v103, 1.0, v103
    v_mfma_f32_16x16x32_bf16 v[80:83], a[160:163], a[48:51], v[80:83]
    ds_read_b64_tr_b16 a[146:147], v5 offset:52736
    v_rcp_f32 v96, v96
    v_mfma_f32_16x16x32_bf16 v[80:83], a[164:167], a[56:59], v[80:83]
    ds_read_b64_tr_b16 a[148:149], v7 offset:50688
    s_mov_b32 s48, 114944
    v_rcp_f32 v97, v97
    v_mfma_f32_16x16x32_bf16 v[80:83], a[168:171], a[64:67], v[80:83]
    ds_read_b64_tr_b16 a[150:151], v7 offset:52736
    v_rcp_f32 v98, v98
    v_mfma_f32_16x16x32_bf16 v[80:83], a[172:175], a[72:75], v[80:83]
    ds_read_b64_tr_b16 a[152:153], v5 offset:59136
    buffer_load_dwordx4 v26, s[36:39], s48 offen offset:0 lds
    v_rcp_f32 v99, v99
    v_mfma_f32_16x16x32_bf16 v[84:87], a[160:163], a[52:55], v[84:87]
    ds_read_b64_tr_b16 a[154:155], v5 offset:61184
    v_rcp_f32 v100, v100
    v_mfma_f32_16x16x32_bf16 v[84:87], a[164:167], a[60:63], v[84:87]
    ds_read_b64_tr_b16 a[156:157], v7 offset:59136
    buffer_load_dwordx4 v27, s[36:39], s48 offen offset:1024 lds
    buffer_load_dwordx4 v28, s[36:39], s48 offen offset:2048 lds
    buffer_load_dwordx4 v29, s[36:39], s48 offen offset:3072 lds
    v_rcp_f32 v101, v101
    v_mfma_f32_16x16x32_bf16 v[84:87], a[168:171], a[68:71], v[84:87]
    ds_read_b64_tr_b16 a[158:159], v7 offset:61184
    v_rcp_f32 v102, v102
    v_mfma_f32_16x16x32_bf16 v[84:87], a[172:175], a[76:79], v[84:87]
    s_waitcnt vmcnt(12) lgkmcnt(15)
    s_barrier
    ds_read_b64_tr_b16 a[160:161], v10 offset:0
    v_rcp_f32 v103, v103
    v_mfma_f32_16x16x32_bf16 v[88:91], a[176:179], a[48:51], v[88:91]
    ds_read_b64_tr_b16 a[162:163], v10 offset:2048
    v_mul_f32 v96, v96, v64
    v_mul_f32 v97, v97, v65
    v_mfma_f32_16x16x32_bf16 v[88:91], a[180:183], a[56:59], v[88:91]
    ds_read_b64_tr_b16 a[164:165], v12 offset:0
    v_mul_f32 v98, v98, v66
    v_mul_f32 v99, v99, v67
    v_mfma_f32_16x16x32_bf16 v[88:91], a[184:187], a[64:67], v[88:91]
    ds_read_b64_tr_b16 a[166:167], v12 offset:2048
    v_mul_f32 v100, v100, v72
    v_mul_f32 v101, v101, v73
    v_mfma_f32_16x16x32_bf16 v[88:91], a[188:191], a[72:75], v[88:91]
    ds_read_b64_tr_b16 a[168:169], v10 offset:8448
    v_mul_f32 v102, v102, v74
    v_mul_f32 v103, v103, v75
    v_mfma_f32_16x16x32_bf16 v[92:95], a[176:179], a[52:55], v[92:95]
    ds_read_b64_tr_b16 a[170:171], v10 offset:10496
    v_cvt_pk_bf16_f32 v160, v96, v97
    v_cvt_pk_bf16_f32 v161, v98, v99
    v_mfma_f32_16x16x32_bf16 v[92:95], a[180:183], a[60:63], v[92:95]
    ds_read_b64_tr_b16 a[172:173], v12 offset:8448
    v_cvt_pk_bf16_f32 v162, v100, v101
    v_cvt_pk_bf16_f32 v163, v102, v103
    v_mfma_f32_16x16x32_bf16 v[92:95], a[184:187], a[68:71], v[92:95]
    ds_read_b64_tr_b16 a[174:175], v12 offset:10496
    s_waitcnt lgkmcnt(14)
    ds_write_b128 v14, v[160:163] offset:16384
    v_mul_f32 v104, 0xbfb8aa3b, v68
    v_mul_f32 v105, 0xbfb8aa3b, v69
    v_mfma_f32_16x16x32_bf16 v[92:95], a[188:191], a[76:79], v[92:95]
    ds_read_b64_tr_b16 a[176:177], v11 offset:0
    v_mul_f32 v106, 0xbfb8aa3b, v70
    v_mul_f32 v107, 0xbfb8aa3b, v71
    v_mfma_f32_16x16x32_bf16 v[80:83], a[192:195], a[80:83], v[80:83]
    ds_read_b64_tr_b16 a[178:179], v11 offset:2048
    s_add_u32 m0, s57, 16896
    v_mul_f32 v108, 0xbfb8aa3b, v76
    v_mul_f32 v109, 0xbfb8aa3b, v77
    v_mfma_f32_16x16x32_bf16 v[80:83], a[196:199], a[88:91], v[80:83]
    ds_read_b64_tr_b16 a[180:181], v13 offset:0
    v_mul_f32 v110, 0xbfb8aa3b, v78
    v_mul_f32 v111, 0xbfb8aa3b, v79
    v_mfma_f32_16x16x32_bf16 v[80:83], a[200:203], a[96:99], v[80:83]
    ds_read_b64_tr_b16 a[182:183], v13 offset:2048
    s_mov_b32 s48, 115072
    v_exp_f32 v104, v104
    v_mfma_f32_16x16x32_bf16 v[80:83], a[204:207], a[104:107], v[80:83]
    ds_read_b64_tr_b16 a[184:185], v11 offset:8448
    v_exp_f32 v105, v105
    v_mfma_f32_16x16x32_bf16 v[84:87], a[192:195], a[84:87], v[84:87]
    ds_read_b64_tr_b16 a[186:187], v11 offset:10496
    v_exp_f32 v106, v106
    v_mfma_f32_16x16x32_bf16 v[84:87], a[196:199], a[92:95], v[84:87]
    ds_read_b64_tr_b16 a[188:189], v13 offset:8448
    buffer_load_dwordx4 v26, s[36:39], s48 offen offset:0 lds
    v_exp_f32 v107, v107
    v_mfma_f32_16x16x32_bf16 v[84:87], a[200:203], a[100:103], v[84:87]
    ds_read_b64_tr_b16 a[190:191], v13 offset:10496
    v_exp_f32 v108, v108
    v_mfma_f32_16x16x32_bf16 v[84:87], a[204:207], a[108:111], v[84:87]
    ds_read_b64_tr_b16 a[192:193], v10 offset:16896
    buffer_load_dwordx4 v27, s[36:39], s48 offen offset:1024 lds
    v_exp_f32 v109, v109
    v_mfma_f32_16x16x32_bf16 v[88:91], a[208:211], a[80:83], v[88:91]
    ds_read_b64_tr_b16 a[194:195], v10 offset:18944
    v_exp_f32 v110, v110
    v_mfma_f32_16x16x32_bf16 v[88:91], a[212:215], a[88:91], v[88:91]
    ds_read_b64_tr_b16 a[196:197], v12 offset:16896
    v_exp_f32 v111, v111
    v_mfma_f32_16x16x32_bf16 v[88:91], a[216:219], a[96:99], v[88:91]
    ds_read_b64_tr_b16 a[198:199], v12 offset:18944
    buffer_load_dwordx4 v28, s[36:39], s48 offen offset:2048 lds
    v_add_f32 v104, 1.0, v104
    v_add_f32 v105, 1.0, v105
    v_mfma_f32_16x16x32_bf16 v[88:91], a[220:223], a[104:107], v[88:91]
    ds_read_b64_tr_b16 a[200:201], v10 offset:25344
    v_add_f32 v106, 1.0, v106
    v_add_f32 v107, 1.0, v107
    v_mfma_f32_16x16x32_bf16 v[92:95], a[208:211], a[84:87], v[92:95]
    ds_read_b64_tr_b16 a[202:203], v10 offset:27392
    buffer_load_dwordx4 v29, s[36:39], s48 offen offset:3072 lds
    v_add_f32 v108, 1.0, v108
    v_add_f32 v109, 1.0, v109
    v_mfma_f32_16x16x32_bf16 v[92:95], a[212:215], a[92:95], v[92:95]
    ds_read_b64_tr_b16 a[204:205], v12 offset:25344
    v_add_f32 v110, 1.0, v110
    v_add_f32 v111, 1.0, v111
    v_mfma_f32_16x16x32_bf16 v[92:95], a[216:219], a[100:103], v[92:95]
    ds_read_b64_tr_b16 a[206:207], v12 offset:27392
    s_add_u32 m0, s57, 33792
    v_rcp_f32 v104, v104
    v_mfma_f32_16x16x32_bf16 v[92:95], a[220:223], a[108:111], v[92:95]
    ds_read_b64_tr_b16 a[208:209], v11 offset:16896
    v_rcp_f32 v105, v105
    v_mfma_f32_16x16x32_bf16 v[192:195], a[224:227], v[128:131], 0
    ds_read_b64_tr_b16 a[210:211], v11 offset:18944
    v_rcp_f32 v106, v106
    v_mfma_f32_16x16x32_bf16 v[192:195], a[228:231], v[136:139], v[192:195]
    ds_read_b64_tr_b16 a[212:213], v13 offset:16896
    s_mov_b32 s48, 512
    v_rcp_f32 v107, v107
    v_mfma_f32_16x16x32_bf16 v[192:195], a[232:235], v[144:147], v[192:195]
    ds_read_b64_tr_b16 a[214:215], v13 offset:18944
    v_rcp_f32 v108, v108
    v_mfma_f32_16x16x32_bf16 v[192:195], a[236:239], v[152:155], v[192:195]
    ds_read_b64_tr_b16 a[216:217], v11 offset:25344
    buffer_load_dwordx4 v26, s[36:39], s48 offen offset:0 lds
    v_rcp_f32 v109, v109
    v_mfma_f32_16x16x32_bf16 v[196:199], a[224:227], v[132:135], 0
    ds_read_b64_tr_b16 a[218:219], v11 offset:27392
    v_rcp_f32 v110, v110
    v_mfma_f32_16x16x32_bf16 v[196:199], a[228:231], v[140:143], v[196:199]
    ds_read_b64_tr_b16 a[220:221], v13 offset:25344
    buffer_load_dwordx4 v27, s[36:39], s48 offen offset:1024 lds
    buffer_load_dwordx4 v28, s[36:39], s48 offen offset:2048 lds
    buffer_load_dwordx4 v29, s[36:39], s48 offen offset:3072 lds
    v_rcp_f32 v111, v111
    v_mfma_f32_16x16x32_bf16 v[196:199], a[232:235], v[148:151], v[196:199]
    ds_read_b64_tr_b16 a[222:223], v13 offset:27392
    v_mul_f32 v104, v104, v68
    v_mul_f32 v105, v105, v69
    v_mul_f32 v106, v106, v70
    v_mul_f32 v107, v107, v71
    v_mul_f32 v108, v108, v76
    v_mul_f32 v109, v109, v77
    v_mul_f32 v110, v110, v78
    v_mul_f32 v111, v111, v79
    v_cvt_pk_bf16_f32 v164, v104, v105
    v_cvt_pk_bf16_f32 v165, v106, v107
    v_cvt_pk_bf16_f32 v166, v108, v109
    v_cvt_pk_bf16_f32 v167, v110, v111
    s_waitcnt lgkmcnt(14)
    ds_write_b128 v14, v[164:167] offset:17408
    v_mfma_f32_16x16x32_bf16 v[196:199], a[236:239], v[156:159], v[196:199]
    s_waitcnt vmcnt(12) lgkmcnt(0)
    s_barrier
    ds_read_b64_tr_b16 a[224:225], v10 offset:33792
    v_mfma_f32_16x16x32_bf16 v[200:203], a[240:243], v[128:131], 0
    ds_read_b64_tr_b16 a[226:227], v10 offset:35840
    v_mul_f32 v96, 0xbfb8aa3b, v80
    v_mfma_f32_16x16x32_bf16 v[200:203], a[244:247], v[136:139], v[200:203]
    ds_read_b64_tr_b16 a[228:229], v12 offset:33792
    v_mul_f32 v97, 0xbfb8aa3b, v81
    v_mfma_f32_16x16x32_bf16 v[200:203], a[248:251], v[144:147], v[200:203]
    ds_read_b64_tr_b16 a[230:231], v12 offset:35840
    v_mul_f32 v98, 0xbfb8aa3b, v82
    v_mfma_f32_16x16x32_bf16 v[200:203], a[252:255], v[152:155], v[200:203]
    ds_read_b64_tr_b16 a[232:233], v10 offset:42240
    v_mul_f32 v99, 0xbfb8aa3b, v83
    v_mfma_f32_16x16x32_bf16 v[204:207], a[240:243], v[132:135], 0
    ds_read_b64_tr_b16 a[234:235], v10 offset:44288
    v_mul_f32 v100, 0xbfb8aa3b, v88
    v_mfma_f32_16x16x32_bf16 v[204:207], a[244:247], v[140:143], v[204:207]
    ds_read_b64_tr_b16 a[236:237], v12 offset:42240
    v_mul_f32 v101, 0xbfb8aa3b, v89
    v_mfma_f32_16x16x32_bf16 v[204:207], a[248:251], v[148:151], v[204:207]
    ds_read_b64_tr_b16 a[238:239], v12 offset:44288
    v_mul_f32 v102, 0xbfb8aa3b, v90
    v_mfma_f32_16x16x32_bf16 v[204:207], a[252:255], v[156:159], v[204:207]
    ds_read_b64_tr_b16 a[240:241], v11 offset:33792
    ds_read_b128 v[168:171], v15 offset:16384
    ds_read_b128 v[172:175], v15 offset:17408
    v_mul_f32 v103, 0xbfb8aa3b, v91
    v_exp_f32 v96, v96
    v_mfma_f32_16x16x32_bf16 v[208:211], a[128:131], v[128:131], 0
    ds_read_b64_tr_b16 a[242:243], v11 offset:35840
    s_add_u32 m0, s57, 50688
    v_exp_f32 v97, v97
    v_mfma_f32_16x16x32_bf16 v[208:211], a[132:135], v[136:139], v[208:211]
    ds_read_b64_tr_b16 a[244:245], v13 offset:33792
    v_exp_f32 v98, v98
    v_mfma_f32_16x16x32_bf16 v[208:211], a[136:139], v[144:147], v[208:211]
    ds_read_b64_tr_b16 a[246:247], v13 offset:35840
    s_mov_b32 s48, 115200
    v_exp_f32 v99, v99
    v_mfma_f32_16x16x32_bf16 v[208:211], a[140:143], v[152:155], v[208:211]
    ds_read_b64_tr_b16 a[248:249], v11 offset:42240
    v_exp_f32 v100, v100
    v_exp_f32 v101, v101
    v_mfma_f32_16x16x32_bf16 v[212:215], a[128:131], v[132:135], 0
    ds_read_b64_tr_b16 a[250:251], v11 offset:44288
    v_exp_f32 v102, v102
    v_mfma_f32_16x16x32_bf16 v[212:215], a[132:135], v[140:143], v[212:215]
    ds_read_b64_tr_b16 a[252:253], v13 offset:42240
    buffer_load_dwordx4 v26, s[36:39], s48 offen offset:0 lds
    v_exp_f32 v103, v103
    v_add_f32 v96, 1.0, v96
    v_mfma_f32_16x16x32_bf16 v[212:215], a[136:139], v[148:151], v[212:215]
    ds_read_b64_tr_b16 a[254:255], v13 offset:44288
    v_add_f32 v97, 1.0, v97
    v_add_f32 v98, 1.0, v98
    v_mfma_f32_16x16x32_bf16 v[212:215], a[140:143], v[156:159], v[212:215]
    ds_read_b64_tr_b16 a[128:129], v10 offset:50688
    buffer_load_dwordx4 v27, s[36:39], s48 offen offset:1024 lds
    v_add_f32 v99, 1.0, v99
    v_add_f32 v100, 1.0, v100
    v_add_f32 v101, 1.0, v101
    v_mfma_f32_16x16x32_bf16 v[216:219], a[144:147], v[128:131], 0
    ds_read_b64_tr_b16 a[130:131], v10 offset:52736
    v_add_f32 v102, 1.0, v102
    v_add_f32 v103, 1.0, v103
    v_mfma_f32_16x16x32_bf16 v[216:219], a[148:151], v[136:139], v[216:219]
    ds_read_b64_tr_b16 a[132:133], v12 offset:50688
    v_rcp_f32 v96, v96
    v_mfma_f32_16x16x32_bf16 v[216:219], a[152:155], v[144:147], v[216:219]
    ds_read_b64_tr_b16 a[134:135], v12 offset:52736
    buffer_load_dwordx4 v28, s[36:39], s48 offen offset:2048 lds
    v_rcp_f32 v97, v97
    v_rcp_f32 v98, v98
    v_mfma_f32_16x16x32_bf16 v[216:219], a[156:159], v[152:155], v[216:219]
    ds_read_b64_tr_b16 a[136:137], v10 offset:59136
    v_rcp_f32 v99, v99
    v_mfma_f32_16x16x32_bf16 v[220:223], a[144:147], v[132:135], 0
    ds_read_b64_tr_b16 a[138:139], v10 offset:61184
    buffer_load_dwordx4 v29, s[36:39], s48 offen offset:3072 lds
    v_rcp_f32 v100, v100
    v_mfma_f32_16x16x32_bf16 v[220:223], a[148:151], v[140:143], v[220:223]
    ds_read_b64_tr_b16 a[140:141], v12 offset:59136
    v_rcp_f32 v101, v101
    v_mfma_f32_16x16x32_bf16 v[220:223], a[152:155], v[148:151], v[220:223]
    ds_read_b64_tr_b16 a[142:143], v12 offset:61184
    s_add_u32 m0, s57, 67584
    v_rcp_f32 v102, v102
    v_rcp_f32 v103, v103
    v_mfma_f32_16x16x32_bf16 v[220:223], a[156:159], v[156:159], v[220:223]
    ds_read_b64_tr_b16 a[144:145], v11 offset:50688
    v_mul_f32 v96, v96, v80
    v_mul_f32 v97, v97, v81
    v_mfma_f32_16x16x32_bf16 v[224:227], a[160:163], v[128:131], 0
    ds_read_b64_tr_b16 a[146:147], v11 offset:52736
    v_mul_f32 v98, v98, v82
    v_mul_f32 v99, v99, v83
    v_mul_f32 v100, v100, v88
    v_mfma_f32_16x16x32_bf16 v[224:227], a[164:167], v[136:139], v[224:227]
    ds_read_b64_tr_b16 a[148:149], v13 offset:50688
    s_mov_b32 s48, 640
    v_mul_f32 v101, v101, v89
    v_mul_f32 v102, v102, v90
    v_mfma_f32_16x16x32_bf16 v[224:227], a[168:171], v[144:147], v[224:227]
    ds_read_b64_tr_b16 a[150:151], v13 offset:52736
    v_mul_f32 v103, v103, v91
    v_cvt_pk_bf16_f32 v176, v96, v97
    v_cvt_pk_bf16_f32 v177, v98, v99
    v_mfma_f32_16x16x32_bf16 v[224:227], a[172:175], v[152:155], v[224:227]
    ds_read_b64_tr_b16 a[152:153], v11 offset:59136
    buffer_load_dwordx4 v26, s[36:39], s48 offen offset:0 lds
    v_cvt_pk_bf16_f32 v178, v100, v101
    v_cvt_pk_bf16_f32 v179, v102, v103
    v_mfma_f32_16x16x32_bf16 v[228:231], a[160:163], v[132:135], 0
    ds_read_b64_tr_b16 a[154:155], v11 offset:61184
    s_waitcnt lgkmcnt(14)
    ds_write_b128 v14, v[176:179] offset:0
    v_mul_f32 v104, 0xbfb8aa3b, v84
    v_mul_f32 v105, 0xbfb8aa3b, v85
    v_mfma_f32_16x16x32_bf16 v[228:231], a[164:167], v[140:143], v[228:231]
    ds_read_b64_tr_b16 a[156:157], v13 offset:59136
    buffer_load_dwordx4 v27, s[36:39], s48 offen offset:1024 lds
    buffer_load_dwordx4 v28, s[36:39], s48 offen offset:2048 lds
    buffer_load_dwordx4 v29, s[36:39], s48 offen offset:3072 lds
    v_mul_f32 v106, 0xbfb8aa3b, v86
    v_mul_f32 v107, 0xbfb8aa3b, v87
    v_mul_f32 v108, 0xbfb8aa3b, v92
    v_mfma_f32_16x16x32_bf16 v[228:231], a[168:171], v[148:151], v[228:231]
    ds_read_b64_tr_b16 a[158:159], v13 offset:61184
    v_mul_f32 v109, 0xbfb8aa3b, v93
    v_mul_f32 v110, 0xbfb8aa3b, v94
    v_mfma_f32_16x16x32_bf16 v[228:231], a[172:175], v[156:159], v[228:231]
    s_waitcnt vmcnt(12)
    s_barrier
    ds_read_b64_tr_b16 a[160:161], v4 offset:0
    v_mul_f32 v111, 0xbfb8aa3b, v95
    v_exp_f32 v104, v104
    v_mfma_f32_16x16x32_bf16 v[232:235], a[176:179], v[128:131], 0
    ds_read_b64_tr_b16 a[162:163], v4 offset:2048
    v_exp_f32 v105, v105
    v_mfma_f32_16x16x32_bf16 v[232:235], a[180:183], v[136:139], v[232:235]
    ds_read_b64_tr_b16 a[164:165], v6 offset:0
    v_exp_f32 v106, v106
    v_mfma_f32_16x16x32_bf16 v[232:235], a[184:187], v[144:147], v[232:235]
    ds_read_b64_tr_b16 a[166:167], v6 offset:2048
    v_exp_f32 v107, v107
    v_mfma_f32_16x16x32_bf16 v[232:235], a[188:191], v[152:155], v[232:235]
    ds_read_b64_tr_b16 a[168:169], v4 offset:8448
    v_exp_f32 v108, v108
    v_exp_f32 v109, v109
    v_mfma_f32_16x16x32_bf16 v[236:239], a[176:179], v[132:135], 0
    ds_read_b64_tr_b16 a[170:171], v4 offset:10496
    v_exp_f32 v110, v110
    v_mfma_f32_16x16x32_bf16 v[236:239], a[180:183], v[140:143], v[236:239]
    ds_read_b64_tr_b16 a[172:173], v6 offset:8448
    v_exp_f32 v111, v111
    v_add_f32 v104, 1.0, v104
    v_mfma_f32_16x16x32_bf16 v[236:239], a[184:187], v[148:151], v[236:239]
    ds_read_b64_tr_b16 a[174:175], v6 offset:10496
    v_add_f32 v105, 1.0, v105
    v_add_f32 v106, 1.0, v106
    v_mfma_f32_16x16x32_bf16 v[236:239], a[188:191], v[156:159], v[236:239]
    ds_read_b64_tr_b16 a[176:177], v5 offset:0
    v_add_f32 v107, 1.0, v107
    v_add_f32 v108, 1.0, v108
    v_add_f32 v109, 1.0, v109
    v_mfma_f32_16x16x32_bf16 v[240:243], a[192:195], v[128:131], 0
    ds_read_b64_tr_b16 a[178:179], v5 offset:2048
    s_add_u32 m0, s57, 84480
    v_add_f32 v110, 1.0, v110
    v_add_f32 v111, 1.0, v111
    v_mfma_f32_16x16x32_bf16 v[240:243], a[196:199], v[136:139], v[240:243]
    ds_read_b64_tr_b16 a[180:181], v7 offset:0
    v_rcp_f32 v104, v104
    v_mfma_f32_16x16x32_bf16 v[240:243], a[200:203], v[144:147], v[240:243]
    ds_read_b64_tr_b16 a[182:183], v7 offset:2048
    s_mov_b32 s48, 115328
    v_rcp_f32 v105, v105
    v_rcp_f32 v106, v106
    v_mfma_f32_16x16x32_bf16 v[240:243], a[204:207], v[152:155], v[240:243]
    ds_read_b64_tr_b16 a[184:185], v5 offset:8448
    v_rcp_f32 v107, v107
    v_mfma_f32_16x16x32_bf16 v[244:247], a[192:195], v[132:135], 0
    ds_read_b64_tr_b16 a[186:187], v5 offset:10496
    v_rcp_f32 v108, v108
    v_mfma_f32_16x16x32_bf16 v[244:247], a[196:199], v[140:143], v[244:247]
    ds_read_b64_tr_b16 a[188:189], v7 offset:8448
    buffer_load_dwordx4 v26, s[36:39], s48 offen offset:0 lds
    v_rcp_f32 v109, v109
    v_mfma_f32_16x16x32_bf16 v[244:247], a[200:203], v[148:151], v[244:247]
    ds_read_b64_tr_b16 a[190:191], v7 offset:10496
    v_rcp_f32 v110, v110
    v_rcp_f32 v111, v111
    v_mul_f32 v104, v104, v84
    v_mul_f32 v105, v105, v85
    v_mul_f32 v106, v106, v86
    v_mul_f32 v107, v107, v87
    v_mul_f32 v108, v108, v92
    v_mul_f32 v109, v109, v93
    v_mul_f32 v110, v110, v94
    v_mul_f32 v111, v111, v95
    v_cvt_pk_bf16_f32 v180, v104, v105
    v_cvt_pk_bf16_f32 v181, v106, v107
    v_cvt_pk_bf16_f32 v182, v108, v109
    v_cvt_pk_bf16_f32 v183, v110, v111
    s_waitcnt lgkmcnt(14)
    ds_write_b128 v14, v[180:183] offset:1024
    v_mfma_f32_16x16x32_bf16 v[244:247], a[204:207], v[156:159], v[244:247]
    s_waitcnt lgkmcnt(0)
    s_barrier
    ds_read_b64_tr_b16 a[192:193], v4 offset:16896
    buffer_load_dwordx4 v27, s[36:39], s48 offen offset:1024 lds
    v_mfma_f32_16x16x32_bf16 v[248:251], a[208:211], v[128:131], 0
    ds_read_b64_tr_b16 a[194:195], v4 offset:18944
    buffer_load_dwordx4 v28, s[36:39], s48 offen offset:2048 lds
    v_mfma_f32_16x16x32_bf16 v[248:251], a[212:215], v[136:139], v[248:251]
    ds_read_b64_tr_b16 a[196:197], v6 offset:16896
    ds_read_b128 v[184:187], v15 offset:0
    v_mfma_f32_16x16x32_bf16 v[248:251], a[216:219], v[144:147], v[248:251]
    ds_read_b64_tr_b16 a[198:199], v6 offset:18944
    buffer_load_dwordx4 v29, s[36:39], s48 offen offset:3072 lds
    v_mfma_f32_16x16x32_bf16 v[248:251], a[220:223], v[152:155], v[248:251]
    ds_read_b64_tr_b16 a[200:201], v4 offset:25344
    ds_read_b128 v[188:191], v15 offset:1024
    v_mfma_f32_16x16x32_bf16 v[252:255], a[208:211], v[132:135], 0
    ds_read_b64_tr_b16 a[202:203], v4 offset:27392
    s_add_u32 m0, s57, 101376
    v_mfma_f32_16x16x32_bf16 v[252:255], a[212:215], v[140:143], v[252:255]
    ds_read_b64_tr_b16 a[204:205], v6 offset:25344
    s_mov_b32 s48, 768
    v_mfma_f32_16x16x32_bf16 v[252:255], a[216:219], v[148:151], v[252:255]
    ds_read_b64_tr_b16 a[206:207], v6 offset:27392
    buffer_load_dwordx4 v26, s[36:39], s48 offen offset:0 lds
    v_mfma_f32_16x16x32_bf16 v[252:255], a[220:223], v[156:159], v[252:255]
    ds_read_b64_tr_b16 a[208:209], v5 offset:16896
    v_mfma_f32_16x16x32_bf16 v[192:195], a[224:227], v[160:163], v[192:195]
    ds_read_b64_tr_b16 a[210:211], v5 offset:18944
    buffer_load_dwordx4 v27, s[36:39], s48 offen offset:1024 lds
    v_mfma_f32_16x16x32_bf16 v[192:195], a[228:231], v[168:171], v[192:195]
    ds_read_b64_tr_b16 a[212:213], v7 offset:16896
    buffer_load_dwordx4 v28, s[36:39], s48 offen offset:2048 lds
    v_mfma_f32_16x16x32_bf16 v[192:195], a[232:235], v[176:179], v[192:195]
    ds_read_b64_tr_b16 a[214:215], v7 offset:18944
    buffer_load_dwordx4 v29, s[36:39], s48 offen offset:3072 lds
    s_waitcnt lgkmcnt(10)
    v_mfma_f32_16x16x32_bf16 v[192:195], a[236:239], v[184:187], v[192:195]
    ds_read_b64_tr_b16 a[216:217], v5 offset:25344
    v_mfma_f32_16x16x32_bf16 v[196:199], a[224:227], v[164:167], v[196:199]
    ds_read_b64_tr_b16 a[218:219], v5 offset:27392
    v_mfma_f32_16x16x32_bf16 v[196:199], a[228:231], v[172:175], v[196:199]
    ds_read_b64_tr_b16 a[220:221], v7 offset:25344
    v_mfma_f32_16x16x32_bf16 v[196:199], a[232:235], v[180:183], v[196:199]
    ds_read_b64_tr_b16 a[222:223], v7 offset:27392
    s_waitcnt lgkmcnt(11)
    v_mfma_f32_16x16x32_bf16 v[196:199], a[236:239], v[188:191], v[196:199]
    s_waitcnt vmcnt(12)
    s_barrier
    ds_read_b64_tr_b16 a[224:225], v4 offset:33792
    v_mfma_f32_16x16x32_bf16 v[200:203], a[240:243], v[160:163], v[200:203]
    ds_read_b64_tr_b16 a[226:227], v4 offset:35840
    s_add_u32 m0, s57, 118272
    v_mfma_f32_16x16x32_bf16 v[200:203], a[244:247], v[168:171], v[200:203]
    ds_read_b64_tr_b16 a[228:229], v6 offset:33792
    v_mfma_f32_16x16x32_bf16 v[200:203], a[248:251], v[176:179], v[200:203]
    ds_read_b64_tr_b16 a[230:231], v6 offset:35840
    v_mfma_f32_16x16x32_bf16 v[200:203], a[252:255], v[184:187], v[200:203]
    ds_read_b64_tr_b16 a[232:233], v4 offset:42240
    v_mfma_f32_16x16x32_bf16 v[204:207], a[240:243], v[164:167], v[204:207]
    ds_read_b64_tr_b16 a[234:235], v4 offset:44288
    s_mov_b32 s48, 115456
    v_mfma_f32_16x16x32_bf16 v[204:207], a[244:247], v[172:175], v[204:207]
    ds_read_b64_tr_b16 a[236:237], v6 offset:42240
    v_mfma_f32_16x16x32_bf16 v[204:207], a[248:251], v[180:183], v[204:207]
    ds_read_b64_tr_b16 a[238:239], v6 offset:44288
    v_mfma_f32_16x16x32_bf16 v[204:207], a[252:255], v[188:191], v[204:207]
    ds_read_b64_tr_b16 a[240:241], v5 offset:33792
    v_mfma_f32_16x16x32_bf16 v[208:211], a[128:131], v[160:163], v[208:211]
    ds_read_b64_tr_b16 a[242:243], v5 offset:35840
    v_mfma_f32_16x16x32_bf16 v[208:211], a[132:135], v[168:171], v[208:211]
    ds_read_b64_tr_b16 a[244:245], v7 offset:33792
    buffer_load_dwordx4 v26, s[36:39], s48 offen offset:0 lds
    v_mfma_f32_16x16x32_bf16 v[208:211], a[136:139], v[176:179], v[208:211]
    ds_read_b64_tr_b16 a[246:247], v7 offset:35840
    v_cvt_pk_bf16_f32 v112, v192, v193
    v_mfma_f32_16x16x32_bf16 v[208:211], a[140:143], v[184:187], v[208:211]
    ds_read_b64_tr_b16 a[248:249], v5 offset:42240
    v_cvt_pk_bf16_f32 v113, v194, v195
    v_mfma_f32_16x16x32_bf16 v[212:215], a[128:131], v[164:167], v[212:215]
    ds_read_b64_tr_b16 a[250:251], v5 offset:44288
    v_cvt_pk_bf16_f32 v114, v200, v201
    v_mfma_f32_16x16x32_bf16 v[212:215], a[132:135], v[172:175], v[212:215]
    ds_read_b64_tr_b16 a[252:253], v7 offset:42240
    v_cvt_pk_bf16_f32 v115, v202, v203
    v_mfma_f32_16x16x32_bf16 v[212:215], a[136:139], v[180:183], v[212:215]
    ds_read_b64_tr_b16 a[254:255], v7 offset:44288
    buffer_store_dwordx4 v[112:115], v49, s[20:23], s63 offen sc1
    v_mfma_f32_16x16x32_bf16 v[212:215], a[140:143], v[188:191], v[212:215]
    ds_read_b64_tr_b16 a[128:129], v4 offset:50688
    v_cvt_pk_bf16_f32 v116, v196, v197
    v_mfma_f32_16x16x32_bf16 v[216:219], a[144:147], v[160:163], v[216:219]
    ds_read_b64_tr_b16 a[130:131], v4 offset:52736
    v_cvt_pk_bf16_f32 v117, v198, v199
    v_mfma_f32_16x16x32_bf16 v[216:219], a[148:151], v[168:171], v[216:219]
    ds_read_b64_tr_b16 a[132:133], v6 offset:50688
    v_cvt_pk_bf16_f32 v118, v204, v205
    v_mfma_f32_16x16x32_bf16 v[216:219], a[152:155], v[176:179], v[216:219]
    ds_read_b64_tr_b16 a[134:135], v6 offset:52736
    v_cvt_pk_bf16_f32 v119, v206, v207
    v_mfma_f32_16x16x32_bf16 v[216:219], a[156:159], v[184:187], v[216:219]
    ds_read_b64_tr_b16 a[136:137], v4 offset:59136
    buffer_store_dwordx4 v[116:119], v50, s[20:23], s63 offen sc1
    v_mfma_f32_16x16x32_bf16 v[220:223], a[144:147], v[164:167], v[220:223]
    ds_read_b64_tr_b16 a[138:139], v4 offset:61184
    s_add_u32 s63, s63, 1024
    v_mfma_f32_16x16x32_bf16 v[220:223], a[148:151], v[172:175], v[220:223]
    ds_read_b64_tr_b16 a[140:141], v6 offset:59136
    buffer_load_dwordx4 v27, s[36:39], s48 offen offset:1024 lds
    v_mfma_f32_16x16x32_bf16 v[220:223], a[152:155], v[180:183], v[220:223]
    ds_read_b64_tr_b16 a[142:143], v6 offset:61184
    buffer_load_dwordx4 v28, s[36:39], s48 offen offset:2048 lds
    v_mfma_f32_16x16x32_bf16 v[220:223], a[156:159], v[188:191], v[220:223]
    ds_read_b64_tr_b16 a[144:145], v5 offset:50688
    v_mfma_f32_16x16x32_bf16 v[224:227], a[160:163], v[160:163], v[224:227]
    ds_read_b64_tr_b16 a[146:147], v5 offset:52736
    buffer_load_dwordx4 v29, s[36:39], s48 offen offset:3072 lds
    v_mfma_f32_16x16x32_bf16 v[224:227], a[164:167], v[168:171], v[224:227]
    ds_read_b64_tr_b16 a[148:149], v7 offset:50688
    v_mfma_f32_16x16x32_bf16 v[224:227], a[168:171], v[176:179], v[224:227]
    ds_read_b64_tr_b16 a[150:151], v7 offset:52736
    v_cvt_pk_bf16_f32 v120, v208, v209
    v_mfma_f32_16x16x32_bf16 v[224:227], a[172:175], v[184:187], v[224:227]
    ds_read_b64_tr_b16 a[152:153], v5 offset:59136
    v_cvt_pk_bf16_f32 v121, v210, v211
    v_mfma_f32_16x16x32_bf16 v[228:231], a[160:163], v[164:167], v[228:231]
    ds_read_b64_tr_b16 a[154:155], v5 offset:61184
    v_cvt_pk_bf16_f32 v122, v216, v217
    v_mfma_f32_16x16x32_bf16 v[228:231], a[164:167], v[172:175], v[228:231]
    ds_read_b64_tr_b16 a[156:157], v7 offset:59136
    v_cvt_pk_bf16_f32 v123, v218, v219
    v_mfma_f32_16x16x32_bf16 v[228:231], a[168:171], v[180:183], v[228:231]
    ds_read_b64_tr_b16 a[158:159], v7 offset:61184
    buffer_store_dwordx4 v[120:123], v49, s[20:23], s63 offen sc1
    v_mfma_f32_16x16x32_bf16 v[228:231], a[172:175], v[188:191], v[228:231]
    s_waitcnt vmcnt(11) lgkmcnt(15)
    s_barrier
    ds_read_b64_tr_b16 a[160:161], v10 offset:0
    v_mfma_f32_16x16x32_bf16 v[232:235], a[176:179], v[160:163], v[232:235]
    ds_read_b64_tr_b16 a[162:163], v10 offset:2048
    v_cvt_pk_bf16_f32 v124, v212, v213
    v_mfma_f32_16x16x32_bf16 v[232:235], a[180:183], v[168:171], v[232:235]
    ds_read_b64_tr_b16 a[164:165], v12 offset:0
    v_cvt_pk_bf16_f32 v125, v214, v215
    v_mfma_f32_16x16x32_bf16 v[232:235], a[184:187], v[176:179], v[232:235]
    ds_read_b64_tr_b16 a[166:167], v12 offset:2048
    v_cvt_pk_bf16_f32 v126, v220, v221
    v_mfma_f32_16x16x32_bf16 v[232:235], a[188:191], v[184:187], v[232:235]
    ds_read_b64_tr_b16 a[168:169], v10 offset:8448
    v_cvt_pk_bf16_f32 v127, v222, v223
    v_mfma_f32_16x16x32_bf16 v[236:239], a[176:179], v[164:167], v[236:239]
    ds_read_b64_tr_b16 a[170:171], v10 offset:10496
    buffer_store_dwordx4 v[124:127], v50, s[20:23], s63 offen sc1
    v_mfma_f32_16x16x32_bf16 v[236:239], a[180:183], v[172:175], v[236:239]
    ds_read_b64_tr_b16 a[172:173], v12 offset:8448
    s_add_u32 s63, s63, 1024
    v_mfma_f32_16x16x32_bf16 v[236:239], a[184:187], v[180:183], v[236:239]
    ds_read_b64_tr_b16 a[174:175], v12 offset:10496
    v_mfma_f32_16x16x32_bf16 v[236:239], a[188:191], v[188:191], v[236:239]
    ds_read_b64_tr_b16 a[176:177], v11 offset:0
    v_mfma_f32_16x16x32_bf16 v[240:243], a[192:195], v[160:163], v[240:243]
    ds_read_b64_tr_b16 a[178:179], v11 offset:2048
    v_mfma_f32_16x16x32_bf16 v[240:243], a[196:199], v[168:171], v[240:243]
    ds_read_b64_tr_b16 a[180:181], v13 offset:0
    v_mfma_f32_16x16x32_bf16 v[240:243], a[200:203], v[176:179], v[240:243]
    ds_read_b64_tr_b16 a[182:183], v13 offset:2048
    v_cvt_pk_bf16_f32 v112, v224, v225
    v_mfma_f32_16x16x32_bf16 v[240:243], a[204:207], v[184:187], v[240:243]
    ds_read_b64_tr_b16 a[184:185], v11 offset:8448
    v_cvt_pk_bf16_f32 v113, v226, v227
    v_mfma_f32_16x16x32_bf16 v[244:247], a[192:195], v[164:167], v[244:247]
    ds_read_b64_tr_b16 a[186:187], v11 offset:10496
    v_cvt_pk_bf16_f32 v114, v232, v233
    v_mfma_f32_16x16x32_bf16 v[244:247], a[196:199], v[172:175], v[244:247]
    ds_read_b64_tr_b16 a[188:189], v13 offset:8448
    v_cvt_pk_bf16_f32 v115, v234, v235
    v_mfma_f32_16x16x32_bf16 v[244:247], a[200:203], v[180:183], v[244:247]
    ds_read_b64_tr_b16 a[190:191], v13 offset:10496
    buffer_store_dwordx4 v[112:115], v49, s[20:23], s63 offen sc1
    v_mfma_f32_16x16x32_bf16 v[244:247], a[204:207], v[188:191], v[244:247]
    ds_read_b64_tr_b16 a[192:193], v10 offset:16896
    v_cvt_pk_bf16_f32 v116, v228, v229
    v_mfma_f32_16x16x32_bf16 v[248:251], a[208:211], v[160:163], v[248:251]
    ds_read_b64_tr_b16 a[194:195], v10 offset:18944
    v_cvt_pk_bf16_f32 v117, v230, v231
    v_mfma_f32_16x16x32_bf16 v[248:251], a[212:215], v[168:171], v[248:251]
    ds_read_b64_tr_b16 a[196:197], v12 offset:16896
    v_cvt_pk_bf16_f32 v118, v236, v237
    v_mfma_f32_16x16x32_bf16 v[248:251], a[216:219], v[176:179], v[248:251]
    ds_read_b64_tr_b16 a[198:199], v12 offset:18944
    v_cvt_pk_bf16_f32 v119, v238, v239
    v_mfma_f32_16x16x32_bf16 v[248:251], a[220:223], v[184:187], v[248:251]
    ds_read_b64_tr_b16 a[200:201], v10 offset:25344
    buffer_store_dwordx4 v[116:119], v50, s[20:23], s63 offen sc1
    v_mfma_f32_16x16x32_bf16 v[252:255], a[208:211], v[164:167], v[252:255]
    ds_read_b64_tr_b16 a[202:203], v10 offset:27392
    s_add_u32 s63, s63, 1024
    v_mfma_f32_16x16x32_bf16 v[252:255], a[212:215], v[172:175], v[252:255]
    ds_read_b64_tr_b16 a[204:205], v12 offset:25344
    v_mfma_f32_16x16x32_bf16 v[252:255], a[216:219], v[180:183], v[252:255]
    ds_read_b64_tr_b16 a[206:207], v12 offset:27392
    v_mfma_f32_16x16x32_bf16 v[252:255], a[220:223], v[188:191], v[252:255]
    ds_read_b64_tr_b16 a[208:209], v11 offset:16896
    v_mfma_f32_16x16x32_bf16 v[192:195], a[224:227], v[128:131], 0
    ds_read_b64_tr_b16 a[210:211], v11 offset:18944
    v_mfma_f32_16x16x32_bf16 v[192:195], a[228:231], v[136:139], v[192:195]
    ds_read_b64_tr_b16 a[212:213], v13 offset:16896
    v_mfma_f32_16x16x32_bf16 v[192:195], a[232:235], v[144:147], v[192:195]
    ds_read_b64_tr_b16 a[214:215], v13 offset:18944
    v_cvt_pk_bf16_f32 v120, v240, v241
    v_mfma_f32_16x16x32_bf16 v[192:195], a[236:239], v[152:155], v[192:195]
    ds_read_b64_tr_b16 a[216:217], v11 offset:25344
    v_cvt_pk_bf16_f32 v121, v242, v243
    v_mfma_f32_16x16x32_bf16 v[196:199], a[224:227], v[132:135], 0
    ds_read_b64_tr_b16 a[218:219], v11 offset:27392
    v_cvt_pk_bf16_f32 v122, v248, v249
    v_mfma_f32_16x16x32_bf16 v[196:199], a[228:231], v[140:143], v[196:199]
    ds_read_b64_tr_b16 a[220:221], v13 offset:25344
    v_cvt_pk_bf16_f32 v123, v250, v251
    v_mfma_f32_16x16x32_bf16 v[196:199], a[232:235], v[148:151], v[196:199]
    ds_read_b64_tr_b16 a[222:223], v13 offset:27392
    buffer_store_dwordx4 v[120:123], v49, s[20:23], s63 offen sc1
    v_mfma_f32_16x16x32_bf16 v[196:199], a[236:239], v[156:159], v[196:199]
    s_waitcnt vmcnt(5) lgkmcnt(15)
    s_barrier
    ds_read_b64_tr_b16 a[224:225], v10 offset:33792
    v_mfma_f32_16x16x32_bf16 v[200:203], a[240:243], v[128:131], 0
    ds_read_b64_tr_b16 a[226:227], v10 offset:35840
    v_cvt_pk_bf16_f32 v124, v244, v245
    v_mfma_f32_16x16x32_bf16 v[200:203], a[244:247], v[136:139], v[200:203]
    ds_read_b64_tr_b16 a[228:229], v12 offset:33792
    v_cvt_pk_bf16_f32 v125, v246, v247
    v_mfma_f32_16x16x32_bf16 v[200:203], a[248:251], v[144:147], v[200:203]
    ds_read_b64_tr_b16 a[230:231], v12 offset:35840
    v_cvt_pk_bf16_f32 v126, v252, v253
    v_mfma_f32_16x16x32_bf16 v[200:203], a[252:255], v[152:155], v[200:203]
    ds_read_b64_tr_b16 a[232:233], v10 offset:42240
    v_cvt_pk_bf16_f32 v127, v254, v255
    v_mfma_f32_16x16x32_bf16 v[204:207], a[240:243], v[132:135], 0
    ds_read_b64_tr_b16 a[234:235], v10 offset:44288
    buffer_store_dwordx4 v[124:127], v50, s[20:23], s63 offen sc1
    v_mfma_f32_16x16x32_bf16 v[204:207], a[244:247], v[140:143], v[204:207]
    ds_read_b64_tr_b16 a[236:237], v12 offset:42240
    s_add_u32 s63, s63, 1024
    v_mfma_f32_16x16x32_bf16 v[204:207], a[248:251], v[148:151], v[204:207]
    ds_read_b64_tr_b16 a[238:239], v12 offset:44288
    v_mfma_f32_16x16x32_bf16 v[204:207], a[252:255], v[156:159], v[204:207]
    ds_read_b64_tr_b16 a[240:241], v11 offset:33792
    v_mfma_f32_16x16x32_bf16 v[192:195], a[128:131], v[160:163], v[192:195]
    ds_read_b64_tr_b16 a[242:243], v11 offset:35840
    v_mfma_f32_16x16x32_bf16 v[192:195], a[132:135], v[168:171], v[192:195]
    ds_read_b64_tr_b16 a[244:245], v13 offset:33792
    v_mfma_f32_16x16x32_bf16 v[192:195], a[136:139], v[176:179], v[192:195]
    ds_read_b64_tr_b16 a[246:247], v13 offset:35840
    v_mfma_f32_16x16x32_bf16 v[192:195], a[140:143], v[184:187], v[192:195]
    ds_read_b64_tr_b16 a[248:249], v11 offset:42240
    v_mfma_f32_16x16x32_bf16 v[196:199], a[128:131], v[164:167], v[196:199]
    ds_read_b64_tr_b16 a[250:251], v11 offset:44288
    v_mfma_f32_16x16x32_bf16 v[196:199], a[132:135], v[172:175], v[196:199]
    ds_read_b64_tr_b16 a[252:253], v13 offset:42240
    v_mfma_f32_16x16x32_bf16 v[196:199], a[136:139], v[180:183], v[196:199]
    ds_read_b64_tr_b16 a[254:255], v13 offset:44288
    v_mfma_f32_16x16x32_bf16 v[196:199], a[140:143], v[188:191], v[196:199]
    ds_read_b64_tr_b16 a[128:129], v10 offset:50688
    v_mfma_f32_16x16x32_bf16 v[200:203], a[144:147], v[160:163], v[200:203]
    ds_read_b64_tr_b16 a[130:131], v10 offset:52736
    v_mfma_f32_16x16x32_bf16 v[200:203], a[148:151], v[168:171], v[200:203]
    ds_read_b64_tr_b16 a[132:133], v12 offset:50688
    v_mfma_f32_16x16x32_bf16 v[200:203], a[152:155], v[176:179], v[200:203]
    ds_read_b64_tr_b16 a[134:135], v12 offset:52736
    v_mfma_f32_16x16x32_bf16 v[200:203], a[156:159], v[184:187], v[200:203]
    ds_read_b64_tr_b16 a[136:137], v10 offset:59136
    v_mfma_f32_16x16x32_bf16 v[204:207], a[144:147], v[164:167], v[204:207]
    ds_read_b64_tr_b16 a[138:139], v10 offset:61184
    v_mfma_f32_16x16x32_bf16 v[204:207], a[148:151], v[172:175], v[204:207]
    ds_read_b64_tr_b16 a[140:141], v12 offset:59136
    v_mfma_f32_16x16x32_bf16 v[204:207], a[152:155], v[180:183], v[204:207]
    ds_read_b64_tr_b16 a[142:143], v12 offset:61184
    v_mfma_f32_16x16x32_bf16 v[204:207], a[156:159], v[188:191], v[204:207]
    ds_read_b64_tr_b16 a[144:145], v11 offset:50688
    v_mfma_f32_16x16x32_bf16 v[208:211], a[160:163], v[128:131], 0
    ds_read_b64_tr_b16 a[146:147], v11 offset:52736
    v_mfma_f32_16x16x32_bf16 v[208:211], a[164:167], v[136:139], v[208:211]
    ds_read_b64_tr_b16 a[148:149], v13 offset:50688
    v_mfma_f32_16x16x32_bf16 v[208:211], a[168:171], v[144:147], v[208:211]
    ds_read_b64_tr_b16 a[150:151], v13 offset:52736
    v_cvt_pk_bf16_f32 v112, v192, v193
    v_mfma_f32_16x16x32_bf16 v[208:211], a[172:175], v[152:155], v[208:211]
    ds_read_b64_tr_b16 a[152:153], v11 offset:59136
    v_cvt_pk_bf16_f32 v113, v194, v195
    v_mfma_f32_16x16x32_bf16 v[212:215], a[160:163], v[132:135], 0
    ds_read_b64_tr_b16 a[154:155], v11 offset:61184
    v_cvt_pk_bf16_f32 v114, v200, v201
    v_mfma_f32_16x16x32_bf16 v[212:215], a[164:167], v[140:143], v[212:215]
    ds_read_b64_tr_b16 a[156:157], v13 offset:59136
    v_cvt_pk_bf16_f32 v115, v202, v203
    v_mfma_f32_16x16x32_bf16 v[212:215], a[168:171], v[148:151], v[212:215]
    ds_read_b64_tr_b16 a[158:159], v13 offset:61184
    buffer_store_dwordx4 v[112:115], v49, s[20:23], s63 offen sc1
    v_mfma_f32_16x16x32_bf16 v[212:215], a[172:175], v[156:159], v[212:215]
    v_cvt_pk_bf16_f32 v116, v196, v197
    v_mfma_f32_16x16x32_bf16 v[216:219], a[176:179], v[128:131], 0
    v_cvt_pk_bf16_f32 v117, v198, v199
    v_mfma_f32_16x16x32_bf16 v[216:219], a[180:183], v[136:139], v[216:219]
    v_cvt_pk_bf16_f32 v118, v204, v205
    v_mfma_f32_16x16x32_bf16 v[216:219], a[184:187], v[144:147], v[216:219]
    v_cvt_pk_bf16_f32 v119, v206, v207
    v_mfma_f32_16x16x32_bf16 v[216:219], a[188:191], v[152:155], v[216:219]
    buffer_store_dwordx4 v[116:119], v50, s[20:23], s63 offen sc1
    v_mfma_f32_16x16x32_bf16 v[220:223], a[176:179], v[132:135], 0
    s_add_u32 s63, s63, 1024
    v_mfma_f32_16x16x32_bf16 v[220:223], a[180:183], v[140:143], v[220:223]
    v_mfma_f32_16x16x32_bf16 v[220:223], a[184:187], v[148:151], v[220:223]
    v_mfma_f32_16x16x32_bf16 v[220:223], a[188:191], v[156:159], v[220:223]
    s_waitcnt lgkmcnt(15)
    v_mfma_f32_16x16x32_bf16 v[208:211], a[192:195], v[160:163], v[208:211]
    v_mfma_f32_16x16x32_bf16 v[208:211], a[196:199], v[168:171], v[208:211]
    v_mfma_f32_16x16x32_bf16 v[208:211], a[200:203], v[176:179], v[208:211]
    v_mfma_f32_16x16x32_bf16 v[208:211], a[204:207], v[184:187], v[208:211]
    v_mfma_f32_16x16x32_bf16 v[212:215], a[192:195], v[164:167], v[212:215]
    v_mfma_f32_16x16x32_bf16 v[212:215], a[196:199], v[172:175], v[212:215]
    v_mfma_f32_16x16x32_bf16 v[212:215], a[200:203], v[180:183], v[212:215]
    v_mfma_f32_16x16x32_bf16 v[212:215], a[204:207], v[188:191], v[212:215]
    v_mfma_f32_16x16x32_bf16 v[216:219], a[208:211], v[160:163], v[216:219]
    v_mfma_f32_16x16x32_bf16 v[216:219], a[212:215], v[168:171], v[216:219]
    v_mfma_f32_16x16x32_bf16 v[216:219], a[216:219], v[176:179], v[216:219]
    v_mfma_f32_16x16x32_bf16 v[216:219], a[220:223], v[184:187], v[216:219]
    v_mfma_f32_16x16x32_bf16 v[220:223], a[208:211], v[164:167], v[220:223]
    v_mfma_f32_16x16x32_bf16 v[220:223], a[212:215], v[172:175], v[220:223]
    v_mfma_f32_16x16x32_bf16 v[220:223], a[216:219], v[180:183], v[220:223]
    v_mfma_f32_16x16x32_bf16 v[220:223], a[220:223], v[188:191], v[220:223]
    v_mfma_f32_16x16x32_bf16 v[224:227], a[224:227], v[128:131], 0
    v_mfma_f32_16x16x32_bf16 v[224:227], a[228:231], v[136:139], v[224:227]
    v_mfma_f32_16x16x32_bf16 v[224:227], a[232:235], v[144:147], v[224:227]
    v_cvt_pk_bf16_f32 v120, v208, v209
    v_mfma_f32_16x16x32_bf16 v[224:227], a[236:239], v[152:155], v[224:227]
    v_cvt_pk_bf16_f32 v121, v210, v211
    v_mfma_f32_16x16x32_bf16 v[228:231], a[224:227], v[132:135], 0
    v_cvt_pk_bf16_f32 v122, v216, v217
    v_mfma_f32_16x16x32_bf16 v[228:231], a[228:231], v[140:143], v[228:231]
    v_cvt_pk_bf16_f32 v123, v218, v219
    v_mfma_f32_16x16x32_bf16 v[228:231], a[232:235], v[148:151], v[228:231]
    buffer_store_dwordx4 v[120:123], v49, s[20:23], s63 offen sc1
    v_mfma_f32_16x16x32_bf16 v[228:231], a[236:239], v[156:159], v[228:231]
    v_cvt_pk_bf16_f32 v124, v212, v213
    v_mfma_f32_16x16x32_bf16 v[232:235], a[240:243], v[128:131], 0
    v_cvt_pk_bf16_f32 v125, v214, v215
    v_mfma_f32_16x16x32_bf16 v[232:235], a[244:247], v[136:139], v[232:235]
    v_cvt_pk_bf16_f32 v126, v220, v221
    v_mfma_f32_16x16x32_bf16 v[232:235], a[248:251], v[144:147], v[232:235]
    v_cvt_pk_bf16_f32 v127, v222, v223
    v_mfma_f32_16x16x32_bf16 v[232:235], a[252:255], v[152:155], v[232:235]
    buffer_store_dwordx4 v[124:127], v50, s[20:23], s63 offen sc1
    v_mfma_f32_16x16x32_bf16 v[236:239], a[240:243], v[132:135], 0
    s_add_u32 s63, s63, 1024
    v_mfma_f32_16x16x32_bf16 v[236:239], a[244:247], v[140:143], v[236:239]
    v_mfma_f32_16x16x32_bf16 v[236:239], a[248:251], v[148:151], v[236:239]
    v_mfma_f32_16x16x32_bf16 v[236:239], a[252:255], v[156:159], v[236:239]
    s_waitcnt lgkmcnt(0)
    v_mfma_f32_16x16x32_bf16 v[224:227], a[128:131], v[160:163], v[224:227]
    v_mfma_f32_16x16x32_bf16 v[224:227], a[132:135], v[168:171], v[224:227]
    v_mfma_f32_16x16x32_bf16 v[224:227], a[136:139], v[176:179], v[224:227]
    v_mfma_f32_16x16x32_bf16 v[224:227], a[140:143], v[184:187], v[224:227]
    v_mfma_f32_16x16x32_bf16 v[228:231], a[128:131], v[164:167], v[228:231]
    v_mfma_f32_16x16x32_bf16 v[228:231], a[132:135], v[172:175], v[228:231]
    v_mfma_f32_16x16x32_bf16 v[228:231], a[136:139], v[180:183], v[228:231]
    v_mfma_f32_16x16x32_bf16 v[228:231], a[140:143], v[188:191], v[228:231]
    v_mfma_f32_16x16x32_bf16 v[232:235], a[144:147], v[160:163], v[232:235]
    v_mfma_f32_16x16x32_bf16 v[232:235], a[148:151], v[168:171], v[232:235]
    v_mfma_f32_16x16x32_bf16 v[232:235], a[152:155], v[176:179], v[232:235]
    v_mfma_f32_16x16x32_bf16 v[232:235], a[156:159], v[184:187], v[232:235]
    v_mfma_f32_16x16x32_bf16 v[236:239], a[144:147], v[164:167], v[236:239]
    v_mfma_f32_16x16x32_bf16 v[236:239], a[148:151], v[172:175], v[236:239]
    v_mfma_f32_16x16x32_bf16 v[236:239], a[152:155], v[180:183], v[236:239]
    v_mfma_f32_16x16x32_bf16 v[236:239], a[156:159], v[188:191], v[236:239]
    s_nop 7
    v_cvt_pk_bf16_f32 v112, v224, v225
    v_cvt_pk_bf16_f32 v113, v226, v227
    v_cvt_pk_bf16_f32 v114, v232, v233
    v_cvt_pk_bf16_f32 v115, v234, v235
    buffer_store_dwordx4 v[112:115], v49, s[20:23], s63 offen sc1
    v_cvt_pk_bf16_f32 v116, v228, v229
    v_cvt_pk_bf16_f32 v117, v230, v231
    v_cvt_pk_bf16_f32 v118, v236, v237
    v_cvt_pk_bf16_f32 v119, v238, v239
    buffer_store_dwordx4 v[116:119], v50, s[20:23], s63 offen sc1
    s_add_u32 s63, s63, 1024
    s_waitcnt vmcnt(0)
    s_barrier
    s_cmp_lg_u32 s52, 0
    s_cbranch_scc1 L_nf2
    s_mov_b64 exec, 1
    v_mov_b32 v36, s49
    v_mov_b32 v37, 6144
    buffer_store_dword v36, v37, s[20:23], s92 offen sc1
    s_mov_b64 exec, -1
L_nf2:
L_r2:
    s_waitcnt vmcnt(0) lgkmcnt(0)
    s_mov_b32 s61, 10240
    buffer_load_dwordx4 v[200:203], v55, s[20:23], s61 offen offset:0 sc1
    buffer_load_dwordx4 v[204:207], v55, s[20:23], s61 offen offset:64 sc1
    buffer_load_dwordx4 v[208:211], v55, s[20:23], s61 offen offset:128 sc1
    buffer_load_dwordx4 v[212:215], v55, s[20:23], s61 offen offset:192 sc1
    v_mov_b32 v2, 0
    v_mov_b32 v3, 0
    v_mov_b32 v4, 0
    v_mov_b32 v5, 0
    v_mov_b32 v6, 0
    v_mov_b32 v7, 0
    v_mov_b32 v8, 0
    v_mov_b32 v9, 0
    v_mov_b32 v10, 0
    v_mov_b32 v11, 0
    v_mov_b32 v12, 0
    v_mov_b32 v13, 0
    v_mov_b32 v14, 0
    v_mov_b32 v15, 0
    v_mov_b32 v16, 0
    v_mov_b32 v17, 0
    s_and_b32 s93, s92, 0xffffff80
    s_add_u32 s93, s93, 6144
    s_add_u32 s91, s58, 0x2400000
    s_mov_b32 s59, 0
    s_lshr_b32 s60, s53, 3
    s_lshl_b32 s62, 0x1555, s60
    s_cmp_lg_u32 s59, 0
    s_cbranch_scc1 L_hv2_0
    s_call_b64 s[94:95], L_gpoll
L_hv2_0:
    s_ff1_i32_b32 s90, s59
    s_bitset0_b32 s59, s90
    s_bitset0_b32 s62, s90
    s_lshr_b32 s90, s90, 1
    s_mul_i32 s60, s90, 1835008
    s_add_u32 s60, s60, s91
    buffer_load_dwordx4 v[64:67], v53, s[20:23], s60 offen offset:0 sc1
    buffer_load_dwordx4 v[68:71], v53, s[20:23], s60 offen offset:512 sc1
    s_cmp_lg_u32 s59, 0
    s_cbranch_scc1 L_hv2_1
    s_call_b64 s[94:95], L_gpoll
L_hv2_1:
    s_ff1_i32_b32 s90, s59
    s_bitset0_b32 s59, s90
    s_bitset0_b32 s62, s90
    s_lshr_b32 s90, s90, 1
    s_mul_i32 s60, s90, 1835008
    s_add_u32 s60, s60, s91
    buffer_load_dwordx4 v[72:75], v53, s[20:23], s60 offen offset:0 sc1
    buffer_load_dwordx4 v[76:79], v53, s[20:23], s60 offen offset:512 sc1
    s_cmp_lg_u32 s59, 0
    s_cbranch_scc1 L_hv2_2
    s_call_b64 s[94:95], L_gpoll
L_hv2_2:
    s_ff1_i32_b32 s90, s59
    s_bitset0_b32 s59, s90
    s_bitset0_b32 s62, s90
    s_lshr_b32 s90, s90, 1
    s_mul_i32 s60, s90, 1835008
    s_add_u32 s60, s60, s91
    buffer_load_dwordx4 v[80:83], v53, s[20:23], s60 offen offset:0 sc1
    buffer_load_dwordx4 v[84:87], v53, s[20:23], s60 offen offset:512 sc1
    s_cmp_lg_u32 s59, 0
    s_cbranch_scc1 L_hv2_3
    s_call_b64 s[94:95], L_gpoll
L_hv2_3:
    s_ff1_i32_b32 s90, s59
    s_bitset0_b32 s59, s90
    s_bitset0_b32 s62, s90
    s_lshr_b32 s90, s90, 1
    s_mul_i32 s60, s90, 1835008
    s_add_u32 s60, s60, s91
    buffer_load_dwordx4 v[88:91], v53, s[20:23], s60 offen offset:0 sc1
    buffer_load_dwordx4 v[92:95], v53, s[20:23], s60 offen offset:512 sc1
    s_cmp_lg_u32 s59, 0
    s_cbranch_scc1 L_hv2_4
    s_call_b64 s[94:95], L_gpoll
L_hv2_4:
    s_ff1_i32_b32 s90, s59
    s_bitset0_b32 s59, s90
    s_bitset0_b32 s62, s90
    s_lshr_b32 s90, s90, 1
    s_mul_i32 s60, s90, 1835008
    s_add_u32 s60, s60, s91
    buffer_load_dwordx4 v[96:99], v53, s[20:23], s60 offen offset:0 sc1
    buffer_load_dwordx4 v[100:103], v53, s[20:23], s60 offen offset:512 sc1
    s_cmp_lg_u32 s59, 0
    s_cbranch_scc1 L_hv2_5
    s_call_b64 s[94:95], L_gpoll
L_hv2_5:
    s_ff1_i32_b32 s90, s59
    s_bitset0_b32 s59, s90
    s_bitset0_b32 s62, s90
    s_lshr_b32 s90, s90, 1
    s_mul_i32 s60, s90, 1835008
    s_add_u32 s60, s60, s91
    buffer_load_dwordx4 v[104:107], v53, s[20:23], s60 offen offset:0 sc1
    buffer_load_dwordx4 v[108:111], v53, s[20:23], s60 offen offset:512 sc1
    s_cmp_lg_u32 s59, 0
    s_cbranch_scc1 L_hv2_6
    s_call_b64 s[94:95], L_gpoll
L_hv2_6:
    s_ff1_i32_b32 s90, s59
    s_bitset0_b32 s59, s90
    s_bitset0_b32 s62, s90
    s_lshr_b32 s90, s90, 1
    s_mul_i32 s60, s90, 1835008
    s_add_u32 s60, s60, s91
    buffer_load_dwordx4 v[112:115], v53, s[20:23], s60 offen offset:0 sc1
    buffer_load_dwordx4 v[116:119], v53, s[20:23], s60 offen offset:512 sc1
    s_waitcnt vmcnt(13)
    v_dot2_f32_bf16 v2, v64, s97, v2
    v_dot2_f32_bf16 v3, v64, s3, v3
    v_dot2_f32_bf16 v4, v65, s97, v4
    v_dot2_f32_bf16 v5, v65, s3, v5
    v_dot2_f32_bf16 v6, v66, s97, v6
    v_dot2_f32_bf16 v7, v66, s3, v7
    v_dot2_f32_bf16 v8, v67, s97, v8
    v_dot2_f32_bf16 v9, v67, s3, v9
    s_waitcnt vmcnt(12)
    v_dot2_f32_bf16 v10, v68, s97, v10
    v_dot2_f32_bf16 v11, v68, s3, v11
    v_dot2_f32_bf16 v12, v69, s97, v12
    v_dot2_f32_bf16 v13, v69, s3, v13
    v_dot2_f32_bf16 v14, v70, s97, v14
    v_dot2_f32_bf16 v15, v70, s3, v15
    v_dot2_f32_bf16 v16, v71, s97, v16
    v_dot2_f32_bf16 v17, v71, s3, v17
    s_waitcnt vmcnt(11)
    v_dot2_f32_bf16 v2, v72, s97, v2
    v_dot2_f32_bf16 v3, v72, s3, v3
    v_dot2_f32_bf16 v4, v73, s97, v4
    v_dot2_f32_bf16 v5, v73, s3, v5
    v_dot2_f32_bf16 v6, v74, s97, v6
    v_dot2_f32_bf16 v7, v74, s3, v7
    v_dot2_f32_bf16 v8, v75, s97, v8
    v_dot2_f32_bf16 v9, v75, s3, v9
    s_waitcnt vmcnt(10)
    v_dot2_f32_bf16 v10, v76, s97, v10
    v_dot2_f32_bf16 v11, v76, s3, v11
    v_dot2_f32_bf16 v12, v77, s97, v12
    v_dot2_f32_bf16 v13, v77, s3, v13
    v_dot2_f32_bf16 v14, v78, s97, v14
    v_dot2_f32_bf16 v15, v78, s3, v15
    v_dot2_f32_bf16 v16, v79, s97, v16
    v_dot2_f32_bf16 v17, v79, s3, v17
    s_waitcnt vmcnt(9)
    v_dot2_f32_bf16 v2, v80, s97, v2
    v_dot2_f32_bf16 v3, v80, s3, v3
    v_dot2_f32_bf16 v4, v81, s97, v4
    v_dot2_f32_bf16 v5, v81, s3, v5
    v_dot2_f32_bf16 v6, v82, s97, v6
    v_dot2_f32_bf16 v7, v82, s3, v7
    v_dot2_f32_bf16 v8, v83, s97, v8
    v_dot2_f32_bf16 v9, v83, s3, v9
    s_waitcnt vmcnt(8)
    v_dot2_f32_bf16 v10, v84, s97, v10
    v_dot2_f32_bf16 v11, v84, s3, v11
    v_dot2_f32_bf16 v12, v85, s97, v12
    v_dot2_f32_bf16 v13, v85, s3, v13
    v_dot2_f32_bf16 v14, v86, s97, v14
    v_dot2_f32_bf16 v15, v86, s3, v15
    v_dot2_f32_bf16 v16, v87, s97, v16
    v_dot2_f32_bf16 v17, v87, s3, v17
    s_waitcnt vmcnt(7)
    v_dot2_f32_bf16 v2, v88, s97, v2
    v_dot2_f32_bf16 v3, v88, s3, v3
    v_dot2_f32_bf16 v4, v89, s97, v4
    v_dot2_f32_bf16 v5, v89, s3, v5
    v_dot2_f32_bf16 v6, v90, s97, v6
    v_dot2_f32_bf16 v7, v90, s3, v7
    v_dot2_f32_bf16 v8, v91, s97, v8
    v_dot2_f32_bf16 v9, v91, s3, v9
    s_waitcnt vmcnt(6)
    v_dot2_f32_bf16 v10, v92, s97, v10
    v_dot2_f32_bf16 v11, v92, s3, v11
    v_dot2_f32_bf16 v12, v93, s97, v12
    v_dot2_f32_bf16 v13, v93, s3, v13
    v_dot2_f32_bf16 v14, v94, s97, v14
    v_dot2_f32_bf16 v15, v94, s3, v15
    v_dot2_f32_bf16 v16, v95, s97, v16
    v_dot2_f32_bf16 v17, v95, s3, v17
    s_waitcnt vmcnt(5)
    v_dot2_f32_bf16 v2, v96, s97, v2
    v_dot2_f32_bf16 v3, v96, s3, v3
    v_dot2_f32_bf16 v4, v97, s97, v4
    v_dot2_f32_bf16 v5, v97, s3, v5
    v_dot2_f32_bf16 v6, v98, s97, v6
    v_dot2_f32_bf16 v7, v98, s3, v7
    v_dot2_f32_bf16 v8, v99, s97, v8
    v_dot2_f32_bf16 v9, v99, s3, v9
    s_waitcnt vmcnt(4)
    v_dot2_f32_bf16 v10, v100, s97, v10
    v_dot2_f32_bf16 v11, v100, s3, v11
    v_dot2_f32_bf16 v12, v101, s97, v12
    v_dot2_f32_bf16 v13, v101, s3, v13
    v_dot2_f32_bf16 v14, v102, s97, v14
    v_dot2_f32_bf16 v15, v102, s3, v15
    v_dot2_f32_bf16 v16, v103, s97, v16
    v_dot2_f32_bf16 v17, v103, s3, v17
    s_waitcnt vmcnt(3)
    v_dot2_f32_bf16 v2, v104, s97, v2
    v_dot2_f32_bf16 v3, v104, s3, v3
    v_dot2_f32_bf16 v4, v105, s97, v4
    v_dot2_f32_bf16 v5, v105, s3, v5
    v_dot2_f32_bf16 v6, v106, s97, v6
    v_dot2_f32_bf16 v7, v106, s3, v7
    v_dot2_f32_bf16 v8, v107, s97, v8
    v_dot2_f32_bf16 v9, v107, s3, v9
    s_waitcnt vmcnt(2)
    v_dot2_f32_bf16 v10, v108, s97, v10
    v_dot2_f32_bf16 v11, v108, s3, v11
    v_dot2_f32_bf16 v12, v109, s97, v12
    v_dot2_f32_bf16 v13, v109, s3, v13
    v_dot2_f32_bf16 v14, v110, s97, v14
    v_dot2_f32_bf16 v15, v110, s3, v15
    v_dot2_f32_bf16 v16, v111, s97, v16
    v_dot2_f32_bf16 v17, v111, s3, v17
    s_waitcnt vmcnt(1)
    v_dot2_f32_bf16 v2, v112, s97, v2
    v_dot2_f32_bf16 v3, v112, s3, v3
    v_dot2_f32_bf16 v4, v113, s97, v4
    v_dot2_f32_bf16 v5, v113, s3, v5
    v_dot2_f32_bf16 v6, v114, s97, v6
    v_dot2_f32_bf16 v7, v114, s3, v7
    v_dot2_f32_bf16 v8, v115, s97, v8
    v_dot2_f32_bf16 v9, v115, s3, v9
    s_waitcnt vmcnt(0)
    v_dot2_f32_bf16 v10, v116, s97, v10
    v_dot2_f32_bf16 v11, v116, s3, v11
    v_dot2_f32_bf16 v12, v117, s97, v12
    v_dot2_f32_bf16 v13, v117, s3, v13
    v_dot2_f32_bf16 v14, v118, s97, v14
    v_dot2_f32_bf16 v15, v118, s3, v15
    v_dot2_f32_bf16 v16, v119, s97, v16
    v_dot2_f32_bf16 v17, v119, s3, v17
    s_nop 2
    v_cvt_pk_bf16_f32 v64, v2, v3
    v_cvt_pk_bf16_f32 v65, v4, v5
    v_cvt_pk_bf16_f32 v66, v6, v7
    v_cvt_pk_bf16_f32 v67, v8, v9
    v_cvt_pk_bf16_f32 v68, v10, v11
    v_cvt_pk_bf16_f32 v69, v12, v13
    v_cvt_pk_bf16_f32 v70, v14, v15
    v_cvt_pk_bf16_f32 v71, v16, v17
    v_lshlrev_b32 v2, 16, v64
    v_and_b32 v3, 0xffff0000, v64
    v_lshlrev_b32 v4, 16, v65
    v_and_b32 v5, 0xffff0000, v65
    v_lshlrev_b32 v6, 16, v66
    v_and_b32 v7, 0xffff0000, v66
    v_lshlrev_b32 v8, 16, v67
    v_and_b32 v9, 0xffff0000, v67
    v_lshlrev_b32 v10, 16, v68
    v_and_b32 v11, 0xffff0000, v68
    v_lshlrev_b32 v12, 16, v69
    v_and_b32 v13, 0xffff0000, v69
    v_lshlrev_b32 v14, 16, v70
    v_and_b32 v15, 0xffff0000, v70
    v_lshlrev_b32 v16, 16, v71
    v_and_b32 v17, 0xffff0000, v71
    v_mul_f32 v2, v2, v200
    v_mul_f32 v3, v3, v201
    v_mul_f32 v4, v4, v202
    v_mul_f32 v5, v5, v203
    v_mul_f32 v6, v6, v204
    v_mul_f32 v7, v7, v205
    v_mul_f32 v8, v8, v206
    v_mul_f32 v9, v9, v207
    v_mul_f32 v10, v10, v208
    v_mul_f32 v11, v11, v209
    v_mul_f32 v12, v12, v210
    v_mul_f32 v13, v13, v211
    v_mul_f32 v14, v14, v212
    v_mul_f32 v15, v15, v213
    v_mul_f32 v16, v16, v214
    v_mul_f32 v17, v17, v215
    v_cvt_pk_bf16_f32 v64, v2, v3
    v_cvt_pk_bf16_f32 v65, v4, v5
    v_cvt_pk_bf16_f32 v66, v6, v7
    v_cvt_pk_bf16_f32 v67, v8, v9
    v_cvt_pk_bf16_f32 v68, v10, v11
    v_cvt_pk_bf16_f32 v69, v12, v13
    v_cvt_pk_bf16_f32 v70, v14, v15
    v_cvt_pk_bf16_f32 v71, v16, v17
    v_lshlrev_b32 v2, 16, v64
    v_and_b32 v3, 0xffff0000, v64
    v_lshlrev_b32 v4, 16, v65
    v_and_b32 v5, 0xffff0000, v65
    v_lshlrev_b32 v6, 16, v66
    v_and_b32 v7, 0xffff0000, v66
    v_lshlrev_b32 v8, 16, v67
    v_and_b32 v9, 0xffff0000, v67
    v_lshlrev_b32 v10, 16, v68
    v_and_b32 v11, 0xffff0000, v68
    v_lshlrev_b32 v12, 16, v69
    v_and_b32 v13, 0xffff0000, v69
    v_lshlrev_b32 v14, 16, v70
    v_and_b32 v15, 0xffff0000, v70
    v_lshlrev_b32 v16, 16, v71
    v_and_b32 v17, 0xffff0000, v71
    s_nop 0
    v_lshlrev_b32 v72, 16, v40
    v_and_b32 v73, 0xffff0000, v40
    v_add_f32 v2, v2, v72
    v_add_f32 v3, v3, v73
    v_lshlrev_b32 v72, 16, v41
    v_and_b32 v73, 0xffff0000, v41
    v_add_f32 v4, v4, v72
    v_add_f32 v5, v5, v73
    v_lshlrev_b32 v72, 16, v42
    v_and_b32 v73, 0xffff0000, v42
    v_add_f32 v6, v6, v72
    v_add_f32 v7, v7, v73
    v_lshlrev_b32 v72, 16, v43
    v_and_b32 v73, 0xffff0000, v43
    v_add_f32 v8, v8, v72
    v_add_f32 v9, v9, v73
    v_lshlrev_b32 v72, 16, v44
    v_and_b32 v73, 0xffff0000, v44
    v_add_f32 v10, v10, v72
    v_add_f32 v11, v11, v73
    v_lshlrev_b32 v72, 16, v45
    v_and_b32 v73, 0xffff0000, v45
    v_add_f32 v12, v12, v72
    v_add_f32 v13, v13, v73
    v_lshlrev_b32 v72, 16, v46
    v_and_b32 v73, 0xffff0000, v46
    v_add_f32 v14, v14, v72
    v_add_f32 v15, v15, v73
    v_lshlrev_b32 v72, 16, v47
    v_and_b32 v73, 0xffff0000, v47
    v_add_f32 v16, v16, v72
    v_add_f32 v17, v17, v73
    v_cvt_pk_bf16_f32 v40, v2, v3
    v_cvt_pk_bf16_f32 v41, v4, v5
    v_cvt_pk_bf16_f32 v42, v6, v7
    v_cvt_pk_bf16_f32 v43, v8, v9
    v_cvt_pk_bf16_f32 v44, v10, v11
    v_cvt_pk_bf16_f32 v45, v12, v13
    v_cvt_pk_bf16_f32 v46, v14, v15
    v_cvt_pk_bf16_f32 v47, v16, v17
    buffer_store_dwordx2 v[40:41], v54, s[28:31], s58 offen offset:0
    buffer_store_dwordx2 v[42:43], v54, s[28:31], s58 offen offset:32
    buffer_store_dwordx2 v[44:45], v54, s[28:31], s58 offen offset:64
    buffer_store_dwordx2 v[46:47], v54, s[28:31], s58 offen offset:96
    s_endpgm
L_gpoll:
    buffer_load_dword v37, v19, s[20:23], s93 offen sc1
    s_waitcnt vmcnt(0)
    v_cmp_eq_u32 vcc, s49, v37
    s_and_b32 s59, vcc_lo, s62
    s_cbranch_scc1 L_gpx
    s_sleep 1
    s_sub_u32 s96, s96, 1
    s_cmp_lg_u32 s96, 0
    s_cbranch_scc1 L_gpoll
    s_mov_b32 s59, s62
    s_mov_b32 s96, 1
L_gpx:
    s_setpc_b64 s[94:95]
L_tr_p1:
    s_call_b64 s[94:95], L_rare1
    s_branch L_bk_p1
L_tr_lp0:
    s_call_b64 s[94:95], L_rare0
    s_branch L_bk_lp0
L_tr_lp1:
    s_call_b64 s[94:95], L_rare1
    s_branch L_bk_lp1
L_tr_lp2:
    s_call_b64 s[94:95], L_rare0
    s_branch L_bk_lp2
L_tr_lp3:
    s_call_b64 s[94:95], L_rare1
    s_branch L_bk_lp3
L_tr_p14:
    s_call_b64 s[94:95], L_rare0
    s_branch L_bk_p14
L_tr_p15:
    s_call_b64 s[94:95], L_rare1
    s_branch L_bk_p15
L_tr_p16:
    s_call_b64 s[94:95], L_rare0
    s_branch L_bk_p16
L_tr_p17:
    s_call_b64 s[94:95], L_rare1
    s_branch L_bk_p17
L_tr_p18:
    s_call_b64 s[94:95], L_rare0
    s_branch L_bk_p18
L_tr_p19:
    s_call_b64 s[94:95], L_rare1
    s_branch L_bk_p19
L_rare0:
    s_nop 15
    v_max3_f32 v36, v128, v129, v130
    v_max3_f32 v36, v36, v131, v136
    v_max3_f32 v36, v36, v137, v138
    v_max_f32 v36, v36, v139
    v_max3_f32 v37, v132, v133, v134
    v_max3_f32 v37, v37, v135, v140
    v_max3_f32 v37, v37, v141, v142
    v_max_f32 v37, v37, v143
    v_mov_b32 v38, v36
    v_mov_b32 v39, v37
    s_nop 1
    v_permlane16_swap_b32 v36, v38
    v_permlane16_swap_b32 v37, v39
    s_nop 1
    v_max_f32 v36, v36, v38
    v_max_f32 v37, v37, v39
    v_mov_b32 v38, v36
    v_mov_b32 v39, v37
    s_nop 1
    v_permlane32_swap_b32 v36, v38
    v_permlane32_swap_b32 v37, v39
    s_nop 1
    v_max_f32 v36, v36, v38
    v_max_f32 v37, v37, v39
    v_max_f32 v36, 0, v36
    v_exp_f32 v38, -v36
    v_max_f32 v37, 0, v37
    v_exp_f32 v39, -v37
    v_sub_f32 v192, v192, v36
    v_sub_f32 v144, v144, v36
    v_sub_f32 v128, v128, v36
    v_sub_f32 v152, v152, v36
    v_sub_f32 v136, v136, v36
    v_sub_f32 v193, v193, v36
    v_sub_f32 v145, v145, v36
    v_sub_f32 v129, v129, v36
    v_sub_f32 v153, v153, v36
    v_sub_f32 v137, v137, v36
    v_sub_f32 v194, v194, v36
    v_sub_f32 v146, v146, v36
    v_sub_f32 v130, v130, v36
    v_sub_f32 v154, v154, v36
    v_sub_f32 v138, v138, v36
    v_sub_f32 v195, v195, v36
    v_sub_f32 v147, v147, v36
    v_sub_f32 v131, v131, v36
    v_sub_f32 v155, v155, v36
    v_sub_f32 v139, v139, v36
    v_mul_f32 v30, v30, v38
    v_sub_f32 v196, v196, v37
    v_sub_f32 v148, v148, v37
    v_sub_f32 v132, v132, v37
    v_sub_f32 v156, v156, v37
    v_sub_f32 v140, v140, v37
    v_sub_f32 v197, v197, v37
    v_sub_f32 v149, v149, v37
    v_sub_f32 v133, v133, v37
    v_sub_f32 v157, v157, v37
    v_sub_f32 v141, v141, v37
    v_sub_f32 v198, v198, v37
    v_sub_f32 v150, v150, v37
    v_sub_f32 v134, v134, v37
    v_sub_f32 v158, v158, v37
    v_sub_f32 v142, v142, v37
    v_sub_f32 v199, v199, v37
    v_sub_f32 v151, v151, v37
    v_sub_f32 v135, v135, v37
    v_sub_f32 v159, v159, v37
    v_sub_f32 v143, v143, v37
    v_mul_f32 v31, v31, v39
    v_accvgpr_read_b32 v160, a0
    v_accvgpr_read_b32 v161, a1
    v_accvgpr_read_b32 v162, a2
    v_accvgpr_read_b32 v163, a3
    v_accvgpr_read_b32 v164, a4
    v_accvgpr_read_b32 v165, a5
    v_accvgpr_read_b32 v166, a6
    v_accvgpr_read_b32 v167, a7
    v_mul_f32 v160, v160, v38
    v_mul_f32 v161, v161, v38
    v_mul_f32 v162, v162, v38
    v_mul_f32 v163, v163, v38
    v_mul_f32 v164, v164, v39
    v_mul_f32 v165, v165, v39
    v_mul_f32 v166, v166, v39
    v_mul_f32 v167, v167, v39
    v_accvgpr_write_b32 a0, v160
    v_accvgpr_write_b32 a1, v161
    v_accvgpr_write_b32 a2, v162
    v_accvgpr_write_b32 a3, v163
    v_accvgpr_write_b32 a4, v164
    v_accvgpr_write_b32 a5, v165
    v_accvgpr_write_b32 a6, v166
    v_accvgpr_write_b32 a7, v167
    v_accvgpr_read_b32 v160, a8
    v_accvgpr_read_b32 v161, a9
    v_accvgpr_read_b32 v162, a10
    v_accvgpr_read_b32 v163, a11
    v_accvgpr_read_b32 v164, a12
    v_accvgpr_read_b32 v165, a13
    v_accvgpr_read_b32 v166, a14
    v_accvgpr_read_b32 v167, a15
    v_mul_f32 v160, v160, v38
    v_mul_f32 v161, v161, v38
    v_mul_f32 v162, v162, v38
    v_mul_f32 v163, v163, v38
    v_mul_f32 v164, v164, v39
    v_mul_f32 v165, v165, v39
    v_mul_f32 v166, v166, v39
    v_mul_f32 v167, v167, v39
    v_accvgpr_write_b32 a8, v160
    v_accvgpr_write_b32 a9, v161
    v_accvgpr_write_b32 a10, v162
    v_accvgpr_write_b32 a11, v163
    v_accvgpr_write_b32 a12, v164
    v_accvgpr_write_b32 a13, v165
    v_accvgpr_write_b32 a14, v166
    v_accvgpr_write_b32 a15, v167
    v_accvgpr_read_b32 v160, a16
    v_accvgpr_read_b32 v161, a17
    v_accvgpr_read_b32 v162, a18
    v_accvgpr_read_b32 v163, a19
    v_accvgpr_read_b32 v164, a20
    v_accvgpr_read_b32 v165, a21
    v_accvgpr_read_b32 v166, a22
    v_accvgpr_read_b32 v167, a23
    v_mul_f32 v160, v160, v38
    v_mul_f32 v161, v161, v38
    v_mul_f32 v162, v162, v38
    v_mul_f32 v163, v163, v38
    v_mul_f32 v164, v164, v39
    v_mul_f32 v165, v165, v39
    v_mul_f32 v166, v166, v39
    v_mul_f32 v167, v167, v39
    v_accvgpr_write_b32 a16, v160
    v_accvgpr_write_b32 a17, v161
    v_accvgpr_write_b32 a18, v162
    v_accvgpr_write_b32 a19, v163
    v_accvgpr_write_b32 a20, v164
    v_accvgpr_write_b32 a21, v165
    v_accvgpr_write_b32 a22, v166
    v_accvgpr_write_b32 a23, v167
    v_accvgpr_read_b32 v160, a24
    v_accvgpr_read_b32 v161, a25
    v_accvgpr_read_b32 v162, a26
    v_accvgpr_read_b32 v163, a27
    v_accvgpr_read_b32 v164, a28
    v_accvgpr_read_b32 v165, a29
    v_accvgpr_read_b32 v166, a30
    v_accvgpr_read_b32 v167, a31
    v_mul_f32 v160, v160, v38
    v_mul_f32 v161, v161, v38
    v_mul_f32 v162, v162, v38
    v_mul_f32 v163, v163, v38
    v_mul_f32 v164, v164, v39
    v_mul_f32 v165, v165, v39
    v_mul_f32 v166, v166, v39
    v_mul_f32 v167, v167, v39
    v_accvgpr_write_b32 a24, v160
    v_accvgpr_write_b32 a25, v161
    v_accvgpr_write_b32 a26, v162
    v_accvgpr_write_b32 a27, v163
    v_accvgpr_write_b32 a28, v164
    v_accvgpr_write_b32 a29, v165
    v_accvgpr_write_b32 a30, v166
    v_accvgpr_write_b32 a31, v167
    v_accvgpr_read_b32 v160, a32
    v_accvgpr_read_b32 v161, a33
    v_accvgpr_read_b32 v162, a34
    v_accvgpr_read_b32 v163, a35
    v_accvgpr_read_b32 v164, a36
    v_accvgpr_read_b32 v165, a37
    v_accvgpr_read_b32 v166, a38
    v_accvgpr_read_b32 v167, a39
    v_mul_f32 v160, v160, v38
    v_mul_f32 v161, v161, v38
    v_mul_f32 v162, v162, v38
    v_mul_f32 v163, v163, v38
    v_mul_f32 v164, v164, v39
    v_mul_f32 v165, v165, v39
    v_mul_f32 v166, v166, v39
    v_mul_f32 v167, v167, v39
    v_accvgpr_write_b32 a32, v160
    v_accvgpr_write_b32 a33, v161
    v_accvgpr_write_b32 a34, v162
    v_accvgpr_write_b32 a35, v163
    v_accvgpr_write_b32 a36, v164
    v_accvgpr_write_b32 a37, v165
    v_accvgpr_write_b32 a38, v166
    v_accvgpr_write_b32 a39, v167
    v_accvgpr_read_b32 v160, a40
    v_accvgpr_read_b32 v161, a41
    v_accvgpr_read_b32 v162, a42
    v_accvgpr_read_b32 v163, a43
    v_accvgpr_read_b32 v164, a44
    v_accvgpr_read_b32 v165, a45
    v_accvgpr_read_b32 v166, a46
    v_accvgpr_read_b32 v167, a47
    v_mul_f32 v160, v160, v38
    v_mul_f32 v161, v161, v38
    v_mul_f32 v162, v162, v38
    v_mul_f32 v163, v163, v38
    v_mul_f32 v164, v164, v39
    v_mul_f32 v165, v165, v39
    v_mul_f32 v166, v166, v39
    v_mul_f32 v167, v167, v39
    v_accvgpr_write_b32 a40, v160
    v_accvgpr_write_b32 a41, v161
    v_accvgpr_write_b32 a42, v162
    v_accvgpr_write_b32 a43, v163
    v_accvgpr_write_b32 a44, v164
    v_accvgpr_write_b32 a45, v165
    v_accvgpr_write_b32 a46, v166
    v_accvgpr_write_b32 a47, v167
    v_accvgpr_read_b32 v160, a48
    v_accvgpr_read_b32 v161, a49
    v_accvgpr_read_b32 v162, a50
    v_accvgpr_read_b32 v163, a51
    v_accvgpr_read_b32 v164, a52
    v_accvgpr_read_b32 v165, a53
    v_accvgpr_read_b32 v166, a54
    v_accvgpr_read_b32 v167, a55
    v_mul_f32 v160, v160, v38
    v_mul_f32 v161, v161, v38
    v_mul_f32 v162, v162, v38
    v_mul_f32 v163, v163, v38
    v_mul_f32 v164, v164, v39
    v_mul_f32 v165, v165, v39
    v_mul_f32 v166, v166, v39
    v_mul_f32 v167, v167, v39
    v_accvgpr_write_b32 a48, v160
    v_accvgpr_write_b32 a49, v161
    v_accvgpr_write_b32 a50, v162
    v_accvgpr_write_b32 a51, v163
    v_accvgpr_write_b32 a52, v164
    v_accvgpr_write_b32 a53, v165
    v_accvgpr_write_b32 a54, v166
    v_accvgpr_write_b32 a55, v167
    v_accvgpr_read_b32 v160, a56
    v_accvgpr_read_b32 v161, a57
    v_accvgpr_read_b32 v162, a58
    v_accvgpr_read_b32 v163, a59
    v_accvgpr_read_b32 v164, a60
    v_accvgpr_read_b32 v165, a61
    v_accvgpr_read_b32 v166, a62
    v_accvgpr_read_b32 v167, a63
    v_mul_f32 v160, v160, v38
    v_mul_f32 v161, v161, v38
    v_mul_f32 v162, v162, v38
    v_mul_f32 v163, v163, v38
    v_mul_f32 v164, v164, v39
    v_mul_f32 v165, v165, v39
    v_mul_f32 v166, v166, v39
    v_mul_f32 v167, v167, v39
    v_accvgpr_write_b32 a56, v160
    v_accvgpr_write_b32 a57, v161
    v_accvgpr_write_b32 a58, v162
    v_accvgpr_write_b32 a59, v163
    v_accvgpr_write_b32 a60, v164
    v_accvgpr_write_b32 a61, v165
    v_accvgpr_write_b32 a62, v166
    v_accvgpr_write_b32 a63, v167
    v_accvgpr_read_b32 v160, a64
    v_accvgpr_read_b32 v161, a65
    v_accvgpr_read_b32 v162, a66
    v_accvgpr_read_b32 v163, a67
    v_accvgpr_read_b32 v164, a68
    v_accvgpr_read_b32 v165, a69
    v_accvgpr_read_b32 v166, a70
    v_accvgpr_read_b32 v167, a71
    v_mul_f32 v160, v160, v38
    v_mul_f32 v161, v161, v38
    v_mul_f32 v162, v162, v38
    v_mul_f32 v163, v163, v38
    v_mul_f32 v164, v164, v39
    v_mul_f32 v165, v165, v39
    v_mul_f32 v166, v166, v39
    v_mul_f32 v167, v167, v39
    v_accvgpr_write_b32 a64, v160
    v_accvgpr_write_b32 a65, v161
    v_accvgpr_write_b32 a66, v162
    v_accvgpr_write_b32 a67, v163
    v_accvgpr_write_b32 a68, v164
    v_accvgpr_write_b32 a69, v165
    v_accvgpr_write_b32 a70, v166
    v_accvgpr_write_b32 a71, v167
    v_accvgpr_read_b32 v160, a72
    v_accvgpr_read_b32 v161, a73
    v_accvgpr_read_b32 v162, a74
    v_accvgpr_read_b32 v163, a75
    v_accvgpr_read_b32 v164, a76
    v_accvgpr_read_b32 v165, a77
    v_accvgpr_read_b32 v166, a78
    v_accvgpr_read_b32 v167, a79
    v_mul_f32 v160, v160, v38
    v_mul_f32 v161, v161, v38
    v_mul_f32 v162, v162, v38
    v_mul_f32 v163, v163, v38
    v_mul_f32 v164, v164, v39
    v_mul_f32 v165, v165, v39
    v_mul_f32 v166, v166, v39
    v_mul_f32 v167, v167, v39
    v_accvgpr_write_b32 a72, v160
    v_accvgpr_write_b32 a73, v161
    v_accvgpr_write_b32 a74, v162
    v_accvgpr_write_b32 a75, v163
    v_accvgpr_write_b32 a76, v164
    v_accvgpr_write_b32 a77, v165
    v_accvgpr_write_b32 a78, v166
    v_accvgpr_write_b32 a79, v167
    v_accvgpr_read_b32 v160, a80
    v_accvgpr_read_b32 v161, a81
    v_accvgpr_read_b32 v162, a82
    v_accvgpr_read_b32 v163, a83
    v_accvgpr_read_b32 v164, a84
    v_accvgpr_read_b32 v165, a85
    v_accvgpr_read_b32 v166, a86
    v_accvgpr_read_b32 v167, a87
    v_mul_f32 v160, v160, v38
    v_mul_f32 v161, v161, v38
    v_mul_f32 v162, v162, v38
    v_mul_f32 v163, v163, v38
    v_mul_f32 v164, v164, v39
    v_mul_f32 v165, v165, v39
    v_mul_f32 v166, v166, v39
    v_mul_f32 v167, v167, v39
    v_accvgpr_write_b32 a80, v160
    v_accvgpr_write_b32 a81, v161
    v_accvgpr_write_b32 a82, v162
    v_accvgpr_write_b32 a83, v163
    v_accvgpr_write_b32 a84, v164
    v_accvgpr_write_b32 a85, v165
    v_accvgpr_write_b32 a86, v166
    v_accvgpr_write_b32 a87, v167
    v_accvgpr_read_b32 v160, a88
    v_accvgpr_read_b32 v161, a89
    v_accvgpr_read_b32 v162, a90
    v_accvgpr_read_b32 v163, a91
    v_accvgpr_read_b32 v164, a92
    v_accvgpr_read_b32 v165, a93
    v_accvgpr_read_b32 v166, a94
    v_accvgpr_read_b32 v167, a95
    v_mul_f32 v160, v160, v38
    v_mul_f32 v161, v161, v38
    v_mul_f32 v162, v162, v38
    v_mul_f32 v163, v163, v38
    v_mul_f32 v164, v164, v39
    v_mul_f32 v165, v165, v39
    v_mul_f32 v166, v166, v39
    v_mul_f32 v167, v167, v39
    v_accvgpr_write_b32 a88, v160
    v_accvgpr_write_b32 a89, v161
    v_accvgpr_write_b32 a90, v162
    v_accvgpr_write_b32 a91, v163
    v_accvgpr_write_b32 a92, v164
    v_accvgpr_write_b32 a93, v165
    v_accvgpr_write_b32 a94, v166
    v_accvgpr_write_b32 a95, v167
    v_accvgpr_read_b32 v160, a96
    v_accvgpr_read_b32 v161, a97
    v_accvgpr_read_b32 v162, a98
    v_accvgpr_read_b32 v163, a99
    v_accvgpr_read_b32 v164, a100
    v_accvgpr_read_b32 v165, a101
    v_accvgpr_read_b32 v166, a102
    v_accvgpr_read_b32 v167, a103
    v_mul_f32 v160, v160, v38
    v_mul_f32 v161, v161, v38
    v_mul_f32 v162, v162, v38
    v_mul_f32 v163, v163, v38
    v_mul_f32 v164, v164, v39
    v_mul_f32 v165, v165, v39
    v_mul_f32 v166, v166, v39
    v_mul_f32 v167, v167, v39
    v_accvgpr_write_b32 a96, v160
    v_accvgpr_write_b32 a97, v161
    v_accvgpr_write_b32 a98, v162
    v_accvgpr_write_b32 a99, v163
    v_accvgpr_write_b32 a100, v164
    v_accvgpr_write_b32 a101, v165
    v_accvgpr_write_b32 a102, v166
    v_accvgpr_write_b32 a103, v167
    v_accvgpr_read_b32 v160, a104
    v_accvgpr_read_b32 v161, a105
    v_accvgpr_read_b32 v162, a106
    v_accvgpr_read_b32 v163, a107
    v_accvgpr_read_b32 v164, a108
    v_accvgpr_read_b32 v165, a109
    v_accvgpr_read_b32 v166, a110
    v_accvgpr_read_b32 v167, a111
    v_mul_f32 v160, v160, v38
    v_mul_f32 v161, v161, v38
    v_mul_f32 v162, v162, v38
    v_mul_f32 v163, v163, v38
    v_mul_f32 v164, v164, v39
    v_mul_f32 v165, v165, v39
    v_mul_f32 v166, v166, v39
    v_mul_f32 v167, v167, v39
    v_accvgpr_write_b32 a104, v160
    v_accvgpr_write_b32 a105, v161
    v_accvgpr_write_b32 a106, v162
    v_accvgpr_write_b32 a107, v163
    v_accvgpr_write_b32 a108, v164
    v_accvgpr_write_b32 a109, v165
    v_accvgpr_write_b32 a110, v166
    v_accvgpr_write_b32 a111, v167
    v_accvgpr_read_b32 v160, a112
    v_accvgpr_read_b32 v161, a113
    v_accvgpr_read_b32 v162, a114
    v_accvgpr_read_b32 v163, a115
    v_accvgpr_read_b32 v164, a116
    v_accvgpr_read_b32 v165, a117
    v_accvgpr_read_b32 v166, a118
    v_accvgpr_read_b32 v167, a119
    v_mul_f32 v160, v160, v38
    v_mul_f32 v161, v161, v38
    v_mul_f32 v162, v162, v38
    v_mul_f32 v163, v163, v38
    v_mul_f32 v164, v164, v39
    v_mul_f32 v165, v165, v39
    v_mul_f32 v166, v166, v39
    v_mul_f32 v167, v167, v39
    v_accvgpr_write_b32 a112, v160
    v_accvgpr_write_b32 a113, v161
    v_accvgpr_write_b32 a114, v162
    v_accvgpr_write_b32 a115, v163
    v_accvgpr_write_b32 a116, v164
    v_accvgpr_write_b32 a117, v165
    v_accvgpr_write_b32 a118, v166
    v_accvgpr_write_b32 a119, v167
    v_accvgpr_read_b32 v160, a120
    v_accvgpr_read_b32 v161, a121
    v_accvgpr_read_b32 v162, a122
    v_accvgpr_read_b32 v163, a123
    v_accvgpr_read_b32 v164, a124
    v_accvgpr_read_b32 v165, a125
    v_accvgpr_read_b32 v166, a126
    v_accvgpr_read_b32 v167, a127
    v_mul_f32 v160, v160, v38
    v_mul_f32 v161, v161, v38
    v_mul_f32 v162, v162, v38
    v_mul_f32 v163, v163, v38
    v_mul_f32 v164, v164, v39
    v_mul_f32 v165, v165, v39
    v_mul_f32 v166, v166, v39
    v_mul_f32 v167, v167, v39
    v_accvgpr_write_b32 a120, v160
    v_accvgpr_write_b32 a121, v161
    v_accvgpr_write_b32 a122, v162
    v_accvgpr_write_b32 a123, v163
    v_accvgpr_write_b32 a124, v164
    v_accvgpr_write_b32 a125, v165
    v_accvgpr_write_b32 a126, v166
    v_accvgpr_write_b32 a127, v167
    v_exp_f32 v160, v128
    v_exp_f32 v161, v129
    v_exp_f32 v162, v130
    v_add_f32 v32, v160, v161
    v_cvt_pk_bf16_f32 v176, v160, v161
    v_exp_f32 v163, v131
    v_add_f32 v32, v32, v162
    v_exp_f32 v164, v132
    v_add_f32 v32, v32, v163
    v_cvt_pk_bf16_f32 v177, v162, v163
    v_exp_f32 v165, v133
    v_exp_f32 v166, v134
    v_add_f32 v33, v164, v165
    v_cvt_pk_bf16_f32 v180, v164, v165
    v_exp_f32 v167, v135
    v_add_f32 v33, v33, v166
    v_exp_f32 v168, v136
    v_add_f32 v33, v33, v167
    v_cvt_pk_bf16_f32 v181, v166, v167
    v_exp_f32 v169, v137
    v_add_f32 v32, v32, v168
    v_exp_f32 v170, v138
    v_add_f32 v32, v32, v169
    v_cvt_pk_bf16_f32 v178, v168, v169
    v_exp_f32 v171, v139
    v_add_f32 v32, v32, v170
    v_exp_f32 v172, v140
    v_add_f32 v32, v32, v171
    v_cvt_pk_bf16_f32 v179, v170, v171
    v_exp_f32 v173, v141
    v_add_f32 v33, v33, v172
    v_exp_f32 v174, v142
    v_add_f32 v33, v33, v173
    v_cvt_pk_bf16_f32 v182, v172, v173
    v_exp_f32 v175, v143
    v_add_f32 v33, v33, v174
    s_nop 0
    v_add_f32 v33, v33, v175
    v_cvt_pk_bf16_f32 v183, v174, v175
    s_nop 1
    s_setpc_b64 s[94:95]
L_rare1:
    s_nop 15
    v_max3_f32 v36, v144, v145, v146
    v_max3_f32 v36, v36, v147, v152
    v_max3_f32 v36, v36, v153, v154
    v_max_f32 v36, v36, v155
    v_max3_f32 v37, v148, v149, v150
    v_max3_f32 v37, v37, v151, v156
    v_max3_f32 v37, v37, v157, v158
    v_max_f32 v37, v37, v159
    v_mov_b32 v38, v36
    v_mov_b32 v39, v37
    s_nop 1
    v_permlane16_swap_b32 v36, v38
    v_permlane16_swap_b32 v37, v39
    s_nop 1
    v_max_f32 v36, v36, v38
    v_max_f32 v37, v37, v39
    v_mov_b32 v38, v36
    v_mov_b32 v39, v37
    s_nop 1
    v_permlane32_swap_b32 v36, v38
    v_permlane32_swap_b32 v37, v39
    s_nop 1
    v_max_f32 v36, v36, v38
    v_max_f32 v37, v37, v39
    v_max_f32 v36, 0, v36
    v_exp_f32 v38, -v36
    v_max_f32 v37, 0, v37
    v_exp_f32 v39, -v37
    v_sub_f32 v192, v192, v36
    v_sub_f32 v128, v128, v36
    v_sub_f32 v144, v144, v36
    v_sub_f32 v136, v136, v36
    v_sub_f32 v152, v152, v36
    v_sub_f32 v193, v193, v36
    v_sub_f32 v129, v129, v36
    v_sub_f32 v145, v145, v36
    v_sub_f32 v137, v137, v36
    v_sub_f32 v153, v153, v36
    v_sub_f32 v194, v194, v36
    v_sub_f32 v130, v130, v36
    v_sub_f32 v146, v146, v36
    v_sub_f32 v138, v138, v36
    v_sub_f32 v154, v154, v36
    v_sub_f32 v195, v195, v36
    v_sub_f32 v131, v131, v36
    v_sub_f32 v147, v147, v36
    v_sub_f32 v139, v139, v36
    v_sub_f32 v155, v155, v36
    v_mul_f32 v30, v30, v38
    v_sub_f32 v196, v196, v37
    v_sub_f32 v132, v132, v37
    v_sub_f32 v148, v148, v37
    v_sub_f32 v140, v140, v37
    v_sub_f32 v156, v156, v37
    v_sub_f32 v197, v197, v37
    v_sub_f32 v133, v133, v37
    v_sub_f32 v149, v149, v37
    v_sub_f32 v141, v141, v37
    v_sub_f32 v157, v157, v37
    v_sub_f32 v198, v198, v37
    v_sub_f32 v134, v134, v37
    v_sub_f32 v150, v150, v37
    v_sub_f32 v142, v142, v37
    v_sub_f32 v158, v158, v37
    v_sub_f32 v199, v199, v37
    v_sub_f32 v135, v135, v37
    v_sub_f32 v151, v151, v37
    v_sub_f32 v143, v143, v37
    v_sub_f32 v159, v159, v37
    v_mul_f32 v31, v31, v39
    v_accvgpr_read_b32 v160, a0
    v_accvgpr_read_b32 v161, a1
    v_accvgpr_read_b32 v162, a2
    v_accvgpr_read_b32 v163, a3
    v_accvgpr_read_b32 v164, a4
    v_accvgpr_read_b32 v165, a5
    v_accvgpr_read_b32 v166, a6
    v_accvgpr_read_b32 v167, a7
    v_mul_f32 v160, v160, v38
    v_mul_f32 v161, v161, v38
    v_mul_f32 v162, v162, v38
    v_mul_f32 v163, v163, v38
    v_mul_f32 v164, v164, v39
    v_mul_f32 v165, v165, v39
    v_mul_f32 v166, v166, v39
    v_mul_f32 v167, v167, v39
    v_accvgpr_write_b32 a0, v160
    v_accvgpr_write_b32 a1, v161
    v_accvgpr_write_b32 a2, v162
    v_accvgpr_write_b32 a3, v163
    v_accvgpr_write_b32 a4, v164
    v_accvgpr_write_b32 a5, v165
    v_accvgpr_write_b32 a6, v166
    v_accvgpr_write_b32 a7, v167
    v_accvgpr_read_b32 v160, a8
    v_accvgpr_read_b32 v161, a9
    v_accvgpr_read_b32 v162, a10
    v_accvgpr_read_b32 v163, a11
    v_accvgpr_read_b32 v164, a12
    v_accvgpr_read_b32 v165, a13
    v_accvgpr_read_b32 v166, a14
    v_accvgpr_read_b32 v167, a15
    v_mul_f32 v160, v160, v38
    v_mul_f32 v161, v161, v38
    v_mul_f32 v162, v162, v38
    v_mul_f32 v163, v163, v38
    v_mul_f32 v164, v164, v39
    v_mul_f32 v165, v165, v39
    v_mul_f32 v166, v166, v39
    v_mul_f32 v167, v167, v39
    v_accvgpr_write_b32 a8, v160
    v_accvgpr_write_b32 a9, v161
    v_accvgpr_write_b32 a10, v162
    v_accvgpr_write_b32 a11, v163
    v_accvgpr_write_b32 a12, v164
    v_accvgpr_write_b32 a13, v165
    v_accvgpr_write_b32 a14, v166
    v_accvgpr_write_b32 a15, v167
    v_accvgpr_read_b32 v160, a16
    v_accvgpr_read_b32 v161, a17
    v_accvgpr_read_b32 v162, a18
    v_accvgpr_read_b32 v163, a19
    v_accvgpr_read_b32 v164, a20
    v_accvgpr_read_b32 v165, a21
    v_accvgpr_read_b32 v166, a22
    v_accvgpr_read_b32 v167, a23
    v_mul_f32 v160, v160, v38
    v_mul_f32 v161, v161, v38
    v_mul_f32 v162, v162, v38
    v_mul_f32 v163, v163, v38
    v_mul_f32 v164, v164, v39
    v_mul_f32 v165, v165, v39
    v_mul_f32 v166, v166, v39
    v_mul_f32 v167, v167, v39
    v_accvgpr_write_b32 a16, v160
    v_accvgpr_write_b32 a17, v161
    v_accvgpr_write_b32 a18, v162
    v_accvgpr_write_b32 a19, v163
    v_accvgpr_write_b32 a20, v164
    v_accvgpr_write_b32 a21, v165
    v_accvgpr_write_b32 a22, v166
    v_accvgpr_write_b32 a23, v167
    v_accvgpr_read_b32 v160, a24
    v_accvgpr_read_b32 v161, a25
    v_accvgpr_read_b32 v162, a26
    v_accvgpr_read_b32 v163, a27
    v_accvgpr_read_b32 v164, a28
    v_accvgpr_read_b32 v165, a29
    v_accvgpr_read_b32 v166, a30
    v_accvgpr_read_b32 v167, a31
    v_mul_f32 v160, v160, v38
    v_mul_f32 v161, v161, v38
    v_mul_f32 v162, v162, v38
    v_mul_f32 v163, v163, v38
    v_mul_f32 v164, v164, v39
    v_mul_f32 v165, v165, v39
    v_mul_f32 v166, v166, v39
    v_mul_f32 v167, v167, v39
    v_accvgpr_write_b32 a24, v160
    v_accvgpr_write_b32 a25, v161
    v_accvgpr_write_b32 a26, v162
    v_accvgpr_write_b32 a27, v163
    v_accvgpr_write_b32 a28, v164
    v_accvgpr_write_b32 a29, v165
    v_accvgpr_write_b32 a30, v166
    v_accvgpr_write_b32 a31, v167
    v_accvgpr_read_b32 v160, a32
    v_accvgpr_read_b32 v161, a33
    v_accvgpr_read_b32 v162, a34
    v_accvgpr_read_b32 v163, a35
    v_accvgpr_read_b32 v164, a36
    v_accvgpr_read_b32 v165, a37
    v_accvgpr_read_b32 v166, a38
    v_accvgpr_read_b32 v167, a39
    v_mul_f32 v160, v160, v38
    v_mul_f32 v161, v161, v38
    v_mul_f32 v162, v162, v38
    v_mul_f32 v163, v163, v38
    v_mul_f32 v164, v164, v39
    v_mul_f32 v165, v165, v39
    v_mul_f32 v166, v166, v39
    v_mul_f32 v167, v167, v39
    v_accvgpr_write_b32 a32, v160
    v_accvgpr_write_b32 a33, v161
    v_accvgpr_write_b32 a34, v162
    v_accvgpr_write_b32 a35, v163
    v_accvgpr_write_b32 a36, v164
    v_accvgpr_write_b32 a37, v165
    v_accvgpr_write_b32 a38, v166
    v_accvgpr_write_b32 a39, v167
    v_accvgpr_read_b32 v160, a40
    v_accvgpr_read_b32 v161, a41
    v_accvgpr_read_b32 v162, a42
    v_accvgpr_read_b32 v163, a43
    v_accvgpr_read_b32 v164, a44
    v_accvgpr_read_b32 v165, a45
    v_accvgpr_read_b32 v166, a46
    v_accvgpr_read_b32 v167, a47
    v_mul_f32 v160, v160, v38
    v_mul_f32 v161, v161, v38
    v_mul_f32 v162, v162, v38
    v_mul_f32 v163, v163, v38
    v_mul_f32 v164, v164, v39
    v_mul_f32 v165, v165, v39
    v_mul_f32 v166, v166, v39
    v_mul_f32 v167, v167, v39
    v_accvgpr_write_b32 a40, v160
    v_accvgpr_write_b32 a41, v161
    v_accvgpr_write_b32 a42, v162
    v_accvgpr_write_b32 a43, v163
    v_accvgpr_write_b32 a44, v164
    v_accvgpr_write_b32 a45, v165
    v_accvgpr_write_b32 a46, v166
    v_accvgpr_write_b32 a47, v167
    v_accvgpr_read_b32 v160, a48
    v_accvgpr_read_b32 v161, a49
    v_accvgpr_read_b32 v162, a50
    v_accvgpr_read_b32 v163, a51
    v_accvgpr_read_b32 v164, a52
    v_accvgpr_read_b32 v165, a53
    v_accvgpr_read_b32 v166, a54
    v_accvgpr_read_b32 v167, a55
    v_mul_f32 v160, v160, v38
    v_mul_f32 v161, v161, v38
    v_mul_f32 v162, v162, v38
    v_mul_f32 v163, v163, v38
    v_mul_f32 v164, v164, v39
    v_mul_f32 v165, v165, v39
    v_mul_f32 v166, v166, v39
    v_mul_f32 v167, v167, v39
    v_accvgpr_write_b32 a48, v160
    v_accvgpr_write_b32 a49, v161
    v_accvgpr_write_b32 a50, v162
    v_accvgpr_write_b32 a51, v163
    v_accvgpr_write_b32 a52, v164
    v_accvgpr_write_b32 a53, v165
    v_accvgpr_write_b32 a54, v166
    v_accvgpr_write_b32 a55, v167
    v_accvgpr_read_b32 v160, a56
    v_accvgpr_read_b32 v161, a57
    v_accvgpr_read_b32 v162, a58
    v_accvgpr_read_b32 v163, a59
    v_accvgpr_read_b32 v164, a60
    v_accvgpr_read_b32 v165, a61
    v_accvgpr_read_b32 v166, a62
    v_accvgpr_read_b32 v167, a63
    v_mul_f32 v160, v160, v38
    v_mul_f32 v161, v161, v38
    v_mul_f32 v162, v162, v38
    v_mul_f32 v163, v163, v38
    v_mul_f32 v164, v164, v39
    v_mul_f32 v165, v165, v39
    v_mul_f32 v166, v166, v39
    v_mul_f32 v167, v167, v39
    v_accvgpr_write_b32 a56, v160
    v_accvgpr_write_b32 a57, v161
    v_accvgpr_write_b32 a58, v162
    v_accvgpr_write_b32 a59, v163
    v_accvgpr_write_b32 a60, v164
    v_accvgpr_write_b32 a61, v165
    v_accvgpr_write_b32 a62, v166
    v_accvgpr_write_b32 a63, v167
    v_accvgpr_read_b32 v160, a64
    v_accvgpr_read_b32 v161, a65
    v_accvgpr_read_b32 v162, a66
    v_accvgpr_read_b32 v163, a67
    v_accvgpr_read_b32 v164, a68
    v_accvgpr_read_b32 v165, a69
    v_accvgpr_read_b32 v166, a70
    v_accvgpr_read_b32 v167, a71
    v_mul_f32 v160, v160, v38
    v_mul_f32 v161, v161, v38
    v_mul_f32 v162, v162, v38
    v_mul_f32 v163, v163, v38
    v_mul_f32 v164, v164, v39
    v_mul_f32 v165, v165, v39
    v_mul_f32 v166, v166, v39
    v_mul_f32 v167, v167, v39
    v_accvgpr_write_b32 a64, v160
    v_accvgpr_write_b32 a65, v161
    v_accvgpr_write_b32 a66, v162
    v_accvgpr_write_b32 a67, v163
    v_accvgpr_write_b32 a68, v164
    v_accvgpr_write_b32 a69, v165
    v_accvgpr_write_b32 a70, v166
    v_accvgpr_write_b32 a71, v167
    v_accvgpr_read_b32 v160, a72
    v_accvgpr_read_b32 v161, a73
    v_accvgpr_read_b32 v162, a74
    v_accvgpr_read_b32 v163, a75
    v_accvgpr_read_b32 v164, a76
    v_accvgpr_read_b32 v165, a77
    v_accvgpr_read_b32 v166, a78
    v_accvgpr_read_b32 v167, a79
    v_mul_f32 v160, v160, v38
    v_mul_f32 v161, v161, v38
    v_mul_f32 v162, v162, v38
    v_mul_f32 v163, v163, v38
    v_mul_f32 v164, v164, v39
    v_mul_f32 v165, v165, v39
    v_mul_f32 v166, v166, v39
    v_mul_f32 v167, v167, v39
    v_accvgpr_write_b32 a72, v160
    v_accvgpr_write_b32 a73, v161
    v_accvgpr_write_b32 a74, v162
    v_accvgpr_write_b32 a75, v163
    v_accvgpr_write_b32 a76, v164
    v_accvgpr_write_b32 a77, v165
    v_accvgpr_write_b32 a78, v166
    v_accvgpr_write_b32 a79, v167
    v_accvgpr_read_b32 v160, a80
    v_accvgpr_read_b32 v161, a81
    v_accvgpr_read_b32 v162, a82
    v_accvgpr_read_b32 v163, a83
    v_accvgpr_read_b32 v164, a84
    v_accvgpr_read_b32 v165, a85
    v_accvgpr_read_b32 v166, a86
    v_accvgpr_read_b32 v167, a87
    v_mul_f32 v160, v160, v38
    v_mul_f32 v161, v161, v38
    v_mul_f32 v162, v162, v38
    v_mul_f32 v163, v163, v38
    v_mul_f32 v164, v164, v39
    v_mul_f32 v165, v165, v39
    v_mul_f32 v166, v166, v39
    v_mul_f32 v167, v167, v39
    v_accvgpr_write_b32 a80, v160
    v_accvgpr_write_b32 a81, v161
    v_accvgpr_write_b32 a82, v162
    v_accvgpr_write_b32 a83, v163
    v_accvgpr_write_b32 a84, v164
    v_accvgpr_write_b32 a85, v165
    v_accvgpr_write_b32 a86, v166
    v_accvgpr_write_b32 a87, v167
    v_accvgpr_read_b32 v160, a88
    v_accvgpr_read_b32 v161, a89
    v_accvgpr_read_b32 v162, a90
    v_accvgpr_read_b32 v163, a91
    v_accvgpr_read_b32 v164, a92
    v_accvgpr_read_b32 v165, a93
    v_accvgpr_read_b32 v166, a94
    v_accvgpr_read_b32 v167, a95
    v_mul_f32 v160, v160, v38
    v_mul_f32 v161, v161, v38
    v_mul_f32 v162, v162, v38
    v_mul_f32 v163, v163, v38
    v_mul_f32 v164, v164, v39
    v_mul_f32 v165, v165, v39
    v_mul_f32 v166, v166, v39
    v_mul_f32 v167, v167, v39
    v_accvgpr_write_b32 a88, v160
    v_accvgpr_write_b32 a89, v161
    v_accvgpr_write_b32 a90, v162
    v_accvgpr_write_b32 a91, v163
    v_accvgpr_write_b32 a92, v164
    v_accvgpr_write_b32 a93, v165
    v_accvgpr_write_b32 a94, v166
    v_accvgpr_write_b32 a95, v167
    v_accvgpr_read_b32 v160, a96
    v_accvgpr_read_b32 v161, a97
    v_accvgpr_read_b32 v162, a98
    v_accvgpr_read_b32 v163, a99
    v_accvgpr_read_b32 v164, a100
    v_accvgpr_read_b32 v165, a101
    v_accvgpr_read_b32 v166, a102
    v_accvgpr_read_b32 v167, a103
    v_mul_f32 v160, v160, v38
    v_mul_f32 v161, v161, v38
    v_mul_f32 v162, v162, v38
    v_mul_f32 v163, v163, v38
    v_mul_f32 v164, v164, v39
    v_mul_f32 v165, v165, v39
    v_mul_f32 v166, v166, v39
    v_mul_f32 v167, v167, v39
    v_accvgpr_write_b32 a96, v160
    v_accvgpr_write_b32 a97, v161
    v_accvgpr_write_b32 a98, v162
    v_accvgpr_write_b32 a99, v163
    v_accvgpr_write_b32 a100, v164
    v_accvgpr_write_b32 a101, v165
    v_accvgpr_write_b32 a102, v166
    v_accvgpr_write_b32 a103, v167
    v_accvgpr_read_b32 v160, a104
    v_accvgpr_read_b32 v161, a105
    v_accvgpr_read_b32 v162, a106
    v_accvgpr_read_b32 v163, a107
    v_accvgpr_read_b32 v164, a108
    v_accvgpr_read_b32 v165, a109
    v_accvgpr_read_b32 v166, a110
    v_accvgpr_read_b32 v167, a111
    v_mul_f32 v160, v160, v38
    v_mul_f32 v161, v161, v38
    v_mul_f32 v162, v162, v38
    v_mul_f32 v163, v163, v38
    v_mul_f32 v164, v164, v39
    v_mul_f32 v165, v165, v39
    v_mul_f32 v166, v166, v39
    v_mul_f32 v167, v167, v39
    v_accvgpr_write_b32 a104, v160
    v_accvgpr_write_b32 a105, v161
    v_accvgpr_write_b32 a106, v162
    v_accvgpr_write_b32 a107, v163
    v_accvgpr_write_b32 a108, v164
    v_accvgpr_write_b32 a109, v165
    v_accvgpr_write_b32 a110, v166
    v_accvgpr_write_b32 a111, v167
    v_accvgpr_read_b32 v160, a112
    v_accvgpr_read_b32 v161, a113
    v_accvgpr_read_b32 v162, a114
    v_accvgpr_read_b32 v163, a115
    v_accvgpr_read_b32 v164, a116
    v_accvgpr_read_b32 v165, a117
    v_accvgpr_read_b32 v166, a118
    v_accvgpr_read_b32 v167, a119
    v_mul_f32 v160, v160, v38
    v_mul_f32 v161, v161, v38
    v_mul_f32 v162, v162, v38
    v_mul_f32 v163, v163, v38
    v_mul_f32 v164, v164, v39
    v_mul_f32 v165, v165, v39
    v_mul_f32 v166, v166, v39
    v_mul_f32 v167, v167, v39
    v_accvgpr_write_b32 a112, v160
    v_accvgpr_write_b32 a113, v161
    v_accvgpr_write_b32 a114, v162
    v_accvgpr_write_b32 a115, v163
    v_accvgpr_write_b32 a116, v164
    v_accvgpr_write_b32 a117, v165
    v_accvgpr_write_b32 a118, v166
    v_accvgpr_write_b32 a119, v167
    v_accvgpr_read_b32 v160, a120
    v_accvgpr_read_b32 v161, a121
    v_accvgpr_read_b32 v162, a122
    v_accvgpr_read_b32 v163, a123
    v_accvgpr_read_b32 v164, a124
    v_accvgpr_read_b32 v165, a125
    v_accvgpr_read_b32 v166, a126
    v_accvgpr_read_b32 v167, a127
    v_mul_f32 v160, v160, v38
    v_mul_f32 v161, v161, v38
    v_mul_f32 v162, v162, v38
    v_mul_f32 v163, v163, v38
    v_mul_f32 v164, v164, v39
    v_mul_f32 v165, v165, v39
    v_mul_f32 v166, v166, v39
    v_mul_f32 v167, v167, v39
    v_accvgpr_write_b32 a120, v160
    v_accvgpr_write_b32 a121, v161
    v_accvgpr_write_b32 a122, v162
    v_accvgpr_write_b32 a123, v163
    v_accvgpr_write_b32 a124, v164
    v_accvgpr_write_b32 a125, v165
    v_accvgpr_write_b32 a126, v166
    v_accvgpr_write_b32 a127, v167
    v_exp_f32 v160, v144
    v_exp_f32 v161, v145
    v_exp_f32 v162, v146
    v_add_f32 v32, v160, v161
    v_cvt_pk_bf16_f32 v184, v160, v161
    v_exp_f32 v163, v147
    v_add_f32 v32, v32, v162
    v_exp_f32 v164, v148
    v_add_f32 v32, v32, v163
    v_cvt_pk_bf16_f32 v185, v162, v163
    v_exp_f32 v165, v149
    v_exp_f32 v166, v150
    v_add_f32 v33, v164, v165
    v_cvt_pk_bf16_f32 v188, v164, v165
    v_exp_f32 v167, v151
    v_add_f32 v33, v33, v166
    v_exp_f32 v168, v152
    v_add_f32 v33, v33, v167
    v_cvt_pk_bf16_f32 v189, v166, v167
    v_exp_f32 v169, v153
    v_add_f32 v32, v32, v168
    v_exp_f32 v170, v154
    v_add_f32 v32, v32, v169
    v_cvt_pk_bf16_f32 v186, v168, v169
    v_exp_f32 v171, v155
    v_add_f32 v32, v32, v170
    v_exp_f32 v172, v156
    v_add_f32 v32, v32, v171
    v_cvt_pk_bf16_f32 v187, v170, v171
    v_exp_f32 v173, v157
    v_add_f32 v33, v33, v172
    v_exp_f32 v174, v158
    v_add_f32 v33, v33, v173
    v_cvt_pk_bf16_f32 v190, v172, v173
    v_exp_f32 v175, v159
    v_add_f32 v33, v33, v174
    s_nop 0
    v_add_f32 v33, v33, v175
    v_cvt_pk_bf16_f32 v191, v174, v175
    s_nop 1
    s_setpc_b64 s[94:95]
L_end:
    s_endpgm
.section .rodata,"a"
.p2align 6
.amdhsa_kernel adaLN_cond__mha_block_cached__dense_activation_silu__prompt_kernel
  .amdhsa_next_free_vgpr 512
  .amdhsa_next_free_sgpr 102
  .amdhsa_accum_offset 256
  .amdhsa_group_segment_fixed_size 0
  .amdhsa_kernarg_size 104
  .amdhsa_user_sgpr_count 2
  .amdhsa_user_sgpr_kernarg_segment_ptr 1
  .amdhsa_system_sgpr_workgroup_id_x 1
.end_amdhsa_kernel
```
